```python
import torch

def _softmax(x, axis=-1):
    return torch.softmax(x, dim=axis)
def _gelu(x):
    return torch.nn.functional.gelu(x, approximate="tanh")
def _silu(x):
    return torch.nn.functional.silu(x)
def _sigmoid(x):
    return torch.sigmoid(x)
def _layernorm(x, axis=-1, eps=1e-5):
    m = x.mean(dim=axis, keepdim=True)
    v = x.var(dim=axis, keepdim=True, unbiased=False)
    return (x - m) / torch.sqrt(v + eps)
def _scatter_add(tgt, idx, src, axis=0):
    return tgt.clone().index_add_(axis, idx, src)
def _segment_sum(src, seg, n):
    out = torch.zeros((n,) + src.shape[1:], dtype=src.dtype)
    return out.index_add_(0, seg, src)
def _pad(x, pw):
    flat = tuple(v for pair in reversed(pw) for v in pair)
    return torch.nn.functional.pad(x, flat)

kernel_name = 'sequential_preLN__compressed_kv_cla__glu_gated_bilinear__prompt'

def setup_inputs():

    _w = (lambda a: (lambda t: t.to(torch.bfloat16) if t.is_floating_point() else t)(torch.as_tensor(a)))
    def _A_setup():
        B, H, Sq, Sk, D, M = 1, 32, 2048, 2048, 128, 512
        Dc = 4 * D
        return {
            "x": _w((lambda *s: torch.randn(*s, dtype=torch.bfloat16) * 0.05)(B, Sq, M)),
            "c_kv": _w((lambda *s: torch.randn(*s, dtype=torch.bfloat16) * 0.4)(B, Sk, Dc)),
            "w_q": _w((lambda *s: torch.randn(*s, dtype=torch.bfloat16) * 1.6)(M, H, D) * (M ** -0.5)),
            "w_uk": _w((lambda *s: torch.randn(*s, dtype=torch.bfloat16) * 1.6)(Dc, H, D) * (Dc ** -0.5)),
            "w_uv": _w((lambda *s: torch.randn(*s, dtype=torch.bfloat16) * 0.4)(Dc, H, D) * (Dc ** -0.5)),
            "w_o": _w((lambda *s: torch.randn(*s, dtype=torch.bfloat16) * 0.4)(H, D, M) * ((H * D) ** -0.5)),
        }
    _A_in = _A_setup()

    def _B_setup():
        B, S, D, F = 1, 2048, 512, 1792
        return {
            "x": _w((lambda *s: torch.randn(*s, dtype=torch.bfloat16) * 0.05)(B, S, D)),
            "w_gate": _w((lambda *s: torch.randn(*s, dtype=torch.bfloat16) * 0.4)(D, F) * (D ** -0.5)),
            "w_up": _w((lambda *s: torch.randn(*s, dtype=torch.bfloat16) * 0.4)(D, F) * (D ** -0.5)),
            "w_down": _w((lambda *s: torch.randn(*s, dtype=torch.bfloat16) * 0.4)(F, D) * (F ** -0.5)),
        }
    _B_in = _B_setup()

    return {
        "A_x": _A_in["x"],
        "A_c_kv": _A_in["c_kv"],
        "A_w_q": _A_in["w_q"],
        "A_w_uk": _A_in["w_uk"],
        "A_w_uv": _A_in["w_uv"],
        "A_w_o": _A_in["w_o"],
        "B_x": _B_in["x"],
        "B_w_gate": _B_in["w_gate"],
        "B_w_up": _B_in["w_up"],
        "B_w_down": _B_in["w_down"],
    }

def reference(A_x, A_c_kv, A_w_q, A_w_uk, A_w_uv, A_w_o, B_x, B_w_gate, B_w_up, B_w_down):
    def _A_ref(x, c_kv, w_q, w_uk, w_uv, w_o):
        B, Sq, M = x.shape[0], x.shape[1], x.shape[2]
        Sk = c_kv.shape[1]
        H, D = w_q.shape[1], w_q.shape[2]
        q = torch.einsum("bqm,mhd->bhqd", x, w_q)
        k = torch.einsum("bkc,chd->bhkd", c_kv, w_uk)
        v = torch.einsum("bkc,chd->bhkd", c_kv, w_uv)
        scores = torch.einsum("bhqd,bhkd->bhqk", q, k) * (D ** -0.5)
        off = Sk - Sq
        qi = torch.arange(Sq)[:, None]
        kj = torch.arange(Sk)[None, :]
        cmask = kj <= (qi + off)
        scores = torch.where(cmask[None, None], scores, -1e9)
        p = _softmax(scores, axis=-1)
        ctx = torch.einsum("bhqk,bhkd->bhqd", p, v)
        return torch.einsum("bhqd,hdm->bqm", ctx, w_o)

    def _B_ref(x, w_gate, w_up, w_down):
        g = torch.einsum("bsd,df->bsf", x, w_gate)
        u = torch.einsum("bsd,df->bsf", x, w_up)
        h = g * u
        return torch.einsum("bsf,fd->bsd", h, w_down)

    x = A_x
    h = x + _A_ref(_layernorm(x, axis=-1), A_c_kv, A_w_q, A_w_uk, A_w_uv, A_w_o)
    h2 = h + _B_ref(_layernorm(h, axis=-1), B_w_gate, B_w_up, B_w_down)
    return h2
```

```asm
; @launch grid=(256,1,1) block=(256,1,1) lds=163840
.amdgcn_target "amdgcn-amd-amdhsa--gfx950"
.text
.globl sequential_preLN__compressed_kv_cla__glu_gated_bilinear__prompt_kernel
.p2align 8
.type sequential_preLN__compressed_kv_cla__glu_gated_bilinear__prompt_kernel,@function
sequential_preLN__compressed_kv_cla__glu_gated_bilinear__prompt_kernel:
    s_cmp_ge_u32 s2, 256
    s_cbranch_scc1 F_done
    s_load_dwordx16 s[68:83], s[0:1], 0
    s_load_dwordx8 s[84:91], s[0:1], 64
    s_load_dwordx2 s[92:93], s[0:1], 96
    v_and_b32 v50, 63, v0
    v_lshrrev_b32 v40, 6, v0
    s_and_b32 s3, s2, 7
    v_readfirstlane_b32 s94, v40
    s_lshl_b32 s3, s3, 2
    s_bfe_u32 s4, s2, 0x20003
    s_add_u32 s32, s3, s4
    s_lshr_b32 s33, s2, 5
    v_lshlrev_b32 v238, 4, v50
    s_lshr_b32 s3, s2, 3
    s_lshl_b32 s3, s3, 2
    s_add_u32 s3, s3, s94
    s_cmp_ge_u32 s3, 10
    s_cbranch_scc1 ct_1
    s_getpc_b64 s[4:5]
pc_2:
    s_add_u32 s4, s4, F_c1-pc_2
    s_addc_u32 s5, s5, 0
    s_lshl_b32 s3, s3, 13
    v_lshl_add_u32 v52, v238, 3, s3
    global_load_dword v254, v52, s[4:5]
ct_1:
F_c1:
    v_lshrrev_b32 v40, 3, v50
    v_and_b32 v41, 2, v40
    v_and_b32 v42, 7, v50
    v_xor_b32 v42, v42, v41
    v_lshlrev_b32 v42, 4, v42
    v_lshl_add_u32 v43, v40, 10, v42
    s_and_b32 s3, s94, 1
    s_lshl_b32 s3, s3, 16
    v_add_u32 v228, s3, v43
    v_xor_b32 v44, 64, v228
    v_add_u32 v229, 7168, v228
    v_add_u32 v230, 14336, v44
    v_add_u32 v231, 21504, v44
    v_lshrrev_b32 v41, 4, v50
    v_and_b32 v42, 15, v50
    v_and_b32 v43, 1, v41
    v_xor_b32 v42, v42, v43
    v_and_b32 v43, 4, v40
    v_xor_b32 v42, v42, v43
    v_lshlrev_b32 v42, 4, v42
    v_lshl_add_u32 v43, v41, 13, v42
    s_and_b32 s3, s94, 1
    s_lshl_b32 s3, s3, 18
    v_add_u32 v234, s3, v43
    v_xor_b32 v44, 128, v234
    v_add_u32 v235, 31744, v234
    v_add_u32 v236, 63488, v44
    v_add_u32 v237, 95232, v44
    s_sub_u32 s3, 15, s33
    s_cmp_lt_u32 s94, 2
    s_cselect_b32 s3, s33, s3
    s_lshl_b32 s34, s3, 17
    s_add_u32 s35, s34, 0x8000
    s_lshl_b32 s36, s32, 8
    s_add_u32 s37, s36, 131072
    s_lshl_b32 s38, s94, 13
    s_lshl_b32 s5, s2, 13
    s_lshl_b32 s4, s94, 11
    s_add_u32 s5, s5, s4
    s_waitcnt lgkmcnt(0)
    s_mov_b32 s48, s68
    s_mov_b32 s49, s69
    s_mov_b32 s50, 0x200000
    s_mov_b32 s51, 0x00020000
    buffer_load_dwordx4 v[0:3], v238, s[48:51], s5 offen
    buffer_load_dwordx4 v[4:7], v238, s[48:51], s5 offen offset:1024
    s_mov_b32 s8, s70
    s_mov_b32 s9, s71
    s_mov_b32 s10, 0x200000
    s_mov_b32 s11, 0x00020000
    s_cmp_ge_u32 s94, 2
    s_cselect_b32 s12, s76, s74
    s_cselect_b32 s13, s77, s75
    s_mov_b32 s14, 0x400000
    s_mov_b32 s15, 0x00020000
    s_mov_b32 s52, s90
    s_mov_b32 s53, s91
    s_mov_b32 s54, 0x100
    s_mov_b32 s55, 0x00020000
    s_or_b32 s3, s2, s94
    s_cmp_lg_u32 s3, 0
    s_cbranch_scc1 P1_nn
    s_memrealtime s[6:7]
    s_waitcnt lgkmcnt(0)
    s_or_b32 s6, s6, 1
    v_mov_b32 v250, s6
    v_mov_b32 v251, s7
    buffer_store_dwordx2 v[250:251], off, s[52:55], 0 sc0 sc1
P1_nn:
    s_add_u32 m0, s38, 0
    s_nop 0
    buffer_load_dwordx4 v228, s[8:11], s34 offen offset:0 lds
    buffer_load_dwordx4 v229, s[8:11], s34 offen offset:1024 lds
    buffer_load_dwordx4 v230, s[8:11], s34 offen offset:2048 lds
    buffer_load_dwordx4 v231, s[8:11], s34 offen offset:3072 lds
    s_add_u32 s34, s34, 128
    s_add_u32 m0, s38, 4096
    s_nop 0
    buffer_load_dwordx4 v228, s[8:11], s35 offen offset:0 lds
    buffer_load_dwordx4 v229, s[8:11], s35 offen offset:1024 lds
    buffer_load_dwordx4 v230, s[8:11], s35 offen offset:2048 lds
    buffer_load_dwordx4 v231, s[8:11], s35 offen offset:3072 lds
    s_add_u32 s35, s35, 128
    s_add_u32 m0, s38, 65536
    s_nop 0
    buffer_load_dwordx4 v234, s[12:15], s36 offen offset:0 lds
    buffer_load_dwordx4 v235, s[12:15], s36 offen offset:1024 lds
    buffer_load_dwordx4 v236, s[12:15], s36 offen offset:2048 lds
    buffer_load_dwordx4 v237, s[12:15], s36 offen offset:3072 lds
    s_add_u32 s36, s36, 524288
    s_add_u32 m0, s38, 69632
    s_nop 0
    buffer_load_dwordx4 v234, s[12:15], s37 offen offset:0 lds
    buffer_load_dwordx4 v235, s[12:15], s37 offen offset:1024 lds
    buffer_load_dwordx4 v236, s[12:15], s37 offen offset:2048 lds
    buffer_load_dwordx4 v237, s[12:15], s37 offen offset:3072 lds
    s_add_u32 s37, s37, 524288
F_c0:
    v_lshrrev_b32 v41, 4, v50
    v_bfe_u32 v42, v50, 3, 1
    v_and_b32 v43, 7, v50
    v_lshl_add_u32 v43, v42, 4, v43
    v_and_b32 v44, 2, v50
    v_lshl_add_u32 v44, v42, 2, v44
    v_xor_b32 v44, v44, v41
    v_lshlrev_b32 v44, 4, v44
    v_lshl_add_u32 v44, v43, 7, v44
    s_and_b32 s3, s94, 1
    s_lshl_b32 s3, s3, 13
    v_add_u32 v232, s3, v44
    v_xor_b32 v233, 64, v232
    v_and_b32 v44, 1, v41
    v_lshl_add_u32 v43, v44, 5, v43
    v_lshlrev_b32 v43, 4, v43
    v_lshrrev_b32 v45, 5, v50
    v_lshl_add_u32 v244, v45, 10, v43
    v_lshl_add_u32 v245, v45, 12, v43
    v_add_u32 v246, 0x4000, v238
    v_bfe_u32 v40, v50, 2, 2
    v_lshl_add_u32 v43, v41, 3, v40
    v_lshlrev_b32 v43, 8, v43
    v_and_b32 v45, 1, v40
    v_lshl_add_u32 v45, v42, 2, v45
    v_lshl_add_u32 v45, v44, 3, v45
    v_lshl_add_u32 v247, v45, 4, v43
    v_and_b32 v46, 2, v50
    v_and_b32 v47, 1, v50
    v_lshl_add_u32 v43, v46, 4, v247
    v_lshl_add_u32 v43, v47, 3, v43
    v_lshl_add_u32 v247, v47, 5, v247
    v_lshl_add_u32 v247, v46, 2, v247
    s_and_b32 s3, s94, 2
    s_lshl_b32 s3, s3, 6
    v_xor_b32 v43, s3, v43
    v_add_u32 v224, 0x10000, v43
    v_xor_b32 v225, 16, v224
    v_xor_b32 v226, 64, v224
    v_xor_b32 v227, 80, v224
    v_and_b32 v40, 15, v50
    v_lshlrev_b32 v240, 10, v40
    v_and_b32 v41, 7, v50
    v_lshlrev_b32 v241, 7, v41
    s_lshr_b32 s3, s2, 3
    s_lshl_b32 s47, s3, 16
    s_lshl_b32 s4, s94, 14
    s_add_u32 s47, s47, s4
    s_lshl_b32 s58, s3, 14
    s_and_b32 s4, s94, 1
    s_lshl_b32 s4, s4, 13
    s_add_u32 s58, s58, s4
    s_and_b32 s4, s2, 7
    s_lshl_b32 s4, s4, 10
    s_add_u32 s58, s58, s4
    s_lshl_b32 s3, s32, 19
    s_add_u32 s16, s92, s3
    s_addc_u32 s17, s93, 0
    s_mov_b32 s18, 0x8000000
    s_mov_b32 s19, 0x00020000
    s_add_u32 s3, s3, 0x1000000
    s_add_u32 s20, s92, s3
    s_addc_u32 s21, s93, 0
    s_mov_b32 s22, 0x8000000
    s_mov_b32 s23, 0x00020000
    s_add_u32 s24, s92, 0x2000000
    s_addc_u32 s25, s93, 0
    s_mov_b32 s26, 0x200000
    s_mov_b32 s27, 0x00020000
    s_mov_b32 s28, s72
    s_mov_b32 s29, s73
    s_mov_b32 s30, 0x400000
    s_mov_b32 s31, 0x00020000
    s_add_u32 s64, s92, 0x5400000
    s_addc_u32 s65, s93, 0
    s_mov_b32 s66, 0x80000
    s_mov_b32 s67, 0x00020000
    s_waitcnt vmcnt(16)
    v_lshlrev_b32 v16, 16, v0
    v_and_b32 v17, 0xffff0000, v0
    v_lshlrev_b32 v18, 16, v1
    v_and_b32 v19, 0xffff0000, v1
    v_lshlrev_b32 v20, 16, v2
    v_and_b32 v21, 0xffff0000, v2
    v_lshlrev_b32 v22, 16, v3
    v_and_b32 v23, 0xffff0000, v3
    v_lshlrev_b32 v24, 16, v4
    v_and_b32 v25, 0xffff0000, v4
    v_lshlrev_b32 v26, 16, v5
    v_and_b32 v27, 0xffff0000, v5
    v_lshlrev_b32 v28, 16, v6
    v_and_b32 v29, 0xffff0000, v6
    v_lshlrev_b32 v30, 16, v7
    v_and_b32 v31, 0xffff0000, v7
    v_add_f32 v32, v16, v17
    v_add_f32 v33, v24, v25
    v_add_f32 v32, v32, v18
    v_add_f32 v33, v33, v26
    v_add_f32 v32, v32, v19
    v_add_f32 v33, v33, v27
    v_add_f32 v32, v32, v20
    v_add_f32 v33, v33, v28
    v_add_f32 v32, v32, v21
    v_add_f32 v33, v33, v29
    v_add_f32 v32, v32, v22
    v_add_f32 v33, v33, v30
    v_add_f32 v32, v32, v23
    v_add_f32 v33, v33, v31
    s_nop 1
    v_add_f32_dpp v32, v32, v32 quad_perm:[1,0,3,2] row_mask:0xf bank_mask:0xf
    v_add_f32_dpp v33, v33, v33 quad_perm:[1,0,3,2] row_mask:0xf bank_mask:0xf
    s_nop 1
    v_add_f32_dpp v32, v32, v32 quad_perm:[2,3,0,1] row_mask:0xf bank_mask:0xf
    v_add_f32_dpp v33, v33, v33 quad_perm:[2,3,0,1] row_mask:0xf bank_mask:0xf
    s_nop 1
    v_add_f32_dpp v32, v32, v32 row_half_mirror row_mask:0xf bank_mask:0xf
    v_add_f32_dpp v33, v33, v33 row_half_mirror row_mask:0xf bank_mask:0xf
    s_nop 1
    v_add_f32_dpp v32, v32, v32 row_mirror row_mask:0xf bank_mask:0xf
    v_add_f32_dpp v33, v33, v33 row_mirror row_mask:0xf bank_mask:0xf
    v_mov_b32 v34, v32
    v_mov_b32 v35, v33
    s_nop 1
    v_permlane16_swap_b32 v32, v34
    v_permlane16_swap_b32 v33, v35
    s_nop 1
    v_add_f32 v32, v32, v34
    v_add_f32 v33, v33, v35
    v_mov_b32 v34, v32
    v_mov_b32 v35, v33
    s_nop 1
    v_permlane32_swap_b32 v32, v34
    v_permlane32_swap_b32 v33, v35
    s_nop 1
    v_add_f32 v32, v32, v34
    v_add_f32 v33, v33, v35
    v_mul_f32 v32, 0x3b000000, v32
    v_mul_f32 v33, 0x3b000000, v33
    v_sub_f32 v16, v16, v32
    v_sub_f32 v24, v24, v33
    v_sub_f32 v17, v17, v32
    v_sub_f32 v25, v25, v33
    v_sub_f32 v18, v18, v32
    v_sub_f32 v26, v26, v33
    v_sub_f32 v19, v19, v32
    v_sub_f32 v27, v27, v33
    v_sub_f32 v20, v20, v32
    v_sub_f32 v28, v28, v33
    v_sub_f32 v21, v21, v32
    v_sub_f32 v29, v29, v33
    v_sub_f32 v22, v22, v32
    v_sub_f32 v30, v30, v33
    v_sub_f32 v23, v23, v32
    v_sub_f32 v31, v31, v33
    v_mul_f32 v32, v16, v16
    v_mul_f32 v33, v24, v24
    v_fmac_f32 v32, v17, v17
    v_fmac_f32 v33, v25, v25
    v_fmac_f32 v32, v18, v18
    v_fmac_f32 v33, v26, v26
    v_fmac_f32 v32, v19, v19
    v_fmac_f32 v33, v27, v27
    v_fmac_f32 v32, v20, v20
    v_fmac_f32 v33, v28, v28
    v_fmac_f32 v32, v21, v21
    v_fmac_f32 v33, v29, v29
    v_fmac_f32 v32, v22, v22
    v_fmac_f32 v33, v30, v30
    v_fmac_f32 v32, v23, v23
    v_fmac_f32 v33, v31, v31
    s_nop 1
    v_add_f32_dpp v32, v32, v32 quad_perm:[1,0,3,2] row_mask:0xf bank_mask:0xf
    v_add_f32_dpp v33, v33, v33 quad_perm:[1,0,3,2] row_mask:0xf bank_mask:0xf
    s_nop 1
    v_add_f32_dpp v32, v32, v32 quad_perm:[2,3,0,1] row_mask:0xf bank_mask:0xf
    v_add_f32_dpp v33, v33, v33 quad_perm:[2,3,0,1] row_mask:0xf bank_mask:0xf
    s_nop 1
    v_add_f32_dpp v32, v32, v32 row_half_mirror row_mask:0xf bank_mask:0xf
    v_add_f32_dpp v33, v33, v33 row_half_mirror row_mask:0xf bank_mask:0xf
    s_nop 1
    v_add_f32_dpp v32, v32, v32 row_mirror row_mask:0xf bank_mask:0xf
    v_add_f32_dpp v33, v33, v33 row_mirror row_mask:0xf bank_mask:0xf
    v_mov_b32 v34, v32
    v_mov_b32 v35, v33
    s_nop 1
    v_permlane16_swap_b32 v32, v34
    v_permlane16_swap_b32 v33, v35
    s_nop 1
    v_add_f32 v32, v32, v34
    v_add_f32 v33, v33, v35
    v_mov_b32 v34, v32
    v_mov_b32 v35, v33
    s_nop 1
    v_permlane32_swap_b32 v32, v34
    v_permlane32_swap_b32 v33, v35
    s_nop 1
    v_add_f32 v32, v32, v34
    v_add_f32 v33, v33, v35
    v_mul_f32 v32, 0x3b000000, v32
    v_mul_f32 v33, 0x3b000000, v33
    v_add_f32 v32, 0x3727c5ac, v32
    v_add_f32 v33, 0x3727c5ac, v33
    v_rsq_f32 v32, v32
    v_rsq_f32 v33, v33
    s_nop 0
    v_mul_f32 v32, 0x3e0293ee, v32
    v_mul_f32 v33, 0x3e0293ee, v33
    v_mul_f32 v16, v16, v32
    v_mul_f32 v24, v24, v33
    v_mul_f32 v17, v17, v32
    v_mul_f32 v25, v25, v33
    v_mul_f32 v18, v18, v32
    v_mul_f32 v26, v26, v33
    v_mul_f32 v19, v19, v32
    v_mul_f32 v27, v27, v33
    v_mul_f32 v20, v20, v32
    v_mul_f32 v28, v28, v33
    v_mul_f32 v21, v21, v32
    v_mul_f32 v29, v29, v33
    v_mul_f32 v22, v22, v32
    v_mul_f32 v30, v30, v33
    v_mul_f32 v23, v23, v32
    v_mul_f32 v31, v31, v33
    v_cvt_pk_bf16_f32 v8, v16, v17
    v_cvt_pk_bf16_f32 v9, v18, v19
    v_cvt_pk_bf16_f32 v10, v20, v21
    v_cvt_pk_bf16_f32 v11, v22, v23
    v_cvt_pk_bf16_f32 v12, v24, v25
    v_cvt_pk_bf16_f32 v13, v26, v27
    v_cvt_pk_bf16_f32 v14, v28, v29
    v_cvt_pk_bf16_f32 v15, v30, v31
    s_mul_i32 s3, s94, 2080
    s_add_u32 s3, s3, 131072
    v_add_u32 v48, s3, v238
    ds_write_b128 v48, v[8:11]
    ds_write_b128 v48, v[12:15] offset:1040
    v_and_b32 v40, 7, v50
    v_lshrrev_b32 v41, 3, v50
    v_mul_u32_u24 v42, 1040, v40
    v_lshl_add_u32 v42, v41, 4, v42
    s_lshl_b32 s3, s94, 8
    s_add_u32 s3, s3, 131072
    v_add_u32 v242, s3, v42
    v_lshlrev_b32 v41, 8, v41
    v_lshl_add_u32 v243, v40, 4, v41
    s_lshr_b32 s3, s2, 1
    s_lshl_b32 s3, s3, 14
    s_and_b32 s4, s2, 1
    s_lshl_b32 s4, s4, 7
    s_add_u32 s3, s3, s4
    s_lshl_b32 s4, s94, 12
    s_add_u32 s56, s3, s4
    s_add_u32 m0, s38, 32768
    s_nop 0
    buffer_load_dwordx4 v228, s[8:11], s34 offen offset:0 lds
    buffer_load_dwordx4 v229, s[8:11], s34 offen offset:1024 lds
    buffer_load_dwordx4 v230, s[8:11], s34 offen offset:2048 lds
    buffer_load_dwordx4 v231, s[8:11], s34 offen offset:3072 lds
    s_add_u32 s34, s34, 128
    s_add_u32 m0, s38, 36864
    s_nop 0
    buffer_load_dwordx4 v228, s[8:11], s35 offen offset:0 lds
    buffer_load_dwordx4 v229, s[8:11], s35 offen offset:1024 lds
    buffer_load_dwordx4 v230, s[8:11], s35 offen offset:2048 lds
    buffer_load_dwordx4 v231, s[8:11], s35 offen offset:3072 lds
    s_add_u32 s35, s35, 128
    s_add_u32 m0, s38, 98304
    s_nop 0
    buffer_load_dwordx4 v234, s[12:15], s36 offen offset:0 lds
    buffer_load_dwordx4 v235, s[12:15], s36 offen offset:1024 lds
    buffer_load_dwordx4 v236, s[12:15], s36 offen offset:2048 lds
    buffer_load_dwordx4 v237, s[12:15], s36 offen offset:3072 lds
    s_add_u32 s36, s36, 524288
    s_add_u32 m0, s38, 102400
    s_nop 0
    buffer_load_dwordx4 v234, s[12:15], s37 offen offset:0 lds
    buffer_load_dwordx4 v235, s[12:15], s37 offen offset:1024 lds
    buffer_load_dwordx4 v236, s[12:15], s37 offen offset:2048 lds
    buffer_load_dwordx4 v237, s[12:15], s37 offen offset:3072 lds
    s_add_u32 s37, s37, 524288
    s_sub_u32 s5, 15, s33
    s_lshl_b32 s5, s5, 17
    s_lshl_b32 s4, s94, 15
    s_add_u32 s40, s5, s4
    s_lshl_b32 s5, s33, 17
    s_xor_b32 s4, s4, 0x18000
    s_add_u32 s41, s5, s4
    s_and_b32 s4, s94, 1
    s_lshr_b32 s5, s94, 1
    s_lshl_b32 s39, s5, 17
    s_lshl_b32 s3, s32, 8
    s_add_u32 s39, s39, s3
    s_lshl_b32 s6, s4, 13
    s_lshl_b32 s7, s5, 12
    s_add_u32 s45, s6, s7
    s_lshl_b32 s3, s33, 15
    s_lshl_b32 s4, s4, 14
    s_add_u32 s3, s3, s4
    s_add_u32 s42, s7, s3
    s_lshl_b32 s6, s5, 11
    s_add_u32 s43, s6, s3
    s_waitcnt vmcnt(16) lgkmcnt(0)
    s_barrier
    ds_read_b128 a[128:131], v242
    ds_read_b128 a[132:135], v242 offset:128
    ds_read_b128 a[64:67], v232 offset:0
    ds_read_b64_tr_b16 a[0:1], v224 offset:0
    ds_read_b64_tr_b16 a[2:3], v224 offset:1024
    ds_read_b64_tr_b16 a[4:5], v225 offset:0
    ds_read_b64_tr_b16 a[6:7], v225 offset:1024
    ds_read_b64_tr_b16 a[8:9], v226 offset:0
    ds_read_b64_tr_b16 a[10:11], v226 offset:1024
    ds_read_b64_tr_b16 a[12:13], v227 offset:0
    ds_read_b64_tr_b16 a[14:15], v227 offset:1024
    ds_read_b64_tr_b16 a[16:17], v224 offset:16384
    ds_read_b64_tr_b16 a[18:19], v224 offset:17408
    ds_read_b64_tr_b16 a[20:21], v225 offset:16384
    ds_read_b64_tr_b16 a[22:23], v225 offset:17408
    ds_read_b64_tr_b16 a[24:25], v226 offset:16384
    ds_read_b64_tr_b16 a[26:27], v226 offset:17408
    ds_read_b64_tr_b16 a[28:29], v227 offset:16384
    ds_read_b64_tr_b16 a[30:31], v227 offset:17408
    ds_read_b128 a[68:71], v232 offset:1024
    ds_read_b128 a[72:75], v232 offset:4096
    ds_read_b128 a[76:79], v232 offset:5120
    ds_read_b128 a[80:83], v232 offset:16384
    ds_read_b128 a[84:87], v232 offset:17408
    ds_read_b128 a[88:91], v232 offset:20480
    s_waitcnt lgkmcnt(14)
    v_mfma_f32_16x16x32_bf16 v[176:179], a[0:3], a[64:67], 0
    ds_read_b128 a[92:95], v232 offset:21504
    v_mfma_f32_16x16x32_bf16 v[180:183], a[4:7], a[64:67], 0
    buffer_load_dword v254, v240, s[8:11], s47 offen offset:256
    v_mfma_f32_16x16x32_bf16 v[184:187], a[8:11], a[64:67], 0
    ds_read_b64_tr_b16 a[32:33], v224 offset:8192
    v_mfma_f32_16x16x32_bf16 v[188:191], a[12:15], a[64:67], 0
    s_waitcnt lgkmcnt(8)
    v_mfma_f32_16x16x32_bf16 v[128:131], a[64:67], a[16:19], 0
    ds_read_b64_tr_b16 a[34:35], v224 offset:9216
    v_mfma_f32_16x16x32_bf16 v[136:139], a[64:67], a[20:23], 0
    v_mfma_f32_16x16x32_bf16 v[144:147], a[64:67], a[24:27], 0
    v_mfma_f32_16x16x32_bf16 v[152:155], a[64:67], a[28:31], 0
    s_waitcnt lgkmcnt(6)
    v_mfma_f32_16x16x32_bf16 v[160:163], a[0:3], a[68:71], 0
    ds_read_b64_tr_b16 a[36:37], v225 offset:8192
    v_mfma_f32_16x16x32_bf16 v[164:167], a[4:7], a[68:71], 0
    s_add_u32 s3, s58, 1048576
    buffer_load_dword v254, v241, s[12:15], s3 offen
    v_mfma_f32_16x16x32_bf16 v[168:171], a[8:11], a[68:71], 0
    ds_read_b128 a[64:67], v233 offset:0
    v_mfma_f32_16x16x32_bf16 v[172:175], a[12:15], a[68:71], 0
    ds_read_b64_tr_b16 a[38:39], v225 offset:9216
    v_mfma_f32_16x16x32_bf16 v[132:135], a[68:71], a[16:19], 0
    v_mfma_f32_16x16x32_bf16 v[140:143], a[68:71], a[20:23], 0
    v_mfma_f32_16x16x32_bf16 v[148:151], a[68:71], a[24:27], 0
    ds_read_b64_tr_b16 a[40:41], v226 offset:8192
    v_mfma_f32_16x16x32_bf16 v[156:159], a[68:71], a[28:31], 0
    v_mfma_f32_16x16x32_bf16 v[192:195], a[0:3], a[72:75], 0
    v_mfma_f32_16x16x32_bf16 v[196:199], a[4:7], a[72:75], 0
    v_mfma_f32_16x16x32_bf16 v[200:203], a[8:11], a[72:75], 0
    ds_read_b128 a[68:71], v233 offset:1024
    v_mfma_f32_16x16x32_bf16 v[204:207], a[12:15], a[72:75], 0
    buffer_load_dword v254, v240, s[8:11], s47 offen offset:384
    v_mfma_f32_16x16x32_bf16 a[96:99], a[72:75], a[16:19], 0
    ds_read_b64_tr_b16 a[42:43], v226 offset:9216
    v_mfma_f32_16x16x32_bf16 a[104:107], a[72:75], a[20:23], 0
    ds_read_b64_tr_b16 a[44:45], v227 offset:8192
    v_mfma_f32_16x16x32_bf16 a[112:115], a[72:75], a[24:27], 0
    v_mfma_f32_16x16x32_bf16 a[120:123], a[72:75], a[28:31], 0
    v_mfma_f32_16x16x32_bf16 v[208:211], a[0:3], a[76:79], 0
    v_mfma_f32_16x16x32_bf16 v[212:215], a[4:7], a[76:79], 0
    ds_read_b64_tr_b16 a[46:47], v227 offset:9216
    v_mfma_f32_16x16x32_bf16 v[216:219], a[8:11], a[76:79], 0
    ds_read_b128 a[72:75], v233 offset:4096
    v_mfma_f32_16x16x32_bf16 v[220:223], a[12:15], a[76:79], 0
    s_add_u32 s3, s58, 1572864
    buffer_load_dword v254, v241, s[12:15], s3 offen
    v_mfma_f32_16x16x32_bf16 a[100:103], a[76:79], a[16:19], 0
    ds_read_b64_tr_b16 a[48:49], v224 offset:24576
    v_mfma_f32_16x16x32_bf16 a[108:111], a[76:79], a[20:23], 0
    v_mfma_f32_16x16x32_bf16 a[116:119], a[76:79], a[24:27], 0
    v_mfma_f32_16x16x32_bf16 a[124:127], a[76:79], a[28:31], 0
    s_waitcnt lgkmcnt(12)
    v_mfma_f32_16x16x32_bf16 v[0:3], a[0:3], a[80:83], 0
    ds_read_b64_tr_b16 a[50:51], v224 offset:25600
    v_mfma_f32_16x16x32_bf16 v[4:7], a[4:7], a[80:83], 0
    v_mfma_f32_16x16x32_bf16 v[8:11], a[8:11], a[80:83], 0
    ds_read_b128 a[76:79], v233 offset:5120
    v_mfma_f32_16x16x32_bf16 v[12:15], a[12:15], a[80:83], 0
    ds_read_b64_tr_b16 a[52:53], v225 offset:24576
    v_mfma_f32_16x16x32_bf16 v[32:35], a[80:83], a[16:19], 0
    buffer_store_dwordx4 a[128:131], v243, s[24:27], s56 offen sc0 sc1
    v_mfma_f32_16x16x32_bf16 v[40:43], a[80:83], a[20:23], 0
    v_mfma_f32_16x16x32_bf16 v[48:51], a[80:83], a[24:27], 0
    ds_read_b64_tr_b16 a[54:55], v225 offset:25600
    v_mfma_f32_16x16x32_bf16 v[56:59], a[80:83], a[28:31], 0
    v_mfma_f32_16x16x32_bf16 v[16:19], a[0:3], a[84:87], 0
    v_mfma_f32_16x16x32_bf16 v[20:23], a[4:7], a[84:87], 0
    v_mfma_f32_16x16x32_bf16 v[24:27], a[8:11], a[84:87], 0
    ds_read_b128 a[80:83], v233 offset:16384
    v_mfma_f32_16x16x32_bf16 v[28:31], a[12:15], a[84:87], 0
    ds_read_b64_tr_b16 a[56:57], v226 offset:24576
    v_mfma_f32_16x16x32_bf16 v[36:39], a[84:87], a[16:19], 0
    v_mfma_f32_16x16x32_bf16 v[44:47], a[84:87], a[20:23], 0
    buffer_store_dwordx4 a[132:135], v243, s[24:27], s56 offen offset:2048 sc0 sc1
    v_mfma_f32_16x16x32_bf16 v[52:55], a[84:87], a[24:27], 0
    ds_read_b64_tr_b16 a[58:59], v226 offset:25600
    v_mfma_f32_16x16x32_bf16 v[60:63], a[84:87], a[28:31], 0
    v_mfma_f32_16x16x32_bf16 v[64:67], a[0:3], a[88:91], 0
    v_mfma_f32_16x16x32_bf16 v[68:71], a[4:7], a[88:91], 0
    ds_read_b64_tr_b16 a[60:61], v227 offset:24576
    v_mfma_f32_16x16x32_bf16 v[72:75], a[8:11], a[88:91], 0
    ds_read_b128 a[84:87], v233 offset:17408
    v_mfma_f32_16x16x32_bf16 v[76:79], a[12:15], a[88:91], 0
    v_mfma_f32_16x16x32_bf16 v[96:99], a[88:91], a[16:19], 0
    ds_read_b64_tr_b16 a[62:63], v227 offset:25600
    v_mfma_f32_16x16x32_bf16 v[104:107], a[88:91], a[20:23], 0
    v_mfma_f32_16x16x32_bf16 v[112:115], a[88:91], a[24:27], 0
    v_mov_b32 v239, 0
    buffer_load_dwordx2 v[252:253], v239, s[52:55], 0 offen sc1
    v_mfma_f32_16x16x32_bf16 v[120:123], a[88:91], a[28:31], 0
    v_mfma_f32_16x16x32_bf16 v[80:83], a[0:3], a[92:95], 0
    v_mfma_f32_16x16x32_bf16 v[84:87], a[4:7], a[92:95], 0
    v_mfma_f32_16x16x32_bf16 v[88:91], a[8:11], a[92:95], 0
    ds_read_b128 a[88:91], v233 offset:20480
    v_mfma_f32_16x16x32_bf16 v[92:95], a[12:15], a[92:95], 0
    v_mfma_f32_16x16x32_bf16 v[100:103], a[92:95], a[16:19], 0
    v_mfma_f32_16x16x32_bf16 v[108:111], a[92:95], a[20:23], 0
    v_mfma_f32_16x16x32_bf16 v[116:119], a[92:95], a[24:27], 0
    v_mfma_f32_16x16x32_bf16 v[124:127], a[92:95], a[28:31], 0
    s_waitcnt lgkmcnt(1)
    v_mfma_f32_16x16x32_bf16 v[176:179], a[32:35], a[64:67], v[176:179]
    ds_read_b128 a[92:95], v233 offset:21504
    v_mfma_f32_16x16x32_bf16 v[180:183], a[36:39], a[64:67], v[180:183]
    v_mfma_f32_16x16x32_bf16 v[184:187], a[40:43], a[64:67], v[184:187]
    v_mfma_f32_16x16x32_bf16 v[188:191], a[44:47], a[64:67], v[188:191]
    v_mfma_f32_16x16x32_bf16 v[128:131], a[64:67], a[48:51], v[128:131]
    v_mfma_f32_16x16x32_bf16 v[136:139], a[64:67], a[52:55], v[136:139]
    v_mfma_f32_16x16x32_bf16 v[144:147], a[64:67], a[56:59], v[144:147]
    v_mfma_f32_16x16x32_bf16 v[152:155], a[64:67], a[60:63], v[152:155]
    v_mfma_f32_16x16x32_bf16 v[160:163], a[32:35], a[68:71], v[160:163]
    v_mfma_f32_16x16x32_bf16 v[164:167], a[36:39], a[68:71], v[164:167]
    v_mfma_f32_16x16x32_bf16 v[168:171], a[40:43], a[68:71], v[168:171]
    v_mfma_f32_16x16x32_bf16 v[172:175], a[44:47], a[68:71], v[172:175]
    v_mfma_f32_16x16x32_bf16 v[132:135], a[68:71], a[48:51], v[132:135]
    v_mfma_f32_16x16x32_bf16 v[140:143], a[68:71], a[52:55], v[140:143]
    v_mfma_f32_16x16x32_bf16 v[148:151], a[68:71], a[56:59], v[148:151]
    v_mfma_f32_16x16x32_bf16 v[156:159], a[68:71], a[60:63], v[156:159]
    s_add_u32 m0, s38, 0
    s_waitcnt vmcnt(7) lgkmcnt(0)
    s_barrier
    v_mfma_f32_16x16x32_bf16 v[192:195], a[32:35], a[72:75], v[192:195]
    buffer_load_dwordx4 v228, s[8:11], s34 offen offset:0 lds
    v_mfma_f32_16x16x32_bf16 v[196:199], a[36:39], a[72:75], v[196:199]
    ds_read_b64_tr_b16 a[0:1], v224 offset:32768
    v_mfma_f32_16x16x32_bf16 v[200:203], a[40:43], a[72:75], v[200:203]
    ds_read_b128 a[64:67], v232 offset:32768
    v_mfma_f32_16x16x32_bf16 v[204:207], a[44:47], a[72:75], v[204:207]
    buffer_load_dwordx4 v229, s[8:11], s34 offen offset:1024 lds
    v_mfma_f32_16x16x32_bf16 a[96:99], a[72:75], a[48:51], a[96:99]
    ds_read_b128 a[68:71], v232 offset:33792
    ds_read_b64_tr_b16 a[2:3], v224 offset:33792
    v_mfma_f32_16x16x32_bf16 a[104:107], a[72:75], a[52:55], a[104:107]
    buffer_load_dwordx4 v230, s[8:11], s34 offen offset:2048 lds
    v_mfma_f32_16x16x32_bf16 a[112:115], a[72:75], a[56:59], a[112:115]
    buffer_load_dwordx4 v231, s[8:11], s34 offen offset:3072 lds
    v_mfma_f32_16x16x32_bf16 a[120:123], a[72:75], a[60:63], a[120:123]
    ds_read_b64_tr_b16 a[4:5], v225 offset:32768
    v_mfma_f32_16x16x32_bf16 v[208:211], a[32:35], a[76:79], v[208:211]
    s_add_u32 s34, s34, 128
    v_mfma_f32_16x16x32_bf16 v[212:215], a[36:39], a[76:79], v[212:215]
    ds_read_b64_tr_b16 a[6:7], v225 offset:33792
    v_mfma_f32_16x16x32_bf16 v[216:219], a[40:43], a[76:79], v[216:219]
    ds_read_b128 a[72:75], v232 offset:36864
    v_mfma_f32_16x16x32_bf16 v[220:223], a[44:47], a[76:79], v[220:223]
    s_add_u32 m0, s38, 4096
    v_mfma_f32_16x16x32_bf16 a[100:103], a[76:79], a[48:51], a[100:103]
    buffer_load_dwordx4 v228, s[8:11], s35 offen offset:0 lds
    v_mfma_f32_16x16x32_bf16 a[108:111], a[76:79], a[52:55], a[108:111]
    ds_read_b64_tr_b16 a[8:9], v226 offset:32768
    v_mfma_f32_16x16x32_bf16 a[116:119], a[76:79], a[56:59], a[116:119]
    buffer_load_dwordx4 v229, s[8:11], s35 offen offset:1024 lds
    v_mfma_f32_16x16x32_bf16 a[124:127], a[76:79], a[60:63], a[124:127]
    ds_read_b64_tr_b16 a[10:11], v226 offset:33792
    v_mfma_f32_16x16x32_bf16 v[0:3], a[32:35], a[80:83], v[0:3]
    buffer_load_dwordx4 v230, s[8:11], s35 offen offset:2048 lds
    v_mfma_f32_16x16x32_bf16 v[4:7], a[36:39], a[80:83], v[4:7]
    ds_read_b64_tr_b16 a[12:13], v227 offset:32768
    v_mfma_f32_16x16x32_bf16 v[8:11], a[40:43], a[80:83], v[8:11]
    ds_read_b128 a[76:79], v232 offset:37888
    ds_read_b64_tr_b16 a[14:15], v227 offset:33792
    v_mfma_f32_16x16x32_bf16 v[12:15], a[44:47], a[80:83], v[12:15]
    buffer_load_dwordx4 v231, s[8:11], s35 offen offset:3072 lds
    v_mfma_f32_16x16x32_bf16 v[32:35], a[80:83], a[48:51], v[32:35]
    s_add_u32 s35, s35, 128
    v_mfma_f32_16x16x32_bf16 v[40:43], a[80:83], a[52:55], v[40:43]
    ds_read_b64_tr_b16 a[16:17], v224 offset:49152
    v_mfma_f32_16x16x32_bf16 v[48:51], a[80:83], a[56:59], v[48:51]
    s_add_u32 m0, s38, 65536
    v_mfma_f32_16x16x32_bf16 v[56:59], a[80:83], a[60:63], v[56:59]
    ds_read_b64_tr_b16 a[18:19], v224 offset:50176
    v_mfma_f32_16x16x32_bf16 v[16:19], a[32:35], a[84:87], v[16:19]
    v_mfma_f32_16x16x32_bf16 v[20:23], a[36:39], a[84:87], v[20:23]
    buffer_load_dwordx4 v234, s[12:15], s36 offen offset:0 lds
    v_mfma_f32_16x16x32_bf16 v[24:27], a[40:43], a[84:87], v[24:27]
    ds_read_b128 a[80:83], v232 offset:49152
    ds_read_b64_tr_b16 a[20:21], v225 offset:49152
    v_mfma_f32_16x16x32_bf16 v[28:31], a[44:47], a[84:87], v[28:31]
    buffer_load_dwordx4 v235, s[12:15], s36 offen offset:1024 lds
    v_mfma_f32_16x16x32_bf16 v[36:39], a[84:87], a[48:51], v[36:39]
    ds_read_b64_tr_b16 a[22:23], v225 offset:50176
    v_mfma_f32_16x16x32_bf16 v[44:47], a[84:87], a[52:55], v[44:47]
    buffer_load_dwordx4 v236, s[12:15], s36 offen offset:2048 lds
    v_mfma_f32_16x16x32_bf16 v[52:55], a[84:87], a[56:59], v[52:55]
    ds_read_b64_tr_b16 a[24:25], v226 offset:49152
    v_mfma_f32_16x16x32_bf16 v[60:63], a[84:87], a[60:63], v[60:63]
    buffer_load_dwordx4 v237, s[12:15], s36 offen offset:3072 lds
    v_mfma_f32_16x16x32_bf16 v[64:67], a[32:35], a[88:91], v[64:67]
    ds_read_b64_tr_b16 a[26:27], v226 offset:50176
    v_mfma_f32_16x16x32_bf16 v[68:71], a[36:39], a[88:91], v[68:71]
    s_add_u32 s36, s36, 524288
    v_mfma_f32_16x16x32_bf16 v[72:75], a[40:43], a[88:91], v[72:75]
    ds_read_b128 a[84:87], v232 offset:50176
    v_mfma_f32_16x16x32_bf16 v[76:79], a[44:47], a[88:91], v[76:79]
    s_add_u32 m0, s38, 69632
    v_mfma_f32_16x16x32_bf16 v[96:99], a[88:91], a[48:51], v[96:99]
    ds_read_b64_tr_b16 a[28:29], v227 offset:49152
    v_mfma_f32_16x16x32_bf16 v[104:107], a[88:91], a[52:55], v[104:107]
    buffer_load_dwordx4 v234, s[12:15], s37 offen offset:0 lds
    v_mfma_f32_16x16x32_bf16 v[112:115], a[88:91], a[56:59], v[112:115]
    ds_read_b64_tr_b16 a[30:31], v227 offset:50176
    v_mfma_f32_16x16x32_bf16 v[120:123], a[88:91], a[60:63], v[120:123]
    buffer_load_dwordx4 v235, s[12:15], s37 offen offset:1024 lds
    v_mfma_f32_16x16x32_bf16 v[80:83], a[32:35], a[92:95], v[80:83]
    v_mfma_f32_16x16x32_bf16 v[84:87], a[36:39], a[92:95], v[84:87]
    buffer_load_dwordx4 v236, s[12:15], s37 offen offset:2048 lds
    v_mfma_f32_16x16x32_bf16 v[88:91], a[40:43], a[92:95], v[88:91]
    ds_read_b128 a[88:91], v232 offset:53248
    v_mfma_f32_16x16x32_bf16 v[92:95], a[44:47], a[92:95], v[92:95]
    buffer_load_dwordx4 v237, s[12:15], s37 offen offset:3072 lds
    v_mfma_f32_16x16x32_bf16 v[100:103], a[92:95], a[48:51], v[100:103]
    v_mfma_f32_16x16x32_bf16 v[108:111], a[92:95], a[52:55], v[108:111]
    s_add_u32 s37, s37, 524288
    v_mfma_f32_16x16x32_bf16 v[116:119], a[92:95], a[56:59], v[116:119]
    v_mfma_f32_16x16x32_bf16 v[124:127], a[92:95], a[60:63], v[124:127]
    s_waitcnt lgkmcnt(1)
    v_mfma_f32_16x16x32_bf16 v[176:179], a[0:3], a[64:67], v[176:179]
    ds_read_b128 a[92:95], v232 offset:54272
    v_mfma_f32_16x16x32_bf16 v[180:183], a[4:7], a[64:67], v[180:183]
    buffer_load_dword v254, v240, s[8:11], s47 offen offset:512
    v_mfma_f32_16x16x32_bf16 v[184:187], a[8:11], a[64:67], v[184:187]
    ds_read_b64_tr_b16 a[32:33], v224 offset:40960
    v_mfma_f32_16x16x32_bf16 v[188:191], a[12:15], a[64:67], v[188:191]
    v_mfma_f32_16x16x32_bf16 v[128:131], a[64:67], a[16:19], v[128:131]
    ds_read_b64_tr_b16 a[34:35], v224 offset:41984
    v_mfma_f32_16x16x32_bf16 v[136:139], a[64:67], a[20:23], v[136:139]
    v_mfma_f32_16x16x32_bf16 v[144:147], a[64:67], a[24:27], v[144:147]
    v_mfma_f32_16x16x32_bf16 v[152:155], a[64:67], a[28:31], v[152:155]
    ds_read_b64_tr_b16 a[36:37], v225 offset:40960
    v_mfma_f32_16x16x32_bf16 v[160:163], a[0:3], a[68:71], v[160:163]
    v_mfma_f32_16x16x32_bf16 v[164:167], a[4:7], a[68:71], v[164:167]
    v_mfma_f32_16x16x32_bf16 v[168:171], a[8:11], a[68:71], v[168:171]
    ds_read_b128 a[64:67], v233 offset:32768
    v_mfma_f32_16x16x32_bf16 v[172:175], a[12:15], a[68:71], v[172:175]
    ds_read_b64_tr_b16 a[38:39], v225 offset:41984
    v_mfma_f32_16x16x32_bf16 v[132:135], a[68:71], a[16:19], v[132:135]
    s_add_u32 s3, s58, 2097152
    buffer_load_dword v254, v241, s[12:15], s3 offen
    v_mfma_f32_16x16x32_bf16 v[140:143], a[68:71], a[20:23], v[140:143]
    v_mfma_f32_16x16x32_bf16 v[148:151], a[68:71], a[24:27], v[148:151]
    ds_read_b64_tr_b16 a[40:41], v226 offset:40960
    v_mfma_f32_16x16x32_bf16 v[156:159], a[68:71], a[28:31], v[156:159]
    v_mfma_f32_16x16x32_bf16 v[192:195], a[0:3], a[72:75], v[192:195]
    v_mfma_f32_16x16x32_bf16 v[196:199], a[4:7], a[72:75], v[196:199]
    v_mfma_f32_16x16x32_bf16 v[200:203], a[8:11], a[72:75], v[200:203]
    ds_read_b128 a[68:71], v233 offset:33792
    v_mfma_f32_16x16x32_bf16 v[204:207], a[12:15], a[72:75], v[204:207]
    ds_read_b64_tr_b16 a[42:43], v226 offset:41984
    v_mfma_f32_16x16x32_bf16 a[96:99], a[72:75], a[16:19], a[96:99]
    v_mfma_f32_16x16x32_bf16 a[104:107], a[72:75], a[20:23], a[104:107]
    ds_read_b64_tr_b16 a[44:45], v227 offset:40960
    v_mfma_f32_16x16x32_bf16 a[112:115], a[72:75], a[24:27], a[112:115]
    v_mfma_f32_16x16x32_bf16 a[120:123], a[72:75], a[28:31], a[120:123]
    v_mfma_f32_16x16x32_bf16 v[208:211], a[0:3], a[76:79], v[208:211]
    v_mfma_f32_16x16x32_bf16 v[212:215], a[4:7], a[76:79], v[212:215]
    s_lshr_b32 s3, s94, 1
    s_lshl_b32 s3, s3, 19
    s_add_u32 s3, s3, s58
    s_add_u32 s3, s3, 0
    buffer_load_dword v254, v241, s[28:31], s3 offen
    v_mfma_f32_16x16x32_bf16 v[216:219], a[8:11], a[76:79], v[216:219]
    ds_read_b128 a[72:75], v233 offset:36864
    v_mfma_f32_16x16x32_bf16 v[220:223], a[12:15], a[76:79], v[220:223]
    ds_read_b64_tr_b16 a[46:47], v227 offset:41984
    v_mfma_f32_16x16x32_bf16 a[100:103], a[76:79], a[16:19], a[100:103]
    ds_read_b64_tr_b16 a[48:49], v224 offset:57344
    v_mfma_f32_16x16x32_bf16 a[108:111], a[76:79], a[20:23], a[108:111]
    v_mfma_f32_16x16x32_bf16 a[116:119], a[76:79], a[24:27], a[116:119]
    v_mfma_f32_16x16x32_bf16 a[124:127], a[76:79], a[28:31], a[124:127]
    s_waitcnt lgkmcnt(12)
    v_mfma_f32_16x16x32_bf16 v[0:3], a[0:3], a[80:83], v[0:3]
    ds_read_b64_tr_b16 a[50:51], v224 offset:58368
    v_mfma_f32_16x16x32_bf16 v[4:7], a[4:7], a[80:83], v[4:7]
    v_mfma_f32_16x16x32_bf16 v[8:11], a[8:11], a[80:83], v[8:11]
    ds_read_b128 a[76:79], v233 offset:37888
    v_mfma_f32_16x16x32_bf16 v[12:15], a[12:15], a[80:83], v[12:15]
    ds_read_b64_tr_b16 a[52:53], v225 offset:57344
    v_mfma_f32_16x16x32_bf16 v[32:35], a[80:83], a[16:19], v[32:35]
    v_mfma_f32_16x16x32_bf16 v[40:43], a[80:83], a[20:23], v[40:43]
    v_mfma_f32_16x16x32_bf16 v[48:51], a[80:83], a[24:27], v[48:51]
    s_waitcnt vmcnt(19)
    v_cmp_eq_u32 vcc, 0, v252
    s_cbranch_vccnz spin_4
ok_3:
    v_mfma_f32_16x16x32_bf16 v[56:59], a[80:83], a[28:31], v[56:59]
    ds_read_b64_tr_b16 a[54:55], v225 offset:58368
    v_mfma_f32_16x16x32_bf16 v[16:19], a[0:3], a[84:87], v[16:19]
    v_mfma_f32_16x16x32_bf16 v[20:23], a[4:7], a[84:87], v[20:23]
    v_mfma_f32_16x16x32_bf16 v[24:27], a[8:11], a[84:87], v[24:27]
    ds_read_b128 a[80:83], v233 offset:49152
    v_mfma_f32_16x16x32_bf16 v[28:31], a[12:15], a[84:87], v[28:31]
    ds_read_b64_tr_b16 a[56:57], v226 offset:57344
    v_mfma_f32_16x16x32_bf16 v[36:39], a[84:87], a[16:19], v[36:39]
    v_mfma_f32_16x16x32_bf16 v[44:47], a[84:87], a[20:23], v[44:47]
    ds_read_b64_tr_b16 a[58:59], v226 offset:58368
    v_mfma_f32_16x16x32_bf16 v[52:55], a[84:87], a[24:27], v[52:55]
    v_mfma_f32_16x16x32_bf16 v[60:63], a[84:87], a[28:31], v[60:63]
    v_mfma_f32_16x16x32_bf16 v[64:67], a[0:3], a[88:91], v[64:67]
    v_mfma_f32_16x16x32_bf16 v[68:71], a[4:7], a[88:91], v[68:71]
    ds_read_b64_tr_b16 a[60:61], v227 offset:57344
    v_mfma_f32_16x16x32_bf16 v[72:75], a[8:11], a[88:91], v[72:75]
    ds_read_b128 a[84:87], v233 offset:50176
    v_mfma_f32_16x16x32_bf16 v[76:79], a[12:15], a[88:91], v[76:79]
    v_readfirstlane_b32 s96, v252
    v_readfirstlane_b32 s97, v253
    v_mov_b32 v250, v252
    v_mov_b32 v251, v253
    v_mfma_f32_16x16x32_bf16 v[96:99], a[88:91], a[16:19], v[96:99]
    ds_read_b64_tr_b16 a[62:63], v227 offset:58368
    v_mfma_f32_16x16x32_bf16 v[104:107], a[88:91], a[20:23], v[104:107]
    v_mfma_f32_16x16x32_bf16 v[112:115], a[88:91], a[24:27], v[112:115]
    v_mfma_f32_16x16x32_bf16 v[120:123], a[88:91], a[28:31], v[120:123]
    v_mfma_f32_16x16x32_bf16 v[80:83], a[0:3], a[92:95], v[80:83]
    v_mfma_f32_16x16x32_bf16 v[84:87], a[4:7], a[92:95], v[84:87]
    v_mfma_f32_16x16x32_bf16 v[88:91], a[8:11], a[92:95], v[88:91]
    ds_read_b128 a[88:91], v233 offset:53248
    v_mfma_f32_16x16x32_bf16 v[92:95], a[12:15], a[92:95], v[92:95]
    v_mfma_f32_16x16x32_bf16 v[100:103], a[92:95], a[16:19], v[100:103]
    v_mfma_f32_16x16x32_bf16 v[108:111], a[92:95], a[20:23], v[108:111]
    v_mfma_f32_16x16x32_bf16 v[116:119], a[92:95], a[24:27], v[116:119]
    v_mfma_f32_16x16x32_bf16 v[124:127], a[92:95], a[28:31], v[124:127]
    s_waitcnt lgkmcnt(1)
    v_mfma_f32_16x16x32_bf16 v[176:179], a[32:35], a[64:67], v[176:179]
    ds_read_b128 a[92:95], v233 offset:54272
    v_mfma_f32_16x16x32_bf16 v[180:183], a[36:39], a[64:67], v[180:183]
    v_mfma_f32_16x16x32_bf16 v[184:187], a[40:43], a[64:67], v[184:187]
    v_mfma_f32_16x16x32_bf16 v[188:191], a[44:47], a[64:67], v[188:191]
    v_mfma_f32_16x16x32_bf16 v[128:131], a[64:67], a[48:51], v[128:131]
    v_mfma_f32_16x16x32_bf16 v[136:139], a[64:67], a[52:55], v[136:139]
    v_mfma_f32_16x16x32_bf16 v[144:147], a[64:67], a[56:59], v[144:147]
    v_mfma_f32_16x16x32_bf16 v[152:155], a[64:67], a[60:63], v[152:155]
    v_mfma_f32_16x16x32_bf16 v[160:163], a[32:35], a[68:71], v[160:163]
    v_mfma_f32_16x16x32_bf16 v[164:167], a[36:39], a[68:71], v[164:167]
    v_mfma_f32_16x16x32_bf16 v[168:171], a[40:43], a[68:71], v[168:171]
    v_mfma_f32_16x16x32_bf16 v[172:175], a[44:47], a[68:71], v[172:175]
    v_mfma_f32_16x16x32_bf16 v[132:135], a[68:71], a[48:51], v[132:135]
    v_mfma_f32_16x16x32_bf16 v[140:143], a[68:71], a[52:55], v[140:143]
    v_mfma_f32_16x16x32_bf16 v[148:151], a[68:71], a[56:59], v[148:151]
    v_mfma_f32_16x16x32_bf16 v[156:159], a[68:71], a[60:63], v[156:159]
    s_add_u32 m0, s38, 32768
    s_waitcnt vmcnt(3) lgkmcnt(0)
    s_barrier
    v_mfma_f32_16x16x32_bf16 v[192:195], a[32:35], a[72:75], v[192:195]
    buffer_load_dwordx4 v228, s[8:11], s34 offen offset:0 lds
    v_mfma_f32_16x16x32_bf16 v[196:199], a[36:39], a[72:75], v[196:199]
    ds_read_b64_tr_b16 a[0:1], v224 offset:0
    v_mfma_f32_16x16x32_bf16 v[200:203], a[40:43], a[72:75], v[200:203]
    ds_read_b128 a[64:67], v232 offset:0
    v_mfma_f32_16x16x32_bf16 v[204:207], a[44:47], a[72:75], v[204:207]
    buffer_load_dwordx4 v229, s[8:11], s34 offen offset:1024 lds
    v_mfma_f32_16x16x32_bf16 a[96:99], a[72:75], a[48:51], a[96:99]
    ds_read_b128 a[68:71], v232 offset:1024
    ds_read_b64_tr_b16 a[2:3], v224 offset:1024
    v_mfma_f32_16x16x32_bf16 a[104:107], a[72:75], a[52:55], a[104:107]
    buffer_load_dwordx4 v230, s[8:11], s34 offen offset:2048 lds
    v_mfma_f32_16x16x32_bf16 a[112:115], a[72:75], a[56:59], a[112:115]
    buffer_load_dwordx4 v231, s[8:11], s34 offen offset:3072 lds
    v_mfma_f32_16x16x32_bf16 a[120:123], a[72:75], a[60:63], a[120:123]
    ds_read_b64_tr_b16 a[4:5], v225 offset:0
    v_mfma_f32_16x16x32_bf16 v[208:211], a[32:35], a[76:79], v[208:211]
    s_add_u32 s34, s34, 128
    v_mfma_f32_16x16x32_bf16 v[212:215], a[36:39], a[76:79], v[212:215]
    ds_read_b64_tr_b16 a[6:7], v225 offset:1024
    v_mfma_f32_16x16x32_bf16 v[216:219], a[40:43], a[76:79], v[216:219]
    ds_read_b128 a[72:75], v232 offset:4096
    v_mfma_f32_16x16x32_bf16 v[220:223], a[44:47], a[76:79], v[220:223]
    s_add_u32 m0, s38, 36864
    v_mfma_f32_16x16x32_bf16 a[100:103], a[76:79], a[48:51], a[100:103]
    buffer_load_dwordx4 v228, s[8:11], s35 offen offset:0 lds
    v_mfma_f32_16x16x32_bf16 a[108:111], a[76:79], a[52:55], a[108:111]
    ds_read_b64_tr_b16 a[8:9], v226 offset:0
    v_mfma_f32_16x16x32_bf16 a[116:119], a[76:79], a[56:59], a[116:119]
    buffer_load_dwordx4 v229, s[8:11], s35 offen offset:1024 lds
    v_mfma_f32_16x16x32_bf16 a[124:127], a[76:79], a[60:63], a[124:127]
    ds_read_b64_tr_b16 a[10:11], v226 offset:1024
    v_mfma_f32_16x16x32_bf16 v[0:3], a[32:35], a[80:83], v[0:3]
    buffer_load_dwordx4 v230, s[8:11], s35 offen offset:2048 lds
    v_mfma_f32_16x16x32_bf16 v[4:7], a[36:39], a[80:83], v[4:7]
    ds_read_b64_tr_b16 a[12:13], v227 offset:0
    v_mfma_f32_16x16x32_bf16 v[8:11], a[40:43], a[80:83], v[8:11]
    ds_read_b128 a[76:79], v232 offset:5120
    ds_read_b64_tr_b16 a[14:15], v227 offset:1024
    v_mfma_f32_16x16x32_bf16 v[12:15], a[44:47], a[80:83], v[12:15]
    buffer_load_dwordx4 v231, s[8:11], s35 offen offset:3072 lds
    v_mfma_f32_16x16x32_bf16 v[32:35], a[80:83], a[48:51], v[32:35]
    s_add_u32 s35, s35, 128
    v_mfma_f32_16x16x32_bf16 v[40:43], a[80:83], a[52:55], v[40:43]
    ds_read_b64_tr_b16 a[16:17], v224 offset:16384
    v_mfma_f32_16x16x32_bf16 v[48:51], a[80:83], a[56:59], v[48:51]
    s_add_u32 m0, s38, 98304
    v_mfma_f32_16x16x32_bf16 v[56:59], a[80:83], a[60:63], v[56:59]
    ds_read_b64_tr_b16 a[18:19], v224 offset:17408
    v_mfma_f32_16x16x32_bf16 v[16:19], a[32:35], a[84:87], v[16:19]
    v_mfma_f32_16x16x32_bf16 v[20:23], a[36:39], a[84:87], v[20:23]
    buffer_load_dwordx4 v234, s[12:15], s36 offen offset:0 lds
    v_mfma_f32_16x16x32_bf16 v[24:27], a[40:43], a[84:87], v[24:27]
    ds_read_b128 a[80:83], v232 offset:16384
    ds_read_b64_tr_b16 a[20:21], v225 offset:16384
    v_mfma_f32_16x16x32_bf16 v[28:31], a[44:47], a[84:87], v[28:31]
    buffer_load_dwordx4 v235, s[12:15], s36 offen offset:1024 lds
    v_mfma_f32_16x16x32_bf16 v[36:39], a[84:87], a[48:51], v[36:39]
    ds_read_b64_tr_b16 a[22:23], v225 offset:17408
    v_mfma_f32_16x16x32_bf16 v[44:47], a[84:87], a[52:55], v[44:47]
    buffer_load_dwordx4 v236, s[12:15], s36 offen offset:2048 lds
    v_mfma_f32_16x16x32_bf16 v[52:55], a[84:87], a[56:59], v[52:55]
    ds_read_b64_tr_b16 a[24:25], v226 offset:16384
    v_mfma_f32_16x16x32_bf16 v[60:63], a[84:87], a[60:63], v[60:63]
    buffer_load_dwordx4 v237, s[12:15], s36 offen offset:3072 lds
    v_mfma_f32_16x16x32_bf16 v[64:67], a[32:35], a[88:91], v[64:67]
    ds_read_b64_tr_b16 a[26:27], v226 offset:17408
    v_mfma_f32_16x16x32_bf16 v[68:71], a[36:39], a[88:91], v[68:71]
    s_add_u32 s36, s36, 524288
    v_mfma_f32_16x16x32_bf16 v[72:75], a[40:43], a[88:91], v[72:75]
    ds_read_b128 a[84:87], v232 offset:17408
    v_mfma_f32_16x16x32_bf16 v[76:79], a[44:47], a[88:91], v[76:79]
    s_add_u32 m0, s38, 102400
    v_mfma_f32_16x16x32_bf16 v[96:99], a[88:91], a[48:51], v[96:99]
    ds_read_b64_tr_b16 a[28:29], v227 offset:16384
    v_mfma_f32_16x16x32_bf16 v[104:107], a[88:91], a[52:55], v[104:107]
    buffer_load_dwordx4 v234, s[12:15], s37 offen offset:0 lds
    v_mfma_f32_16x16x32_bf16 v[112:115], a[88:91], a[56:59], v[112:115]
    ds_read_b64_tr_b16 a[30:31], v227 offset:17408
    v_mfma_f32_16x16x32_bf16 v[120:123], a[88:91], a[60:63], v[120:123]
    buffer_load_dwordx4 v235, s[12:15], s37 offen offset:1024 lds
    v_mfma_f32_16x16x32_bf16 v[80:83], a[32:35], a[92:95], v[80:83]
    v_mfma_f32_16x16x32_bf16 v[84:87], a[36:39], a[92:95], v[84:87]
    buffer_load_dwordx4 v236, s[12:15], s37 offen offset:2048 lds
    v_mfma_f32_16x16x32_bf16 v[88:91], a[40:43], a[92:95], v[88:91]
    ds_read_b128 a[88:91], v232 offset:20480
    v_mfma_f32_16x16x32_bf16 v[92:95], a[44:47], a[92:95], v[92:95]
    buffer_load_dwordx4 v237, s[12:15], s37 offen offset:3072 lds
    v_mfma_f32_16x16x32_bf16 v[100:103], a[92:95], a[48:51], v[100:103]
    v_mfma_f32_16x16x32_bf16 v[108:111], a[92:95], a[52:55], v[108:111]
    s_add_u32 s37, s37, 524288
    v_mfma_f32_16x16x32_bf16 v[116:119], a[92:95], a[56:59], v[116:119]
    v_mfma_f32_16x16x32_bf16 v[124:127], a[92:95], a[60:63], v[124:127]
    s_waitcnt lgkmcnt(1)
    v_mfma_f32_16x16x32_bf16 v[176:179], a[0:3], a[64:67], v[176:179]
    ds_read_b128 a[92:95], v232 offset:21504
    v_mfma_f32_16x16x32_bf16 v[180:183], a[4:7], a[64:67], v[180:183]
    buffer_load_dword v254, v240, s[8:11], s47 offen offset:640
    v_mfma_f32_16x16x32_bf16 v[184:187], a[8:11], a[64:67], v[184:187]
    ds_read_b64_tr_b16 a[32:33], v224 offset:8192
    v_mfma_f32_16x16x32_bf16 v[188:191], a[12:15], a[64:67], v[188:191]
    v_mfma_f32_16x16x32_bf16 v[128:131], a[64:67], a[16:19], v[128:131]
    ds_read_b64_tr_b16 a[34:35], v224 offset:9216
    v_mfma_f32_16x16x32_bf16 v[136:139], a[64:67], a[20:23], v[136:139]
    v_mfma_f32_16x16x32_bf16 v[144:147], a[64:67], a[24:27], v[144:147]
    v_mfma_f32_16x16x32_bf16 v[152:155], a[64:67], a[28:31], v[152:155]
    ds_read_b64_tr_b16 a[36:37], v225 offset:8192
    v_mfma_f32_16x16x32_bf16 v[160:163], a[0:3], a[68:71], v[160:163]
    v_mfma_f32_16x16x32_bf16 v[164:167], a[4:7], a[68:71], v[164:167]
    v_mfma_f32_16x16x32_bf16 v[168:171], a[8:11], a[68:71], v[168:171]
    ds_read_b128 a[64:67], v233 offset:0
    v_mfma_f32_16x16x32_bf16 v[172:175], a[12:15], a[68:71], v[172:175]
    ds_read_b64_tr_b16 a[38:39], v225 offset:9216
    v_mfma_f32_16x16x32_bf16 v[132:135], a[68:71], a[16:19], v[132:135]
    v_mfma_f32_16x16x32_bf16 v[140:143], a[68:71], a[20:23], v[140:143]
    v_mfma_f32_16x16x32_bf16 v[148:151], a[68:71], a[24:27], v[148:151]
    ds_read_b64_tr_b16 a[40:41], v226 offset:8192
    v_mfma_f32_16x16x32_bf16 v[156:159], a[68:71], a[28:31], v[156:159]
    v_mfma_f32_16x16x32_bf16 v[192:195], a[0:3], a[72:75], v[192:195]
    s_add_u32 s3, s58, 2621440
    buffer_load_dword v254, v241, s[12:15], s3 offen
    v_mfma_f32_16x16x32_bf16 v[196:199], a[4:7], a[72:75], v[196:199]
    v_mfma_f32_16x16x32_bf16 v[200:203], a[8:11], a[72:75], v[200:203]
    ds_read_b128 a[68:71], v233 offset:1024
    v_mfma_f32_16x16x32_bf16 v[204:207], a[12:15], a[72:75], v[204:207]
    ds_read_b64_tr_b16 a[42:43], v226 offset:9216
    v_mfma_f32_16x16x32_bf16 a[96:99], a[72:75], a[16:19], a[96:99]
    v_mfma_f32_16x16x32_bf16 a[104:107], a[72:75], a[20:23], a[104:107]
    ds_read_b64_tr_b16 a[44:45], v227 offset:8192
    v_mfma_f32_16x16x32_bf16 a[112:115], a[72:75], a[24:27], a[112:115]
    v_mfma_f32_16x16x32_bf16 a[120:123], a[72:75], a[28:31], a[120:123]
    v_mfma_f32_16x16x32_bf16 v[208:211], a[0:3], a[76:79], v[208:211]
    v_mfma_f32_16x16x32_bf16 v[212:215], a[4:7], a[76:79], v[212:215]
    ds_read_b64_tr_b16 a[46:47], v227 offset:9216
    v_mfma_f32_16x16x32_bf16 v[216:219], a[8:11], a[76:79], v[216:219]
    ds_read_b128 a[72:75], v233 offset:4096
    v_mfma_f32_16x16x32_bf16 v[220:223], a[12:15], a[76:79], v[220:223]
    v_mfma_f32_16x16x32_bf16 a[100:103], a[76:79], a[16:19], a[100:103]
    ds_read_b64_tr_b16 a[48:49], v224 offset:24576
    v_mfma_f32_16x16x32_bf16 a[108:111], a[76:79], a[20:23], a[108:111]
    v_mfma_f32_16x16x32_bf16 a[116:119], a[76:79], a[24:27], a[116:119]
    v_mfma_f32_16x16x32_bf16 a[124:127], a[76:79], a[28:31], a[124:127]
    s_waitcnt lgkmcnt(12)
    v_mfma_f32_16x16x32_bf16 v[0:3], a[0:3], a[80:83], v[0:3]
    s_lshr_b32 s3, s94, 1
    s_lshl_b32 s3, s3, 19
    s_add_u32 s3, s3, s58
    s_add_u32 s3, s3, 1048576
    buffer_load_dword v254, v241, s[28:31], s3 offen
    v_mfma_f32_16x16x32_bf16 v[4:7], a[4:7], a[80:83], v[4:7]
    ds_read_b64_tr_b16 a[50:51], v224 offset:25600
    v_mfma_f32_16x16x32_bf16 v[8:11], a[8:11], a[80:83], v[8:11]
    ds_read_b128 a[76:79], v233 offset:5120
    v_mfma_f32_16x16x32_bf16 v[12:15], a[12:15], a[80:83], v[12:15]
    ds_read_b64_tr_b16 a[52:53], v225 offset:24576
    v_mfma_f32_16x16x32_bf16 v[32:35], a[80:83], a[16:19], v[32:35]
    v_mfma_f32_16x16x32_bf16 v[40:43], a[80:83], a[20:23], v[40:43]
    v_mfma_f32_16x16x32_bf16 v[48:51], a[80:83], a[24:27], v[48:51]
    ds_read_b64_tr_b16 a[54:55], v225 offset:25600
    v_mfma_f32_16x16x32_bf16 v[56:59], a[80:83], a[28:31], v[56:59]
    v_mfma_f32_16x16x32_bf16 v[16:19], a[0:3], a[84:87], v[16:19]
    v_mfma_f32_16x16x32_bf16 v[20:23], a[4:7], a[84:87], v[20:23]
    v_mfma_f32_16x16x32_bf16 v[24:27], a[8:11], a[84:87], v[24:27]
    ds_read_b128 a[80:83], v233 offset:16384
    v_mfma_f32_16x16x32_bf16 v[28:31], a[12:15], a[84:87], v[28:31]
    ds_read_b64_tr_b16 a[56:57], v226 offset:24576
    v_mfma_f32_16x16x32_bf16 v[36:39], a[84:87], a[16:19], v[36:39]
    v_mfma_f32_16x16x32_bf16 v[44:47], a[84:87], a[20:23], v[44:47]
    ds_read_b64_tr_b16 a[58:59], v226 offset:25600
    v_mfma_f32_16x16x32_bf16 v[52:55], a[84:87], a[24:27], v[52:55]
    v_mfma_f32_16x16x32_bf16 v[60:63], a[84:87], a[28:31], v[60:63]
    v_mfma_f32_16x16x32_bf16 v[64:67], a[0:3], a[88:91], v[64:67]
    s_cmp_lg_u32 s94, 0
    s_cbranch_scc1 nf_5
    s_lshl_b32 s3, s2, 3
    buffer_store_dwordx2 v[250:251], off, s[64:67], s3 sc0 sc1
nf_5:
    v_mfma_f32_16x16x32_bf16 v[68:71], a[4:7], a[88:91], v[68:71]
    ds_read_b64_tr_b16 a[60:61], v227 offset:24576
    v_mfma_f32_16x16x32_bf16 v[72:75], a[8:11], a[88:91], v[72:75]
    ds_read_b128 a[84:87], v233 offset:17408
    v_mfma_f32_16x16x32_bf16 v[76:79], a[12:15], a[88:91], v[76:79]
    v_mfma_f32_16x16x32_bf16 v[96:99], a[88:91], a[16:19], v[96:99]
    ds_read_b64_tr_b16 a[62:63], v227 offset:25600
    v_mfma_f32_16x16x32_bf16 v[104:107], a[88:91], a[20:23], v[104:107]
    v_mfma_f32_16x16x32_bf16 v[112:115], a[88:91], a[24:27], v[112:115]
    v_mfma_f32_16x16x32_bf16 v[120:123], a[88:91], a[28:31], v[120:123]
    v_mfma_f32_16x16x32_bf16 v[80:83], a[0:3], a[92:95], v[80:83]
    v_mfma_f32_16x16x32_bf16 v[84:87], a[4:7], a[92:95], v[84:87]
    v_mfma_f32_16x16x32_bf16 v[88:91], a[8:11], a[92:95], v[88:91]
    ds_read_b128 a[88:91], v233 offset:20480
    v_mfma_f32_16x16x32_bf16 v[92:95], a[12:15], a[92:95], v[92:95]
    v_mfma_f32_16x16x32_bf16 v[100:103], a[92:95], a[16:19], v[100:103]
    v_mfma_f32_16x16x32_bf16 v[108:111], a[92:95], a[20:23], v[108:111]
    v_mfma_f32_16x16x32_bf16 v[116:119], a[92:95], a[24:27], v[116:119]
    v_mfma_f32_16x16x32_bf16 v[124:127], a[92:95], a[28:31], v[124:127]
    s_waitcnt lgkmcnt(1)
    v_mfma_f32_16x16x32_bf16 v[176:179], a[32:35], a[64:67], v[176:179]
    ds_read_b128 a[92:95], v233 offset:21504
    v_mfma_f32_16x16x32_bf16 v[180:183], a[36:39], a[64:67], v[180:183]
    v_mfma_f32_16x16x32_bf16 v[184:187], a[40:43], a[64:67], v[184:187]
    v_mfma_f32_16x16x32_bf16 v[188:191], a[44:47], a[64:67], v[188:191]
    v_mfma_f32_16x16x32_bf16 v[128:131], a[64:67], a[48:51], v[128:131]
    v_mfma_f32_16x16x32_bf16 v[136:139], a[64:67], a[52:55], v[136:139]
    v_mfma_f32_16x16x32_bf16 v[144:147], a[64:67], a[56:59], v[144:147]
    v_mfma_f32_16x16x32_bf16 v[152:155], a[64:67], a[60:63], v[152:155]
    v_mfma_f32_16x16x32_bf16 v[160:163], a[32:35], a[68:71], v[160:163]
    v_mfma_f32_16x16x32_bf16 v[164:167], a[36:39], a[68:71], v[164:167]
    v_mfma_f32_16x16x32_bf16 v[168:171], a[40:43], a[68:71], v[168:171]
    v_mfma_f32_16x16x32_bf16 v[172:175], a[44:47], a[68:71], v[172:175]
    v_mfma_f32_16x16x32_bf16 v[132:135], a[68:71], a[48:51], v[132:135]
    v_mfma_f32_16x16x32_bf16 v[140:143], a[68:71], a[52:55], v[140:143]
    v_mfma_f32_16x16x32_bf16 v[148:151], a[68:71], a[56:59], v[148:151]
    v_mfma_f32_16x16x32_bf16 v[156:159], a[68:71], a[60:63], v[156:159]
    s_add_u32 m0, s38, 0
    s_waitcnt vmcnt(3) lgkmcnt(0)
    s_barrier
    v_mfma_f32_16x16x32_bf16 v[192:195], a[32:35], a[72:75], v[192:195]
    buffer_load_dwordx4 v228, s[8:11], s34 offen offset:0 lds
    v_mfma_f32_16x16x32_bf16 v[196:199], a[36:39], a[72:75], v[196:199]
    ds_read_b64_tr_b16 a[0:1], v224 offset:32768
    v_mfma_f32_16x16x32_bf16 v[200:203], a[40:43], a[72:75], v[200:203]
    ds_read_b128 a[64:67], v232 offset:32768
    v_mfma_f32_16x16x32_bf16 v[204:207], a[44:47], a[72:75], v[204:207]
    buffer_load_dwordx4 v229, s[8:11], s34 offen offset:1024 lds
    v_mfma_f32_16x16x32_bf16 a[96:99], a[72:75], a[48:51], a[96:99]
    ds_read_b128 a[68:71], v232 offset:33792
    ds_read_b64_tr_b16 a[2:3], v224 offset:33792
    v_mfma_f32_16x16x32_bf16 a[104:107], a[72:75], a[52:55], a[104:107]
    buffer_load_dwordx4 v230, s[8:11], s34 offen offset:2048 lds
    v_mfma_f32_16x16x32_bf16 a[112:115], a[72:75], a[56:59], a[112:115]
    buffer_load_dwordx4 v231, s[8:11], s34 offen offset:3072 lds
    v_mfma_f32_16x16x32_bf16 a[120:123], a[72:75], a[60:63], a[120:123]
    ds_read_b64_tr_b16 a[4:5], v225 offset:32768
    v_mfma_f32_16x16x32_bf16 v[208:211], a[32:35], a[76:79], v[208:211]
    s_add_u32 s34, s34, 128
    v_mfma_f32_16x16x32_bf16 v[212:215], a[36:39], a[76:79], v[212:215]
    ds_read_b64_tr_b16 a[6:7], v225 offset:33792
    v_mfma_f32_16x16x32_bf16 v[216:219], a[40:43], a[76:79], v[216:219]
    ds_read_b128 a[72:75], v232 offset:36864
    v_mfma_f32_16x16x32_bf16 v[220:223], a[44:47], a[76:79], v[220:223]
    s_add_u32 m0, s38, 4096
    v_mfma_f32_16x16x32_bf16 a[100:103], a[76:79], a[48:51], a[100:103]
    buffer_load_dwordx4 v228, s[8:11], s35 offen offset:0 lds
    v_mfma_f32_16x16x32_bf16 a[108:111], a[76:79], a[52:55], a[108:111]
    ds_read_b64_tr_b16 a[8:9], v226 offset:32768
    v_mfma_f32_16x16x32_bf16 a[116:119], a[76:79], a[56:59], a[116:119]
    buffer_load_dwordx4 v229, s[8:11], s35 offen offset:1024 lds
    v_mfma_f32_16x16x32_bf16 a[124:127], a[76:79], a[60:63], a[124:127]
    ds_read_b64_tr_b16 a[10:11], v226 offset:33792
    v_mfma_f32_16x16x32_bf16 v[0:3], a[32:35], a[80:83], v[0:3]
    buffer_load_dwordx4 v230, s[8:11], s35 offen offset:2048 lds
    v_mfma_f32_16x16x32_bf16 v[4:7], a[36:39], a[80:83], v[4:7]
    ds_read_b64_tr_b16 a[12:13], v227 offset:32768
    v_mfma_f32_16x16x32_bf16 v[8:11], a[40:43], a[80:83], v[8:11]
    ds_read_b128 a[76:79], v232 offset:37888
    ds_read_b64_tr_b16 a[14:15], v227 offset:33792
    v_mfma_f32_16x16x32_bf16 v[12:15], a[44:47], a[80:83], v[12:15]
    buffer_load_dwordx4 v231, s[8:11], s35 offen offset:3072 lds
    v_mfma_f32_16x16x32_bf16 v[32:35], a[80:83], a[48:51], v[32:35]
    s_add_u32 s35, s35, 128
    v_mfma_f32_16x16x32_bf16 v[40:43], a[80:83], a[52:55], v[40:43]
    ds_read_b64_tr_b16 a[16:17], v224 offset:49152
    v_mfma_f32_16x16x32_bf16 v[48:51], a[80:83], a[56:59], v[48:51]
    s_add_u32 m0, s38, 65536
    v_mfma_f32_16x16x32_bf16 v[56:59], a[80:83], a[60:63], v[56:59]
    ds_read_b64_tr_b16 a[18:19], v224 offset:50176
    v_mfma_f32_16x16x32_bf16 v[16:19], a[32:35], a[84:87], v[16:19]
    v_mfma_f32_16x16x32_bf16 v[20:23], a[36:39], a[84:87], v[20:23]
    buffer_load_dwordx4 v234, s[12:15], s36 offen offset:0 lds
    v_mfma_f32_16x16x32_bf16 v[24:27], a[40:43], a[84:87], v[24:27]
    ds_read_b128 a[80:83], v232 offset:49152
    ds_read_b64_tr_b16 a[20:21], v225 offset:49152
    v_mfma_f32_16x16x32_bf16 v[28:31], a[44:47], a[84:87], v[28:31]
    buffer_load_dwordx4 v235, s[12:15], s36 offen offset:1024 lds
    v_mfma_f32_16x16x32_bf16 v[36:39], a[84:87], a[48:51], v[36:39]
    ds_read_b64_tr_b16 a[22:23], v225 offset:50176
    v_mfma_f32_16x16x32_bf16 v[44:47], a[84:87], a[52:55], v[44:47]
    buffer_load_dwordx4 v236, s[12:15], s36 offen offset:2048 lds
    v_mfma_f32_16x16x32_bf16 v[52:55], a[84:87], a[56:59], v[52:55]
    ds_read_b64_tr_b16 a[24:25], v226 offset:49152
    v_mfma_f32_16x16x32_bf16 v[60:63], a[84:87], a[60:63], v[60:63]
    buffer_load_dwordx4 v237, s[12:15], s36 offen offset:3072 lds
    v_mfma_f32_16x16x32_bf16 v[64:67], a[32:35], a[88:91], v[64:67]
    ds_read_b64_tr_b16 a[26:27], v226 offset:50176
    v_mfma_f32_16x16x32_bf16 v[68:71], a[36:39], a[88:91], v[68:71]
    s_add_u32 s36, s36, 524288
    v_mfma_f32_16x16x32_bf16 v[72:75], a[40:43], a[88:91], v[72:75]
    ds_read_b128 a[84:87], v232 offset:50176
    v_mfma_f32_16x16x32_bf16 v[76:79], a[44:47], a[88:91], v[76:79]
    s_add_u32 m0, s38, 69632
    v_mfma_f32_16x16x32_bf16 v[96:99], a[88:91], a[48:51], v[96:99]
    ds_read_b64_tr_b16 a[28:29], v227 offset:49152
    v_mfma_f32_16x16x32_bf16 v[104:107], a[88:91], a[52:55], v[104:107]
    buffer_load_dwordx4 v234, s[12:15], s37 offen offset:0 lds
    v_mfma_f32_16x16x32_bf16 v[112:115], a[88:91], a[56:59], v[112:115]
    ds_read_b64_tr_b16 a[30:31], v227 offset:50176
    v_mfma_f32_16x16x32_bf16 v[120:123], a[88:91], a[60:63], v[120:123]
    buffer_load_dwordx4 v235, s[12:15], s37 offen offset:1024 lds
    v_mfma_f32_16x16x32_bf16 v[80:83], a[32:35], a[92:95], v[80:83]
    v_mfma_f32_16x16x32_bf16 v[84:87], a[36:39], a[92:95], v[84:87]
    buffer_load_dwordx4 v236, s[12:15], s37 offen offset:2048 lds
    v_mfma_f32_16x16x32_bf16 v[88:91], a[40:43], a[92:95], v[88:91]
    ds_read_b128 a[88:91], v232 offset:53248
    v_mfma_f32_16x16x32_bf16 v[92:95], a[44:47], a[92:95], v[92:95]
    buffer_load_dwordx4 v237, s[12:15], s37 offen offset:3072 lds
    v_mfma_f32_16x16x32_bf16 v[100:103], a[92:95], a[48:51], v[100:103]
    v_mfma_f32_16x16x32_bf16 v[108:111], a[92:95], a[52:55], v[108:111]
    s_add_u32 s37, s37, 524288
    v_mfma_f32_16x16x32_bf16 v[116:119], a[92:95], a[56:59], v[116:119]
    v_mfma_f32_16x16x32_bf16 v[124:127], a[92:95], a[60:63], v[124:127]
    s_waitcnt lgkmcnt(1)
    v_mfma_f32_16x16x32_bf16 v[176:179], a[0:3], a[64:67], v[176:179]
    ds_read_b128 a[92:95], v232 offset:54272
    v_mfma_f32_16x16x32_bf16 v[180:183], a[4:7], a[64:67], v[180:183]
    buffer_load_dword v254, v240, s[8:11], s47 offen offset:768
    v_mfma_f32_16x16x32_bf16 v[184:187], a[8:11], a[64:67], v[184:187]
    ds_read_b64_tr_b16 a[32:33], v224 offset:40960
    v_mfma_f32_16x16x32_bf16 v[188:191], a[12:15], a[64:67], v[188:191]
    v_mfma_f32_16x16x32_bf16 v[128:131], a[64:67], a[16:19], v[128:131]
    ds_read_b64_tr_b16 a[34:35], v224 offset:41984
    v_mfma_f32_16x16x32_bf16 v[136:139], a[64:67], a[20:23], v[136:139]
    v_mfma_f32_16x16x32_bf16 v[144:147], a[64:67], a[24:27], v[144:147]
    v_mfma_f32_16x16x32_bf16 v[152:155], a[64:67], a[28:31], v[152:155]
    ds_read_b64_tr_b16 a[36:37], v225 offset:40960
    v_mfma_f32_16x16x32_bf16 v[160:163], a[0:3], a[68:71], v[160:163]
    v_mfma_f32_16x16x32_bf16 v[164:167], a[4:7], a[68:71], v[164:167]
    v_mfma_f32_16x16x32_bf16 v[168:171], a[8:11], a[68:71], v[168:171]
    ds_read_b128 a[64:67], v233 offset:32768
    v_mfma_f32_16x16x32_bf16 v[172:175], a[12:15], a[68:71], v[172:175]
    ds_read_b64_tr_b16 a[38:39], v225 offset:41984
    v_mfma_f32_16x16x32_bf16 v[132:135], a[68:71], a[16:19], v[132:135]
    v_mfma_f32_16x16x32_bf16 v[140:143], a[68:71], a[20:23], v[140:143]
    v_mfma_f32_16x16x32_bf16 v[148:151], a[68:71], a[24:27], v[148:151]
    ds_read_b64_tr_b16 a[40:41], v226 offset:40960
    v_mfma_f32_16x16x32_bf16 v[156:159], a[68:71], a[28:31], v[156:159]
    v_mfma_f32_16x16x32_bf16 v[192:195], a[0:3], a[72:75], v[192:195]
    v_mfma_f32_16x16x32_bf16 v[196:199], a[4:7], a[72:75], v[196:199]
    v_mfma_f32_16x16x32_bf16 v[200:203], a[8:11], a[72:75], v[200:203]
    ds_read_b128 a[68:71], v233 offset:33792
    v_mfma_f32_16x16x32_bf16 v[204:207], a[12:15], a[72:75], v[204:207]
    ds_read_b64_tr_b16 a[42:43], v226 offset:41984
    v_mfma_f32_16x16x32_bf16 a[96:99], a[72:75], a[16:19], a[96:99]
    v_mfma_f32_16x16x32_bf16 a[104:107], a[72:75], a[20:23], a[104:107]
    s_add_u32 s3, s58, 3145728
    buffer_load_dword v254, v241, s[12:15], s3 offen
    v_mfma_f32_16x16x32_bf16 a[112:115], a[72:75], a[24:27], a[112:115]
    ds_read_b64_tr_b16 a[44:45], v227 offset:40960
    v_mfma_f32_16x16x32_bf16 a[120:123], a[72:75], a[28:31], a[120:123]
    v_mfma_f32_16x16x32_bf16 v[208:211], a[0:3], a[76:79], v[208:211]
    v_mfma_f32_16x16x32_bf16 v[212:215], a[4:7], a[76:79], v[212:215]
    ds_read_b64_tr_b16 a[46:47], v227 offset:41984
    v_mfma_f32_16x16x32_bf16 v[216:219], a[8:11], a[76:79], v[216:219]
    ds_read_b128 a[72:75], v233 offset:36864
    v_mfma_f32_16x16x32_bf16 v[220:223], a[12:15], a[76:79], v[220:223]
    v_mfma_f32_16x16x32_bf16 a[100:103], a[76:79], a[16:19], a[100:103]
    ds_read_b64_tr_b16 a[48:49], v224 offset:57344
    v_mfma_f32_16x16x32_bf16 a[108:111], a[76:79], a[20:23], a[108:111]
    v_mfma_f32_16x16x32_bf16 a[116:119], a[76:79], a[24:27], a[116:119]
    v_mfma_f32_16x16x32_bf16 a[124:127], a[76:79], a[28:31], a[124:127]
    s_waitcnt lgkmcnt(12)
    v_mfma_f32_16x16x32_bf16 v[0:3], a[0:3], a[80:83], v[0:3]
    ds_read_b64_tr_b16 a[50:51], v224 offset:58368
    v_mfma_f32_16x16x32_bf16 v[4:7], a[4:7], a[80:83], v[4:7]
    v_mfma_f32_16x16x32_bf16 v[8:11], a[8:11], a[80:83], v[8:11]
    ds_read_b128 a[76:79], v233 offset:37888
    v_mfma_f32_16x16x32_bf16 v[12:15], a[12:15], a[80:83], v[12:15]
    ds_read_b64_tr_b16 a[52:53], v225 offset:57344
    v_mfma_f32_16x16x32_bf16 v[32:35], a[80:83], a[16:19], v[32:35]
    v_mfma_f32_16x16x32_bf16 v[40:43], a[80:83], a[20:23], v[40:43]
    v_mfma_f32_16x16x32_bf16 v[48:51], a[80:83], a[24:27], v[48:51]
    ds_read_b64_tr_b16 a[54:55], v225 offset:58368
    v_mfma_f32_16x16x32_bf16 v[56:59], a[80:83], a[28:31], v[56:59]
    v_mfma_f32_16x16x32_bf16 v[16:19], a[0:3], a[84:87], v[16:19]
    v_mfma_f32_16x16x32_bf16 v[20:23], a[4:7], a[84:87], v[20:23]
    v_mfma_f32_16x16x32_bf16 v[24:27], a[8:11], a[84:87], v[24:27]
    ds_read_b128 a[80:83], v233 offset:49152
    v_mfma_f32_16x16x32_bf16 v[28:31], a[12:15], a[84:87], v[28:31]
    s_lshr_b32 s3, s94, 1
    s_lshl_b32 s3, s3, 19
    s_add_u32 s3, s3, s58
    s_add_u32 s3, s3, 2097152
    buffer_load_dword v254, v241, s[28:31], s3 offen
    v_mfma_f32_16x16x32_bf16 v[36:39], a[84:87], a[16:19], v[36:39]
    ds_read_b64_tr_b16 a[56:57], v226 offset:57344
    v_mfma_f32_16x16x32_bf16 v[44:47], a[84:87], a[20:23], v[44:47]
    ds_read_b64_tr_b16 a[58:59], v226 offset:58368
    v_mfma_f32_16x16x32_bf16 v[52:55], a[84:87], a[24:27], v[52:55]
    v_mfma_f32_16x16x32_bf16 v[60:63], a[84:87], a[28:31], v[60:63]
    v_mfma_f32_16x16x32_bf16 v[64:67], a[0:3], a[88:91], v[64:67]
    v_mfma_f32_16x16x32_bf16 v[68:71], a[4:7], a[88:91], v[68:71]
    ds_read_b64_tr_b16 a[60:61], v227 offset:57344
    v_mfma_f32_16x16x32_bf16 v[72:75], a[8:11], a[88:91], v[72:75]
    ds_read_b128 a[84:87], v233 offset:50176
    v_mfma_f32_16x16x32_bf16 v[76:79], a[12:15], a[88:91], v[76:79]
    v_mfma_f32_16x16x32_bf16 v[96:99], a[88:91], a[16:19], v[96:99]
    ds_read_b64_tr_b16 a[62:63], v227 offset:58368
    v_mfma_f32_16x16x32_bf16 v[104:107], a[88:91], a[20:23], v[104:107]
    v_mfma_f32_16x16x32_bf16 v[112:115], a[88:91], a[24:27], v[112:115]
    v_mfma_f32_16x16x32_bf16 v[120:123], a[88:91], a[28:31], v[120:123]
    v_mfma_f32_16x16x32_bf16 v[80:83], a[0:3], a[92:95], v[80:83]
    v_mfma_f32_16x16x32_bf16 v[84:87], a[4:7], a[92:95], v[84:87]
    v_mfma_f32_16x16x32_bf16 v[88:91], a[8:11], a[92:95], v[88:91]
    ds_read_b128 a[88:91], v233 offset:53248
    v_mfma_f32_16x16x32_bf16 v[92:95], a[12:15], a[92:95], v[92:95]
    v_mfma_f32_16x16x32_bf16 v[100:103], a[92:95], a[16:19], v[100:103]
    v_mfma_f32_16x16x32_bf16 v[108:111], a[92:95], a[20:23], v[108:111]
    v_mfma_f32_16x16x32_bf16 v[116:119], a[92:95], a[24:27], v[116:119]
    v_mfma_f32_16x16x32_bf16 v[124:127], a[92:95], a[28:31], v[124:127]
    s_waitcnt lgkmcnt(1)
    v_mfma_f32_16x16x32_bf16 v[176:179], a[32:35], a[64:67], v[176:179]
    ds_read_b128 a[92:95], v233 offset:54272
    v_mfma_f32_16x16x32_bf16 v[180:183], a[36:39], a[64:67], v[180:183]
    v_mfma_f32_16x16x32_bf16 v[184:187], a[40:43], a[64:67], v[184:187]
    v_mfma_f32_16x16x32_bf16 v[188:191], a[44:47], a[64:67], v[188:191]
    v_mfma_f32_16x16x32_bf16 v[128:131], a[64:67], a[48:51], v[128:131]
    v_mfma_f32_16x16x32_bf16 v[136:139], a[64:67], a[52:55], v[136:139]
    v_mfma_f32_16x16x32_bf16 v[144:147], a[64:67], a[56:59], v[144:147]
    v_mfma_f32_16x16x32_bf16 v[152:155], a[64:67], a[60:63], v[152:155]
    v_mfma_f32_16x16x32_bf16 v[160:163], a[32:35], a[68:71], v[160:163]
    v_mfma_f32_16x16x32_bf16 v[164:167], a[36:39], a[68:71], v[164:167]
    v_mfma_f32_16x16x32_bf16 v[168:171], a[40:43], a[68:71], v[168:171]
    v_mfma_f32_16x16x32_bf16 v[172:175], a[44:47], a[68:71], v[172:175]
    v_mfma_f32_16x16x32_bf16 v[132:135], a[68:71], a[48:51], v[132:135]
    v_mfma_f32_16x16x32_bf16 v[140:143], a[68:71], a[52:55], v[140:143]
    v_mfma_f32_16x16x32_bf16 v[148:151], a[68:71], a[56:59], v[148:151]
    v_mfma_f32_16x16x32_bf16 v[156:159], a[68:71], a[60:63], v[156:159]
    s_add_u32 m0, s38, 32768
    s_waitcnt vmcnt(3) lgkmcnt(0)
    s_barrier
    v_mfma_f32_16x16x32_bf16 v[192:195], a[32:35], a[72:75], v[192:195]
    buffer_load_dwordx4 v228, s[8:11], s34 offen offset:0 lds
    v_mfma_f32_16x16x32_bf16 v[196:199], a[36:39], a[72:75], v[196:199]
    ds_read_b64_tr_b16 a[0:1], v224 offset:0
    v_mfma_f32_16x16x32_bf16 v[200:203], a[40:43], a[72:75], v[200:203]
    ds_read_b128 a[64:67], v232 offset:0
    v_mfma_f32_16x16x32_bf16 v[204:207], a[44:47], a[72:75], v[204:207]
    buffer_load_dwordx4 v229, s[8:11], s34 offen offset:1024 lds
    v_mfma_f32_16x16x32_bf16 a[96:99], a[72:75], a[48:51], a[96:99]
    ds_read_b128 a[68:71], v232 offset:1024
    ds_read_b64_tr_b16 a[2:3], v224 offset:1024
    v_mfma_f32_16x16x32_bf16 a[104:107], a[72:75], a[52:55], a[104:107]
    buffer_load_dwordx4 v230, s[8:11], s34 offen offset:2048 lds
    v_mfma_f32_16x16x32_bf16 a[112:115], a[72:75], a[56:59], a[112:115]
    buffer_load_dwordx4 v231, s[8:11], s34 offen offset:3072 lds
    v_mfma_f32_16x16x32_bf16 a[120:123], a[72:75], a[60:63], a[120:123]
    ds_read_b64_tr_b16 a[4:5], v225 offset:0
    v_mfma_f32_16x16x32_bf16 v[208:211], a[32:35], a[76:79], v[208:211]
    s_add_u32 s34, s34, 128
    v_mfma_f32_16x16x32_bf16 v[212:215], a[36:39], a[76:79], v[212:215]
    ds_read_b64_tr_b16 a[6:7], v225 offset:1024
    v_mfma_f32_16x16x32_bf16 v[216:219], a[40:43], a[76:79], v[216:219]
    ds_read_b128 a[72:75], v232 offset:4096
    v_mfma_f32_16x16x32_bf16 v[220:223], a[44:47], a[76:79], v[220:223]
    s_add_u32 m0, s38, 36864
    v_mfma_f32_16x16x32_bf16 a[100:103], a[76:79], a[48:51], a[100:103]
    buffer_load_dwordx4 v228, s[8:11], s35 offen offset:0 lds
    v_mfma_f32_16x16x32_bf16 a[108:111], a[76:79], a[52:55], a[108:111]
    ds_read_b64_tr_b16 a[8:9], v226 offset:0
    v_mfma_f32_16x16x32_bf16 a[116:119], a[76:79], a[56:59], a[116:119]
    buffer_load_dwordx4 v229, s[8:11], s35 offen offset:1024 lds
    v_mfma_f32_16x16x32_bf16 a[124:127], a[76:79], a[60:63], a[124:127]
    ds_read_b64_tr_b16 a[10:11], v226 offset:1024
    v_mfma_f32_16x16x32_bf16 v[0:3], a[32:35], a[80:83], v[0:3]
    buffer_load_dwordx4 v230, s[8:11], s35 offen offset:2048 lds
    v_mfma_f32_16x16x32_bf16 v[4:7], a[36:39], a[80:83], v[4:7]
    ds_read_b64_tr_b16 a[12:13], v227 offset:0
    v_mfma_f32_16x16x32_bf16 v[8:11], a[40:43], a[80:83], v[8:11]
    ds_read_b128 a[76:79], v232 offset:5120
    ds_read_b64_tr_b16 a[14:15], v227 offset:1024
    v_mfma_f32_16x16x32_bf16 v[12:15], a[44:47], a[80:83], v[12:15]
    buffer_load_dwordx4 v231, s[8:11], s35 offen offset:3072 lds
    v_mfma_f32_16x16x32_bf16 v[32:35], a[80:83], a[48:51], v[32:35]
    s_add_u32 s35, s35, 128
    v_mfma_f32_16x16x32_bf16 v[40:43], a[80:83], a[52:55], v[40:43]
    ds_read_b64_tr_b16 a[16:17], v224 offset:16384
    v_mfma_f32_16x16x32_bf16 v[48:51], a[80:83], a[56:59], v[48:51]
    s_add_u32 m0, s38, 98304
    v_mfma_f32_16x16x32_bf16 v[56:59], a[80:83], a[60:63], v[56:59]
    ds_read_b64_tr_b16 a[18:19], v224 offset:17408
    v_mfma_f32_16x16x32_bf16 v[16:19], a[32:35], a[84:87], v[16:19]
    v_mfma_f32_16x16x32_bf16 v[20:23], a[36:39], a[84:87], v[20:23]
    buffer_load_dwordx4 v234, s[12:15], s36 offen offset:0 lds
    v_mfma_f32_16x16x32_bf16 v[24:27], a[40:43], a[84:87], v[24:27]
    ds_read_b128 a[80:83], v232 offset:16384
    ds_read_b64_tr_b16 a[20:21], v225 offset:16384
    v_mfma_f32_16x16x32_bf16 v[28:31], a[44:47], a[84:87], v[28:31]
    buffer_load_dwordx4 v235, s[12:15], s36 offen offset:1024 lds
    v_mfma_f32_16x16x32_bf16 v[36:39], a[84:87], a[48:51], v[36:39]
    ds_read_b64_tr_b16 a[22:23], v225 offset:17408
    v_mfma_f32_16x16x32_bf16 v[44:47], a[84:87], a[52:55], v[44:47]
    buffer_load_dwordx4 v236, s[12:15], s36 offen offset:2048 lds
    v_mfma_f32_16x16x32_bf16 v[52:55], a[84:87], a[56:59], v[52:55]
    ds_read_b64_tr_b16 a[24:25], v226 offset:16384
    v_mfma_f32_16x16x32_bf16 v[60:63], a[84:87], a[60:63], v[60:63]
    buffer_load_dwordx4 v237, s[12:15], s36 offen offset:3072 lds
    v_mfma_f32_16x16x32_bf16 v[64:67], a[32:35], a[88:91], v[64:67]
    ds_read_b64_tr_b16 a[26:27], v226 offset:17408
    v_mfma_f32_16x16x32_bf16 v[68:71], a[36:39], a[88:91], v[68:71]
    s_add_u32 s36, s36, 524288
    v_mfma_f32_16x16x32_bf16 v[72:75], a[40:43], a[88:91], v[72:75]
    ds_read_b128 a[84:87], v232 offset:17408
    v_mfma_f32_16x16x32_bf16 v[76:79], a[44:47], a[88:91], v[76:79]
    s_add_u32 m0, s38, 102400
    v_mfma_f32_16x16x32_bf16 v[96:99], a[88:91], a[48:51], v[96:99]
    ds_read_b64_tr_b16 a[28:29], v227 offset:16384
    v_mfma_f32_16x16x32_bf16 v[104:107], a[88:91], a[52:55], v[104:107]
    buffer_load_dwordx4 v234, s[12:15], s37 offen offset:0 lds
    v_mfma_f32_16x16x32_bf16 v[112:115], a[88:91], a[56:59], v[112:115]
    ds_read_b64_tr_b16 a[30:31], v227 offset:17408
    v_mfma_f32_16x16x32_bf16 v[120:123], a[88:91], a[60:63], v[120:123]
    buffer_load_dwordx4 v235, s[12:15], s37 offen offset:1024 lds
    v_mfma_f32_16x16x32_bf16 v[80:83], a[32:35], a[92:95], v[80:83]
    v_mfma_f32_16x16x32_bf16 v[84:87], a[36:39], a[92:95], v[84:87]
    buffer_load_dwordx4 v236, s[12:15], s37 offen offset:2048 lds
    v_mfma_f32_16x16x32_bf16 v[88:91], a[40:43], a[92:95], v[88:91]
    ds_read_b128 a[88:91], v232 offset:20480
    v_mfma_f32_16x16x32_bf16 v[92:95], a[44:47], a[92:95], v[92:95]
    buffer_load_dwordx4 v237, s[12:15], s37 offen offset:3072 lds
    v_mfma_f32_16x16x32_bf16 v[100:103], a[92:95], a[48:51], v[100:103]
    v_mfma_f32_16x16x32_bf16 v[108:111], a[92:95], a[52:55], v[108:111]
    s_add_u32 s37, s37, 524288
    v_mfma_f32_16x16x32_bf16 v[116:119], a[92:95], a[56:59], v[116:119]
    v_mfma_f32_16x16x32_bf16 v[124:127], a[92:95], a[60:63], v[124:127]
    s_waitcnt lgkmcnt(1)
    v_mfma_f32_16x16x32_bf16 v[176:179], a[0:3], a[64:67], v[176:179]
    ds_read_b128 a[92:95], v232 offset:21504
    v_mfma_f32_16x16x32_bf16 v[180:183], a[4:7], a[64:67], v[180:183]
    buffer_load_dword v254, v240, s[8:11], s47 offen offset:896
    v_mfma_f32_16x16x32_bf16 v[184:187], a[8:11], a[64:67], v[184:187]
    ds_read_b64_tr_b16 a[32:33], v224 offset:8192
    v_mfma_f32_16x16x32_bf16 v[188:191], a[12:15], a[64:67], v[188:191]
    v_mfma_f32_16x16x32_bf16 v[128:131], a[64:67], a[16:19], v[128:131]
    ds_read_b64_tr_b16 a[34:35], v224 offset:9216
    v_mfma_f32_16x16x32_bf16 v[136:139], a[64:67], a[20:23], v[136:139]
    v_mfma_f32_16x16x32_bf16 v[144:147], a[64:67], a[24:27], v[144:147]
    v_mfma_f32_16x16x32_bf16 v[152:155], a[64:67], a[28:31], v[152:155]
    ds_read_b64_tr_b16 a[36:37], v225 offset:8192
    v_mfma_f32_16x16x32_bf16 v[160:163], a[0:3], a[68:71], v[160:163]
    v_mfma_f32_16x16x32_bf16 v[164:167], a[4:7], a[68:71], v[164:167]
    v_mfma_f32_16x16x32_bf16 v[168:171], a[8:11], a[68:71], v[168:171]
    ds_read_b128 a[64:67], v233 offset:0
    v_mfma_f32_16x16x32_bf16 v[172:175], a[12:15], a[68:71], v[172:175]
    ds_read_b64_tr_b16 a[38:39], v225 offset:9216
    v_mfma_f32_16x16x32_bf16 v[132:135], a[68:71], a[16:19], v[132:135]
    v_mfma_f32_16x16x32_bf16 v[140:143], a[68:71], a[20:23], v[140:143]
    v_mfma_f32_16x16x32_bf16 v[148:151], a[68:71], a[24:27], v[148:151]
    ds_read_b64_tr_b16 a[40:41], v226 offset:8192
    v_mfma_f32_16x16x32_bf16 v[156:159], a[68:71], a[28:31], v[156:159]
    v_mfma_f32_16x16x32_bf16 v[192:195], a[0:3], a[72:75], v[192:195]
    s_add_u32 s3, s58, 3670016
    buffer_load_dword v254, v241, s[12:15], s3 offen
    v_mfma_f32_16x16x32_bf16 v[196:199], a[4:7], a[72:75], v[196:199]
    v_mfma_f32_16x16x32_bf16 v[200:203], a[8:11], a[72:75], v[200:203]
    ds_read_b128 a[68:71], v233 offset:1024
    v_mfma_f32_16x16x32_bf16 v[204:207], a[12:15], a[72:75], v[204:207]
    ds_read_b64_tr_b16 a[42:43], v226 offset:9216
    v_mfma_f32_16x16x32_bf16 a[96:99], a[72:75], a[16:19], a[96:99]
    v_mfma_f32_16x16x32_bf16 a[104:107], a[72:75], a[20:23], a[104:107]
    ds_read_b64_tr_b16 a[44:45], v227 offset:8192
    v_mfma_f32_16x16x32_bf16 a[112:115], a[72:75], a[24:27], a[112:115]
    v_mfma_f32_16x16x32_bf16 a[120:123], a[72:75], a[28:31], a[120:123]
    v_mfma_f32_16x16x32_bf16 v[208:211], a[0:3], a[76:79], v[208:211]
    v_mfma_f32_16x16x32_bf16 v[212:215], a[4:7], a[76:79], v[212:215]
    ds_read_b64_tr_b16 a[46:47], v227 offset:9216
    v_mfma_f32_16x16x32_bf16 v[216:219], a[8:11], a[76:79], v[216:219]
    ds_read_b128 a[72:75], v233 offset:4096
    v_mfma_f32_16x16x32_bf16 v[220:223], a[12:15], a[76:79], v[220:223]
    v_mfma_f32_16x16x32_bf16 a[100:103], a[76:79], a[16:19], a[100:103]
    ds_read_b64_tr_b16 a[48:49], v224 offset:24576
    v_mfma_f32_16x16x32_bf16 a[108:111], a[76:79], a[20:23], a[108:111]
    v_mfma_f32_16x16x32_bf16 a[116:119], a[76:79], a[24:27], a[116:119]
    v_mfma_f32_16x16x32_bf16 a[124:127], a[76:79], a[28:31], a[124:127]
    s_waitcnt lgkmcnt(12)
    v_mfma_f32_16x16x32_bf16 v[0:3], a[0:3], a[80:83], v[0:3]
    s_lshr_b32 s3, s94, 1
    s_lshl_b32 s3, s3, 19
    s_add_u32 s3, s3, s58
    s_add_u32 s3, s3, 3145728
    buffer_load_dword v254, v241, s[28:31], s3 offen
    v_mfma_f32_16x16x32_bf16 v[4:7], a[4:7], a[80:83], v[4:7]
    ds_read_b64_tr_b16 a[50:51], v224 offset:25600
    v_mfma_f32_16x16x32_bf16 v[8:11], a[8:11], a[80:83], v[8:11]
    ds_read_b128 a[76:79], v233 offset:5120
    v_mfma_f32_16x16x32_bf16 v[12:15], a[12:15], a[80:83], v[12:15]
    ds_read_b64_tr_b16 a[52:53], v225 offset:24576
    v_mfma_f32_16x16x32_bf16 v[32:35], a[80:83], a[16:19], v[32:35]
    v_mfma_f32_16x16x32_bf16 v[40:43], a[80:83], a[20:23], v[40:43]
    v_mfma_f32_16x16x32_bf16 v[48:51], a[80:83], a[24:27], v[48:51]
    ds_read_b64_tr_b16 a[54:55], v225 offset:25600
    v_mfma_f32_16x16x32_bf16 v[56:59], a[80:83], a[28:31], v[56:59]
    v_mfma_f32_16x16x32_bf16 v[16:19], a[0:3], a[84:87], v[16:19]
    v_mfma_f32_16x16x32_bf16 v[20:23], a[4:7], a[84:87], v[20:23]
    v_mfma_f32_16x16x32_bf16 v[24:27], a[8:11], a[84:87], v[24:27]
    ds_read_b128 a[80:83], v233 offset:16384
    v_mfma_f32_16x16x32_bf16 v[28:31], a[12:15], a[84:87], v[28:31]
    ds_read_b64_tr_b16 a[56:57], v226 offset:24576
    v_mfma_f32_16x16x32_bf16 v[36:39], a[84:87], a[16:19], v[36:39]
    v_mfma_f32_16x16x32_bf16 v[44:47], a[84:87], a[20:23], v[44:47]
    ds_read_b64_tr_b16 a[58:59], v226 offset:25600
    v_mfma_f32_16x16x32_bf16 v[52:55], a[84:87], a[24:27], v[52:55]
    v_mfma_f32_16x16x32_bf16 v[60:63], a[84:87], a[28:31], v[60:63]
    v_mfma_f32_16x16x32_bf16 v[64:67], a[0:3], a[88:91], v[64:67]
    v_and_b32 v239, 64, v238
    v_cmp_eq_u32 vcc, 0, v239
    v_mov_b32 v252, s41
    v_mov_b32 v253, s40
    v_cndmask_b32 v239, v252, v253, vcc
    v_lshrrev_b32 v239, 10, v239
    v_bfe_u32 v252, v238, 4, 2
    v_lshl_add_u32 v239, v252, 3, v239
    buffer_load_dwordx2 v[252:253], v239, s[64:67], 0 offen sc1
    v_mfma_f32_16x16x32_bf16 v[68:71], a[4:7], a[88:91], v[68:71]
    ds_read_b64_tr_b16 a[60:61], v227 offset:24576
    v_mfma_f32_16x16x32_bf16 v[72:75], a[8:11], a[88:91], v[72:75]
    ds_read_b128 a[84:87], v233 offset:17408
    v_mfma_f32_16x16x32_bf16 v[76:79], a[12:15], a[88:91], v[76:79]
    v_mfma_f32_16x16x32_bf16 v[96:99], a[88:91], a[16:19], v[96:99]
    ds_read_b64_tr_b16 a[62:63], v227 offset:25600
    v_mfma_f32_16x16x32_bf16 v[104:107], a[88:91], a[20:23], v[104:107]
    v_mfma_f32_16x16x32_bf16 v[112:115], a[88:91], a[24:27], v[112:115]
    v_mfma_f32_16x16x32_bf16 v[120:123], a[88:91], a[28:31], v[120:123]
    v_mfma_f32_16x16x32_bf16 v[80:83], a[0:3], a[92:95], v[80:83]
    v_mfma_f32_16x16x32_bf16 v[84:87], a[4:7], a[92:95], v[84:87]
    v_mfma_f32_16x16x32_bf16 v[88:91], a[8:11], a[92:95], v[88:91]
    ds_read_b128 a[88:91], v233 offset:20480
    v_mfma_f32_16x16x32_bf16 v[92:95], a[12:15], a[92:95], v[92:95]
    v_mfma_f32_16x16x32_bf16 v[100:103], a[92:95], a[16:19], v[100:103]
    v_mfma_f32_16x16x32_bf16 v[108:111], a[92:95], a[20:23], v[108:111]
    v_mfma_f32_16x16x32_bf16 v[116:119], a[92:95], a[24:27], v[116:119]
    v_mfma_f32_16x16x32_bf16 v[124:127], a[92:95], a[28:31], v[124:127]
    s_waitcnt lgkmcnt(1)
    v_mfma_f32_16x16x32_bf16 v[176:179], a[32:35], a[64:67], v[176:179]
    ds_read_b128 a[92:95], v233 offset:21504
    v_mfma_f32_16x16x32_bf16 v[180:183], a[36:39], a[64:67], v[180:183]
    v_mfma_f32_16x16x32_bf16 v[184:187], a[40:43], a[64:67], v[184:187]
    v_mfma_f32_16x16x32_bf16 v[188:191], a[44:47], a[64:67], v[188:191]
    v_mfma_f32_16x16x32_bf16 v[128:131], a[64:67], a[48:51], v[128:131]
    v_mfma_f32_16x16x32_bf16 v[136:139], a[64:67], a[52:55], v[136:139]
    v_mfma_f32_16x16x32_bf16 v[144:147], a[64:67], a[56:59], v[144:147]
    v_mfma_f32_16x16x32_bf16 v[152:155], a[64:67], a[60:63], v[152:155]
    v_mfma_f32_16x16x32_bf16 v[160:163], a[32:35], a[68:71], v[160:163]
    v_mfma_f32_16x16x32_bf16 v[164:167], a[36:39], a[68:71], v[164:167]
    v_mfma_f32_16x16x32_bf16 v[168:171], a[40:43], a[68:71], v[168:171]
    v_mfma_f32_16x16x32_bf16 v[172:175], a[44:47], a[68:71], v[172:175]
    v_mfma_f32_16x16x32_bf16 v[132:135], a[68:71], a[48:51], v[132:135]
    v_mfma_f32_16x16x32_bf16 v[140:143], a[68:71], a[52:55], v[140:143]
    v_mfma_f32_16x16x32_bf16 v[148:151], a[68:71], a[56:59], v[148:151]
    v_mfma_f32_16x16x32_bf16 v[156:159], a[68:71], a[60:63], v[156:159]
    s_add_u32 m0, s38, 0
    s_waitcnt vmcnt(4) lgkmcnt(0)
    s_barrier
    v_mfma_f32_16x16x32_bf16 v[192:195], a[32:35], a[72:75], v[192:195]
    buffer_load_dwordx4 v228, s[8:11], s34 offen offset:0 lds
    v_mfma_f32_16x16x32_bf16 v[196:199], a[36:39], a[72:75], v[196:199]
    ds_read_b64_tr_b16 a[0:1], v224 offset:32768
    v_mfma_f32_16x16x32_bf16 v[200:203], a[40:43], a[72:75], v[200:203]
    ds_read_b128 a[64:67], v232 offset:32768
    v_mfma_f32_16x16x32_bf16 v[204:207], a[44:47], a[72:75], v[204:207]
    buffer_load_dwordx4 v229, s[8:11], s34 offen offset:1024 lds
    v_mfma_f32_16x16x32_bf16 a[96:99], a[72:75], a[48:51], a[96:99]
    ds_read_b128 a[68:71], v232 offset:33792
    ds_read_b64_tr_b16 a[2:3], v224 offset:33792
    v_mfma_f32_16x16x32_bf16 a[104:107], a[72:75], a[52:55], a[104:107]
    buffer_load_dwordx4 v230, s[8:11], s34 offen offset:2048 lds
    v_mfma_f32_16x16x32_bf16 a[112:115], a[72:75], a[56:59], a[112:115]
    buffer_load_dwordx4 v231, s[8:11], s34 offen offset:3072 lds
    v_mfma_f32_16x16x32_bf16 a[120:123], a[72:75], a[60:63], a[120:123]
    ds_read_b64_tr_b16 a[4:5], v225 offset:32768
    v_mfma_f32_16x16x32_bf16 v[208:211], a[32:35], a[76:79], v[208:211]
    s_add_u32 s34, s34, 128
    v_mfma_f32_16x16x32_bf16 v[212:215], a[36:39], a[76:79], v[212:215]
    ds_read_b64_tr_b16 a[6:7], v225 offset:33792
    v_mfma_f32_16x16x32_bf16 v[216:219], a[40:43], a[76:79], v[216:219]
    ds_read_b128 a[72:75], v232 offset:36864
    v_mfma_f32_16x16x32_bf16 v[220:223], a[44:47], a[76:79], v[220:223]
    s_add_u32 m0, s38, 4096
    v_mfma_f32_16x16x32_bf16 a[100:103], a[76:79], a[48:51], a[100:103]
    buffer_load_dwordx4 v228, s[8:11], s35 offen offset:0 lds
    v_mfma_f32_16x16x32_bf16 a[108:111], a[76:79], a[52:55], a[108:111]
    ds_read_b64_tr_b16 a[8:9], v226 offset:32768
    v_mfma_f32_16x16x32_bf16 a[116:119], a[76:79], a[56:59], a[116:119]
    buffer_load_dwordx4 v229, s[8:11], s35 offen offset:1024 lds
    v_mfma_f32_16x16x32_bf16 a[124:127], a[76:79], a[60:63], a[124:127]
    ds_read_b64_tr_b16 a[10:11], v226 offset:33792
    v_mfma_f32_16x16x32_bf16 v[0:3], a[32:35], a[80:83], v[0:3]
    buffer_load_dwordx4 v230, s[8:11], s35 offen offset:2048 lds
    v_mfma_f32_16x16x32_bf16 v[4:7], a[36:39], a[80:83], v[4:7]
    ds_read_b64_tr_b16 a[12:13], v227 offset:32768
    v_mfma_f32_16x16x32_bf16 v[8:11], a[40:43], a[80:83], v[8:11]
    ds_read_b128 a[76:79], v232 offset:37888
    ds_read_b64_tr_b16 a[14:15], v227 offset:33792
    v_mfma_f32_16x16x32_bf16 v[12:15], a[44:47], a[80:83], v[12:15]
    buffer_load_dwordx4 v231, s[8:11], s35 offen offset:3072 lds
    v_mfma_f32_16x16x32_bf16 v[32:35], a[80:83], a[48:51], v[32:35]
    s_add_u32 s35, s35, 128
    v_mfma_f32_16x16x32_bf16 v[40:43], a[80:83], a[52:55], v[40:43]
    ds_read_b64_tr_b16 a[16:17], v224 offset:49152
    v_mfma_f32_16x16x32_bf16 v[48:51], a[80:83], a[56:59], v[48:51]
    s_add_u32 m0, s38, 65536
    v_mfma_f32_16x16x32_bf16 v[56:59], a[80:83], a[60:63], v[56:59]
    ds_read_b64_tr_b16 a[18:19], v224 offset:50176
    v_mfma_f32_16x16x32_bf16 v[16:19], a[32:35], a[84:87], v[16:19]
    v_mfma_f32_16x16x32_bf16 v[20:23], a[36:39], a[84:87], v[20:23]
    buffer_load_dwordx4 v234, s[12:15], s36 offen offset:0 lds
    v_mfma_f32_16x16x32_bf16 v[24:27], a[40:43], a[84:87], v[24:27]
    ds_read_b128 a[80:83], v232 offset:49152
    ds_read_b64_tr_b16 a[20:21], v225 offset:49152
    v_mfma_f32_16x16x32_bf16 v[28:31], a[44:47], a[84:87], v[28:31]
    buffer_load_dwordx4 v235, s[12:15], s36 offen offset:1024 lds
    v_mfma_f32_16x16x32_bf16 v[36:39], a[84:87], a[48:51], v[36:39]
    ds_read_b64_tr_b16 a[22:23], v225 offset:50176
    v_mfma_f32_16x16x32_bf16 v[44:47], a[84:87], a[52:55], v[44:47]
    buffer_load_dwordx4 v236, s[12:15], s36 offen offset:2048 lds
    v_mfma_f32_16x16x32_bf16 v[52:55], a[84:87], a[56:59], v[52:55]
    ds_read_b64_tr_b16 a[24:25], v226 offset:49152
    v_mfma_f32_16x16x32_bf16 v[60:63], a[84:87], a[60:63], v[60:63]
    buffer_load_dwordx4 v237, s[12:15], s36 offen offset:3072 lds
    v_mfma_f32_16x16x32_bf16 v[64:67], a[32:35], a[88:91], v[64:67]
    ds_read_b64_tr_b16 a[26:27], v226 offset:50176
    v_mfma_f32_16x16x32_bf16 v[68:71], a[36:39], a[88:91], v[68:71]
    s_add_u32 s36, s36, 524288
    v_mfma_f32_16x16x32_bf16 v[72:75], a[40:43], a[88:91], v[72:75]
    ds_read_b128 a[84:87], v232 offset:50176
    v_mfma_f32_16x16x32_bf16 v[76:79], a[44:47], a[88:91], v[76:79]
    s_add_u32 m0, s38, 69632
    v_mfma_f32_16x16x32_bf16 v[96:99], a[88:91], a[48:51], v[96:99]
    ds_read_b64_tr_b16 a[28:29], v227 offset:49152
    v_mfma_f32_16x16x32_bf16 v[104:107], a[88:91], a[52:55], v[104:107]
    buffer_load_dwordx4 v234, s[12:15], s37 offen offset:0 lds
    v_mfma_f32_16x16x32_bf16 v[112:115], a[88:91], a[56:59], v[112:115]
    ds_read_b64_tr_b16 a[30:31], v227 offset:50176
    v_mfma_f32_16x16x32_bf16 v[120:123], a[88:91], a[60:63], v[120:123]
    buffer_load_dwordx4 v235, s[12:15], s37 offen offset:1024 lds
    v_mfma_f32_16x16x32_bf16 v[80:83], a[32:35], a[92:95], v[80:83]
    v_mfma_f32_16x16x32_bf16 v[84:87], a[36:39], a[92:95], v[84:87]
    buffer_load_dwordx4 v236, s[12:15], s37 offen offset:2048 lds
    v_mfma_f32_16x16x32_bf16 v[88:91], a[40:43], a[92:95], v[88:91]
    ds_read_b128 a[88:91], v232 offset:53248
    v_mfma_f32_16x16x32_bf16 v[92:95], a[44:47], a[92:95], v[92:95]
    buffer_load_dwordx4 v237, s[12:15], s37 offen offset:3072 lds
    v_mfma_f32_16x16x32_bf16 v[100:103], a[92:95], a[48:51], v[100:103]
    v_mfma_f32_16x16x32_bf16 v[108:111], a[92:95], a[52:55], v[108:111]
    s_add_u32 s37, s37, 524288
    v_mfma_f32_16x16x32_bf16 v[116:119], a[92:95], a[56:59], v[116:119]
    v_mfma_f32_16x16x32_bf16 v[124:127], a[92:95], a[60:63], v[124:127]
    s_waitcnt lgkmcnt(1)
    v_mfma_f32_16x16x32_bf16 v[176:179], a[0:3], a[64:67], v[176:179]
    ds_read_b128 a[92:95], v232 offset:54272
    v_mfma_f32_16x16x32_bf16 v[180:183], a[4:7], a[64:67], v[180:183]
    s_lshr_b32 s3, s2, 3
    s_lshl_b32 s3, s3, 2
    s_add_u32 s3, s3, s94
    s_cmp_ge_u32 s3, 5
    s_cbranch_scc1 ct_6
    s_getpc_b64 s[4:5]
pc_7:
    s_add_u32 s4, s4, Q_code-pc_7
    s_addc_u32 s5, s5, 0
    s_lshl_b32 s3, s3, 13
    v_lshl_add_u32 v242, v238, 3, s3
    global_load_dword v254, v242, s[4:5]
ct_6:
    v_mfma_f32_16x16x32_bf16 v[184:187], a[8:11], a[64:67], v[184:187]
    ds_read_b64_tr_b16 a[32:33], v224 offset:40960
    v_mfma_f32_16x16x32_bf16 v[188:191], a[12:15], a[64:67], v[188:191]
    v_mfma_f32_16x16x32_bf16 v[128:131], a[64:67], a[16:19], v[128:131]
    s_waitcnt vmcnt(16)
    v_cmp_ne_u64 vcc, s[96:97], v[252:253]
    s_cbranch_vccnz spin_9
ok_8:
    v_mfma_f32_16x16x32_bf16 v[136:139], a[64:67], a[20:23], v[136:139]
    ds_read_b64_tr_b16 a[34:35], v224 offset:41984
    v_mfma_f32_16x16x32_bf16 v[144:147], a[64:67], a[24:27], v[144:147]
    v_mfma_f32_16x16x32_bf16 v[152:155], a[64:67], a[28:31], v[152:155]
    ds_read_b64_tr_b16 a[36:37], v225 offset:40960
    v_mfma_f32_16x16x32_bf16 v[160:163], a[0:3], a[68:71], v[160:163]
    v_mfma_f32_16x16x32_bf16 v[164:167], a[4:7], a[68:71], v[164:167]
    s_add_u32 m0, s45, 131072
    v_mfma_f32_16x16x32_bf16 v[168:171], a[8:11], a[68:71], v[168:171]
    ds_read_b128 a[64:67], v233 offset:32768
    v_mfma_f32_16x16x32_bf16 v[172:175], a[12:15], a[68:71], v[172:175]
    ds_read_b64_tr_b16 a[38:39], v225 offset:41984
    v_mfma_f32_16x16x32_bf16 v[132:135], a[68:71], a[16:19], v[132:135]
    v_mfma_f32_16x16x32_bf16 v[140:143], a[68:71], a[20:23], v[140:143]
    buffer_load_dwordx4 v234, s[28:31], s39 offen offset:0 lds
    v_mfma_f32_16x16x32_bf16 v[148:151], a[68:71], a[24:27], v[148:151]
    ds_read_b64_tr_b16 a[40:41], v226 offset:40960
    v_mfma_f32_16x16x32_bf16 v[156:159], a[68:71], a[28:31], v[156:159]
    v_mfma_f32_16x16x32_bf16 v[192:195], a[0:3], a[72:75], v[192:195]
    v_mfma_f32_16x16x32_bf16 v[196:199], a[4:7], a[72:75], v[196:199]
    v_mfma_f32_16x16x32_bf16 v[200:203], a[8:11], a[72:75], v[200:203]
    ds_read_b128 a[68:71], v233 offset:33792
    v_mfma_f32_16x16x32_bf16 v[204:207], a[12:15], a[72:75], v[204:207]
    buffer_load_dwordx4 v235, s[28:31], s39 offen offset:1024 lds
    v_mfma_f32_16x16x32_bf16 a[96:99], a[72:75], a[16:19], a[96:99]
    ds_read_b64_tr_b16 a[42:43], v226 offset:41984
    v_mfma_f32_16x16x32_bf16 a[104:107], a[72:75], a[20:23], a[104:107]
    ds_read_b64_tr_b16 a[44:45], v227 offset:40960
    v_mfma_f32_16x16x32_bf16 a[112:115], a[72:75], a[24:27], a[112:115]
    buffer_load_dwordx4 v236, s[28:31], s39 offen offset:2048 lds
    v_mfma_f32_16x16x32_bf16 a[120:123], a[72:75], a[28:31], a[120:123]
    v_mfma_f32_16x16x32_bf16 v[208:211], a[0:3], a[76:79], v[208:211]
    v_mfma_f32_16x16x32_bf16 v[212:215], a[4:7], a[76:79], v[212:215]
    ds_read_b64_tr_b16 a[46:47], v227 offset:41984
    v_mfma_f32_16x16x32_bf16 v[216:219], a[8:11], a[76:79], v[216:219]
    ds_read_b128 a[72:75], v233 offset:36864
    v_mfma_f32_16x16x32_bf16 v[220:223], a[12:15], a[76:79], v[220:223]
    buffer_load_dwordx4 v237, s[28:31], s39 offen offset:3072 lds
    v_mfma_f32_16x16x32_bf16 a[100:103], a[76:79], a[16:19], a[100:103]
    ds_read_b64_tr_b16 a[48:49], v224 offset:57344
    v_mfma_f32_16x16x32_bf16 a[108:111], a[76:79], a[20:23], a[108:111]
    v_mfma_f32_16x16x32_bf16 a[116:119], a[76:79], a[24:27], a[116:119]
    v_mfma_f32_16x16x32_bf16 a[124:127], a[76:79], a[28:31], a[124:127]
    s_waitcnt lgkmcnt(12)
    v_mfma_f32_16x16x32_bf16 v[0:3], a[0:3], a[80:83], v[0:3]
    s_add_u32 s39, s39, 524288
    v_mfma_f32_16x16x32_bf16 v[4:7], a[4:7], a[80:83], v[4:7]
    ds_read_b64_tr_b16 a[50:51], v224 offset:58368
    v_mfma_f32_16x16x32_bf16 v[8:11], a[8:11], a[80:83], v[8:11]
    ds_read_b128 a[76:79], v233 offset:37888
    v_mfma_f32_16x16x32_bf16 v[12:15], a[12:15], a[80:83], v[12:15]
    ds_read_b64_tr_b16 a[52:53], v225 offset:57344
    v_mfma_f32_16x16x32_bf16 v[32:35], a[80:83], a[16:19], v[32:35]
    s_add_u32 m0, s45, 147456
    v_mfma_f32_16x16x32_bf16 v[40:43], a[80:83], a[20:23], v[40:43]
    v_mfma_f32_16x16x32_bf16 v[48:51], a[80:83], a[24:27], v[48:51]
    ds_read_b64_tr_b16 a[54:55], v225 offset:58368
    v_mfma_f32_16x16x32_bf16 v[56:59], a[80:83], a[28:31], v[56:59]
    v_mfma_f32_16x16x32_bf16 v[16:19], a[0:3], a[84:87], v[16:19]
    v_mfma_f32_16x16x32_bf16 v[20:23], a[4:7], a[84:87], v[20:23]
    buffer_load_dwordx4 v234, s[28:31], s39 offen offset:0 lds
    v_mfma_f32_16x16x32_bf16 v[24:27], a[8:11], a[84:87], v[24:27]
    ds_read_b128 a[80:83], v233 offset:49152
    v_mfma_f32_16x16x32_bf16 v[28:31], a[12:15], a[84:87], v[28:31]
    ds_read_b64_tr_b16 a[56:57], v226 offset:57344
    v_mfma_f32_16x16x32_bf16 v[36:39], a[84:87], a[16:19], v[36:39]
    v_mfma_f32_16x16x32_bf16 v[44:47], a[84:87], a[20:23], v[44:47]
    buffer_load_dwordx4 v235, s[28:31], s39 offen offset:1024 lds
    v_mfma_f32_16x16x32_bf16 v[52:55], a[84:87], a[24:27], v[52:55]
    ds_read_b64_tr_b16 a[58:59], v226 offset:58368
    v_mfma_f32_16x16x32_bf16 v[60:63], a[84:87], a[28:31], v[60:63]
    v_mfma_f32_16x16x32_bf16 v[64:67], a[0:3], a[88:91], v[64:67]
    v_mfma_f32_16x16x32_bf16 v[68:71], a[4:7], a[88:91], v[68:71]
    ds_read_b64_tr_b16 a[60:61], v227 offset:57344
    v_mfma_f32_16x16x32_bf16 v[72:75], a[8:11], a[88:91], v[72:75]
    ds_read_b128 a[84:87], v233 offset:50176
    v_mfma_f32_16x16x32_bf16 v[76:79], a[12:15], a[88:91], v[76:79]
    buffer_load_dwordx4 v236, s[28:31], s39 offen offset:2048 lds
    v_mfma_f32_16x16x32_bf16 v[96:99], a[88:91], a[16:19], v[96:99]
    ds_read_b64_tr_b16 a[62:63], v227 offset:58368
    v_mfma_f32_16x16x32_bf16 v[104:107], a[88:91], a[20:23], v[104:107]
    v_mfma_f32_16x16x32_bf16 v[112:115], a[88:91], a[24:27], v[112:115]
    buffer_load_dwordx4 v237, s[28:31], s39 offen offset:3072 lds
    v_mfma_f32_16x16x32_bf16 v[120:123], a[88:91], a[28:31], v[120:123]
    v_mfma_f32_16x16x32_bf16 v[80:83], a[0:3], a[92:95], v[80:83]
    v_mfma_f32_16x16x32_bf16 v[84:87], a[4:7], a[92:95], v[84:87]
    v_mfma_f32_16x16x32_bf16 v[88:91], a[8:11], a[92:95], v[88:91]
    ds_read_b128 a[88:91], v233 offset:53248
    v_mfma_f32_16x16x32_bf16 v[92:95], a[12:15], a[92:95], v[92:95]
    s_add_u32 s39, s39, 524288
    v_mfma_f32_16x16x32_bf16 v[100:103], a[92:95], a[16:19], v[100:103]
    v_mfma_f32_16x16x32_bf16 v[108:111], a[92:95], a[20:23], v[108:111]
    v_mfma_f32_16x16x32_bf16 v[116:119], a[92:95], a[24:27], v[116:119]
    v_mfma_f32_16x16x32_bf16 v[124:127], a[92:95], a[28:31], v[124:127]
    s_waitcnt lgkmcnt(1)
    v_mfma_f32_16x16x32_bf16 v[176:179], a[32:35], a[64:67], v[176:179]
    ds_read_b128 a[92:95], v233 offset:54272
    v_mfma_f32_16x16x32_bf16 v[180:183], a[36:39], a[64:67], v[180:183]
    v_mfma_f32_16x16x32_bf16 v[184:187], a[40:43], a[64:67], v[184:187]
    v_mfma_f32_16x16x32_bf16 v[188:191], a[44:47], a[64:67], v[188:191]
    v_mfma_f32_16x16x32_bf16 v[128:131], a[64:67], a[48:51], v[128:131]
    v_mfma_f32_16x16x32_bf16 v[136:139], a[64:67], a[52:55], v[136:139]
    v_mfma_f32_16x16x32_bf16 v[144:147], a[64:67], a[56:59], v[144:147]
    v_mfma_f32_16x16x32_bf16 v[152:155], a[64:67], a[60:63], v[152:155]
    v_mfma_f32_16x16x32_bf16 v[160:163], a[32:35], a[68:71], v[160:163]
    v_mfma_f32_16x16x32_bf16 v[164:167], a[36:39], a[68:71], v[164:167]
    v_mfma_f32_16x16x32_bf16 v[168:171], a[40:43], a[68:71], v[168:171]
    v_mfma_f32_16x16x32_bf16 v[172:175], a[44:47], a[68:71], v[172:175]
    v_mfma_f32_16x16x32_bf16 v[132:135], a[68:71], a[48:51], v[132:135]
    v_mfma_f32_16x16x32_bf16 v[140:143], a[68:71], a[52:55], v[140:143]
    v_mfma_f32_16x16x32_bf16 v[148:151], a[68:71], a[56:59], v[148:151]
    v_mfma_f32_16x16x32_bf16 v[156:159], a[68:71], a[60:63], v[156:159]
    s_add_u32 m0, s38, 32768
    s_waitcnt vmcnt(8) lgkmcnt(0)
    s_barrier
    v_mfma_f32_16x16x32_bf16 v[192:195], a[32:35], a[72:75], v[192:195]
    buffer_load_dwordx4 v228, s[8:11], s34 offen offset:0 lds
    v_mfma_f32_16x16x32_bf16 v[196:199], a[36:39], a[72:75], v[196:199]
    ds_read_b64_tr_b16 a[0:1], v224 offset:0
    v_mfma_f32_16x16x32_bf16 v[200:203], a[40:43], a[72:75], v[200:203]
    ds_read_b128 a[64:67], v232 offset:0
    v_mfma_f32_16x16x32_bf16 v[204:207], a[44:47], a[72:75], v[204:207]
    buffer_load_dwordx4 v229, s[8:11], s34 offen offset:1024 lds
    v_mfma_f32_16x16x32_bf16 a[96:99], a[72:75], a[48:51], a[96:99]
    ds_read_b128 a[68:71], v232 offset:1024
    ds_read_b64_tr_b16 a[2:3], v224 offset:1024
    v_mfma_f32_16x16x32_bf16 a[104:107], a[72:75], a[52:55], a[104:107]
    buffer_load_dwordx4 v230, s[8:11], s34 offen offset:2048 lds
    v_mfma_f32_16x16x32_bf16 a[112:115], a[72:75], a[56:59], a[112:115]
    buffer_load_dwordx4 v231, s[8:11], s34 offen offset:3072 lds
    v_mfma_f32_16x16x32_bf16 a[120:123], a[72:75], a[60:63], a[120:123]
    ds_read_b64_tr_b16 a[4:5], v225 offset:0
    v_mfma_f32_16x16x32_bf16 v[208:211], a[32:35], a[76:79], v[208:211]
    s_add_u32 s34, s34, 128
    v_mfma_f32_16x16x32_bf16 v[212:215], a[36:39], a[76:79], v[212:215]
    ds_read_b64_tr_b16 a[6:7], v225 offset:1024
    v_mfma_f32_16x16x32_bf16 v[216:219], a[40:43], a[76:79], v[216:219]
    ds_read_b128 a[72:75], v232 offset:4096
    v_mfma_f32_16x16x32_bf16 v[220:223], a[44:47], a[76:79], v[220:223]
    s_add_u32 m0, s38, 36864
    v_mfma_f32_16x16x32_bf16 a[100:103], a[76:79], a[48:51], a[100:103]
    buffer_load_dwordx4 v228, s[8:11], s35 offen offset:0 lds
    v_mfma_f32_16x16x32_bf16 a[108:111], a[76:79], a[52:55], a[108:111]
    ds_read_b64_tr_b16 a[8:9], v226 offset:0
    v_mfma_f32_16x16x32_bf16 a[116:119], a[76:79], a[56:59], a[116:119]
    buffer_load_dwordx4 v229, s[8:11], s35 offen offset:1024 lds
    v_mfma_f32_16x16x32_bf16 a[124:127], a[76:79], a[60:63], a[124:127]
    ds_read_b64_tr_b16 a[10:11], v226 offset:1024
    v_mfma_f32_16x16x32_bf16 v[0:3], a[32:35], a[80:83], v[0:3]
    buffer_load_dwordx4 v230, s[8:11], s35 offen offset:2048 lds
    v_mfma_f32_16x16x32_bf16 v[4:7], a[36:39], a[80:83], v[4:7]
    ds_read_b64_tr_b16 a[12:13], v227 offset:0
    v_mfma_f32_16x16x32_bf16 v[8:11], a[40:43], a[80:83], v[8:11]
    ds_read_b128 a[76:79], v232 offset:5120
    ds_read_b64_tr_b16 a[14:15], v227 offset:1024
    v_mfma_f32_16x16x32_bf16 v[12:15], a[44:47], a[80:83], v[12:15]
    buffer_load_dwordx4 v231, s[8:11], s35 offen offset:3072 lds
    v_mfma_f32_16x16x32_bf16 v[32:35], a[80:83], a[48:51], v[32:35]
    s_add_u32 s35, s35, 128
    v_mfma_f32_16x16x32_bf16 v[40:43], a[80:83], a[52:55], v[40:43]
    ds_read_b64_tr_b16 a[16:17], v224 offset:16384
    v_mfma_f32_16x16x32_bf16 v[48:51], a[80:83], a[56:59], v[48:51]
    s_add_u32 m0, s38, 98304
    v_mfma_f32_16x16x32_bf16 v[56:59], a[80:83], a[60:63], v[56:59]
    ds_read_b64_tr_b16 a[18:19], v224 offset:17408
    v_mfma_f32_16x16x32_bf16 v[16:19], a[32:35], a[84:87], v[16:19]
    v_mfma_f32_16x16x32_bf16 v[20:23], a[36:39], a[84:87], v[20:23]
    buffer_load_dwordx4 v234, s[12:15], s36 offen offset:0 lds
    v_mfma_f32_16x16x32_bf16 v[24:27], a[40:43], a[84:87], v[24:27]
    ds_read_b128 a[80:83], v232 offset:16384
    ds_read_b64_tr_b16 a[20:21], v225 offset:16384
    v_mfma_f32_16x16x32_bf16 v[28:31], a[44:47], a[84:87], v[28:31]
    buffer_load_dwordx4 v235, s[12:15], s36 offen offset:1024 lds
    v_mfma_f32_16x16x32_bf16 v[36:39], a[84:87], a[48:51], v[36:39]
    ds_read_b64_tr_b16 a[22:23], v225 offset:17408
    v_mfma_f32_16x16x32_bf16 v[44:47], a[84:87], a[52:55], v[44:47]
    buffer_load_dwordx4 v236, s[12:15], s36 offen offset:2048 lds
    v_mfma_f32_16x16x32_bf16 v[52:55], a[84:87], a[56:59], v[52:55]
    ds_read_b64_tr_b16 a[24:25], v226 offset:16384
    v_mfma_f32_16x16x32_bf16 v[60:63], a[84:87], a[60:63], v[60:63]
    buffer_load_dwordx4 v237, s[12:15], s36 offen offset:3072 lds
    v_mfma_f32_16x16x32_bf16 v[64:67], a[32:35], a[88:91], v[64:67]
    ds_read_b64_tr_b16 a[26:27], v226 offset:17408
    v_mfma_f32_16x16x32_bf16 v[68:71], a[36:39], a[88:91], v[68:71]
    s_add_u32 s36, s36, 524288
    v_mfma_f32_16x16x32_bf16 v[72:75], a[40:43], a[88:91], v[72:75]
    ds_read_b128 a[84:87], v232 offset:17408
    v_mfma_f32_16x16x32_bf16 v[76:79], a[44:47], a[88:91], v[76:79]
    s_add_u32 m0, s38, 102400
    v_mfma_f32_16x16x32_bf16 v[96:99], a[88:91], a[48:51], v[96:99]
    ds_read_b64_tr_b16 a[28:29], v227 offset:16384
    v_mfma_f32_16x16x32_bf16 v[104:107], a[88:91], a[52:55], v[104:107]
    buffer_load_dwordx4 v234, s[12:15], s37 offen offset:0 lds
    v_mfma_f32_16x16x32_bf16 v[112:115], a[88:91], a[56:59], v[112:115]
    ds_read_b64_tr_b16 a[30:31], v227 offset:17408
    v_mfma_f32_16x16x32_bf16 v[120:123], a[88:91], a[60:63], v[120:123]
    buffer_load_dwordx4 v235, s[12:15], s37 offen offset:1024 lds
    v_mfma_f32_16x16x32_bf16 v[80:83], a[32:35], a[92:95], v[80:83]
    v_mfma_f32_16x16x32_bf16 v[84:87], a[36:39], a[92:95], v[84:87]
    buffer_load_dwordx4 v236, s[12:15], s37 offen offset:2048 lds
    v_mfma_f32_16x16x32_bf16 v[88:91], a[40:43], a[92:95], v[88:91]
    ds_read_b128 a[88:91], v232 offset:20480
    v_mfma_f32_16x16x32_bf16 v[92:95], a[44:47], a[92:95], v[92:95]
    buffer_load_dwordx4 v237, s[12:15], s37 offen offset:3072 lds
    v_mfma_f32_16x16x32_bf16 v[100:103], a[92:95], a[48:51], v[100:103]
    v_mfma_f32_16x16x32_bf16 v[108:111], a[92:95], a[52:55], v[108:111]
    s_add_u32 s37, s37, 524288
    v_mfma_f32_16x16x32_bf16 v[116:119], a[92:95], a[56:59], v[116:119]
    v_mfma_f32_16x16x32_bf16 v[124:127], a[92:95], a[60:63], v[124:127]
    s_waitcnt lgkmcnt(1)
    v_mfma_f32_16x16x32_bf16 v[176:179], a[0:3], a[64:67], v[176:179]
    ds_read_b128 a[92:95], v232 offset:21504
    v_mfma_f32_16x16x32_bf16 v[180:183], a[4:7], a[64:67], v[180:183]
    buffer_load_dwordx4 a[192:195], v238, s[24:27], s40 offen offset:0 sc1
    v_mfma_f32_16x16x32_bf16 v[184:187], a[8:11], a[64:67], v[184:187]
    ds_read_b64_tr_b16 a[32:33], v224 offset:8192
    v_mfma_f32_16x16x32_bf16 v[188:191], a[12:15], a[64:67], v[188:191]
    buffer_load_dwordx4 a[196:199], v246, s[24:27], s40 offen offset:0 sc1
    v_mfma_f32_16x16x32_bf16 v[128:131], a[64:67], a[16:19], v[128:131]
    ds_read_b64_tr_b16 a[34:35], v224 offset:9216
    v_mfma_f32_16x16x32_bf16 v[136:139], a[64:67], a[20:23], v[136:139]
    v_mfma_f32_16x16x32_bf16 v[144:147], a[64:67], a[24:27], v[144:147]
    v_mfma_f32_16x16x32_bf16 v[152:155], a[64:67], a[28:31], v[152:155]
    buffer_load_dwordx4 a[200:203], v238, s[24:27], s41 offen offset:0 sc1
    v_mfma_f32_16x16x32_bf16 v[160:163], a[0:3], a[68:71], v[160:163]
    ds_read_b64_tr_b16 a[36:37], v225 offset:8192
    v_mfma_f32_16x16x32_bf16 v[164:167], a[4:7], a[68:71], v[164:167]
    v_mfma_f32_16x16x32_bf16 v[168:171], a[8:11], a[68:71], v[168:171]
    ds_read_b128 a[64:67], v233 offset:0
    v_mfma_f32_16x16x32_bf16 v[172:175], a[12:15], a[68:71], v[172:175]
    buffer_load_dwordx4 a[204:207], v246, s[24:27], s41 offen offset:0 sc1
    v_mfma_f32_16x16x32_bf16 v[132:135], a[68:71], a[16:19], v[132:135]
    ds_read_b64_tr_b16 a[38:39], v225 offset:9216
    v_mfma_f32_16x16x32_bf16 v[140:143], a[68:71], a[20:23], v[140:143]
    v_mfma_f32_16x16x32_bf16 v[148:151], a[68:71], a[24:27], v[148:151]
    buffer_load_dwordx4 a[208:211], v238, s[24:27], s40 offen offset:1024 sc1
    v_mfma_f32_16x16x32_bf16 v[156:159], a[68:71], a[28:31], v[156:159]
    ds_read_b64_tr_b16 a[40:41], v226 offset:8192
    v_mfma_f32_16x16x32_bf16 v[192:195], a[0:3], a[72:75], v[192:195]
    v_mfma_f32_16x16x32_bf16 v[196:199], a[4:7], a[72:75], v[196:199]
    buffer_load_dwordx4 a[212:215], v246, s[24:27], s40 offen offset:1024 sc1
    v_mfma_f32_16x16x32_bf16 v[200:203], a[8:11], a[72:75], v[200:203]
    ds_read_b128 a[68:71], v233 offset:1024
    v_mfma_f32_16x16x32_bf16 v[204:207], a[12:15], a[72:75], v[204:207]
    ds_read_b64_tr_b16 a[42:43], v226 offset:9216
    v_mfma_f32_16x16x32_bf16 a[96:99], a[72:75], a[16:19], a[96:99]
    v_mfma_f32_16x16x32_bf16 a[104:107], a[72:75], a[20:23], a[104:107]
    buffer_load_dwordx4 a[216:219], v238, s[24:27], s41 offen offset:1024 sc1
    v_mfma_f32_16x16x32_bf16 a[112:115], a[72:75], a[24:27], a[112:115]
    ds_read_b64_tr_b16 a[44:45], v227 offset:8192
    v_mfma_f32_16x16x32_bf16 a[120:123], a[72:75], a[28:31], a[120:123]
    v_mfma_f32_16x16x32_bf16 v[208:211], a[0:3], a[76:79], v[208:211]
    buffer_load_dwordx4 a[220:223], v246, s[24:27], s41 offen offset:1024 sc1
    v_mfma_f32_16x16x32_bf16 v[212:215], a[4:7], a[76:79], v[212:215]
    ds_read_b64_tr_b16 a[46:47], v227 offset:9216
    v_mfma_f32_16x16x32_bf16 v[216:219], a[8:11], a[76:79], v[216:219]
    ds_read_b128 a[72:75], v233 offset:4096
    v_mfma_f32_16x16x32_bf16 v[220:223], a[12:15], a[76:79], v[220:223]
    v_mfma_f32_16x16x32_bf16 a[100:103], a[76:79], a[16:19], a[100:103]
    buffer_load_dwordx4 a[224:227], v238, s[24:27], s40 offen offset:2048 sc1
    v_mfma_f32_16x16x32_bf16 a[108:111], a[76:79], a[20:23], a[108:111]
    ds_read_b64_tr_b16 a[48:49], v224 offset:24576
    v_mfma_f32_16x16x32_bf16 a[116:119], a[76:79], a[24:27], a[116:119]
    v_mfma_f32_16x16x32_bf16 a[124:127], a[76:79], a[28:31], a[124:127]
    s_waitcnt lgkmcnt(12)
    v_mfma_f32_16x16x32_bf16 v[0:3], a[0:3], a[80:83], v[0:3]
    buffer_load_dwordx4 a[228:231], v246, s[24:27], s40 offen offset:2048 sc1
    v_mfma_f32_16x16x32_bf16 v[4:7], a[4:7], a[80:83], v[4:7]
    ds_read_b64_tr_b16 a[50:51], v224 offset:25600
    v_mfma_f32_16x16x32_bf16 v[8:11], a[8:11], a[80:83], v[8:11]
    ds_read_b128 a[76:79], v233 offset:5120
    v_mfma_f32_16x16x32_bf16 v[12:15], a[12:15], a[80:83], v[12:15]
    buffer_load_dwordx4 a[232:235], v238, s[24:27], s41 offen offset:2048 sc1
    v_mfma_f32_16x16x32_bf16 v[32:35], a[80:83], a[16:19], v[32:35]
    ds_read_b64_tr_b16 a[52:53], v225 offset:24576
    v_mfma_f32_16x16x32_bf16 v[40:43], a[80:83], a[20:23], v[40:43]
    v_mfma_f32_16x16x32_bf16 v[48:51], a[80:83], a[24:27], v[48:51]
    ds_read_b64_tr_b16 a[54:55], v225 offset:25600
    v_mfma_f32_16x16x32_bf16 v[56:59], a[80:83], a[28:31], v[56:59]
    buffer_load_dwordx4 a[236:239], v246, s[24:27], s41 offen offset:2048 sc1
    v_mfma_f32_16x16x32_bf16 v[16:19], a[0:3], a[84:87], v[16:19]
    v_mfma_f32_16x16x32_bf16 v[20:23], a[4:7], a[84:87], v[20:23]
    v_mfma_f32_16x16x32_bf16 v[24:27], a[8:11], a[84:87], v[24:27]
    ds_read_b128 a[80:83], v233 offset:16384
    v_mfma_f32_16x16x32_bf16 v[28:31], a[12:15], a[84:87], v[28:31]
    buffer_load_dwordx4 a[240:243], v238, s[24:27], s40 offen offset:3072 sc1
    v_mfma_f32_16x16x32_bf16 v[36:39], a[84:87], a[16:19], v[36:39]
    ds_read_b64_tr_b16 a[56:57], v226 offset:24576
    v_mfma_f32_16x16x32_bf16 v[44:47], a[84:87], a[20:23], v[44:47]
    ds_read_b64_tr_b16 a[58:59], v226 offset:25600
    v_mfma_f32_16x16x32_bf16 v[52:55], a[84:87], a[24:27], v[52:55]
    buffer_load_dwordx4 a[244:247], v246, s[24:27], s40 offen offset:3072 sc1
    v_mfma_f32_16x16x32_bf16 v[60:63], a[84:87], a[28:31], v[60:63]
    v_mfma_f32_16x16x32_bf16 v[64:67], a[0:3], a[88:91], v[64:67]
    v_mfma_f32_16x16x32_bf16 v[68:71], a[4:7], a[88:91], v[68:71]
    buffer_load_dwordx4 a[248:251], v238, s[24:27], s41 offen offset:3072 sc1
    v_mfma_f32_16x16x32_bf16 v[72:75], a[8:11], a[88:91], v[72:75]
    ds_read_b128 a[84:87], v233 offset:17408
    v_mfma_f32_16x16x32_bf16 v[76:79], a[12:15], a[88:91], v[76:79]
    ds_read_b64_tr_b16 a[60:61], v227 offset:24576
    v_mfma_f32_16x16x32_bf16 v[96:99], a[88:91], a[16:19], v[96:99]
    ds_read_b64_tr_b16 a[62:63], v227 offset:25600
    v_mfma_f32_16x16x32_bf16 v[104:107], a[88:91], a[20:23], v[104:107]
    buffer_load_dwordx4 a[252:255], v246, s[24:27], s41 offen offset:3072 sc1
    v_mfma_f32_16x16x32_bf16 v[112:115], a[88:91], a[24:27], v[112:115]
    v_mfma_f32_16x16x32_bf16 v[120:123], a[88:91], a[28:31], v[120:123]
    v_mfma_f32_16x16x32_bf16 v[80:83], a[0:3], a[92:95], v[80:83]
    s_add_u32 s40, s40, 4096
    v_mfma_f32_16x16x32_bf16 v[84:87], a[4:7], a[92:95], v[84:87]
    v_mfma_f32_16x16x32_bf16 v[88:91], a[8:11], a[92:95], v[88:91]
    ds_read_b128 a[88:91], v233 offset:20480
    v_mfma_f32_16x16x32_bf16 v[92:95], a[12:15], a[92:95], v[92:95]
    v_mfma_f32_16x16x32_bf16 v[100:103], a[92:95], a[16:19], v[100:103]
    s_add_u32 s41, s41, 4096
    v_mfma_f32_16x16x32_bf16 v[108:111], a[92:95], a[20:23], v[108:111]
    v_mfma_f32_16x16x32_bf16 v[116:119], a[92:95], a[24:27], v[116:119]
    v_mfma_f32_16x16x32_bf16 v[124:127], a[92:95], a[28:31], v[124:127]
    s_waitcnt lgkmcnt(1)
    v_mfma_f32_16x16x32_bf16 v[176:179], a[32:35], a[64:67], v[176:179]
    ds_read_b128 a[92:95], v233 offset:21504
    v_mfma_f32_16x16x32_bf16 v[180:183], a[36:39], a[64:67], v[180:183]
    v_mfma_f32_16x16x32_bf16 v[184:187], a[40:43], a[64:67], v[184:187]
    v_mfma_f32_16x16x32_bf16 v[188:191], a[44:47], a[64:67], v[188:191]
    v_mfma_f32_16x16x32_bf16 v[128:131], a[64:67], a[48:51], v[128:131]
    v_mfma_f32_16x16x32_bf16 v[136:139], a[64:67], a[52:55], v[136:139]
    v_mfma_f32_16x16x32_bf16 v[144:147], a[64:67], a[56:59], v[144:147]
    v_mfma_f32_16x16x32_bf16 v[152:155], a[64:67], a[60:63], v[152:155]
    v_mfma_f32_16x16x32_bf16 v[160:163], a[32:35], a[68:71], v[160:163]
    v_mfma_f32_16x16x32_bf16 v[164:167], a[36:39], a[68:71], v[164:167]
    v_mfma_f32_16x16x32_bf16 v[168:171], a[40:43], a[68:71], v[168:171]
    v_mfma_f32_16x16x32_bf16 v[172:175], a[44:47], a[68:71], v[172:175]
    v_mfma_f32_16x16x32_bf16 v[132:135], a[68:71], a[48:51], v[132:135]
    v_mfma_f32_16x16x32_bf16 v[140:143], a[68:71], a[52:55], v[140:143]
    v_mfma_f32_16x16x32_bf16 v[148:151], a[68:71], a[56:59], v[148:151]
    v_mfma_f32_16x16x32_bf16 v[156:159], a[68:71], a[60:63], v[156:159]
    s_waitcnt vmcnt(16) lgkmcnt(0)
    s_barrier
    v_mfma_f32_16x16x32_bf16 v[192:195], a[32:35], a[72:75], v[192:195]
    s_add_u32 m0, s45, 0
    v_mfma_f32_16x16x32_bf16 v[196:199], a[36:39], a[72:75], v[196:199]
    ds_read_b64_tr_b16 a[0:1], v224 offset:32768
    v_mfma_f32_16x16x32_bf16 v[200:203], a[40:43], a[72:75], v[200:203]
    ds_read_b128 a[64:67], v232 offset:32768
    v_mfma_f32_16x16x32_bf16 v[204:207], a[44:47], a[72:75], v[204:207]
    buffer_load_dwordx4 v234, s[28:31], s39 offen offset:0 lds
    v_mfma_f32_16x16x32_bf16 a[96:99], a[72:75], a[48:51], a[96:99]
    ds_read_b128 a[68:71], v232 offset:33792
    ds_read_b64_tr_b16 a[2:3], v224 offset:33792
    v_mfma_f32_16x16x32_bf16 a[104:107], a[72:75], a[52:55], a[104:107]
    buffer_load_dwordx4 v235, s[28:31], s39 offen offset:1024 lds
    v_mfma_f32_16x16x32_bf16 a[112:115], a[72:75], a[56:59], a[112:115]
    buffer_load_dwordx4 v236, s[28:31], s39 offen offset:2048 lds
    v_mfma_f32_16x16x32_bf16 a[120:123], a[72:75], a[60:63], a[120:123]
    ds_read_b64_tr_b16 a[4:5], v225 offset:32768
    v_mfma_f32_16x16x32_bf16 v[208:211], a[32:35], a[76:79], v[208:211]
    buffer_load_dwordx4 v237, s[28:31], s39 offen offset:3072 lds
    v_mfma_f32_16x16x32_bf16 v[212:215], a[36:39], a[76:79], v[212:215]
    ds_read_b64_tr_b16 a[6:7], v225 offset:33792
    v_mfma_f32_16x16x32_bf16 v[216:219], a[40:43], a[76:79], v[216:219]
    ds_read_b128 a[72:75], v232 offset:36864
    v_mfma_f32_16x16x32_bf16 v[220:223], a[44:47], a[76:79], v[220:223]
    s_add_u32 s39, s39, 524288
    v_mfma_f32_16x16x32_bf16 a[100:103], a[76:79], a[48:51], a[100:103]
    s_add_u32 m0, s45, 16384
    v_mfma_f32_16x16x32_bf16 a[108:111], a[76:79], a[52:55], a[108:111]
    ds_read_b64_tr_b16 a[8:9], v226 offset:32768
    v_mfma_f32_16x16x32_bf16 a[116:119], a[76:79], a[56:59], a[116:119]
    buffer_load_dwordx4 v234, s[28:31], s39 offen offset:0 lds
    v_mfma_f32_16x16x32_bf16 a[124:127], a[76:79], a[60:63], a[124:127]
    ds_read_b64_tr_b16 a[10:11], v226 offset:33792
    v_mfma_f32_16x16x32_bf16 v[0:3], a[32:35], a[80:83], v[0:3]
    buffer_load_dwordx4 v235, s[28:31], s39 offen offset:1024 lds
    v_mfma_f32_16x16x32_bf16 v[4:7], a[36:39], a[80:83], v[4:7]
    ds_read_b64_tr_b16 a[12:13], v227 offset:32768
    v_mfma_f32_16x16x32_bf16 v[8:11], a[40:43], a[80:83], v[8:11]
    ds_read_b128 a[76:79], v232 offset:37888
    ds_read_b64_tr_b16 a[14:15], v227 offset:33792
    v_mfma_f32_16x16x32_bf16 v[12:15], a[44:47], a[80:83], v[12:15]
    buffer_load_dwordx4 v236, s[28:31], s39 offen offset:2048 lds
    v_mfma_f32_16x16x32_bf16 v[32:35], a[80:83], a[48:51], v[32:35]
    buffer_load_dwordx4 v237, s[28:31], s39 offen offset:3072 lds
    v_mfma_f32_16x16x32_bf16 v[40:43], a[80:83], a[52:55], v[40:43]
    ds_read_b64_tr_b16 a[16:17], v224 offset:49152
    v_mfma_f32_16x16x32_bf16 v[48:51], a[80:83], a[56:59], v[48:51]
    s_add_u32 s39, s39, 524288
    v_mfma_f32_16x16x32_bf16 v[56:59], a[80:83], a[60:63], v[56:59]
    ds_read_b64_tr_b16 a[18:19], v224 offset:50176
    v_mfma_f32_16x16x32_bf16 v[16:19], a[32:35], a[84:87], v[16:19]
    s_add_u32 m0, s45, 65536
    v_mfma_f32_16x16x32_bf16 v[20:23], a[36:39], a[84:87], v[20:23]
    ds_read_b64_tr_b16 a[20:21], v225 offset:49152
    v_mfma_f32_16x16x32_bf16 v[24:27], a[40:43], a[84:87], v[24:27]
    ds_read_b128 a[80:83], v232 offset:49152
    v_mfma_f32_16x16x32_bf16 v[28:31], a[44:47], a[84:87], v[28:31]
    buffer_load_dwordx4 v234, s[28:31], s39 offen offset:0 lds
    v_mfma_f32_16x16x32_bf16 v[36:39], a[84:87], a[48:51], v[36:39]
    buffer_load_dwordx4 v235, s[28:31], s39 offen offset:1024 lds
    v_mfma_f32_16x16x32_bf16 v[44:47], a[84:87], a[52:55], v[44:47]
    ds_read_b64_tr_b16 a[22:23], v225 offset:50176
    v_mfma_f32_16x16x32_bf16 v[52:55], a[84:87], a[56:59], v[52:55]
    buffer_load_dwordx4 v236, s[28:31], s39 offen offset:2048 lds
    v_mfma_f32_16x16x32_bf16 v[60:63], a[84:87], a[60:63], v[60:63]
    ds_read_b64_tr_b16 a[24:25], v226 offset:49152
    v_mfma_f32_16x16x32_bf16 v[64:67], a[32:35], a[88:91], v[64:67]
    buffer_load_dwordx4 v237, s[28:31], s39 offen offset:3072 lds
    v_mfma_f32_16x16x32_bf16 v[68:71], a[36:39], a[88:91], v[68:71]
    ds_read_b64_tr_b16 a[26:27], v226 offset:50176
    v_mfma_f32_16x16x32_bf16 v[72:75], a[40:43], a[88:91], v[72:75]
    ds_read_b128 a[84:87], v232 offset:50176
    v_mfma_f32_16x16x32_bf16 v[76:79], a[44:47], a[88:91], v[76:79]
    s_add_u32 s39, s39, 524288
    v_mfma_f32_16x16x32_bf16 v[96:99], a[88:91], a[48:51], v[96:99]
    s_add_u32 m0, s45, 81920
    v_mfma_f32_16x16x32_bf16 v[104:107], a[88:91], a[52:55], v[104:107]
    ds_read_b64_tr_b16 a[28:29], v227 offset:49152
    v_mfma_f32_16x16x32_bf16 v[112:115], a[88:91], a[56:59], v[112:115]
    buffer_load_dwordx4 v234, s[28:31], s39 offen offset:0 lds
    v_mfma_f32_16x16x32_bf16 v[120:123], a[88:91], a[60:63], v[120:123]
    ds_read_b64_tr_b16 a[30:31], v227 offset:50176
    v_mfma_f32_16x16x32_bf16 v[80:83], a[32:35], a[92:95], v[80:83]
    buffer_load_dwordx4 v235, s[28:31], s39 offen offset:1024 lds
    v_mfma_f32_16x16x32_bf16 v[84:87], a[36:39], a[92:95], v[84:87]
    v_mfma_f32_16x16x32_bf16 v[88:91], a[40:43], a[92:95], v[88:91]
    ds_read_b128 a[88:91], v232 offset:53248
    v_mfma_f32_16x16x32_bf16 v[92:95], a[44:47], a[92:95], v[92:95]
    buffer_load_dwordx4 v236, s[28:31], s39 offen offset:2048 lds
    v_mfma_f32_16x16x32_bf16 v[100:103], a[92:95], a[48:51], v[100:103]
    buffer_load_dwordx4 v237, s[28:31], s39 offen offset:3072 lds
    v_mfma_f32_16x16x32_bf16 v[108:111], a[92:95], a[52:55], v[108:111]
    v_mfma_f32_16x16x32_bf16 v[116:119], a[92:95], a[56:59], v[116:119]
    s_add_u32 s39, s39, 524288
    v_mfma_f32_16x16x32_bf16 v[124:127], a[92:95], a[60:63], v[124:127]
    s_waitcnt lgkmcnt(1)
    v_mfma_f32_16x16x32_bf16 v[176:179], a[0:3], a[64:67], v[176:179]
    ds_read_b128 a[92:95], v232 offset:54272
    v_mfma_f32_16x16x32_bf16 v[180:183], a[4:7], a[64:67], v[180:183]
    buffer_load_dwordx4 a[128:131], v238, s[24:27], s40 offen offset:0 sc1
    v_mfma_f32_16x16x32_bf16 v[184:187], a[8:11], a[64:67], v[184:187]
    ds_read_b64_tr_b16 a[32:33], v224 offset:40960
    v_mfma_f32_16x16x32_bf16 v[188:191], a[12:15], a[64:67], v[188:191]
    buffer_load_dwordx4 a[132:135], v246, s[24:27], s40 offen offset:0 sc1
    v_mfma_f32_16x16x32_bf16 v[128:131], a[64:67], a[16:19], v[128:131]
    ds_read_b64_tr_b16 a[34:35], v224 offset:41984
    v_mfma_f32_16x16x32_bf16 v[136:139], a[64:67], a[20:23], v[136:139]
    v_mfma_f32_16x16x32_bf16 v[144:147], a[64:67], a[24:27], v[144:147]
    v_mfma_f32_16x16x32_bf16 v[152:155], a[64:67], a[28:31], v[152:155]
    buffer_load_dwordx4 a[136:139], v238, s[24:27], s41 offen offset:0 sc1
    v_mfma_f32_16x16x32_bf16 v[160:163], a[0:3], a[68:71], v[160:163]
    ds_read_b64_tr_b16 a[36:37], v225 offset:40960
    v_mfma_f32_16x16x32_bf16 v[164:167], a[4:7], a[68:71], v[164:167]
    v_mfma_f32_16x16x32_bf16 v[168:171], a[8:11], a[68:71], v[168:171]
    ds_read_b128 a[64:67], v233 offset:32768
    v_mfma_f32_16x16x32_bf16 v[172:175], a[12:15], a[68:71], v[172:175]
    buffer_load_dwordx4 a[140:143], v246, s[24:27], s41 offen offset:0 sc1
    v_mfma_f32_16x16x32_bf16 v[132:135], a[68:71], a[16:19], v[132:135]
    ds_read_b64_tr_b16 a[38:39], v225 offset:41984
    v_mfma_f32_16x16x32_bf16 v[140:143], a[68:71], a[20:23], v[140:143]
    v_mfma_f32_16x16x32_bf16 v[148:151], a[68:71], a[24:27], v[148:151]
    buffer_load_dwordx4 a[144:147], v238, s[24:27], s40 offen offset:1024 sc1
    v_mfma_f32_16x16x32_bf16 v[156:159], a[68:71], a[28:31], v[156:159]
    ds_read_b64_tr_b16 a[40:41], v226 offset:40960
    v_mfma_f32_16x16x32_bf16 v[192:195], a[0:3], a[72:75], v[192:195]
    v_mfma_f32_16x16x32_bf16 v[196:199], a[4:7], a[72:75], v[196:199]
    buffer_load_dwordx4 a[148:151], v246, s[24:27], s40 offen offset:1024 sc1
    v_mfma_f32_16x16x32_bf16 v[200:203], a[8:11], a[72:75], v[200:203]
    ds_read_b128 a[68:71], v233 offset:33792
    v_mfma_f32_16x16x32_bf16 v[204:207], a[12:15], a[72:75], v[204:207]
    ds_read_b64_tr_b16 a[42:43], v226 offset:41984
    v_mfma_f32_16x16x32_bf16 a[96:99], a[72:75], a[16:19], a[96:99]
    v_mfma_f32_16x16x32_bf16 a[104:107], a[72:75], a[20:23], a[104:107]
    buffer_load_dwordx4 a[152:155], v238, s[24:27], s41 offen offset:1024 sc1
    v_mfma_f32_16x16x32_bf16 a[112:115], a[72:75], a[24:27], a[112:115]
    ds_read_b64_tr_b16 a[44:45], v227 offset:40960
    v_mfma_f32_16x16x32_bf16 a[120:123], a[72:75], a[28:31], a[120:123]
    v_mfma_f32_16x16x32_bf16 v[208:211], a[0:3], a[76:79], v[208:211]
    buffer_load_dwordx4 a[156:159], v246, s[24:27], s41 offen offset:1024 sc1
    v_mfma_f32_16x16x32_bf16 v[212:215], a[4:7], a[76:79], v[212:215]
    ds_read_b64_tr_b16 a[46:47], v227 offset:41984
    v_mfma_f32_16x16x32_bf16 v[216:219], a[8:11], a[76:79], v[216:219]
    ds_read_b128 a[72:75], v233 offset:36864
    v_mfma_f32_16x16x32_bf16 v[220:223], a[12:15], a[76:79], v[220:223]
    v_mfma_f32_16x16x32_bf16 a[100:103], a[76:79], a[16:19], a[100:103]
    buffer_load_dwordx4 a[160:163], v238, s[24:27], s40 offen offset:2048 sc1
    v_mfma_f32_16x16x32_bf16 a[108:111], a[76:79], a[20:23], a[108:111]
    ds_read_b64_tr_b16 a[48:49], v224 offset:57344
    v_mfma_f32_16x16x32_bf16 a[116:119], a[76:79], a[24:27], a[116:119]
    v_mfma_f32_16x16x32_bf16 a[124:127], a[76:79], a[28:31], a[124:127]
    s_waitcnt lgkmcnt(12)
    v_mfma_f32_16x16x32_bf16 v[0:3], a[0:3], a[80:83], v[0:3]
    buffer_load_dwordx4 a[164:167], v246, s[24:27], s40 offen offset:2048 sc1
    v_mfma_f32_16x16x32_bf16 v[4:7], a[4:7], a[80:83], v[4:7]
    ds_read_b64_tr_b16 a[50:51], v224 offset:58368
    v_mfma_f32_16x16x32_bf16 v[8:11], a[8:11], a[80:83], v[8:11]
    ds_read_b128 a[76:79], v233 offset:37888
    v_mfma_f32_16x16x32_bf16 v[12:15], a[12:15], a[80:83], v[12:15]
    buffer_load_dwordx4 a[168:171], v238, s[24:27], s41 offen offset:2048 sc1
    v_mfma_f32_16x16x32_bf16 v[32:35], a[80:83], a[16:19], v[32:35]
    ds_read_b64_tr_b16 a[52:53], v225 offset:57344
    v_mfma_f32_16x16x32_bf16 v[40:43], a[80:83], a[20:23], v[40:43]
    v_mfma_f32_16x16x32_bf16 v[48:51], a[80:83], a[24:27], v[48:51]
    ds_read_b64_tr_b16 a[54:55], v225 offset:58368
    v_mfma_f32_16x16x32_bf16 v[56:59], a[80:83], a[28:31], v[56:59]
    buffer_load_dwordx4 a[172:175], v246, s[24:27], s41 offen offset:2048 sc1
    v_mfma_f32_16x16x32_bf16 v[16:19], a[0:3], a[84:87], v[16:19]
    v_mfma_f32_16x16x32_bf16 v[20:23], a[4:7], a[84:87], v[20:23]
    v_mfma_f32_16x16x32_bf16 v[24:27], a[8:11], a[84:87], v[24:27]
    ds_read_b128 a[80:83], v233 offset:49152
    v_mfma_f32_16x16x32_bf16 v[28:31], a[12:15], a[84:87], v[28:31]
    buffer_load_dwordx4 a[176:179], v238, s[24:27], s40 offen offset:3072 sc1
    v_mfma_f32_16x16x32_bf16 v[36:39], a[84:87], a[16:19], v[36:39]
    ds_read_b64_tr_b16 a[56:57], v226 offset:57344
    v_mfma_f32_16x16x32_bf16 v[44:47], a[84:87], a[20:23], v[44:47]
    ds_read_b64_tr_b16 a[58:59], v226 offset:58368
    v_mfma_f32_16x16x32_bf16 v[52:55], a[84:87], a[24:27], v[52:55]
    buffer_load_dwordx4 a[180:183], v246, s[24:27], s40 offen offset:3072 sc1
    v_mfma_f32_16x16x32_bf16 v[60:63], a[84:87], a[28:31], v[60:63]
    v_mfma_f32_16x16x32_bf16 v[64:67], a[0:3], a[88:91], v[64:67]
    v_mfma_f32_16x16x32_bf16 v[68:71], a[4:7], a[88:91], v[68:71]
    buffer_load_dwordx4 a[184:187], v238, s[24:27], s41 offen offset:3072 sc1
    v_mfma_f32_16x16x32_bf16 v[72:75], a[8:11], a[88:91], v[72:75]
    ds_read_b128 a[84:87], v233 offset:50176
    v_mfma_f32_16x16x32_bf16 v[76:79], a[12:15], a[88:91], v[76:79]
    ds_read_b64_tr_b16 a[60:61], v227 offset:57344
    v_mfma_f32_16x16x32_bf16 v[96:99], a[88:91], a[16:19], v[96:99]
    ds_read_b64_tr_b16 a[62:63], v227 offset:58368
    v_mfma_f32_16x16x32_bf16 v[104:107], a[88:91], a[20:23], v[104:107]
    buffer_load_dwordx4 a[188:191], v246, s[24:27], s41 offen offset:3072 sc1
    v_mfma_f32_16x16x32_bf16 v[112:115], a[88:91], a[24:27], v[112:115]
    v_mfma_f32_16x16x32_bf16 v[120:123], a[88:91], a[28:31], v[120:123]
    v_mfma_f32_16x16x32_bf16 v[80:83], a[0:3], a[92:95], v[80:83]
    s_add_u32 s40, s40, 4096
    v_mfma_f32_16x16x32_bf16 v[84:87], a[4:7], a[92:95], v[84:87]
    v_mfma_f32_16x16x32_bf16 v[88:91], a[8:11], a[92:95], v[88:91]
    ds_read_b128 a[88:91], v233 offset:53248
    v_mfma_f32_16x16x32_bf16 v[92:95], a[12:15], a[92:95], v[92:95]
    v_mfma_f32_16x16x32_bf16 v[100:103], a[92:95], a[16:19], v[100:103]
    s_add_u32 s41, s41, 4096
    v_mfma_f32_16x16x32_bf16 v[108:111], a[92:95], a[20:23], v[108:111]
    v_mfma_f32_16x16x32_bf16 v[116:119], a[92:95], a[24:27], v[116:119]
    v_mfma_f32_16x16x32_bf16 v[124:127], a[92:95], a[28:31], v[124:127]
    s_waitcnt lgkmcnt(1)
    v_mfma_f32_16x16x32_bf16 v[176:179], a[32:35], a[64:67], v[176:179]
    ds_read_b128 a[92:95], v233 offset:54272
    v_mfma_f32_16x16x32_bf16 v[180:183], a[36:39], a[64:67], v[180:183]
    v_mfma_f32_16x16x32_bf16 v[184:187], a[40:43], a[64:67], v[184:187]
    v_add_u32 v224, 131072, v247
    v_xor_b32 v225, 16, v224
    v_xor_b32 v226, 64, v224
    v_xor_b32 v227, 80, v224
    v_mfma_f32_16x16x32_bf16 v[188:191], a[44:47], a[64:67], v[188:191]
    v_mfma_f32_16x16x32_bf16 v[128:131], a[64:67], a[48:51], v[128:131]
    v_xor_b32 v228, 128, v224
    v_xor_b32 v229, 144, v224
    v_xor_b32 v230, 192, v224
    v_xor_b32 v231, 208, v224
    v_mfma_f32_16x16x32_bf16 v[136:139], a[64:67], a[52:55], v[136:139]
    v_mfma_f32_16x16x32_bf16 v[144:147], a[64:67], a[56:59], v[144:147]
    v_mfma_f32_16x16x32_bf16 v[152:155], a[64:67], a[60:63], v[152:155]
    v_mfma_f32_16x16x32_bf16 v[160:163], a[32:35], a[68:71], v[160:163]
    v_mfma_f32_16x16x32_bf16 v[164:167], a[36:39], a[68:71], v[164:167]
    v_mfma_f32_16x16x32_bf16 v[168:171], a[40:43], a[68:71], v[168:171]
    v_mfma_f32_16x16x32_bf16 v[172:175], a[44:47], a[68:71], v[172:175]
    v_mfma_f32_16x16x32_bf16 v[132:135], a[68:71], a[48:51], v[132:135]
    v_cvt_pk_bf16_f32 v176, v176, v177
    v_cvt_pk_bf16_f32 v177, v178, v179
    v_mfma_f32_16x16x32_bf16 v[140:143], a[68:71], a[52:55], v[140:143]
    v_cvt_pk_bf16_f32 v178, v180, v181
    v_mfma_f32_16x16x32_bf16 v[148:151], a[68:71], a[56:59], v[148:151]
    v_cvt_pk_bf16_f32 v179, v182, v183
    v_cvt_pk_bf16_f32 v180, v184, v185
    v_mfma_f32_16x16x32_bf16 v[156:159], a[68:71], a[60:63], v[156:159]
    s_waitcnt vmcnt(63) lgkmcnt(0)
    s_barrier
    v_mfma_f32_16x16x32_bf16 v[192:195], a[32:35], a[72:75], v[192:195]
    s_add_u32 m0, s45, 98304
    v_mfma_f32_16x16x32_bf16 v[196:199], a[36:39], a[72:75], v[196:199]
    ds_read_b64_tr_b16 a[0:1], v224 offset:0
    v_cvt_pk_bf16_f32 v181, v186, v187
    v_mfma_f32_16x16x32_bf16 v[200:203], a[40:43], a[72:75], v[200:203]
    v_cvt_pk_bf16_f32 v182, v188, v189
    v_mfma_f32_16x16x32_bf16 v[204:207], a[44:47], a[72:75], v[204:207]
    ds_read_b64_tr_b16 a[2:3], v224 offset:1024
    v_cvt_pk_bf16_f32 v183, v190, v191
    v_mfma_f32_16x16x32_bf16 a[96:99], a[72:75], a[48:51], a[96:99]
    buffer_load_dwordx4 v234, s[28:31], s39 offen offset:0 lds
    v_mfma_f32_16x16x32_bf16 a[104:107], a[72:75], a[52:55], a[104:107]
    v_mfma_f32_16x16x32_bf16 a[112:115], a[72:75], a[56:59], a[112:115]
    ds_read_b64_tr_b16 a[4:5], v225 offset:0
    v_cvt_pk_bf16_f32 v184, v160, v161
    v_cvt_pk_bf16_f32 v185, v162, v163
    v_cvt_pk_bf16_f32 v186, v164, v165
    v_mfma_f32_16x16x32_bf16 a[120:123], a[72:75], a[60:63], a[120:123]
    v_cvt_pk_bf16_f32 v187, v166, v167
    v_cvt_pk_bf16_f32 v188, v168, v169
    v_cvt_pk_bf16_f32 v189, v170, v171
    v_mfma_f32_16x16x32_bf16 v[208:211], a[32:35], a[76:79], v[208:211]
    buffer_load_dwordx4 v235, s[28:31], s39 offen offset:1024 lds
    v_mfma_f32_16x16x32_bf16 v[212:215], a[36:39], a[76:79], v[212:215]
    ds_read_b64_tr_b16 a[6:7], v225 offset:1024
    v_cvt_pk_bf16_f32 v190, v172, v173
    v_cvt_pk_bf16_f32 v191, v174, v175
    v_cvt_pk_bf16_f32 v128, v128, v129
    v_mfma_f32_16x16x32_bf16 v[216:219], a[40:43], a[76:79], v[216:219]
    v_cvt_pk_bf16_f32 v129, v130, v131
    v_cvt_pk_bf16_f32 v130, v132, v133
    v_cvt_pk_bf16_f32 v131, v134, v135
    v_mfma_f32_16x16x32_bf16 v[220:223], a[44:47], a[76:79], v[220:223]
    ds_read_b64_tr_b16 a[8:9], v226 offset:0
    v_cvt_pk_bf16_f32 v132, v136, v137
    v_cvt_pk_bf16_f32 v133, v138, v139
    v_cvt_pk_bf16_f32 v134, v140, v141
    v_mfma_f32_16x16x32_bf16 a[100:103], a[76:79], a[48:51], a[100:103]
    buffer_load_dwordx4 v236, s[28:31], s39 offen offset:2048 lds
    v_mfma_f32_16x16x32_bf16 a[108:111], a[76:79], a[52:55], a[108:111]
    v_cvt_pk_bf16_f32 v135, v142, v143
    v_cvt_pk_bf16_f32 v136, v144, v145
    v_cvt_pk_bf16_f32 v137, v146, v147
    v_mfma_f32_16x16x32_bf16 a[116:119], a[76:79], a[56:59], a[116:119]
    ds_read_b64_tr_b16 a[10:11], v226 offset:1024
    v_cvt_pk_bf16_f32 v138, v148, v149
    v_cvt_pk_bf16_f32 v139, v150, v151
    v_cvt_pk_bf16_f32 v140, v152, v153
    v_mfma_f32_16x16x32_bf16 a[124:127], a[76:79], a[60:63], a[124:127]
    v_cvt_pk_bf16_f32 v141, v154, v155
    v_cvt_pk_bf16_f32 v142, v156, v157
    v_cvt_pk_bf16_f32 v143, v158, v159
    v_mfma_f32_16x16x32_bf16 v[0:3], a[32:35], a[80:83], v[0:3]
    buffer_load_dwordx4 v237, s[28:31], s39 offen offset:3072 lds
    v_mfma_f32_16x16x32_bf16 v[4:7], a[36:39], a[80:83], v[4:7]
    ds_read_b64_tr_b16 a[12:13], v227 offset:0
    v_cvt_pk_bf16_f32 v192, v192, v193
    v_cvt_pk_bf16_f32 v193, v194, v195
    v_cvt_pk_bf16_f32 v194, v196, v197
    v_mfma_f32_16x16x32_bf16 v[8:11], a[40:43], a[80:83], v[8:11]
    v_cvt_pk_bf16_f32 v195, v198, v199
    v_cvt_pk_bf16_f32 v196, v200, v201
    v_cvt_pk_bf16_f32 v197, v202, v203
    v_mfma_f32_16x16x32_bf16 v[12:15], a[44:47], a[80:83], v[12:15]
    ds_read_b64_tr_b16 a[14:15], v227 offset:1024
    v_cvt_pk_bf16_f32 v198, v204, v205
    v_cvt_pk_bf16_f32 v199, v206, v207
    v_mfma_f32_16x16x32_bf16 v[32:35], a[80:83], a[48:51], v[32:35]
    s_add_u32 s39, s39, 524288
    v_mfma_f32_16x16x32_bf16 v[40:43], a[80:83], a[52:55], v[40:43]
    v_mfma_f32_16x16x32_bf16 v[48:51], a[80:83], a[56:59], v[48:51]
    ds_read_b64_tr_b16 a[16:17], v228 offset:0
    v_cvt_pk_bf16_f32 v200, v208, v209
    v_cvt_pk_bf16_f32 v201, v210, v211
    v_cvt_pk_bf16_f32 v202, v212, v213
    v_cvt_pk_bf16_f32 v203, v214, v215
    v_cvt_pk_bf16_f32 v204, v216, v217
    v_cvt_pk_bf16_f32 v205, v218, v219
    v_mfma_f32_16x16x32_bf16 v[56:59], a[80:83], a[60:63], v[56:59]
    v_cvt_pk_bf16_f32 v206, v220, v221
    v_cvt_pk_bf16_f32 v207, v222, v223
    v_accvgpr_read_b32 v248, a96
    v_accvgpr_read_b32 v249, a97
    v_cvt_pk_bf16_f32 v144, v248, v249
    v_mfma_f32_16x16x32_bf16 v[16:19], a[32:35], a[84:87], v[16:19]
    s_add_u32 m0, s45, 114688
    v_accvgpr_read_b32 v248, a98
    v_accvgpr_read_b32 v249, a99
    v_cvt_pk_bf16_f32 v145, v248, v249
    v_accvgpr_read_b32 v248, a100
    v_accvgpr_read_b32 v249, a101
    v_cvt_pk_bf16_f32 v146, v248, v249
    v_mfma_f32_16x16x32_bf16 v[20:23], a[36:39], a[84:87], v[20:23]
    ds_read_b64_tr_b16 a[18:19], v228 offset:1024
    v_accvgpr_read_b32 v248, a102
    v_accvgpr_read_b32 v249, a103
    v_cvt_pk_bf16_f32 v147, v248, v249
    v_accvgpr_read_b32 v248, a104
    v_accvgpr_read_b32 v249, a105
    v_cvt_pk_bf16_f32 v148, v248, v249
    v_mfma_f32_16x16x32_bf16 v[24:27], a[40:43], a[84:87], v[24:27]
    v_accvgpr_read_b32 v248, a106
    v_accvgpr_read_b32 v249, a107
    v_cvt_pk_bf16_f32 v149, v248, v249
    v_accvgpr_read_b32 v248, a108
    v_accvgpr_read_b32 v249, a109
    v_cvt_pk_bf16_f32 v150, v248, v249
    v_mfma_f32_16x16x32_bf16 v[28:31], a[44:47], a[84:87], v[28:31]
    ds_read_b64_tr_b16 a[20:21], v229 offset:0
    v_accvgpr_read_b32 v248, a110
    v_accvgpr_read_b32 v249, a111
    v_cvt_pk_bf16_f32 v151, v248, v249
    v_accvgpr_read_b32 v248, a112
    v_accvgpr_read_b32 v249, a113
    v_cvt_pk_bf16_f32 v152, v248, v249
    v_mfma_f32_16x16x32_bf16 v[36:39], a[84:87], a[48:51], v[36:39]
    buffer_load_dwordx4 v234, s[28:31], s39 offen offset:0 lds
    v_accvgpr_read_b32 v248, a114
    v_accvgpr_read_b32 v249, a115
    v_cvt_pk_bf16_f32 v153, v248, v249
    v_mfma_f32_16x16x32_bf16 v[44:47], a[84:87], a[52:55], v[44:47]
    v_accvgpr_read_b32 v248, a116
    v_accvgpr_read_b32 v249, a117
    v_cvt_pk_bf16_f32 v154, v248, v249
    v_accvgpr_read_b32 v248, a118
    v_accvgpr_read_b32 v249, a119
    v_cvt_pk_bf16_f32 v155, v248, v249
    v_mfma_f32_16x16x32_bf16 v[52:55], a[84:87], a[56:59], v[52:55]
    ds_read_b64_tr_b16 a[22:23], v229 offset:1024
    v_accvgpr_read_b32 v248, a120
    v_accvgpr_read_b32 v249, a121
    v_cvt_pk_bf16_f32 v156, v248, v249
    v_accvgpr_read_b32 v248, a122
    v_accvgpr_read_b32 v249, a123
    v_cvt_pk_bf16_f32 v157, v248, v249
    v_mfma_f32_16x16x32_bf16 v[60:63], a[84:87], a[60:63], v[60:63]
    v_accvgpr_read_b32 v248, a124
    v_accvgpr_read_b32 v249, a125
    v_cvt_pk_bf16_f32 v158, v248, v249
    v_accvgpr_read_b32 v248, a126
    v_accvgpr_read_b32 v249, a127
    v_cvt_pk_bf16_f32 v159, v248, v249
    v_mfma_f32_16x16x32_bf16 v[64:67], a[32:35], a[88:91], v[64:67]
    buffer_load_dwordx4 v235, s[28:31], s39 offen offset:1024 lds
    v_mfma_f32_16x16x32_bf16 v[68:71], a[36:39], a[88:91], v[68:71]
    ds_read_b64_tr_b16 a[24:25], v230 offset:0
    v_cvt_pk_bf16_f32 v208, v0, v1
    v_cvt_pk_bf16_f32 v209, v2, v3
    v_mfma_f32_16x16x32_bf16 v[72:75], a[40:43], a[88:91], v[72:75]
    v_cvt_pk_bf16_f32 v210, v4, v5
    v_cvt_pk_bf16_f32 v211, v6, v7
    v_cvt_pk_bf16_f32 v212, v8, v9
    v_cvt_pk_bf16_f32 v213, v10, v11
    v_mfma_f32_16x16x32_bf16 v[76:79], a[44:47], a[88:91], v[76:79]
    ds_read_b64_tr_b16 a[26:27], v230 offset:1024
    v_cvt_pk_bf16_f32 v214, v12, v13
    v_cvt_pk_bf16_f32 v215, v14, v15
    v_mfma_f32_16x16x32_bf16 v[96:99], a[88:91], a[48:51], v[96:99]
    buffer_load_dwordx4 v236, s[28:31], s39 offen offset:2048 lds
    v_mfma_f32_16x16x32_bf16 v[104:107], a[88:91], a[52:55], v[104:107]
    v_mfma_f32_16x16x32_bf16 v[112:115], a[88:91], a[56:59], v[112:115]
    ds_read_b64_tr_b16 a[28:29], v231 offset:0
    v_cvt_pk_bf16_f32 v216, v16, v17
    v_cvt_pk_bf16_f32 v217, v18, v19
    v_mfma_f32_16x16x32_bf16 v[120:123], a[88:91], a[60:63], v[120:123]
    v_cvt_pk_bf16_f32 v218, v20, v21
    v_cvt_pk_bf16_f32 v219, v22, v23
    v_cvt_pk_bf16_f32 v220, v24, v25
    v_mfma_f32_16x16x32_bf16 v[80:83], a[32:35], a[92:95], v[80:83]
    buffer_load_dwordx4 v237, s[28:31], s39 offen offset:3072 lds
    v_mfma_f32_16x16x32_bf16 v[84:87], a[36:39], a[92:95], v[84:87]
    ds_read_b64_tr_b16 a[30:31], v231 offset:1024
    v_cvt_pk_bf16_f32 v221, v26, v27
    v_cvt_pk_bf16_f32 v222, v28, v29
    v_mfma_f32_16x16x32_bf16 v[88:91], a[40:43], a[92:95], v[88:91]
    v_cvt_pk_bf16_f32 v223, v30, v31
    v_cvt_pk_bf16_f32 v160, v32, v33
    v_cvt_pk_bf16_f32 v161, v34, v35
    v_mfma_f32_16x16x32_bf16 v[92:95], a[44:47], a[92:95], v[92:95]
    v_cvt_pk_bf16_f32 v162, v36, v37
    v_cvt_pk_bf16_f32 v163, v38, v39
    v_cvt_pk_bf16_f32 v164, v40, v41
    v_mfma_f32_16x16x32_bf16 v[100:103], a[92:95], a[48:51], v[100:103]
    s_add_u32 s39, s39, 524288
    v_cvt_pk_bf16_f32 v165, v42, v43
    v_cvt_pk_bf16_f32 v166, v44, v45
    v_cvt_pk_bf16_f32 v64, v64, v65
    v_cvt_pk_bf16_f32 v65, v66, v67
    v_cvt_pk_bf16_f32 v66, v68, v69
    v_cvt_pk_bf16_f32 v67, v70, v71
    v_mfma_f32_16x16x32_bf16 v[108:111], a[92:95], a[52:55], v[108:111]
    v_cvt_pk_bf16_f32 v167, v46, v47
    v_cvt_pk_bf16_f32 v168, v48, v49
    v_cvt_pk_bf16_f32 v169, v50, v51
    v_accvgpr_write_b32 a64, v64
    v_accvgpr_write_b32 a65, v65
    v_accvgpr_write_b32 a66, v66
    v_accvgpr_write_b32 a67, v67
    v_mfma_f32_16x16x32_bf16 v[116:119], a[92:95], a[56:59], v[116:119]
    v_cvt_pk_bf16_f32 v170, v52, v53
    v_cvt_pk_bf16_f32 v171, v54, v55
    v_cvt_pk_bf16_f32 v172, v56, v57
    v_cvt_pk_bf16_f32 v72, v72, v73
    v_cvt_pk_bf16_f32 v73, v74, v75
    v_cvt_pk_bf16_f32 v74, v76, v77
    v_cvt_pk_bf16_f32 v75, v78, v79
    v_mfma_f32_16x16x32_bf16 v[124:127], a[92:95], a[60:63], v[124:127]
    v_cvt_pk_bf16_f32 v173, v58, v59
    v_cvt_pk_bf16_f32 v174, v60, v61
    v_cvt_pk_bf16_f32 v175, v62, v63
    v_accvgpr_write_b32 a68, v72
    v_accvgpr_write_b32 a69, v73
    v_accvgpr_write_b32 a70, v74
    v_accvgpr_write_b32 a71, v75
    s_nop 7
    v_cvt_pk_bf16_f32 v80, v80, v81
    v_cvt_pk_bf16_f32 v81, v82, v83
    v_cvt_pk_bf16_f32 v82, v84, v85
    v_cvt_pk_bf16_f32 v83, v86, v87
    v_accvgpr_write_b32 a72, v80
    v_accvgpr_write_b32 a73, v81
    v_accvgpr_write_b32 a74, v82
    v_accvgpr_write_b32 a75, v83
    v_cvt_pk_bf16_f32 v88, v88, v89
    v_cvt_pk_bf16_f32 v89, v90, v91
    v_cvt_pk_bf16_f32 v90, v92, v93
    v_cvt_pk_bf16_f32 v91, v94, v95
    v_accvgpr_write_b32 a76, v88
    v_accvgpr_write_b32 a77, v89
    v_accvgpr_write_b32 a78, v90
    v_accvgpr_write_b32 a79, v91
    v_cvt_pk_bf16_f32 v96, v96, v97
    v_cvt_pk_bf16_f32 v97, v98, v99
    v_cvt_pk_bf16_f32 v98, v100, v101
    v_cvt_pk_bf16_f32 v99, v102, v103
    v_accvgpr_write_b32 a80, v96
    v_accvgpr_write_b32 a81, v97
    v_accvgpr_write_b32 a82, v98
    v_accvgpr_write_b32 a83, v99
    v_cvt_pk_bf16_f32 v104, v104, v105
    v_cvt_pk_bf16_f32 v105, v106, v107
    v_cvt_pk_bf16_f32 v106, v108, v109
    v_cvt_pk_bf16_f32 v107, v110, v111
    v_accvgpr_write_b32 a84, v104
    v_accvgpr_write_b32 a85, v105
    v_accvgpr_write_b32 a86, v106
    v_accvgpr_write_b32 a87, v107
    v_cvt_pk_bf16_f32 v112, v112, v113
    v_cvt_pk_bf16_f32 v113, v114, v115
    v_cvt_pk_bf16_f32 v114, v116, v117
    v_cvt_pk_bf16_f32 v115, v118, v119
    v_accvgpr_write_b32 a88, v112
    v_accvgpr_write_b32 a89, v113
    v_accvgpr_write_b32 a90, v114
    v_accvgpr_write_b32 a91, v115
    v_cvt_pk_bf16_f32 v120, v120, v121
    v_cvt_pk_bf16_f32 v121, v122, v123
    v_cvt_pk_bf16_f32 v122, v124, v125
    v_cvt_pk_bf16_f32 v123, v126, v127
    v_accvgpr_write_b32 a92, v120
    v_accvgpr_write_b32 a93, v121
    v_accvgpr_write_b32 a94, v122
    v_accvgpr_write_b32 a95, v123
Q_code:
    s_waitcnt vmcnt(48)
    s_waitcnt lgkmcnt(8)
    v_mfma_f32_16x16x32_bf16 v[64:67], a[0:3], a[192:195], 0
    ds_read_b64_tr_b16 a[32:33], v224 offset:8192
    v_mfma_f32_16x16x32_bf16 v[72:75], a[0:3], a[196:199], 0
    buffer_load_dwordx4 a[96:99], v238, s[24:27], s40 offen offset:0 sc1
    v_mfma_f32_16x16x32_bf16 v[0:3], a[0:3], a[200:203], 0
    ds_read_b64_tr_b16 a[34:35], v224 offset:9216
    s_and_b32 s3, s94, 1
    v_mfma_f32_16x16x32_bf16 v[8:11], a[0:3], a[204:207], 0
    s_lshl_b32 s3, s3, 14
    v_mfma_f32_16x16x32_bf16 v[68:71], a[4:7], a[192:195], 0
    buffer_load_dwordx4 a[100:103], v246, s[24:27], s40 offen offset:0 sc1
    v_mfma_f32_16x16x32_bf16 v[76:79], a[4:7], a[196:199], 0
    ds_read_b64_tr_b16 a[36:37], v225 offset:8192
    v_mfma_f32_16x16x32_bf16 v[4:7], a[4:7], a[200:203], 0
    ds_read_b64_tr_b16 a[38:39], v225 offset:9216
    v_mfma_f32_16x16x32_bf16 v[12:15], a[4:7], a[204:207], 0
    buffer_load_dwordx4 a[104:107], v238, s[24:27], s41 offen offset:0 sc1
    v_mfma_f32_16x16x32_bf16 v[80:83], a[8:11], a[192:195], 0
    ds_read_b64_tr_b16 a[40:41], v226 offset:8192
    s_lshr_b32 s4, s94, 1
    v_mfma_f32_16x16x32_bf16 v[88:91], a[8:11], a[196:199], 0
    s_lshl_b32 s5, s4, 12
    v_mfma_f32_16x16x32_bf16 v[16:19], a[8:11], a[200:203], 0
    buffer_load_dwordx4 a[108:111], v246, s[24:27], s41 offen offset:0 sc1
    v_mfma_f32_16x16x32_bf16 v[24:27], a[8:11], a[204:207], 0
    ds_read_b64_tr_b16 a[42:43], v226 offset:9216
    v_mfma_f32_16x16x32_bf16 v[84:87], a[12:15], a[192:195], 0
    ds_read_b64_tr_b16 a[44:45], v227 offset:8192
    v_mfma_f32_16x16x32_bf16 v[92:95], a[12:15], a[196:199], 0
    buffer_load_dwordx4 a[112:115], v238, s[24:27], s40 offen offset:1024 sc1
    v_mfma_f32_16x16x32_bf16 v[20:23], a[12:15], a[200:203], 0
    ds_read_b64_tr_b16 a[46:47], v227 offset:9216
    s_add_u32 s5, s5, s3
    v_mfma_f32_16x16x32_bf16 v[28:31], a[12:15], a[204:207], 0
    s_waitcnt lgkmcnt(8)
    v_mfma_f32_16x16x32_bf16 v[96:99], a[16:19], a[192:195], 0
    buffer_load_dwordx4 a[116:119], v246, s[24:27], s40 offen offset:1024 sc1
    v_mfma_f32_16x16x32_bf16 v[104:107], a[16:19], a[196:199], 0
    ds_read_b64_tr_b16 a[48:49], v228 offset:8192
    v_mfma_f32_16x16x32_bf16 v[32:35], a[16:19], a[200:203], 0
    ds_read_b64_tr_b16 a[50:51], v228 offset:9216
    v_mfma_f32_16x16x32_bf16 v[40:43], a[16:19], a[204:207], 0
    buffer_load_dwordx4 a[120:123], v238, s[24:27], s41 offen offset:1024 sc1
    v_mfma_f32_16x16x32_bf16 v[100:103], a[20:23], a[192:195], 0
    ds_read_b64_tr_b16 a[52:53], v229 offset:8192
    s_add_u32 s5, s5, 0x8000
    v_mfma_f32_16x16x32_bf16 v[108:111], a[20:23], a[196:199], 0
    v_add_u32 v248, s5, v244
    v_mfma_f32_16x16x32_bf16 v[36:39], a[20:23], a[200:203], 0
    buffer_load_dwordx4 a[124:127], v246, s[24:27], s41 offen offset:1024 sc1
    v_mfma_f32_16x16x32_bf16 v[44:47], a[20:23], a[204:207], 0
    ds_read_b64_tr_b16 a[54:55], v229 offset:9216
    v_mfma_f32_16x16x32_bf16 v[112:115], a[24:27], a[192:195], 0
    ds_read_b64_tr_b16 a[56:57], v230 offset:8192
    v_mfma_f32_16x16x32_bf16 v[120:123], a[24:27], a[196:199], 0
    s_add_u32 s44, s42, 0
    s_lshl_b32 s5, s4, 11
    v_mfma_f32_16x16x32_bf16 v[48:51], a[24:27], a[200:203], 0
    ds_read_b64_tr_b16 a[58:59], v230 offset:9216
    v_mfma_f32_16x16x32_bf16 v[56:59], a[24:27], a[204:207], 0
    s_add_u32 s5, s5, s3
    v_mfma_f32_16x16x32_bf16 v[116:119], a[28:31], a[192:195], 0
    buffer_store_dwordx4 v[176:179], v244, s[16:19], s44 offen offset:0 sc0 sc1
    v_mfma_f32_16x16x32_bf16 v[124:127], a[28:31], a[196:199], 0
    ds_read_b64_tr_b16 a[60:61], v231 offset:8192
    v_mfma_f32_16x16x32_bf16 v[52:55], a[28:31], a[200:203], 0
    ds_read_b64_tr_b16 a[62:63], v231 offset:9216
    s_add_u32 s5, s5, 0x20000
    v_mfma_f32_16x16x32_bf16 v[60:63], a[28:31], a[204:207], 0
    v_add_u32 v249, s5, v245
    s_waitcnt lgkmcnt(8)
    v_mfma_f32_16x16x32_bf16 v[64:67], a[32:35], a[208:211], v[64:67]
    ds_read_b64_tr_b16 a[0:1], v224 offset:16384
    v_mfma_f32_16x16x32_bf16 v[72:75], a[32:35], a[212:215], v[72:75]
    s_add_u32 s44, s42, 0
    v_mfma_f32_16x16x32_bf16 v[0:3], a[32:35], a[216:219], v[0:3]
    ds_read_b64_tr_b16 a[2:3], v224 offset:17408
    v_mfma_f32_16x16x32_bf16 v[8:11], a[32:35], a[220:223], v[8:11]
    v_mfma_f32_16x16x32_bf16 v[68:71], a[36:39], a[208:211], v[68:71]
    ds_read_b64_tr_b16 a[4:5], v225 offset:16384
    v_mfma_f32_16x16x32_bf16 v[76:79], a[36:39], a[212:215], v[76:79]
    v_mfma_f32_16x16x32_bf16 v[4:7], a[36:39], a[216:219], v[4:7]
    ds_read_b64_tr_b16 a[6:7], v225 offset:17408
    v_mfma_f32_16x16x32_bf16 v[12:15], a[36:39], a[220:223], v[12:15]
    v_mfma_f32_16x16x32_bf16 v[80:83], a[40:43], a[208:211], v[80:83]
    buffer_store_dwordx4 v[180:183], v244, s[16:19], s44 offen offset:2048 sc0 sc1
    v_mfma_f32_16x16x32_bf16 v[88:91], a[40:43], a[212:215], v[88:91]
    ds_read_b64_tr_b16 a[8:9], v226 offset:16384
    v_mfma_f32_16x16x32_bf16 v[16:19], a[40:43], a[216:219], v[16:19]
    ds_read_b64_tr_b16 a[10:11], v226 offset:17408
    v_mfma_f32_16x16x32_bf16 v[24:27], a[40:43], a[220:223], v[24:27]
    v_mfma_f32_16x16x32_bf16 v[84:87], a[44:47], a[208:211], v[84:87]
    ds_read_b64_tr_b16 a[12:13], v227 offset:16384
    v_mfma_f32_16x16x32_bf16 v[92:95], a[44:47], a[212:215], v[92:95]
    v_mfma_f32_16x16x32_bf16 v[20:23], a[44:47], a[216:219], v[20:23]
    ds_read_b64_tr_b16 a[14:15], v227 offset:17408
    v_mfma_f32_16x16x32_bf16 v[28:31], a[44:47], a[220:223], v[28:31]
    s_waitcnt lgkmcnt(8)
    v_mfma_f32_16x16x32_bf16 v[96:99], a[48:51], a[208:211], v[96:99]
    ds_write_b128 v248, v[176:179] offset:0
    v_mfma_f32_16x16x32_bf16 v[104:107], a[48:51], a[212:215], v[104:107]
    ds_read_b64_tr_b16 a[16:17], v228 offset:16384
    v_mfma_f32_16x16x32_bf16 v[32:35], a[48:51], a[216:219], v[32:35]
    ds_read_b64_tr_b16 a[18:19], v228 offset:17408
    v_mfma_f32_16x16x32_bf16 v[40:43], a[48:51], a[220:223], v[40:43]
    v_mfma_f32_16x16x32_bf16 v[100:103], a[52:55], a[208:211], v[100:103]
    ds_read_b64_tr_b16 a[20:21], v229 offset:16384
    v_mfma_f32_16x16x32_bf16 v[108:111], a[52:55], a[212:215], v[108:111]
    v_mfma_f32_16x16x32_bf16 v[36:39], a[52:55], a[216:219], v[36:39]
    ds_read_b64_tr_b16 a[22:23], v229 offset:17408
    v_mfma_f32_16x16x32_bf16 v[44:47], a[52:55], a[220:223], v[44:47]
    v_mfma_f32_16x16x32_bf16 v[112:115], a[56:59], a[208:211], v[112:115]
    ds_write_b128 v248, v[180:183] offset:2048
    v_mfma_f32_16x16x32_bf16 v[120:123], a[56:59], a[212:215], v[120:123]
    ds_read_b64_tr_b16 a[24:25], v230 offset:16384
    v_mfma_f32_16x16x32_bf16 v[48:51], a[56:59], a[216:219], v[48:51]
    ds_read_b64_tr_b16 a[26:27], v230 offset:17408
    v_mfma_f32_16x16x32_bf16 v[56:59], a[56:59], a[220:223], v[56:59]
    v_mfma_f32_16x16x32_bf16 v[116:119], a[60:63], a[208:211], v[116:119]
    ds_read_b64_tr_b16 a[28:29], v231 offset:16384
    v_mfma_f32_16x16x32_bf16 v[124:127], a[60:63], a[212:215], v[124:127]
    v_mfma_f32_16x16x32_bf16 v[52:55], a[60:63], a[216:219], v[52:55]
    ds_read_b64_tr_b16 a[30:31], v231 offset:17408
    v_mfma_f32_16x16x32_bf16 v[60:63], a[60:63], a[220:223], v[60:63]
    s_waitcnt vmcnt(50)
    s_waitcnt lgkmcnt(10)
    v_mfma_f32_16x16x32_bf16 v[64:67], a[0:3], a[224:227], v[64:67]
    ds_read_b64_tr_b16 a[32:33], v224 offset:24576
    v_mfma_f32_16x16x32_bf16 v[72:75], a[0:3], a[228:231], v[72:75]
    buffer_load_dwordx4 a[192:195], v238, s[24:27], s40 offen offset:2048 sc1
    v_mfma_f32_16x16x32_bf16 v[0:3], a[0:3], a[232:235], v[0:3]
    ds_read_b64_tr_b16 a[34:35], v224 offset:25600
    v_mfma_f32_16x16x32_bf16 v[8:11], a[0:3], a[236:239], v[8:11]
    buffer_load_dwordx4 a[196:199], v246, s[24:27], s40 offen offset:2048 sc1
    v_mfma_f32_16x16x32_bf16 v[68:71], a[4:7], a[224:227], v[68:71]
    ds_read_b64_tr_b16 a[36:37], v225 offset:24576
    v_mfma_f32_16x16x32_bf16 v[76:79], a[4:7], a[228:231], v[76:79]
    ds_read_b64_tr_b16 a[38:39], v225 offset:25600
    v_mfma_f32_16x16x32_bf16 v[4:7], a[4:7], a[232:235], v[4:7]
    buffer_load_dwordx4 a[200:203], v238, s[24:27], s41 offen offset:2048 sc1
    v_mfma_f32_16x16x32_bf16 v[12:15], a[4:7], a[236:239], v[12:15]
    ds_read_b64_tr_b16 a[40:41], v226 offset:24576
    v_mfma_f32_16x16x32_bf16 v[80:83], a[8:11], a[224:227], v[80:83]
    buffer_load_dwordx4 a[204:207], v246, s[24:27], s41 offen offset:2048 sc1
    v_mfma_f32_16x16x32_bf16 v[88:91], a[8:11], a[228:231], v[88:91]
    ds_read_b64_tr_b16 a[42:43], v226 offset:25600
    v_mfma_f32_16x16x32_bf16 v[16:19], a[8:11], a[232:235], v[16:19]
    ds_read_b64_tr_b16 a[44:45], v227 offset:24576
    v_mfma_f32_16x16x32_bf16 v[24:27], a[8:11], a[236:239], v[24:27]
    buffer_load_dwordx4 a[208:211], v238, s[24:27], s40 offen offset:3072 sc1
    v_mfma_f32_16x16x32_bf16 v[84:87], a[12:15], a[224:227], v[84:87]
    ds_read_b64_tr_b16 a[46:47], v227 offset:25600
    ds_read_b64_tr_b16 a[48:49], v228 offset:24576
    v_mfma_f32_16x16x32_bf16 v[92:95], a[12:15], a[228:231], v[92:95]
    buffer_load_dwordx4 a[212:215], v246, s[24:27], s40 offen offset:3072 sc1
    v_mfma_f32_16x16x32_bf16 v[20:23], a[12:15], a[232:235], v[20:23]
    ds_read_b64_tr_b16 a[50:51], v228 offset:25600
    v_mfma_f32_16x16x32_bf16 v[28:31], a[12:15], a[236:239], v[28:31]
    ds_read_b64_tr_b16 a[52:53], v229 offset:24576
    s_waitcnt lgkmcnt(11)
    v_mfma_f32_16x16x32_bf16 v[96:99], a[16:19], a[224:227], v[96:99]
    buffer_load_dwordx4 a[216:219], v238, s[24:27], s41 offen offset:3072 sc1
    v_mfma_f32_16x16x32_bf16 v[104:107], a[16:19], a[228:231], v[104:107]
    ds_read_b64_tr_b16 a[54:55], v229 offset:25600
    v_mfma_f32_16x16x32_bf16 v[32:35], a[16:19], a[232:235], v[32:35]
    ds_read_b64_tr_b16 a[56:57], v230 offset:24576
    v_mfma_f32_16x16x32_bf16 v[40:43], a[16:19], a[236:239], v[40:43]
    buffer_load_dwordx4 a[220:223], v246, s[24:27], s41 offen offset:3072 sc1
    s_add_u32 s40, s40, 4096
    s_add_u32 s41, s41, 4096
    v_mfma_f32_16x16x32_bf16 v[100:103], a[20:23], a[224:227], v[100:103]
    ds_read_b64_tr_b16 a[58:59], v230 offset:25600
    v_mfma_f32_16x16x32_bf16 v[108:111], a[20:23], a[228:231], v[108:111]
    s_add_u32 s44, s42, 0
    v_mfma_f32_16x16x32_bf16 v[36:39], a[20:23], a[232:235], v[36:39]
    ds_read_b64_tr_b16 a[60:61], v231 offset:24576
    v_mfma_f32_16x16x32_bf16 v[44:47], a[20:23], a[236:239], v[44:47]
    ds_read_b64_tr_b16 a[62:63], v231 offset:25600
    v_mfma_f32_16x16x32_bf16 v[112:115], a[24:27], a[224:227], v[112:115]
    buffer_store_dwordx4 v[184:187], v244, s[16:19], s44 offen offset:128 sc0 sc1
    v_mfma_f32_16x16x32_bf16 v[120:123], a[24:27], a[228:231], v[120:123]
    v_mfma_f32_16x16x32_bf16 v[48:51], a[24:27], a[232:235], v[48:51]
    ds_write_b128 v248, v[184:187] offset:128
    v_mfma_f32_16x16x32_bf16 v[56:59], a[24:27], a[236:239], v[56:59]
    v_mfma_f32_16x16x32_bf16 v[116:119], a[28:31], a[224:227], v[116:119]
    v_mfma_f32_16x16x32_bf16 v[124:127], a[28:31], a[228:231], v[124:127]
    ds_write_b128 v248, v[188:191] offset:2176
    v_mfma_f32_16x16x32_bf16 v[52:55], a[28:31], a[232:235], v[52:55]
    v_mfma_f32_16x16x32_bf16 v[60:63], a[28:31], a[236:239], v[60:63]
    v_add_u32 v224, 0xfffe0000, v224
    v_add_u32 v225, 0xfffe0000, v225
    v_add_u32 v226, 0xfffe0000, v226
    v_add_u32 v227, 0xfffe0000, v227
    v_add_u32 v228, 0xfffe0000, v228
    v_add_u32 v229, 0xfffe0000, v229
    v_add_u32 v230, 0xfffe0000, v230
    v_add_u32 v231, 0xfffe0000, v231
    s_waitcnt vmcnt(51) lgkmcnt(0)
    s_barrier
    v_mfma_f32_16x16x32_bf16 v[64:67], a[32:35], a[240:243], v[64:67]
    ds_read_b64_tr_b16 a[0:1], v224 offset:0
    v_mfma_f32_16x16x32_bf16 v[72:75], a[32:35], a[244:247], v[72:75]
    s_add_u32 s44, s42, 0
    v_mfma_f32_16x16x32_bf16 v[0:3], a[32:35], a[248:251], v[0:3]
    ds_read_b64_tr_b16 a[2:3], v224 offset:1024
    v_mfma_f32_16x16x32_bf16 v[8:11], a[32:35], a[252:255], v[8:11]
    v_mfma_f32_16x16x32_bf16 v[68:71], a[36:39], a[240:243], v[68:71]
    ds_read_b64_tr_b16 a[4:5], v225 offset:0
    v_mfma_f32_16x16x32_bf16 v[76:79], a[36:39], a[244:247], v[76:79]
    v_mfma_f32_16x16x32_bf16 v[4:7], a[36:39], a[248:251], v[4:7]
    ds_read_b64_tr_b16 a[6:7], v225 offset:1024
    v_mfma_f32_16x16x32_bf16 v[12:15], a[36:39], a[252:255], v[12:15]
    v_mfma_f32_16x16x32_bf16 v[80:83], a[40:43], a[240:243], v[80:83]
    buffer_store_dwordx4 v[188:191], v244, s[16:19], s44 offen offset:2176 sc0 sc1
    v_mfma_f32_16x16x32_bf16 v[88:91], a[40:43], a[244:247], v[88:91]
    ds_read_b64_tr_b16 a[8:9], v226 offset:0
    v_mfma_f32_16x16x32_bf16 v[16:19], a[40:43], a[248:251], v[16:19]
    ds_read_b64_tr_b16 a[10:11], v226 offset:1024
    v_mfma_f32_16x16x32_bf16 v[24:27], a[40:43], a[252:255], v[24:27]
    v_mfma_f32_16x16x32_bf16 v[84:87], a[44:47], a[240:243], v[84:87]
    ds_read_b64_tr_b16 a[12:13], v227 offset:0
    v_mfma_f32_16x16x32_bf16 v[92:95], a[44:47], a[244:247], v[92:95]
    v_mfma_f32_16x16x32_bf16 v[20:23], a[44:47], a[248:251], v[20:23]
    ds_read_b64_tr_b16 a[14:15], v227 offset:1024
    v_mfma_f32_16x16x32_bf16 v[28:31], a[44:47], a[252:255], v[28:31]
    v_mfma_f32_16x16x32_bf16 v[96:99], a[48:51], a[240:243], v[96:99]
    ds_write_b128 v248, v[192:195] offset:8192
    v_mfma_f32_16x16x32_bf16 v[104:107], a[48:51], a[244:247], v[104:107]
    ds_read_b64_tr_b16 a[16:17], v228 offset:0
    v_mfma_f32_16x16x32_bf16 v[32:35], a[48:51], a[248:251], v[32:35]
    ds_read_b64_tr_b16 a[18:19], v228 offset:1024
    v_mfma_f32_16x16x32_bf16 v[40:43], a[48:51], a[252:255], v[40:43]
    v_mfma_f32_16x16x32_bf16 v[100:103], a[52:55], a[240:243], v[100:103]
    ds_read_b64_tr_b16 a[20:21], v229 offset:0
    v_mfma_f32_16x16x32_bf16 v[108:111], a[52:55], a[244:247], v[108:111]
    v_mfma_f32_16x16x32_bf16 v[36:39], a[52:55], a[248:251], v[36:39]
    ds_read_b64_tr_b16 a[22:23], v229 offset:1024
    v_mfma_f32_16x16x32_bf16 v[44:47], a[52:55], a[252:255], v[44:47]
    v_mfma_f32_16x16x32_bf16 v[112:115], a[56:59], a[240:243], v[112:115]
    ds_write_b128 v248, v[196:199] offset:10240
    v_mfma_f32_16x16x32_bf16 v[120:123], a[56:59], a[244:247], v[120:123]
    ds_read_b64_tr_b16 a[24:25], v230 offset:0
    v_mfma_f32_16x16x32_bf16 v[48:51], a[56:59], a[248:251], v[48:51]
    ds_read_b64_tr_b16 a[26:27], v230 offset:1024
    v_mfma_f32_16x16x32_bf16 v[56:59], a[56:59], a[252:255], v[56:59]
    v_mfma_f32_16x16x32_bf16 v[116:119], a[60:63], a[240:243], v[116:119]
    ds_read_b64_tr_b16 a[28:29], v231 offset:0
    v_mfma_f32_16x16x32_bf16 v[124:127], a[60:63], a[244:247], v[124:127]
    v_mfma_f32_16x16x32_bf16 v[52:55], a[60:63], a[248:251], v[52:55]
    ds_read_b64_tr_b16 a[30:31], v231 offset:1024
    v_mfma_f32_16x16x32_bf16 v[60:63], a[60:63], a[252:255], v[60:63]
    s_waitcnt vmcnt(36)
    s_waitcnt lgkmcnt(10)
    v_mfma_f32_16x16x32_bf16 v[64:67], a[0:3], a[128:131], v[64:67]
    ds_read_b64_tr_b16 a[32:33], v224 offset:8192
    v_mfma_f32_16x16x32_bf16 v[72:75], a[0:3], a[132:135], v[72:75]
    buffer_load_dwordx4 a[224:227], v238, s[24:27], s40 offen offset:0 sc1
    v_mfma_f32_16x16x32_bf16 v[0:3], a[0:3], a[136:139], v[0:3]
    ds_read_b64_tr_b16 a[34:35], v224 offset:9216
    v_mfma_f32_16x16x32_bf16 v[8:11], a[0:3], a[140:143], v[8:11]
    buffer_load_dwordx4 a[228:231], v246, s[24:27], s40 offen offset:0 sc1
    v_mfma_f32_16x16x32_bf16 v[68:71], a[4:7], a[128:131], v[68:71]
    ds_read_b64_tr_b16 a[36:37], v225 offset:8192
    v_mfma_f32_16x16x32_bf16 v[76:79], a[4:7], a[132:135], v[76:79]
    v_mfma_f32_16x16x32_bf16 v[4:7], a[4:7], a[136:139], v[4:7]
    buffer_load_dwordx4 a[232:235], v238, s[24:27], s41 offen offset:0 sc1
    v_mfma_f32_16x16x32_bf16 v[12:15], a[4:7], a[140:143], v[12:15]
    ds_read_b64_tr_b16 a[38:39], v225 offset:9216
    v_mfma_f32_16x16x32_bf16 v[80:83], a[8:11], a[128:131], v[80:83]
    buffer_load_dwordx4 a[236:239], v246, s[24:27], s41 offen offset:0 sc1
    v_mfma_f32_16x16x32_bf16 v[88:91], a[8:11], a[132:135], v[88:91]
    ds_read_b64_tr_b16 a[40:41], v226 offset:8192
    v_mfma_f32_16x16x32_bf16 v[16:19], a[8:11], a[136:139], v[16:19]
    ds_read_b64_tr_b16 a[42:43], v226 offset:9216
    v_mfma_f32_16x16x32_bf16 v[24:27], a[8:11], a[140:143], v[24:27]
    buffer_load_dwordx4 a[240:243], v238, s[24:27], s40 offen offset:1024 sc1
    v_mfma_f32_16x16x32_bf16 v[84:87], a[12:15], a[128:131], v[84:87]
    ds_read_b64_tr_b16 a[44:45], v227 offset:8192
    v_mfma_f32_16x16x32_bf16 v[92:95], a[12:15], a[132:135], v[92:95]
    buffer_load_dwordx4 a[244:247], v246, s[24:27], s40 offen offset:1024 sc1
    v_mfma_f32_16x16x32_bf16 v[20:23], a[12:15], a[136:139], v[20:23]
    ds_read_b64_tr_b16 a[46:47], v227 offset:9216
    v_mfma_f32_16x16x32_bf16 v[28:31], a[12:15], a[140:143], v[28:31]
    s_waitcnt lgkmcnt(8)
    v_mfma_f32_16x16x32_bf16 v[96:99], a[16:19], a[128:131], v[96:99]
    buffer_load_dwordx4 a[248:251], v238, s[24:27], s41 offen offset:1024 sc1
    v_mfma_f32_16x16x32_bf16 v[104:107], a[16:19], a[132:135], v[104:107]
    ds_read_b64_tr_b16 a[48:49], v228 offset:8192
    v_mfma_f32_16x16x32_bf16 v[32:35], a[16:19], a[136:139], v[32:35]
    ds_read_b64_tr_b16 a[50:51], v228 offset:9216
    v_mfma_f32_16x16x32_bf16 v[40:43], a[16:19], a[140:143], v[40:43]
    buffer_load_dwordx4 a[252:255], v246, s[24:27], s41 offen offset:1024 sc1
    v_mfma_f32_16x16x32_bf16 v[100:103], a[20:23], a[128:131], v[100:103]
    ds_read_b64_tr_b16 a[52:53], v229 offset:8192
    v_mfma_f32_16x16x32_bf16 v[108:111], a[20:23], a[132:135], v[108:111]
    s_add_u32 s44, s42, 8192
    v_mfma_f32_16x16x32_bf16 v[36:39], a[20:23], a[136:139], v[36:39]
    ds_read_b64_tr_b16 a[54:55], v229 offset:9216
    v_mfma_f32_16x16x32_bf16 v[44:47], a[20:23], a[140:143], v[44:47]
    v_mfma_f32_16x16x32_bf16 v[112:115], a[24:27], a[128:131], v[112:115]
    buffer_store_dwordx4 v[192:195], v244, s[16:19], s44 offen offset:0 sc0 sc1
    v_mfma_f32_16x16x32_bf16 v[120:123], a[24:27], a[132:135], v[120:123]
    ds_read_b64_tr_b16 a[56:57], v230 offset:8192
    v_mfma_f32_16x16x32_bf16 v[48:51], a[24:27], a[136:139], v[48:51]
    ds_write_b128 v248, v[200:203] offset:8320
    v_mfma_f32_16x16x32_bf16 v[56:59], a[24:27], a[140:143], v[56:59]
    ds_read_b64_tr_b16 a[58:59], v230 offset:9216
    v_mfma_f32_16x16x32_bf16 v[116:119], a[28:31], a[128:131], v[116:119]
    ds_read_b64_tr_b16 a[60:61], v231 offset:8192
    v_mfma_f32_16x16x32_bf16 v[124:127], a[28:31], a[132:135], v[124:127]
    ds_write_b128 v248, v[204:207] offset:10368
    v_mfma_f32_16x16x32_bf16 v[52:55], a[28:31], a[136:139], v[52:55]
    ds_read_b64_tr_b16 a[62:63], v231 offset:9216
    v_mfma_f32_16x16x32_bf16 v[60:63], a[28:31], a[140:143], v[60:63]
    s_waitcnt lgkmcnt(10)
    v_mfma_f32_16x16x32_bf16 v[64:67], a[32:35], a[144:147], v[64:67]
    ds_read_b64_tr_b16 a[0:1], v224 offset:16384
    v_mfma_f32_16x16x32_bf16 v[72:75], a[32:35], a[148:151], v[72:75]
    s_add_u32 s44, s42, 8192
    v_mfma_f32_16x16x32_bf16 v[0:3], a[32:35], a[152:155], v[0:3]
    ds_read_b64_tr_b16 a[2:3], v224 offset:17408
    v_mfma_f32_16x16x32_bf16 v[8:11], a[32:35], a[156:159], v[8:11]
    v_mfma_f32_16x16x32_bf16 v[68:71], a[36:39], a[144:147], v[68:71]
    ds_read_b64_tr_b16 a[4:5], v225 offset:16384
    v_mfma_f32_16x16x32_bf16 v[76:79], a[36:39], a[148:151], v[76:79]
    v_mfma_f32_16x16x32_bf16 v[4:7], a[36:39], a[152:155], v[4:7]
    ds_read_b64_tr_b16 a[6:7], v225 offset:17408
    v_mfma_f32_16x16x32_bf16 v[12:15], a[36:39], a[156:159], v[12:15]
    v_mfma_f32_16x16x32_bf16 v[80:83], a[40:43], a[144:147], v[80:83]
    ds_read_b64_tr_b16 a[8:9], v226 offset:16384
    v_mfma_f32_16x16x32_bf16 v[88:91], a[40:43], a[148:151], v[88:91]
    v_mfma_f32_16x16x32_bf16 v[16:19], a[40:43], a[152:155], v[16:19]
    ds_read_b64_tr_b16 a[10:11], v226 offset:17408
    v_mfma_f32_16x16x32_bf16 v[24:27], a[40:43], a[156:159], v[24:27]
    v_mfma_f32_16x16x32_bf16 v[84:87], a[44:47], a[144:147], v[84:87]
    ds_read_b64_tr_b16 a[12:13], v227 offset:16384
    v_mfma_f32_16x16x32_bf16 v[92:95], a[44:47], a[148:151], v[92:95]
    v_mfma_f32_16x16x32_bf16 v[20:23], a[44:47], a[152:155], v[20:23]
    ds_read_b64_tr_b16 a[14:15], v227 offset:17408
    v_mfma_f32_16x16x32_bf16 v[28:31], a[44:47], a[156:159], v[28:31]
    s_waitcnt lgkmcnt(8)
    v_mfma_f32_16x16x32_bf16 v[96:99], a[48:51], a[144:147], v[96:99]
    buffer_store_dwordx4 v[196:199], v244, s[16:19], s44 offen offset:2048 sc0 sc1
    v_mfma_f32_16x16x32_bf16 v[104:107], a[48:51], a[148:151], v[104:107]
    ds_read_b64_tr_b16 a[16:17], v228 offset:16384
    v_mfma_f32_16x16x32_bf16 v[32:35], a[48:51], a[152:155], v[32:35]
    ds_read_b64_tr_b16 a[18:19], v228 offset:17408
    v_mfma_f32_16x16x32_bf16 v[40:43], a[48:51], a[156:159], v[40:43]
    v_mfma_f32_16x16x32_bf16 v[100:103], a[52:55], a[144:147], v[100:103]
    ds_read_b64_tr_b16 a[20:21], v229 offset:16384
    v_mfma_f32_16x16x32_bf16 v[108:111], a[52:55], a[148:151], v[108:111]
    v_mfma_f32_16x16x32_bf16 v[36:39], a[52:55], a[152:155], v[36:39]
    ds_read_b64_tr_b16 a[22:23], v229 offset:17408
    v_mfma_f32_16x16x32_bf16 v[44:47], a[52:55], a[156:159], v[44:47]
    v_mfma_f32_16x16x32_bf16 v[112:115], a[56:59], a[144:147], v[112:115]
    ds_read_b64_tr_b16 a[24:25], v230 offset:16384
    v_mfma_f32_16x16x32_bf16 v[120:123], a[56:59], a[148:151], v[120:123]
    v_mfma_f32_16x16x32_bf16 v[48:51], a[56:59], a[152:155], v[48:51]
    ds_read_b64_tr_b16 a[26:27], v230 offset:17408
    v_mfma_f32_16x16x32_bf16 v[56:59], a[56:59], a[156:159], v[56:59]
    v_mfma_f32_16x16x32_bf16 v[116:119], a[60:63], a[144:147], v[116:119]
    ds_read_b64_tr_b16 a[28:29], v231 offset:16384
    v_mfma_f32_16x16x32_bf16 v[124:127], a[60:63], a[148:151], v[124:127]
    v_mfma_f32_16x16x32_bf16 v[52:55], a[60:63], a[152:155], v[52:55]
    ds_read_b64_tr_b16 a[30:31], v231 offset:17408
    v_mfma_f32_16x16x32_bf16 v[60:63], a[60:63], a[156:159], v[60:63]
    s_waitcnt vmcnt(38)
    s_waitcnt lgkmcnt(8)
    v_mfma_f32_16x16x32_bf16 v[64:67], a[0:3], a[160:163], v[64:67]
    ds_read_b64_tr_b16 a[32:33], v224 offset:24576
    v_mfma_f32_16x16x32_bf16 v[72:75], a[0:3], a[164:167], v[72:75]
    buffer_load_dwordx4 a[128:131], v238, s[24:27], s40 offen offset:2048 sc1
    v_mfma_f32_16x16x32_bf16 v[0:3], a[0:3], a[168:171], v[0:3]
    ds_read_b64_tr_b16 a[34:35], v224 offset:25600
    v_mfma_f32_16x16x32_bf16 v[8:11], a[0:3], a[172:175], v[8:11]
    ds_read_b64_tr_b16 a[36:37], v225 offset:24576
    v_mfma_f32_16x16x32_bf16 v[68:71], a[4:7], a[160:163], v[68:71]
    buffer_load_dwordx4 a[132:135], v246, s[24:27], s40 offen offset:2048 sc1
    v_mfma_f32_16x16x32_bf16 v[76:79], a[4:7], a[164:167], v[76:79]
    ds_read_b64_tr_b16 a[38:39], v225 offset:25600
    v_mfma_f32_16x16x32_bf16 v[4:7], a[4:7], a[168:171], v[4:7]
    ds_read_b64_tr_b16 a[40:41], v226 offset:24576
    v_mfma_f32_16x16x32_bf16 v[12:15], a[4:7], a[172:175], v[12:15]
    buffer_load_dwordx4 a[136:139], v238, s[24:27], s41 offen offset:2048 sc1
    v_mfma_f32_16x16x32_bf16 v[80:83], a[8:11], a[160:163], v[80:83]
    ds_read_b64_tr_b16 a[42:43], v226 offset:25600
    v_mfma_f32_16x16x32_bf16 v[88:91], a[8:11], a[164:167], v[88:91]
    ds_read_b64_tr_b16 a[44:45], v227 offset:24576
    v_mfma_f32_16x16x32_bf16 v[16:19], a[8:11], a[168:171], v[16:19]
    buffer_load_dwordx4 a[140:143], v246, s[24:27], s41 offen offset:2048 sc1
    v_mfma_f32_16x16x32_bf16 v[24:27], a[8:11], a[172:175], v[24:27]
    ds_read_b64_tr_b16 a[46:47], v227 offset:25600
    v_mfma_f32_16x16x32_bf16 v[84:87], a[12:15], a[160:163], v[84:87]
    ds_read_b64_tr_b16 a[48:49], v228 offset:24576
    v_mfma_f32_16x16x32_bf16 v[92:95], a[12:15], a[164:167], v[92:95]
    buffer_load_dwordx4 a[144:147], v238, s[24:27], s40 offen offset:3072 sc1
    v_mfma_f32_16x16x32_bf16 v[20:23], a[12:15], a[168:171], v[20:23]
    ds_read_b64_tr_b16 a[50:51], v228 offset:25600
    v_mfma_f32_16x16x32_bf16 v[28:31], a[12:15], a[172:175], v[28:31]
    ds_read_b64_tr_b16 a[52:53], v229 offset:24576
    s_waitcnt lgkmcnt(11)
    v_mfma_f32_16x16x32_bf16 v[96:99], a[16:19], a[160:163], v[96:99]
    buffer_load_dwordx4 a[148:151], v246, s[24:27], s40 offen offset:3072 sc1
    v_mfma_f32_16x16x32_bf16 v[104:107], a[16:19], a[164:167], v[104:107]
    ds_read_b64_tr_b16 a[54:55], v229 offset:25600
    v_mfma_f32_16x16x32_bf16 v[32:35], a[16:19], a[168:171], v[32:35]
    ds_read_b64_tr_b16 a[56:57], v230 offset:24576
    v_mfma_f32_16x16x32_bf16 v[40:43], a[16:19], a[172:175], v[40:43]
    buffer_load_dwordx4 a[152:155], v238, s[24:27], s41 offen offset:3072 sc1
    v_mfma_f32_16x16x32_bf16 v[100:103], a[20:23], a[160:163], v[100:103]
    ds_read_b64_tr_b16 a[58:59], v230 offset:25600
    v_mfma_f32_16x16x32_bf16 v[108:111], a[20:23], a[164:167], v[108:111]
    ds_read_b64_tr_b16 a[60:61], v231 offset:24576
    v_mfma_f32_16x16x32_bf16 v[36:39], a[20:23], a[168:171], v[36:39]
    buffer_load_dwordx4 a[156:159], v246, s[24:27], s41 offen offset:3072 sc1
    s_add_u32 s40, s40, 4096
    s_add_u32 s41, s41, 4096
    v_mfma_f32_16x16x32_bf16 v[44:47], a[20:23], a[172:175], v[44:47]
    ds_read_b64_tr_b16 a[62:63], v231 offset:25600
    v_mfma_f32_16x16x32_bf16 v[112:115], a[24:27], a[160:163], v[112:115]
    v_mfma_f32_16x16x32_bf16 v[120:123], a[24:27], a[164:167], v[120:123]
    s_add_u32 s44, s42, 8192
    v_mfma_f32_16x16x32_bf16 v[48:51], a[24:27], a[168:171], v[48:51]
    v_mfma_f32_16x16x32_bf16 v[56:59], a[24:27], a[172:175], v[56:59]
    v_mfma_f32_16x16x32_bf16 v[116:119], a[28:31], a[160:163], v[116:119]
    buffer_store_dwordx4 v[200:203], v244, s[16:19], s44 offen offset:128 sc0 sc1
    v_mfma_f32_16x16x32_bf16 v[124:127], a[28:31], a[164:167], v[124:127]
    v_mfma_f32_16x16x32_bf16 v[52:55], a[28:31], a[168:171], v[52:55]
    v_mfma_f32_16x16x32_bf16 v[60:63], a[28:31], a[172:175], v[60:63]
    v_add_u32 v224, 0x10000, v224
    v_add_u32 v225, 0x10000, v225
    v_add_u32 v226, 0x10000, v226
    v_add_u32 v227, 0x10000, v227
    v_add_u32 v228, 0x10000, v228
    v_add_u32 v229, 0x10000, v229
    v_add_u32 v230, 0x10000, v230
    v_add_u32 v231, 0x10000, v231
    s_waitcnt vmcnt(63) lgkmcnt(0)
    s_barrier
    v_mfma_f32_16x16x32_bf16 v[64:67], a[32:35], a[176:179], v[64:67]
    ds_read_b64_tr_b16 a[0:1], v224 offset:0
    v_mfma_f32_16x16x32_bf16 v[72:75], a[32:35], a[180:183], v[72:75]
    s_add_u32 s44, s42, 8192
    v_mfma_f32_16x16x32_bf16 v[0:3], a[32:35], a[184:187], v[0:3]
    ds_read_b64_tr_b16 a[2:3], v224 offset:1024
    v_mfma_f32_16x16x32_bf16 v[8:11], a[32:35], a[188:191], v[8:11]
    v_mfma_f32_16x16x32_bf16 v[68:71], a[36:39], a[176:179], v[68:71]
    ds_read_b64_tr_b16 a[4:5], v225 offset:0
    v_mfma_f32_16x16x32_bf16 v[76:79], a[36:39], a[180:183], v[76:79]
    v_mfma_f32_16x16x32_bf16 v[4:7], a[36:39], a[184:187], v[4:7]
    ds_read_b64_tr_b16 a[6:7], v225 offset:1024
    v_mfma_f32_16x16x32_bf16 v[12:15], a[36:39], a[188:191], v[12:15]
    v_mfma_f32_16x16x32_bf16 v[80:83], a[40:43], a[176:179], v[80:83]
    buffer_store_dwordx4 v[204:207], v244, s[16:19], s44 offen offset:2176 sc0 sc1
    v_mfma_f32_16x16x32_bf16 v[88:91], a[40:43], a[180:183], v[88:91]
    ds_read_b64_tr_b16 a[8:9], v226 offset:0
    v_mfma_f32_16x16x32_bf16 v[16:19], a[40:43], a[184:187], v[16:19]
    ds_read_b64_tr_b16 a[10:11], v226 offset:1024
    v_mfma_f32_16x16x32_bf16 v[24:27], a[40:43], a[188:191], v[24:27]
    v_mfma_f32_16x16x32_bf16 v[84:87], a[44:47], a[176:179], v[84:87]
    ds_read_b64_tr_b16 a[12:13], v227 offset:0
    v_mfma_f32_16x16x32_bf16 v[92:95], a[44:47], a[180:183], v[92:95]
    v_mfma_f32_16x16x32_bf16 v[20:23], a[44:47], a[184:187], v[20:23]
    ds_read_b64_tr_b16 a[14:15], v227 offset:1024
    v_mfma_f32_16x16x32_bf16 v[28:31], a[44:47], a[188:191], v[28:31]
    v_mfma_f32_16x16x32_bf16 v[96:99], a[48:51], a[176:179], v[96:99]
    ds_write_b128 v249, v[128:131] offset:0
    v_mfma_f32_16x16x32_bf16 v[104:107], a[48:51], a[180:183], v[104:107]
    ds_read_b64_tr_b16 a[16:17], v228 offset:0
    v_mfma_f32_16x16x32_bf16 v[32:35], a[48:51], a[184:187], v[32:35]
    ds_read_b64_tr_b16 a[18:19], v228 offset:1024
    v_mfma_f32_16x16x32_bf16 v[40:43], a[48:51], a[188:191], v[40:43]
    v_mfma_f32_16x16x32_bf16 v[100:103], a[52:55], a[176:179], v[100:103]
    ds_read_b64_tr_b16 a[20:21], v229 offset:0
    v_mfma_f32_16x16x32_bf16 v[108:111], a[52:55], a[180:183], v[108:111]
    v_mfma_f32_16x16x32_bf16 v[36:39], a[52:55], a[184:187], v[36:39]
    ds_read_b64_tr_b16 a[22:23], v229 offset:1024
    v_mfma_f32_16x16x32_bf16 v[44:47], a[52:55], a[188:191], v[44:47]
    v_mfma_f32_16x16x32_bf16 v[112:115], a[56:59], a[176:179], v[112:115]
    ds_write_b128 v249, v[132:135] offset:128
    v_mfma_f32_16x16x32_bf16 v[120:123], a[56:59], a[180:183], v[120:123]
    ds_read_b64_tr_b16 a[24:25], v230 offset:0
    v_mfma_f32_16x16x32_bf16 v[48:51], a[56:59], a[184:187], v[48:51]
    ds_read_b64_tr_b16 a[26:27], v230 offset:1024
    v_mfma_f32_16x16x32_bf16 v[56:59], a[56:59], a[188:191], v[56:59]
    v_mfma_f32_16x16x32_bf16 v[116:119], a[60:63], a[176:179], v[116:119]
    ds_read_b64_tr_b16 a[28:29], v231 offset:0
    v_mfma_f32_16x16x32_bf16 v[124:127], a[60:63], a[180:183], v[124:127]
    v_mfma_f32_16x16x32_bf16 v[52:55], a[60:63], a[184:187], v[52:55]
    ds_read_b64_tr_b16 a[30:31], v231 offset:1024
    v_mfma_f32_16x16x32_bf16 v[60:63], a[60:63], a[188:191], v[60:63]
    s_waitcnt vmcnt(32)
    s_waitcnt lgkmcnt(10)
    v_mfma_f32_16x16x32_bf16 v[64:67], a[0:3], a[96:99], v[64:67]
    ds_read_b64_tr_b16 a[32:33], v224 offset:8192
    v_mfma_f32_16x16x32_bf16 v[72:75], a[0:3], a[100:103], v[72:75]
    s_add_u32 s44, s43, 0
    v_mfma_f32_16x16x32_bf16 v[0:3], a[0:3], a[104:107], v[0:3]
    ds_read_b64_tr_b16 a[34:35], v224 offset:9216
    v_mfma_f32_16x16x32_bf16 v[8:11], a[0:3], a[108:111], v[8:11]
    v_mfma_f32_16x16x32_bf16 v[68:71], a[4:7], a[96:99], v[68:71]
    ds_read_b64_tr_b16 a[36:37], v225 offset:8192
    v_mfma_f32_16x16x32_bf16 v[76:79], a[4:7], a[100:103], v[76:79]
    v_mfma_f32_16x16x32_bf16 v[4:7], a[4:7], a[104:107], v[4:7]
    buffer_store_dwordx4 v[128:131], v245, s[20:23], s44 offen offset:0 sc0 sc1
    v_mfma_f32_16x16x32_bf16 v[12:15], a[4:7], a[108:111], v[12:15]
    ds_read_b64_tr_b16 a[38:39], v225 offset:9216
    v_mfma_f32_16x16x32_bf16 v[80:83], a[8:11], a[96:99], v[80:83]
    ds_read_b64_tr_b16 a[40:41], v226 offset:8192
    v_mfma_f32_16x16x32_bf16 v[88:91], a[8:11], a[100:103], v[88:91]
    v_mfma_f32_16x16x32_bf16 v[16:19], a[8:11], a[104:107], v[16:19]
    ds_read_b64_tr_b16 a[42:43], v226 offset:9216
    v_mfma_f32_16x16x32_bf16 v[24:27], a[8:11], a[108:111], v[24:27]
    s_add_u32 s44, s43, 0
    v_mfma_f32_16x16x32_bf16 v[84:87], a[12:15], a[96:99], v[84:87]
    ds_read_b64_tr_b16 a[44:45], v227 offset:8192
    v_mfma_f32_16x16x32_bf16 v[92:95], a[12:15], a[100:103], v[92:95]
    v_mfma_f32_16x16x32_bf16 v[20:23], a[12:15], a[104:107], v[20:23]
    ds_read_b64_tr_b16 a[46:47], v227 offset:9216
    v_mfma_f32_16x16x32_bf16 v[28:31], a[12:15], a[108:111], v[28:31]
    s_waitcnt lgkmcnt(8)
    v_mfma_f32_16x16x32_bf16 v[96:99], a[16:19], a[96:99], v[96:99]
    buffer_store_dwordx4 v[132:135], v245, s[20:23], s44 offen offset:128 sc0 sc1
    v_mfma_f32_16x16x32_bf16 v[104:107], a[16:19], a[100:103], v[104:107]
    ds_read_b64_tr_b16 a[48:49], v228 offset:8192
    v_mfma_f32_16x16x32_bf16 v[32:35], a[16:19], a[104:107], v[32:35]
    ds_read_b64_tr_b16 a[50:51], v228 offset:9216
    v_mfma_f32_16x16x32_bf16 v[40:43], a[16:19], a[108:111], v[40:43]
    v_mfma_f32_16x16x32_bf16 v[100:103], a[20:23], a[96:99], v[100:103]
    ds_read_b64_tr_b16 a[52:53], v229 offset:8192
    v_mfma_f32_16x16x32_bf16 v[108:111], a[20:23], a[100:103], v[108:111]
    ds_write_b128 v249, v[136:139] offset:1024
    v_mfma_f32_16x16x32_bf16 v[36:39], a[20:23], a[104:107], v[36:39]
    ds_read_b64_tr_b16 a[54:55], v229 offset:9216
    v_mfma_f32_16x16x32_bf16 v[44:47], a[20:23], a[108:111], v[44:47]
    v_mfma_f32_16x16x32_bf16 v[112:115], a[24:27], a[96:99], v[112:115]
    ds_read_b64_tr_b16 a[56:57], v230 offset:8192
    v_mfma_f32_16x16x32_bf16 v[120:123], a[24:27], a[100:103], v[120:123]
    v_mfma_f32_16x16x32_bf16 v[48:51], a[24:27], a[104:107], v[48:51]
    ds_write_b128 v249, v[140:143] offset:1152
    v_mfma_f32_16x16x32_bf16 v[56:59], a[24:27], a[108:111], v[56:59]
    ds_read_b64_tr_b16 a[58:59], v230 offset:9216
    v_mfma_f32_16x16x32_bf16 v[116:119], a[28:31], a[96:99], v[116:119]
    ds_read_b64_tr_b16 a[60:61], v231 offset:8192
    v_mfma_f32_16x16x32_bf16 v[124:127], a[28:31], a[100:103], v[124:127]
    v_mfma_f32_16x16x32_bf16 v[52:55], a[28:31], a[104:107], v[52:55]
    ds_read_b64_tr_b16 a[62:63], v231 offset:9216
    v_mfma_f32_16x16x32_bf16 v[60:63], a[28:31], a[108:111], v[60:63]
    s_waitcnt lgkmcnt(10)
    v_mfma_f32_16x16x32_bf16 v[64:67], a[32:35], a[112:115], v[64:67]
    ds_read_b64_tr_b16 a[0:1], v224 offset:16384
    v_mfma_f32_16x16x32_bf16 v[72:75], a[32:35], a[116:119], v[72:75]
    s_add_u32 s44, s43, 0
    s_lshl_b32 s52, s94, 12
    v_mfma_f32_16x16x32_bf16 v[0:3], a[32:35], a[120:123], v[0:3]
    ds_read_b64_tr_b16 a[2:3], v224 offset:17408
    v_mfma_f32_16x16x32_bf16 v[8:11], a[32:35], a[124:127], v[8:11]
    v_add_u32 v242, s52, v238
    v_mfma_f32_16x16x32_bf16 v[68:71], a[36:39], a[112:115], v[68:71]
    ds_read_b64_tr_b16 a[4:5], v225 offset:16384
    v_add_u32 v243, 0x4000, v242
    v_mfma_f32_16x16x32_bf16 v[76:79], a[36:39], a[116:119], v[76:79]
    v_mov_b32 v240, v238
    v_mfma_f32_16x16x32_bf16 v[4:7], a[36:39], a[120:123], v[4:7]
    buffer_store_dwordx4 v[136:139], v245, s[20:23], s44 offen offset:1024 sc0 sc1
    v_mfma_f32_16x16x32_bf16 v[12:15], a[36:39], a[124:127], v[12:15]
    ds_read_b64_tr_b16 a[6:7], v225 offset:17408
    v_mfma_f32_16x16x32_bf16 v[80:83], a[40:43], a[112:115], v[80:83]
    ds_read_b64_tr_b16 a[8:9], v226 offset:16384
    v_add_u32 v241, 0x10000, v238
    v_mfma_f32_16x16x32_bf16 v[88:91], a[40:43], a[116:119], v[88:91]
    s_mov_b32 s53, 0x4e800000
    v_mfma_f32_16x16x32_bf16 v[16:19], a[40:43], a[120:123], v[16:19]
    ds_read_b64_tr_b16 a[10:11], v226 offset:17408
    v_mfma_f32_16x16x32_bf16 v[24:27], a[40:43], a[124:127], v[24:27]
    s_add_u32 s44, s43, 0
    s_add_u32 s12, s92, 0x4000000
    v_mfma_f32_16x16x32_bf16 v[84:87], a[44:47], a[112:115], v[84:87]
    ds_read_b64_tr_b16 a[12:13], v227 offset:16384
    v_mfma_f32_16x16x32_bf16 v[92:95], a[44:47], a[116:119], v[92:95]
    s_addc_u32 s13, s93, 0
    v_mfma_f32_16x16x32_bf16 v[20:23], a[44:47], a[120:123], v[20:23]
    ds_read_b64_tr_b16 a[14:15], v227 offset:17408
    s_mov_b32 s14, 0x1000000
    v_mfma_f32_16x16x32_bf16 v[28:31], a[44:47], a[124:127], v[28:31]
    s_waitcnt lgkmcnt(8)
    v_mfma_f32_16x16x32_bf16 v[96:99], a[48:51], a[112:115], v[96:99]
    buffer_store_dwordx4 v[140:143], v245, s[20:23], s44 offen offset:1152 sc0 sc1
    v_mfma_f32_16x16x32_bf16 v[104:107], a[48:51], a[116:119], v[104:107]
    ds_read_b64_tr_b16 a[16:17], v228 offset:16384
    v_mfma_f32_16x16x32_bf16 v[32:35], a[48:51], a[120:123], v[32:35]
    ds_read_b64_tr_b16 a[18:19], v228 offset:17408
    s_mov_b32 s15, 0x00020000
    v_mfma_f32_16x16x32_bf16 v[40:43], a[48:51], a[124:127], v[40:43]
    s_lshl_b32 s46, s33, 15
    v_mfma_f32_16x16x32_bf16 v[100:103], a[52:55], a[112:115], v[100:103]
    ds_read_b64_tr_b16 a[20:21], v229 offset:16384
    v_mfma_f32_16x16x32_bf16 v[108:111], a[52:55], a[116:119], v[108:111]
    ds_write_b128 v249, v[144:147] offset:8192
    s_mov_b32 s47, s46
    v_mfma_f32_16x16x32_bf16 v[36:39], a[52:55], a[120:123], v[36:39]
    ds_read_b64_tr_b16 a[22:23], v229 offset:17408
    v_mfma_f32_16x16x32_bf16 v[44:47], a[52:55], a[124:127], v[44:47]
    s_mov_b32 s48, s46
    v_mfma_f32_16x16x32_bf16 v[112:115], a[56:59], a[112:115], v[112:115]
    ds_read_b64_tr_b16 a[24:25], v230 offset:16384
    s_mov_b32 s49, s46
    v_mfma_f32_16x16x32_bf16 v[120:123], a[56:59], a[116:119], v[120:123]
    s_lshl_b32 s56, s33, 1
    v_mfma_f32_16x16x32_bf16 v[48:51], a[56:59], a[120:123], v[48:51]
    ds_write_b128 v249, v[148:151] offset:8320
    v_mfma_f32_16x16x32_bf16 v[56:59], a[56:59], a[124:127], v[56:59]
    ds_read_b64_tr_b16 a[26:27], v230 offset:17408
    s_add_u32 s55, s56, 1
    v_mfma_f32_16x16x32_bf16 v[116:119], a[60:63], a[112:115], v[116:119]
    ds_read_b64_tr_b16 a[28:29], v231 offset:16384
    v_mfma_f32_16x16x32_bf16 v[124:127], a[60:63], a[116:119], v[124:127]
    s_mov_b32 s50, 1
    v_mfma_f32_16x16x32_bf16 v[52:55], a[60:63], a[120:123], v[52:55]
    ds_read_b64_tr_b16 a[30:31], v231 offset:17408
    s_mov_b32 s51, 0
    v_mfma_f32_16x16x32_bf16 v[60:63], a[60:63], a[124:127], v[60:63]
    s_mov_b32 s54, 1
    s_waitcnt vmcnt(26)
    s_waitcnt lgkmcnt(10)
    v_mfma_f32_16x16x32_bf16 v[64:67], a[0:3], a[192:195], v[64:67]
    ds_read_b64_tr_b16 a[32:33], v224 offset:24576
    v_mfma_f32_16x16x32_bf16 v[72:75], a[0:3], a[196:199], v[72:75]
    s_add_u32 s44, s43, 8192
    v_mfma_f32_16x16x32_bf16 v[0:3], a[0:3], a[200:203], v[0:3]
    ds_read_b64_tr_b16 a[34:35], v224 offset:25600
    v_mfma_f32_16x16x32_bf16 v[8:11], a[0:3], a[204:207], v[8:11]
    ds_read_b64_tr_b16 a[36:37], v225 offset:24576
    v_mfma_f32_16x16x32_bf16 v[68:71], a[4:7], a[192:195], v[68:71]
    ds_read_b64_tr_b16 a[38:39], v225 offset:25600
    v_mfma_f32_16x16x32_bf16 v[76:79], a[4:7], a[196:199], v[76:79]
    v_mfma_f32_16x16x32_bf16 v[4:7], a[4:7], a[200:203], v[4:7]
    buffer_store_dwordx4 v[144:147], v245, s[20:23], s44 offen offset:0 sc0 sc1
    v_mfma_f32_16x16x32_bf16 v[12:15], a[4:7], a[204:207], v[12:15]
    ds_read_b64_tr_b16 a[40:41], v226 offset:24576
    v_mfma_f32_16x16x32_bf16 v[80:83], a[8:11], a[192:195], v[80:83]
    ds_read_b64_tr_b16 a[42:43], v226 offset:25600
    v_mfma_f32_16x16x32_bf16 v[88:91], a[8:11], a[196:199], v[88:91]
    ds_read_b64_tr_b16 a[44:45], v227 offset:24576
    v_mfma_f32_16x16x32_bf16 v[16:19], a[8:11], a[200:203], v[16:19]
    ds_read_b64_tr_b16 a[46:47], v227 offset:25600
    v_mfma_f32_16x16x32_bf16 v[24:27], a[8:11], a[204:207], v[24:27]
    s_add_u32 s44, s43, 8192
    v_mfma_f32_16x16x32_bf16 v[84:87], a[12:15], a[192:195], v[84:87]
    ds_read_b64_tr_b16 a[48:49], v228 offset:24576
    v_mfma_f32_16x16x32_bf16 v[92:95], a[12:15], a[196:199], v[92:95]
    ds_read_b64_tr_b16 a[50:51], v228 offset:25600
    v_mfma_f32_16x16x32_bf16 v[20:23], a[12:15], a[200:203], v[20:23]
    v_mfma_f32_16x16x32_bf16 v[28:31], a[12:15], a[204:207], v[28:31]
    ds_read_b64_tr_b16 a[52:53], v229 offset:24576
    s_waitcnt lgkmcnt(11)
    v_mfma_f32_16x16x32_bf16 v[96:99], a[16:19], a[192:195], v[96:99]
    buffer_store_dwordx4 v[148:151], v245, s[20:23], s44 offen offset:128 sc0 sc1
    v_mfma_f32_16x16x32_bf16 v[104:107], a[16:19], a[196:199], v[104:107]
    ds_read_b64_tr_b16 a[54:55], v229 offset:25600
    v_mfma_f32_16x16x32_bf16 v[32:35], a[16:19], a[200:203], v[32:35]
    ds_read_b64_tr_b16 a[56:57], v230 offset:24576
    v_mfma_f32_16x16x32_bf16 v[40:43], a[16:19], a[204:207], v[40:43]
    ds_read_b64_tr_b16 a[58:59], v230 offset:25600
    v_mfma_f32_16x16x32_bf16 v[100:103], a[20:23], a[192:195], v[100:103]
    v_mfma_f32_16x16x32_bf16 v[108:111], a[20:23], a[196:199], v[108:111]
    ds_write_b128 v249, v[152:155] offset:9216
    v_mfma_f32_16x16x32_bf16 v[36:39], a[20:23], a[200:203], v[36:39]
    ds_read_b64_tr_b16 a[60:61], v231 offset:24576
    v_mfma_f32_16x16x32_bf16 v[44:47], a[20:23], a[204:207], v[44:47]
    ds_read_b64_tr_b16 a[62:63], v231 offset:25600
    v_mfma_f32_16x16x32_bf16 v[112:115], a[24:27], a[192:195], v[112:115]
    v_mfma_f32_16x16x32_bf16 v[120:123], a[24:27], a[196:199], v[120:123]
    v_mfma_f32_16x16x32_bf16 v[48:51], a[24:27], a[200:203], v[48:51]
    ds_write_b128 v249, v[156:159] offset:9344
    v_mfma_f32_16x16x32_bf16 v[56:59], a[24:27], a[204:207], v[56:59]
    v_mfma_f32_16x16x32_bf16 v[116:119], a[28:31], a[192:195], v[116:119]
    v_mfma_f32_16x16x32_bf16 v[124:127], a[28:31], a[196:199], v[124:127]
    v_mfma_f32_16x16x32_bf16 v[52:55], a[28:31], a[200:203], v[52:55]
    v_mfma_f32_16x16x32_bf16 v[60:63], a[28:31], a[204:207], v[60:63]
    s_waitcnt vmcnt(46) lgkmcnt(0)
    s_barrier
    v_mfma_f32_16x16x32_bf16 v[64:67], a[32:35], a[208:211], v[64:67]
    ds_read_b64_tr_b16 a[0:1], v224 offset:32768
    v_mfma_f32_16x16x32_bf16 v[72:75], a[32:35], a[212:215], v[72:75]
    s_add_u32 s44, s43, 8192
    v_mfma_f32_16x16x32_bf16 v[0:3], a[32:35], a[216:219], v[0:3]
    ds_read_b64_tr_b16 a[2:3], v224 offset:33792
    v_mfma_f32_16x16x32_bf16 v[8:11], a[32:35], a[220:223], v[8:11]
    v_mfma_f32_16x16x32_bf16 v[68:71], a[36:39], a[208:211], v[68:71]
    buffer_store_dwordx4 v[152:155], v245, s[20:23], s44 offen offset:1024 sc0 sc1
    v_mfma_f32_16x16x32_bf16 v[76:79], a[36:39], a[212:215], v[76:79]
    ds_read_b64_tr_b16 a[4:5], v225 offset:32768
    v_mfma_f32_16x16x32_bf16 v[4:7], a[36:39], a[216:219], v[4:7]
    ds_read_b64_tr_b16 a[6:7], v225 offset:33792
    v_mfma_f32_16x16x32_bf16 v[12:15], a[36:39], a[220:223], v[12:15]
    s_add_u32 s44, s43, 8192
    v_mfma_f32_16x16x32_bf16 v[80:83], a[40:43], a[208:211], v[80:83]
    ds_read_b64_tr_b16 a[8:9], v226 offset:32768
    v_mfma_f32_16x16x32_bf16 v[88:91], a[40:43], a[212:215], v[88:91]
    v_mfma_f32_16x16x32_bf16 v[16:19], a[40:43], a[216:219], v[16:19]
    ds_read_b64_tr_b16 a[10:11], v226 offset:33792
    v_mfma_f32_16x16x32_bf16 v[24:27], a[40:43], a[220:223], v[24:27]
    buffer_store_dwordx4 v[156:159], v245, s[20:23], s44 offen offset:1152 sc0 sc1
    v_mfma_f32_16x16x32_bf16 v[84:87], a[44:47], a[208:211], v[84:87]
    ds_read_b64_tr_b16 a[12:13], v227 offset:32768
    v_mfma_f32_16x16x32_bf16 v[92:95], a[44:47], a[212:215], v[92:95]
    v_mfma_f32_16x16x32_bf16 v[20:23], a[44:47], a[216:219], v[20:23]
    v_add_u32 v248, 0x8000, v248
    v_mfma_f32_16x16x32_bf16 v[28:31], a[44:47], a[220:223], v[28:31]
    v_mfma_f32_16x16x32_bf16 v[96:99], a[48:51], a[208:211], v[96:99]
    ds_read_b64_tr_b16 a[14:15], v227 offset:33792
    v_mfma_f32_16x16x32_bf16 v[104:107], a[48:51], a[212:215], v[104:107]
    ds_read_b64_tr_b16 a[16:17], v228 offset:32768
    v_mfma_f32_16x16x32_bf16 v[32:35], a[48:51], a[216:219], v[32:35]
    ds_write_b128 v248, v[208:211] offset:0
    v_mfma_f32_16x16x32_bf16 v[40:43], a[48:51], a[220:223], v[40:43]
    ds_read_b64_tr_b16 a[18:19], v228 offset:33792
    v_mfma_f32_16x16x32_bf16 v[100:103], a[52:55], a[208:211], v[100:103]
    ds_read_b64_tr_b16 a[20:21], v229 offset:32768
    v_mfma_f32_16x16x32_bf16 v[108:111], a[52:55], a[212:215], v[108:111]
    ds_write_b128 v248, v[212:215] offset:2048
    v_mfma_f32_16x16x32_bf16 v[36:39], a[52:55], a[216:219], v[36:39]
    ds_read_b64_tr_b16 a[22:23], v229 offset:33792
    v_mfma_f32_16x16x32_bf16 v[44:47], a[52:55], a[220:223], v[44:47]
    v_mfma_f32_16x16x32_bf16 v[112:115], a[56:59], a[208:211], v[112:115]
    ds_read_b64_tr_b16 a[24:25], v230 offset:32768
    v_mfma_f32_16x16x32_bf16 v[120:123], a[56:59], a[212:215], v[120:123]
    ds_write_b128 v248, v[216:219] offset:128
    v_mfma_f32_16x16x32_bf16 v[48:51], a[56:59], a[216:219], v[48:51]
    ds_read_b64_tr_b16 a[26:27], v230 offset:33792
    v_mfma_f32_16x16x32_bf16 v[56:59], a[56:59], a[220:223], v[56:59]
    v_mfma_f32_16x16x32_bf16 v[116:119], a[60:63], a[208:211], v[116:119]
    ds_write_b128 v248, v[220:223] offset:2176
    v_mfma_f32_16x16x32_bf16 v[124:127], a[60:63], a[212:215], v[124:127]
    ds_read_b64_tr_b16 a[28:29], v231 offset:32768
    v_mfma_f32_16x16x32_bf16 v[52:55], a[60:63], a[216:219], v[52:55]
    ds_read_b64_tr_b16 a[30:31], v231 offset:33792
    v_mfma_f32_16x16x32_bf16 v[60:63], a[60:63], a[220:223], v[60:63]
    s_waitcnt vmcnt(20)
    s_waitcnt lgkmcnt(12)
    v_mfma_f32_16x16x32_bf16 v[64:67], a[0:3], a[224:227], v[64:67]
    ds_read_b64_tr_b16 a[32:33], v224 offset:40960
    v_mfma_f32_16x16x32_bf16 v[72:75], a[0:3], a[228:231], v[72:75]
    s_lshl_b32 s44, s33, 1
    s_sub_u32 s44, 15, s44
    s_lshl_b32 s44, s44, 15
    s_add_u32 s42, s42, s44
    s_add_u32 s43, s43, s44
    s_add_u32 s44, s42, 0
    buffer_store_dwordx4 v[208:211], v244, s[16:19], s44 offen offset:0 sc0 sc1
    v_mfma_f32_16x16x32_bf16 v[0:3], a[0:3], a[232:235], v[0:3]
    ds_read_b64_tr_b16 a[34:35], v224 offset:41984
    v_mfma_f32_16x16x32_bf16 v[8:11], a[0:3], a[236:239], v[8:11]
    v_mfma_f32_16x16x32_bf16 v[68:71], a[4:7], a[224:227], v[68:71]
    ds_read_b64_tr_b16 a[36:37], v225 offset:40960
    v_mfma_f32_16x16x32_bf16 v[76:79], a[4:7], a[228:231], v[76:79]
    s_add_u32 s44, s42, 0
    v_mfma_f32_16x16x32_bf16 v[4:7], a[4:7], a[232:235], v[4:7]
    ds_read_b64_tr_b16 a[38:39], v225 offset:41984
    v_mfma_f32_16x16x32_bf16 v[12:15], a[4:7], a[236:239], v[12:15]
    v_mfma_f32_16x16x32_bf16 v[80:83], a[8:11], a[224:227], v[80:83]
    ds_read_b64_tr_b16 a[40:41], v226 offset:40960
    v_mfma_f32_16x16x32_bf16 v[88:91], a[8:11], a[228:231], v[88:91]
    buffer_store_dwordx4 v[212:215], v244, s[16:19], s44 offen offset:2048 sc0 sc1
    v_mfma_f32_16x16x32_bf16 v[16:19], a[8:11], a[232:235], v[16:19]
    ds_read_b64_tr_b16 a[42:43], v226 offset:41984
    v_mfma_f32_16x16x32_bf16 v[24:27], a[8:11], a[236:239], v[24:27]
    v_mfma_f32_16x16x32_bf16 v[84:87], a[12:15], a[224:227], v[84:87]
    ds_read_b64_tr_b16 a[44:45], v227 offset:40960
    v_mfma_f32_16x16x32_bf16 v[92:95], a[12:15], a[228:231], v[92:95]
    v_mfma_f32_16x16x32_bf16 v[20:23], a[12:15], a[232:235], v[20:23]
    ds_write_b128 v248, a[64:67] offset:8192
    v_mfma_f32_16x16x32_bf16 v[28:31], a[12:15], a[236:239], v[28:31]
    s_waitcnt lgkmcnt(8)
    v_mfma_f32_16x16x32_bf16 v[96:99], a[16:19], a[224:227], v[96:99]
    ds_read_b64_tr_b16 a[46:47], v227 offset:41984
    v_mfma_f32_16x16x32_bf16 v[104:107], a[16:19], a[228:231], v[104:107]
    ds_read_b64_tr_b16 a[48:49], v228 offset:40960
    v_mfma_f32_16x16x32_bf16 v[32:35], a[16:19], a[232:235], v[32:35]
    ds_write_b128 v248, a[68:71] offset:10240
    v_mfma_f32_16x16x32_bf16 v[40:43], a[16:19], a[236:239], v[40:43]
    ds_read_b64_tr_b16 a[50:51], v228 offset:41984
    v_mfma_f32_16x16x32_bf16 v[100:103], a[20:23], a[224:227], v[100:103]
    ds_read_b64_tr_b16 a[52:53], v229 offset:40960
    v_mfma_f32_16x16x32_bf16 v[108:111], a[20:23], a[228:231], v[108:111]
    v_mfma_f32_16x16x32_bf16 v[36:39], a[20:23], a[232:235], v[36:39]
    ds_read_b64_tr_b16 a[54:55], v229 offset:41984
    v_mfma_f32_16x16x32_bf16 v[44:47], a[20:23], a[236:239], v[44:47]
    ds_write_b128 v248, a[72:75] offset:8320
    v_mfma_f32_16x16x32_bf16 v[112:115], a[24:27], a[224:227], v[112:115]
    ds_read_b64_tr_b16 a[56:57], v230 offset:40960
    v_mfma_f32_16x16x32_bf16 v[120:123], a[24:27], a[228:231], v[120:123]
    v_mfma_f32_16x16x32_bf16 v[48:51], a[24:27], a[232:235], v[48:51]
    ds_read_b64_tr_b16 a[58:59], v230 offset:41984
    v_mfma_f32_16x16x32_bf16 v[56:59], a[24:27], a[236:239], v[56:59]
    ds_write_b128 v248, a[76:79] offset:10368
    v_mfma_f32_16x16x32_bf16 v[116:119], a[28:31], a[224:227], v[116:119]
    ds_read_b64_tr_b16 a[60:61], v231 offset:40960
    v_mfma_f32_16x16x32_bf16 v[124:127], a[28:31], a[228:231], v[124:127]
    v_mfma_f32_16x16x32_bf16 v[52:55], a[28:31], a[232:235], v[52:55]
    ds_read_b64_tr_b16 a[62:63], v231 offset:41984
    v_mfma_f32_16x16x32_bf16 v[60:63], a[28:31], a[236:239], v[60:63]
    s_waitcnt lgkmcnt(11)
    v_mfma_f32_16x16x32_bf16 v[64:67], a[32:35], a[240:243], v[64:67]
    ds_read_b64_tr_b16 a[0:1], v224 offset:49152
    v_mfma_f32_16x16x32_bf16 v[72:75], a[32:35], a[244:247], v[72:75]
    s_add_u32 s44, s42, 0
    v_mfma_f32_16x16x32_bf16 v[0:3], a[32:35], a[248:251], v[0:3]
    ds_read_b64_tr_b16 a[2:3], v224 offset:50176
    v_lshrrev_b32 v252, 4, v238
    v_mfma_f32_16x16x32_bf16 v[8:11], a[32:35], a[252:255], v[8:11]
    v_lshrrev_b32 v253, 5, v252
    v_and_b32 v252, 31, v252
    v_mfma_f32_16x16x32_bf16 v[68:71], a[36:39], a[240:243], v[68:71]
    ds_read_b64_tr_b16 a[4:5], v225 offset:49152
    v_lshlrev_b32 v253, 2, v253
    v_mfma_f32_16x16x32_bf16 v[76:79], a[36:39], a[244:247], v[76:79]
    v_sub_u32 v252, v252, v253
    v_mov_b32 v253, 0xf149f2ca
    v_mfma_f32_16x16x32_bf16 v[4:7], a[36:39], a[248:251], v[4:7]
    ds_read_b64_tr_b16 a[6:7], v225 offset:50176
    v_mov_b32 v176, 0
    v_mfma_f32_16x16x32_bf16 v[12:15], a[36:39], a[252:255], v[12:15]
    v_mov_b32 v177, 0
    v_mov_b32 v178, 0
    v_mfma_f32_16x16x32_bf16 v[80:83], a[40:43], a[240:243], v[80:83]
    buffer_store_dwordx4 v[216:219], v244, s[16:19], s44 offen offset:128 sc0 sc1
    v_mfma_f32_16x16x32_bf16 v[88:91], a[40:43], a[244:247], v[88:91]
    ds_read_b64_tr_b16 a[8:9], v226 offset:49152
    v_mov_b32 v179, 0
    v_mfma_f32_16x16x32_bf16 v[16:19], a[40:43], a[248:251], v[16:19]
    ds_read_b64_tr_b16 a[10:11], v226 offset:50176
    v_mov_b32 v180, 0
    v_mfma_f32_16x16x32_bf16 v[24:27], a[40:43], a[252:255], v[24:27]
    v_mov_b32 v181, 0
    v_mov_b32 v182, 0
    v_mfma_f32_16x16x32_bf16 v[84:87], a[44:47], a[240:243], v[84:87]
    ds_read_b64_tr_b16 a[12:13], v227 offset:49152
    v_mov_b32 v183, 0
    v_mfma_f32_16x16x32_bf16 v[92:95], a[44:47], a[244:247], v[92:95]
    v_mov_b32 v184, 0
    v_mov_b32 v185, 0
    v_mfma_f32_16x16x32_bf16 v[20:23], a[44:47], a[248:251], v[20:23]
    ds_read_b64_tr_b16 a[14:15], v227 offset:50176
    v_mov_b32 v186, 0
    v_mfma_f32_16x16x32_bf16 v[28:31], a[44:47], a[252:255], v[28:31]
    s_waitcnt vmcnt(3) lgkmcnt(0)
    s_barrier
    s_cmp_lg_u32 s94, 0
    s_cbranch_scc1 nf_10
    s_lshl_b32 s3, s32, 6
    s_lshl_b32 s4, s33, 3
    s_add_u32 s3, s3, s4
    s_add_u32 s3, s3, 2048
    buffer_store_dwordx2 v[250:251], off, s[64:67], s3 sc0 sc1
nf_10:
    v_mfma_f32_16x16x32_bf16 v[96:99], a[48:51], a[240:243], v[96:99]
    s_add_u32 s44, s42, 0
    v_mov_b32 v187, 0
    v_mfma_f32_16x16x32_bf16 v[104:107], a[48:51], a[244:247], v[104:107]
    ds_read_b64_tr_b16 a[16:17], v228 offset:49152
    v_mov_b32 v188, 0
    v_mfma_f32_16x16x32_bf16 v[32:35], a[48:51], a[248:251], v[32:35]
    ds_read_b64_tr_b16 a[18:19], v228 offset:50176
    v_mov_b32 v189, 0
    v_mfma_f32_16x16x32_bf16 v[40:43], a[48:51], a[252:255], v[40:43]
    v_mov_b32 v190, 0
    v_mov_b32 v191, 0
    v_mfma_f32_16x16x32_bf16 v[100:103], a[52:55], a[240:243], v[100:103]
    ds_read_b64_tr_b16 a[20:21], v229 offset:49152
    v_mov_b32 v192, 0
    v_mfma_f32_16x16x32_bf16 v[108:111], a[52:55], a[244:247], v[108:111]
    v_mov_b32 v193, 0
    v_mov_b32 v194, 0
    v_mfma_f32_16x16x32_bf16 v[36:39], a[52:55], a[248:251], v[36:39]
    ds_read_b64_tr_b16 a[22:23], v229 offset:50176
    v_mov_b32 v195, 0
    v_mfma_f32_16x16x32_bf16 v[44:47], a[52:55], a[252:255], v[44:47]
    v_mov_b32 v196, 0
    v_mov_b32 v197, 0
    v_mfma_f32_16x16x32_bf16 v[112:115], a[56:59], a[240:243], v[112:115]
    buffer_store_dwordx4 v[220:223], v244, s[16:19], s44 offen offset:2176 sc0 sc1
    v_mfma_f32_16x16x32_bf16 v[120:123], a[56:59], a[244:247], v[120:123]
    ds_read_b64_tr_b16 a[24:25], v230 offset:49152
    v_mov_b32 v198, 0
    v_mfma_f32_16x16x32_bf16 v[48:51], a[56:59], a[248:251], v[48:51]
    ds_read_b64_tr_b16 a[26:27], v230 offset:50176
    v_mov_b32 v199, 0
    v_mfma_f32_16x16x32_bf16 v[56:59], a[56:59], a[252:255], v[56:59]
    v_mov_b32 v200, 0
    v_mov_b32 v201, 0
    v_mfma_f32_16x16x32_bf16 v[116:119], a[60:63], a[240:243], v[116:119]
    ds_read_b64_tr_b16 a[28:29], v231 offset:49152
    v_mov_b32 v202, 0
    v_mfma_f32_16x16x32_bf16 v[124:127], a[60:63], a[244:247], v[124:127]
    v_mov_b32 v203, 0
    v_mov_b32 v204, 0
    v_mfma_f32_16x16x32_bf16 v[52:55], a[60:63], a[248:251], v[52:55]
    ds_read_b64_tr_b16 a[30:31], v231 offset:50176
    v_mov_b32 v205, 0
    v_mfma_f32_16x16x32_bf16 v[60:63], a[60:63], a[252:255], v[60:63]
    v_mov_b32 v206, 0
    v_mov_b32 v207, 0
    s_waitcnt vmcnt(14)
    s_waitcnt lgkmcnt(8)
    v_mfma_f32_16x16x32_bf16 v[64:67], a[0:3], a[128:131], v[64:67]
    ds_read_b64_tr_b16 a[32:33], v224 offset:57344
    v_cmp_gt_i32 s[8:9], 0, v252
    v_mfma_f32_16x16x32_bf16 v[72:75], a[0:3], a[132:135], v[72:75]
    s_add_u32 s44, s42, 8192
    v_mfma_f32_16x16x32_bf16 v[0:3], a[0:3], a[136:139], v[0:3]
    ds_read_b64_tr_b16 a[34:35], v224 offset:58368
    v_cmp_gt_i32 s[10:11], 1, v252
    v_mfma_f32_16x16x32_bf16 v[8:11], a[0:3], a[140:143], v[8:11]
    ds_read_b64_tr_b16 a[36:37], v225 offset:57344
    v_mfma_f32_16x16x32_bf16 v[68:71], a[4:7], a[128:131], v[68:71]
    ds_read_b64_tr_b16 a[38:39], v225 offset:58368
    v_cmp_gt_i32 s[34:35], 2, v252
    v_mfma_f32_16x16x32_bf16 v[76:79], a[4:7], a[132:135], v[76:79]
    v_cmp_gt_i32 s[36:37], 3, v252
    v_cmp_gt_i32 s[30:31], 8, v252
    v_mfma_f32_16x16x32_bf16 v[4:7], a[4:7], a[136:139], v[4:7]
    ds_read_b64_tr_b16 a[40:41], v226 offset:57344
    v_mfma_f32_16x16x32_bf16 v[12:15], a[4:7], a[140:143], v[12:15]
    ds_read_b64_tr_b16 a[42:43], v226 offset:58368
    v_cmp_gt_i32 s[60:61], 9, v252
    v_mfma_f32_16x16x32_bf16 v[80:83], a[8:11], a[128:131], v[80:83]
    buffer_store_dwordx4 a[64:67], v244, s[16:19], s44 offen offset:0 sc0 sc1
    v_mfma_f32_16x16x32_bf16 v[88:91], a[8:11], a[132:135], v[88:91]
    ds_read_b64_tr_b16 a[44:45], v227 offset:57344
    v_cmp_gt_i32 s[62:63], 10, v252
    v_mfma_f32_16x16x32_bf16 v[16:19], a[8:11], a[136:139], v[16:19]
    ds_read_b64_tr_b16 a[46:47], v227 offset:58368
    v_mfma_f32_16x16x32_bf16 v[24:27], a[8:11], a[140:143], v[24:27]
    v_cmp_gt_i32 s[6:7], 11, v252
    v_cndmask_b32 v128, 0, v253, s[8:9]
    v_mfma_f32_16x16x32_bf16 v[84:87], a[12:15], a[128:131], v[84:87]
    ds_read_b64_tr_b16 a[48:49], v228 offset:57344
    v_mfma_f32_16x16x32_bf16 v[92:95], a[12:15], a[132:135], v[92:95]
    ds_read_b64_tr_b16 a[50:51], v228 offset:58368
    v_cndmask_b32 v129, 0, v253, s[10:11]
    v_mfma_f32_16x16x32_bf16 v[20:23], a[12:15], a[136:139], v[20:23]
    v_cndmask_b32 v130, 0, v253, s[34:35]
    v_cndmask_b32 v131, 0, v253, s[36:37]
    v_mfma_f32_16x16x32_bf16 v[28:31], a[12:15], a[140:143], v[28:31]
    ds_read_b64_tr_b16 a[52:53], v229 offset:57344
    s_waitcnt lgkmcnt(11)
    v_mfma_f32_16x16x32_bf16 v[96:99], a[16:19], a[128:131], v[96:99]
    s_add_u32 s44, s42, 8192
    v_mfma_f32_16x16x32_bf16 v[104:107], a[16:19], a[132:135], v[104:107]
    ds_read_b64_tr_b16 a[54:55], v229 offset:58368
    v_cndmask_b32 v132, 0, v253, s[30:31]
    v_mfma_f32_16x16x32_bf16 v[32:35], a[16:19], a[136:139], v[32:35]
    ds_read_b64_tr_b16 a[56:57], v230 offset:57344
    v_cndmask_b32 v133, 0, v253, s[60:61]
    v_mfma_f32_16x16x32_bf16 v[40:43], a[16:19], a[140:143], v[40:43]
    ds_read_b64_tr_b16 a[58:59], v230 offset:58368
    v_mfma_f32_16x16x32_bf16 v[100:103], a[20:23], a[128:131], v[100:103]
    v_cndmask_b32 v134, 0, v253, s[62:63]
    v_cndmask_b32 v135, 0, v253, s[6:7]
    v_mfma_f32_16x16x32_bf16 v[108:111], a[20:23], a[132:135], v[108:111]
    ds_read_b64_tr_b16 a[60:61], v231 offset:57344
    v_mfma_f32_16x16x32_bf16 v[36:39], a[20:23], a[136:139], v[36:39]
    ds_read_b64_tr_b16 a[62:63], v231 offset:58368
    s_lshl_b32 s3, s33, 2
    v_mfma_f32_16x16x32_bf16 v[44:47], a[20:23], a[140:143], v[44:47]
    s_add_u32 s3, s3, 3
    s_sub_u32 s3, s3, s94
    v_mfma_f32_16x16x32_bf16 v[112:115], a[24:27], a[128:131], v[112:115]
    buffer_store_dwordx4 a[68:71], v244, s[16:19], s44 offen offset:2048 sc0 sc1
    v_mfma_f32_16x16x32_bf16 v[120:123], a[24:27], a[132:135], v[120:123]
    s_lshl_b32 s4, s3, 18
    v_mfma_f32_16x16x32_bf16 v[48:51], a[24:27], a[136:139], v[48:51]
    s_lshl_b32 s5, s32, 13
    s_add_u32 s57, s4, s5
    v_mfma_f32_16x16x32_bf16 v[56:59], a[24:27], a[140:143], v[56:59]
    s_lshl_b32 s4, s3, 12
    s_lshl_b32 s5, s32, 3
    v_mfma_f32_16x16x32_bf16 v[116:119], a[28:31], a[128:131], v[116:119]
    s_add_u32 s4, s4, s5
    v_mfma_f32_16x16x32_bf16 v[124:127], a[28:31], a[132:135], v[124:127]
    s_add_u32 s58, s4, 65536
    v_mov_b32 v216, 0
    v_mfma_f32_16x16x32_bf16 v[52:55], a[28:31], a[136:139], v[52:55]
    v_mov_b32 v217, 0
    v_mfma_f32_16x16x32_bf16 v[60:63], a[28:31], a[140:143], v[60:63]
    v_mov_b32 v214, 0
    v_mov_b32 v215, 0
    s_waitcnt lgkmcnt(8)
    v_mfma_f32_16x16x32_bf16 v[64:67], a[32:35], a[144:147], v[64:67]
    v_cmp_gt_i32 s[8:9], 16, v252
    v_mfma_f32_16x16x32_bf16 v[72:75], a[32:35], a[148:151], v[72:75]
    s_add_u32 s44, s42, 8192
    v_mfma_f32_16x16x32_bf16 v[0:3], a[32:35], a[152:155], v[0:3]
    v_mfma_f32_16x16x32_bf16 v[8:11], a[32:35], a[156:159], v[8:11]
    v_cmp_gt_i32 s[10:11], 17, v252
    v_mfma_f32_16x16x32_bf16 v[68:71], a[36:39], a[144:147], v[68:71]
    v_mfma_f32_16x16x32_bf16 v[76:79], a[36:39], a[148:151], v[76:79]
    v_cmp_gt_i32 s[34:35], 18, v252
    v_mfma_f32_16x16x32_bf16 v[4:7], a[36:39], a[152:155], v[4:7]
    v_cmp_gt_i32 s[36:37], 19, v252
    v_mfma_f32_16x16x32_bf16 v[12:15], a[36:39], a[156:159], v[12:15]
    v_mfma_f32_16x16x32_bf16 v[80:83], a[40:43], a[144:147], v[80:83]
    buffer_store_dwordx4 a[72:75], v244, s[16:19], s44 offen offset:128 sc0 sc1
    v_mfma_f32_16x16x32_bf16 v[88:91], a[40:43], a[148:151], v[88:91]
    v_cmp_gt_i32 s[30:31], 24, v252
    v_mfma_f32_16x16x32_bf16 v[16:19], a[40:43], a[152:155], v[16:19]
    v_mfma_f32_16x16x32_bf16 v[24:27], a[40:43], a[156:159], v[24:27]
    v_cmp_gt_i32 s[60:61], 25, v252
    v_mfma_f32_16x16x32_bf16 v[84:87], a[44:47], a[144:147], v[84:87]
    v_cmp_gt_i32 s[62:63], 26, v252
    v_mfma_f32_16x16x32_bf16 v[92:95], a[44:47], a[148:151], v[92:95]
    v_mfma_f32_16x16x32_bf16 v[20:23], a[44:47], a[152:155], v[20:23]
    v_cmp_gt_i32 s[6:7], 27, v252
    v_mfma_f32_16x16x32_bf16 v[28:31], a[44:47], a[156:159], v[28:31]
    s_waitcnt lgkmcnt(0)
    v_mfma_f32_16x16x32_bf16 v[96:99], a[48:51], a[144:147], v[96:99]
    s_add_u32 s44, s42, 8192
    v_mfma_f32_16x16x32_bf16 v[104:107], a[48:51], a[148:151], v[104:107]
    v_mfma_f32_16x16x32_bf16 v[32:35], a[48:51], a[152:155], v[32:35]
    v_cndmask_b32 v136, 0, v253, s[8:9]
    v_mfma_f32_16x16x32_bf16 v[40:43], a[48:51], a[156:159], v[40:43]
    v_mfma_f32_16x16x32_bf16 v[100:103], a[52:55], a[144:147], v[100:103]
    v_cndmask_b32 v137, 0, v253, s[10:11]
    v_mfma_f32_16x16x32_bf16 v[108:111], a[52:55], a[148:151], v[108:111]
    v_cndmask_b32 v138, 0, v253, s[34:35]
    v_mfma_f32_16x16x32_bf16 v[36:39], a[52:55], a[152:155], v[36:39]
    v_mfma_f32_16x16x32_bf16 v[44:47], a[52:55], a[156:159], v[44:47]
    v_cndmask_b32 v139, 0, v253, s[36:37]
    v_mfma_f32_16x16x32_bf16 v[112:115], a[56:59], a[144:147], v[112:115]
    buffer_store_dwordx4 a[76:79], v244, s[16:19], s44 offen offset:2176 sc0 sc1
    v_mfma_f32_16x16x32_bf16 v[120:123], a[56:59], a[148:151], v[120:123]
    v_mfma_f32_16x16x32_bf16 v[48:51], a[56:59], a[152:155], v[48:51]
    v_cndmask_b32 v140, 0, v253, s[30:31]
    v_mfma_f32_16x16x32_bf16 v[56:59], a[56:59], a[156:159], v[56:59]
    v_cndmask_b32 v141, 0, v253, s[60:61]
    v_mfma_f32_16x16x32_bf16 v[116:119], a[60:63], a[144:147], v[116:119]
    v_mfma_f32_16x16x32_bf16 v[124:127], a[60:63], a[148:151], v[124:127]
    v_cndmask_b32 v142, 0, v253, s[62:63]
    v_mfma_f32_16x16x32_bf16 v[52:55], a[60:63], a[152:155], v[52:55]
    v_mfma_f32_16x16x32_bf16 v[60:63], a[60:63], a[156:159], v[60:63]
    v_cndmask_b32 v143, 0, v253, s[6:7]
    s_nop 3
    s_lshl_b32 s45, s32, 6
    s_add_u32 s45, s45, 2048
    v_lshrrev_b32 v239, 1, v238
    v_and_b32 v239, 56, v239
    buffer_load_dwordx2 v[252:253], v239, s[64:67], s45 offen sc1
    s_mov_b32 s34, 0
    s_mov_b32 s35, 268435456
    s_add_u32 s48, s46, s34
    s_add_u32 s49, s47, s34
    s_add_u32 s50, s50, 1
    s_cmp_ge_u32 s50, 17
    s_cselect_b32 s46, s35, s51
    s_cselect_b32 s4, 0xffffd000, 0
    s_cselect_b32 s34, 0xff002000, 0
    s_cselect_b32 s5, 0x2000, 0
    s_sub_u32 s35, s35, s5
    s_add_u32 s4, s4, s46
    s_cmp_le_u32 s50, s55
    s_cselect_b32 s47, 268435456, s4
    s_cselect_b32 s3, 1, 2
    s_lshl_b32 s3, s3, 14
    s_add_u32 s51, s51, s3
    v_cvt_pk_bf16_f32 v0, v0, v1
    v_cvt_pk_bf16_f32 v1, v2, v3
    v_cvt_pk_bf16_f32 v2, v4, v5
    v_cvt_pk_bf16_f32 v3, v6, v7
    v_cvt_pk_bf16_f32 v8, v8, v9
    v_cvt_pk_bf16_f32 v9, v10, v11
    v_cvt_pk_bf16_f32 v10, v12, v13
    v_cvt_pk_bf16_f32 v11, v14, v15
    v_cvt_pk_bf16_f32 v16, v16, v17
    v_cvt_pk_bf16_f32 v17, v18, v19
    v_cvt_pk_bf16_f32 v18, v20, v21
    v_cvt_pk_bf16_f32 v19, v22, v23
    v_cvt_pk_bf16_f32 v24, v24, v25
    v_cvt_pk_bf16_f32 v25, v26, v27
    v_cvt_pk_bf16_f32 v26, v28, v29
    v_cvt_pk_bf16_f32 v27, v30, v31
    s_nop 0
    v_permlane16_swap_b32 v0, v8
    v_permlane16_swap_b32 v1, v9
    v_permlane16_swap_b32 v2, v10
    v_permlane16_swap_b32 v3, v11
    v_permlane16_swap_b32 v16, v24
    v_permlane16_swap_b32 v17, v25
    v_permlane16_swap_b32 v18, v26
    v_permlane16_swap_b32 v19, v27
    v_accvgpr_write_b32 a160, v0
    v_accvgpr_write_b32 a161, v1
    v_accvgpr_write_b32 a162, v2
    v_accvgpr_write_b32 a163, v3
    v_accvgpr_write_b32 a164, v8
    v_accvgpr_write_b32 a165, v9
    v_accvgpr_write_b32 a166, v10
    v_accvgpr_write_b32 a167, v11
    v_accvgpr_write_b32 a168, v16
    v_accvgpr_write_b32 a169, v17
    v_accvgpr_write_b32 a170, v18
    v_accvgpr_write_b32 a171, v19
    v_accvgpr_write_b32 a172, v24
    v_accvgpr_write_b32 a173, v25
    v_accvgpr_write_b32 a174, v26
    v_accvgpr_write_b32 a175, v27
    v_cvt_pk_bf16_f32 v32, v32, v33
    v_cvt_pk_bf16_f32 v33, v34, v35
    v_cvt_pk_bf16_f32 v34, v36, v37
    v_cvt_pk_bf16_f32 v35, v38, v39
    v_cvt_pk_bf16_f32 v40, v40, v41
    v_cvt_pk_bf16_f32 v41, v42, v43
    v_cvt_pk_bf16_f32 v42, v44, v45
    v_cvt_pk_bf16_f32 v43, v46, v47
    v_cvt_pk_bf16_f32 v48, v48, v49
    v_cvt_pk_bf16_f32 v49, v50, v51
    v_cvt_pk_bf16_f32 v50, v52, v53
    v_cvt_pk_bf16_f32 v51, v54, v55
    v_cvt_pk_bf16_f32 v56, v56, v57
    v_cvt_pk_bf16_f32 v57, v58, v59
    v_cvt_pk_bf16_f32 v58, v60, v61
    v_cvt_pk_bf16_f32 v59, v62, v63
    s_nop 0
    v_permlane16_swap_b32 v32, v40
    v_permlane16_swap_b32 v33, v41
    v_permlane16_swap_b32 v34, v42
    v_permlane16_swap_b32 v35, v43
    v_permlane16_swap_b32 v48, v56
    v_permlane16_swap_b32 v49, v57
    v_permlane16_swap_b32 v50, v58
    v_permlane16_swap_b32 v51, v59
    v_accvgpr_write_b32 a176, v32
    v_accvgpr_write_b32 a177, v33
    v_accvgpr_write_b32 a178, v34
    v_accvgpr_write_b32 a179, v35
    v_accvgpr_write_b32 a180, v40
    v_accvgpr_write_b32 a181, v41
    v_accvgpr_write_b32 a182, v42
    v_accvgpr_write_b32 a183, v43
    v_accvgpr_write_b32 a184, v48
    v_accvgpr_write_b32 a185, v49
    v_accvgpr_write_b32 a186, v50
    v_accvgpr_write_b32 a187, v51
    v_accvgpr_write_b32 a188, v56
    v_accvgpr_write_b32 a189, v57
    v_accvgpr_write_b32 a190, v58
    v_accvgpr_write_b32 a191, v59
    v_cvt_pk_bf16_f32 v64, v64, v65
    v_cvt_pk_bf16_f32 v65, v66, v67
    v_cvt_pk_bf16_f32 v66, v68, v69
    v_cvt_pk_bf16_f32 v67, v70, v71
    v_cvt_pk_bf16_f32 v72, v72, v73
    v_cvt_pk_bf16_f32 v73, v74, v75
    v_cvt_pk_bf16_f32 v74, v76, v77
    v_cvt_pk_bf16_f32 v75, v78, v79
    v_cvt_pk_bf16_f32 v80, v80, v81
    v_cvt_pk_bf16_f32 v81, v82, v83
    v_cvt_pk_bf16_f32 v82, v84, v85
    v_cvt_pk_bf16_f32 v83, v86, v87
    v_cvt_pk_bf16_f32 v88, v88, v89
    v_cvt_pk_bf16_f32 v89, v90, v91
    v_cvt_pk_bf16_f32 v90, v92, v93
    v_cvt_pk_bf16_f32 v91, v94, v95
    s_nop 0
    v_permlane16_swap_b32 v64, v72
    v_permlane16_swap_b32 v65, v73
    v_permlane16_swap_b32 v66, v74
    v_permlane16_swap_b32 v67, v75
    v_permlane16_swap_b32 v80, v88
    v_permlane16_swap_b32 v81, v89
    v_permlane16_swap_b32 v82, v90
    v_permlane16_swap_b32 v83, v91
    v_accvgpr_write_b32 a128, v64
    v_accvgpr_write_b32 a129, v65
    v_accvgpr_write_b32 a130, v66
    v_accvgpr_write_b32 a131, v67
    v_accvgpr_write_b32 a132, v72
    v_accvgpr_write_b32 a133, v73
    v_accvgpr_write_b32 a134, v74
    v_accvgpr_write_b32 a135, v75
    v_accvgpr_write_b32 a136, v80
    v_accvgpr_write_b32 a137, v81
    v_accvgpr_write_b32 a138, v82
    v_accvgpr_write_b32 a139, v83
    v_accvgpr_write_b32 a140, v88
    v_accvgpr_write_b32 a141, v89
    v_accvgpr_write_b32 a142, v90
    v_accvgpr_write_b32 a143, v91
    s_waitcnt vmcnt(0)
    v_cmp_ne_u64 vcc, s[96:97], v[252:253]
    s_cbranch_vccnz spin_12
ok_11:
    s_add_u32 m0, s52, 0
    s_nop 0
    buffer_load_dwordx4 v242, s[16:19], s46 offen offset:0 sc1 lds
    buffer_load_dwordx4 v242, s[16:19], s46 offen offset:1024 sc1 lds
    buffer_load_dwordx4 v242, s[16:19], s46 offen offset:2048 sc1 lds
    buffer_load_dwordx4 v242, s[16:19], s46 offen offset:3072 sc1 lds
    s_add_u32 m0, s52, 16384
    s_nop 0
    buffer_load_dwordx4 v243, s[16:19], s47 offen offset:0 sc1 lds
    buffer_load_dwordx4 v243, s[16:19], s47 offen offset:1024 sc1 lds
    buffer_load_dwordx4 v243, s[16:19], s47 offen offset:2048 sc1 lds
    buffer_load_dwordx4 v243, s[16:19], s47 offen offset:3072 sc1 lds
    v_cvt_pk_bf16_f32 v96, v96, v97
    v_cvt_pk_bf16_f32 v97, v98, v99
    v_cvt_pk_bf16_f32 v98, v100, v101
    v_cvt_pk_bf16_f32 v99, v102, v103
    v_cvt_pk_bf16_f32 v104, v104, v105
    v_cvt_pk_bf16_f32 v105, v106, v107
    v_cvt_pk_bf16_f32 v106, v108, v109
    v_cvt_pk_bf16_f32 v107, v110, v111
    v_cvt_pk_bf16_f32 v112, v112, v113
    v_cvt_pk_bf16_f32 v113, v114, v115
    v_cvt_pk_bf16_f32 v114, v116, v117
    v_cvt_pk_bf16_f32 v115, v118, v119
    v_cvt_pk_bf16_f32 v120, v120, v121
    v_cvt_pk_bf16_f32 v121, v122, v123
    v_cvt_pk_bf16_f32 v122, v124, v125
    v_cvt_pk_bf16_f32 v123, v126, v127
    s_nop 0
    v_permlane16_swap_b32 v96, v104
    v_permlane16_swap_b32 v97, v105
    v_permlane16_swap_b32 v98, v106
    v_permlane16_swap_b32 v99, v107
    v_permlane16_swap_b32 v112, v120
    v_permlane16_swap_b32 v113, v121
    v_permlane16_swap_b32 v114, v122
    v_permlane16_swap_b32 v115, v123
    v_accvgpr_write_b32 a144, v96
    v_accvgpr_write_b32 a145, v97
    v_accvgpr_write_b32 a146, v98
    v_accvgpr_write_b32 a147, v99
    v_accvgpr_write_b32 a148, v104
    v_accvgpr_write_b32 a149, v105
    v_accvgpr_write_b32 a150, v106
    v_accvgpr_write_b32 a151, v107
    v_accvgpr_write_b32 a152, v112
    v_accvgpr_write_b32 a153, v113
    v_accvgpr_write_b32 a154, v114
    v_accvgpr_write_b32 a155, v115
    v_accvgpr_write_b32 a156, v120
    v_accvgpr_write_b32 a157, v121
    v_accvgpr_write_b32 a158, v122
    v_accvgpr_write_b32 a159, v123
    v_add_u32 v246, 0x20000, v238
    s_waitcnt lgkmcnt(0)
    s_barrier
    s_cmp_eq_u32 s94, 1
    s_cbranch_scc1 K2_D1_1
    s_cmp_eq_u32 s94, 2
    s_cbranch_scc1 K2_D1_2
    s_cmp_eq_u32 s94, 3
    s_cbranch_scc1 K2_D1_3
K2_D1_0:
    ds_read_b128 a[224:227], v241 offset:0
    ds_read_b128 a[228:231], v241 offset:1024
    ds_read_b128 a[232:235], v241 offset:2048
    ds_read_b128 a[236:239], v241 offset:3072
    ds_read_b128 a[240:243], v241 offset:4096
    ds_read_b128 a[244:247], v241 offset:5120
    ds_read_b128 a[248:251], v241 offset:6144
    ds_read_b128 a[252:255], v241 offset:7168
    s_waitcnt lgkmcnt(4)
    v_mfma_f32_32x32x16_bf16 v[0:15], a[224:227], a[128:131], v[128:143]
    s_add_u32 s44, s43, 0
    buffer_store_dwordx4 v[160:163], v245, s[20:23], s44 offen offset:0 sc0 sc1
    ds_read_b128 a[192:195], v240 offset:32768
    v_mfma_f32_32x32x16_bf16 v[0:15], a[228:231], a[132:135], v[0:15]
    ds_read_b128 a[196:199], v240 offset:33792
    v_subrev_u32 v249, 0x8000, v249
    ds_write_b128 v249, v[160:163] offset:0
    v_mfma_f32_32x32x16_bf16 v[0:15], a[232:235], a[136:139], v[0:15]
    s_add_u32 s44, s43, 0
    buffer_store_dwordx4 v[164:167], v245, s[20:23], s44 offen offset:128 sc0 sc1
    ds_read_b128 a[200:203], v240 offset:34816
    v_mfma_f32_32x32x16_bf16 v[0:15], a[236:239], a[140:143], v[0:15]
    ds_read_b128 a[204:207], v240 offset:35840
    ds_write_b128 v249, v[164:167] offset:128
    ds_write_b128 v249, v[168:171] offset:1024
    s_waitcnt lgkmcnt(7)
    v_mfma_f32_32x32x16_bf16 v[0:15], a[240:243], a[144:147], v[0:15]
    ds_read_b128 a[208:211], v240 offset:36864
    ds_read_b128 v[32:35], v240 offset:57344
    ds_write_b128 v249, v[172:175] offset:1152
    v_mfma_f32_32x32x16_bf16 v[0:15], a[244:247], a[148:151], v[0:15]
    s_add_u32 s44, s43, 0
    buffer_store_dwordx4 v[168:171], v245, s[20:23], s44 offen offset:1024 sc0 sc1
    ds_read_b128 a[212:215], v240 offset:37888
    ds_read_b128 v[36:39], v240 offset:58368
    v_mfma_f32_32x32x16_bf16 v[0:15], a[248:251], a[152:155], v[0:15]
    ds_read_b128 a[216:219], v240 offset:38912
    ds_read_b128 v[40:43], v240 offset:59392
    ds_write_b128 v249, a[80:83] offset:8192
    v_mfma_f32_32x32x16_bf16 v[0:15], a[252:255], a[156:159], v[0:15]
    ds_read_b128 a[220:223], v240 offset:39936
    ds_read_b128 v[44:47], v240 offset:60416
    s_waitcnt lgkmcnt(12)
    v_mfma_f32_32x32x16_bf16 v[64:79], a[192:195], a[160:163], 0
    s_add_u32 s44, s43, 0
    buffer_store_dwordx4 v[172:175], v245, s[20:23], s44 offen offset:1152 sc0 sc1
    ds_read_b128 a[224:227], v240 offset:40960
    ds_read_b128 v[48:51], v240 offset:61440
    v_mfma_f32_32x32x16_bf16 v[64:79], a[196:199], a[164:167], v[64:79]
    ds_read_b128 a[228:231], v240 offset:41984
    ds_read_b128 v[52:55], v240 offset:62464
    ds_write_b128 v249, a[84:87] offset:8320
    ds_write_b128 v249, a[88:91] offset:9216
    v_mfma_f32_32x32x16_bf16 v[64:79], a[200:203], a[168:171], v[64:79]
    ds_read_b128 a[232:235], v240 offset:43008
    ds_read_b128 v[56:59], v240 offset:63488
    ds_write_b128 v249, a[92:95] offset:9344
    v_mfma_f32_32x32x16_bf16 v[64:79], a[204:207], a[172:175], v[64:79]
    s_add_u32 s44, s43, 8192
    buffer_store_dwordx4 a[80:83], v245, s[20:23], s44 offen offset:0 sc0 sc1
    ds_read_b128 a[236:239], v240 offset:44032
    ds_read_b128 v[60:63], v240 offset:64512
    s_waitcnt lgkmcnt(12)
    v_mfma_f32_32x32x16_bf16 v[64:79], a[208:211], a[176:179], v[64:79]
    ds_read_b128 a[240:243], v240 offset:45056
    v_max3_f32 v228, v0, v1, v2
    v_max3_f32 v228, v228, v3, v4
    v_max3_f32 v228, v228, v5, v6
    v_max3_f32 v228, v228, v7, v8
    v_max3_f32 v228, v228, v9, v10
    v_max3_f32 v228, v228, v11, v12
    v_max3_f32 v228, v228, v13, v14
    v_mfma_f32_32x32x16_bf16 v[64:79], a[212:215], a[180:183], v[64:79]
    s_add_u32 s44, s43, 8192
    buffer_store_dwordx4 a[84:87], v245, s[20:23], s44 offen offset:128 sc0 sc1
    ds_read_b128 a[244:247], v240 offset:46080
    v_max_f32 v228, v228, v15
    v_exp_f32 v208, v0
    v_mfma_f32_32x32x16_bf16 v[64:79], a[216:219], a[184:187], v[64:79]
    ds_read_b128 a[248:251], v240 offset:47104
    v_exp_f32 v209, v1
    v_exp_f32 v210, v2
    v_add_f32 v232, v208, v209
    v_exp_f32 v211, v3
    v_cvt_pk_bf16_f32 v220, v208, v209
    v_mfma_f32_32x32x16_bf16 v[64:79], a[220:223], a[188:191], v[64:79]
    ds_read_b128 a[252:255], v240 offset:48128
    v_exp_f32 v212, v4
    v_add_f32 v232, v232, v210
    v_exp_f32 v213, v5
    v_add_f32 v232, v232, v211
    s_waitcnt lgkmcnt(5)
    v_mfma_f32_32x32x16_bf16 v[80:95], a[224:227], a[160:163], 0
    s_add_u32 s44, s43, 8192
    buffer_store_dwordx4 a[88:91], v245, s[20:23], s44 offen offset:1024 sc0 sc1
    ds_read_b128 a[192:195], v240 offset:49152
    ds_read_b128 a[196:199], v240 offset:50176
    v_cvt_pk_bf16_f32 v221, v210, v211
    v_exp_f32 v208, v6
    v_mfma_f32_32x32x16_bf16 v[80:95], a[228:231], a[164:167], v[80:95]
    ds_read_b128 a[200:203], v240 offset:51200
    v_add_f32 v232, v232, v212
    v_exp_f32 v209, v7
    v_add_f32 v232, v232, v213
    v_cvt_pk_bf16_f32 v222, v212, v213
    v_exp_f32 v210, v8
    v_mfma_f32_32x32x16_bf16 v[80:95], a[232:235], a[168:171], v[80:95]
    ds_read_b128 a[204:207], v240 offset:52224
    v_add_f32 v232, v232, v208
    v_exp_f32 v211, v9
    v_add_f32 v232, v232, v209
    v_cvt_pk_bf16_f32 v223, v208, v209
    v_exp_f32 v212, v10
    v_mfma_f32_32x32x16_bf16 v[80:95], a[236:239], a[172:175], v[80:95]
    s_add_u32 s44, s43, 8192
    buffer_store_dwordx4 a[92:95], v245, s[20:23], s44 offen offset:1152 sc0 sc1
    ds_read_b128 a[208:211], v240 offset:53248
    ds_read_b128 a[212:215], v240 offset:54272
    v_add_f32 v232, v232, v210
    s_waitcnt lgkmcnt(6)
    v_mfma_f32_32x32x16_bf16 v[80:95], a[240:243], a[176:179], v[80:95]
    ds_read_b128 a[216:219], v240 offset:55296
    v_exp_f32 v213, v11
    v_add_f32 v232, v232, v211
    v_cvt_pk_bf16_f32 v224, v210, v211
    v_exp_f32 v208, v12
    v_add_f32 v232, v232, v212
    v_mfma_f32_32x32x16_bf16 v[80:95], a[244:247], a[180:183], v[80:95]
    ds_read_b128 a[220:223], v240 offset:56320
    v_exp_f32 v209, v13
    v_add_f32 v232, v232, v213
    v_cvt_pk_bf16_f32 v225, v212, v213
    v_exp_f32 v210, v14
    v_add_f32 v232, v232, v208
    v_mfma_f32_32x32x16_bf16 v[80:95], a[248:251], a[184:187], v[80:95]
    v_exp_f32 v211, v15
    v_add_f32 v232, v232, v209
    v_cvt_pk_bf16_f32 v226, v208, v209
    v_add_f32 v232, v232, v210
    v_cvt_pk_bf16_f32 v227, v210, v211
    v_add_f32 v232, v232, v211
    v_max3_f32 v229, v64, v65, v66
    v_mfma_f32_32x32x16_bf16 v[80:95], a[252:255], a[188:191], v[80:95]
    v_max3_f32 v229, v229, v67, v68
    v_max3_f32 v229, v229, v69, v70
    v_max3_f32 v229, v229, v71, v72
    v_max3_f32 v229, v229, v73, v74
    v_max3_f32 v229, v229, v75, v76
    s_waitcnt vmcnt(8) lgkmcnt(0)
    s_barrier
    v_mfma_f32_32x32x16_bf16 v[96:111], a[192:195], a[160:163], 0
    s_add_u32 s48, s46, s34
    s_add_u32 s49, s47, s34
    s_add_u32 s50, s50, 1
    v_max3_f32 v229, v229, v77, v78
    v_max_f32 v229, v229, v79
    v_exp_f32 v208, v64
    v_mfma_f32_32x32x16_bf16 v[96:111], a[196:199], a[164:167], v[96:111]
    s_cmp_ge_u32 s50, 17
    s_cselect_b32 s46, s35, s51
    s_cselect_b32 s4, 0xffffd000, 0
    s_cselect_b32 s34, 0xff002000, 0
    s_cselect_b32 s5, 0x2000, 0
    v_exp_f32 v209, v65
    v_exp_f32 v210, v66
    v_mfma_f32_32x32x16_bf16 v[96:111], a[200:203], a[168:171], v[96:111]
    s_sub_u32 s35, s35, s5
    s_add_u32 s4, s4, s46
    s_cmp_le_u32 s50, s55
    s_cselect_b32 s47, 268435456, s4
    s_cselect_b32 s3, 1, 2
    v_add_f32 v233, v208, v209
    v_exp_f32 v211, v67
    v_mfma_f32_32x32x16_bf16 v[96:111], a[204:207], a[172:175], v[96:111]
    s_lshl_b32 s3, s3, 14
    s_add_u32 s51, s51, s3
    v_cvt_pk_bf16_f32 v144, v208, v209
    v_exp_f32 v212, v68
    v_add_f32 v233, v233, v210
    v_exp_f32 v213, v69
    v_mfma_f32_32x32x16_bf16 v[96:111], a[208:211], a[176:179], v[96:111]
    s_add_u32 m0, s52, 65536
    s_nop 0
    buffer_load_dwordx4 v242, s[16:19], s46 offen offset:0 sc1 lds
    v_add_f32 v233, v233, v211
    v_cvt_pk_bf16_f32 v145, v210, v211
    v_exp_f32 v208, v70
    v_add_f32 v233, v233, v212
    v_mfma_f32_32x32x16_bf16 v[96:111], a[212:215], a[180:183], v[96:111]
    buffer_load_dwordx4 v242, s[16:19], s46 offen offset:1024 sc1 lds
    v_exp_f32 v209, v71
    v_add_f32 v233, v233, v213
    v_cvt_pk_bf16_f32 v146, v212, v213
    v_exp_f32 v210, v72
    v_mfma_f32_32x32x16_bf16 v[96:111], a[216:219], a[184:187], v[96:111]
    buffer_load_dwordx4 v242, s[16:19], s46 offen offset:2048 sc1 lds
    v_add_f32 v233, v233, v208
    v_exp_f32 v211, v73
    v_add_f32 v233, v233, v209
    v_cvt_pk_bf16_f32 v147, v208, v209
    v_mfma_f32_32x32x16_bf16 v[96:111], a[220:223], a[188:191], v[96:111]
    buffer_load_dwordx4 v242, s[16:19], s46 offen offset:3072 sc1 lds
    s_add_u32 m0, s52, 81920
    v_exp_f32 v212, v74
    v_add_f32 v233, v233, v210
    v_exp_f32 v213, v75
    v_mfma_f32_32x32x16_bf16 v[112:127], v[32:35], a[160:163], v[128:143]
    ds_read_b128 a[192:195], v240 offset:0
    buffer_load_dwordx4 v243, s[16:19], s47 offen offset:0 sc1 lds
    v_add_f32 v233, v233, v211
    v_cvt_pk_bf16_f32 v148, v210, v211
    v_exp_f32 v208, v76
    v_mfma_f32_32x32x16_bf16 v[112:127], v[36:39], a[164:167], v[112:127]
    ds_read_b128 a[196:199], v240 offset:1024
    buffer_load_dwordx4 v243, s[16:19], s47 offen offset:1024 sc1 lds
    v_add_f32 v233, v233, v212
    v_exp_f32 v209, v77
    v_add_f32 v233, v233, v213
    v_mfma_f32_32x32x16_bf16 v[112:127], v[40:43], a[168:171], v[112:127]
    ds_read_b128 a[200:203], v240 offset:2048
    buffer_load_dwordx4 v243, s[16:19], s47 offen offset:2048 sc1 lds
    v_cvt_pk_bf16_f32 v149, v212, v213
    v_exp_f32 v210, v78
    v_add_f32 v233, v233, v208
    v_exp_f32 v211, v79
    v_mfma_f32_32x32x16_bf16 v[112:127], v[44:47], a[172:175], v[112:127]
    ds_read_b128 a[204:207], v240 offset:3072
    buffer_load_dwordx4 v243, s[16:19], s47 offen offset:3072 sc1 lds
    s_add_u32 m0, s52, 32768
    v_add_f32 v233, v233, v209
    v_cvt_pk_bf16_f32 v150, v208, v209
    v_add_f32 v233, v233, v210
    v_mfma_f32_32x32x16_bf16 v[112:127], v[48:51], a[176:179], v[112:127]
    ds_read_b128 a[208:211], v240 offset:4096
    buffer_load_dwordx4 v242, s[20:23], s48 offen offset:0 sc1 lds
    v_cvt_pk_bf16_f32 v151, v210, v211
    v_add_f32 v233, v233, v211
    v_max3_f32 v229, v229, v80, v81
    v_max3_f32 v229, v229, v82, v83
    v_mfma_f32_32x32x16_bf16 v[112:127], v[52:55], a[180:183], v[112:127]
    ds_read_b128 a[212:215], v240 offset:5120
    buffer_load_dwordx4 v242, s[20:23], s48 offen offset:1024 sc1 lds
    v_max3_f32 v229, v229, v84, v85
    v_max3_f32 v229, v229, v86, v87
    v_max3_f32 v229, v229, v88, v89
    v_max3_f32 v229, v229, v90, v91
    v_max3_f32 v229, v229, v92, v93
    v_mfma_f32_32x32x16_bf16 v[112:127], v[56:59], a[184:187], v[112:127]
    ds_read_b128 a[216:219], v240 offset:6144
    ds_read_b128 a[220:223], v240 offset:7168
    buffer_load_dwordx4 v242, s[20:23], s48 offen offset:2048 sc1 lds
    v_max3_f32 v229, v229, v94, v95
    v_max3_f32 v229, v229, v96, v97
    v_max3_f32 v229, v229, v98, v99
    v_mfma_f32_32x32x16_bf16 v[112:127], v[60:63], a[188:191], v[112:127]
    buffer_load_dwordx4 v242, s[20:23], s48 offen offset:3072 sc1 lds
    v_max3_f32 v229, v229, v100, v101
    v_max3_f32 v229, v229, v102, v103
    v_max3_f32 v229, v229, v104, v105
    v_max3_f32 v229, v229, v106, v107
    v_max3_f32 v229, v229, v108, v109
    v_max3_f32 v229, v229, v110, v111
    v_mov_b32 v230, 0xc2200000
    s_mov_b32 s3, 0x41c00000
    s_nop 7
    v_max3_f32 v229, v229, v112, v113
    v_max3_f32 v229, v229, v114, v115
    v_max3_f32 v229, v229, v116, v117
    v_max3_f32 v229, v229, v118, v119
    v_max3_f32 v229, v229, v120, v121
    v_max3_f32 v229, v229, v122, v123
    v_max3_f32 v229, v229, v124, v125
    v_max3_f32 v229, v229, v126, v127
    v_mov_b32 v218, v228
    v_mov_b32 v219, v229
    s_nop 1
    v_permlane32_swap_b32 v228, v218
    v_permlane32_swap_b32 v229, v219
    s_nop 1
    v_max_f32 v228, v228, v218
    v_max_f32 v229, v229, v219
    v_med3_f32 v218, v228, v230, s3
    v_med3_f32 v219, v229, v230, s3
    v_cmp_neq_f32 vcc, v218, v228
    v_cmp_neq_f32 s[4:5], v219, v229
    s_nop 3
    s_or_b64 vcc, vcc, s[4:5]
    s_cbranch_vccnz K2_fx0
    s_branch K2_D1e
K2_D1_1:
    ds_read_b128 a[224:227], v241 offset:0
    ds_read_b128 a[228:231], v241 offset:1024
    ds_read_b128 a[232:235], v241 offset:2048
    ds_read_b128 a[236:239], v241 offset:3072
    ds_read_b128 a[240:243], v241 offset:4096
    ds_read_b128 a[244:247], v241 offset:5120
    ds_read_b128 a[248:251], v241 offset:6144
    ds_read_b128 a[252:255], v241 offset:7168
    s_waitcnt lgkmcnt(4)
    v_mfma_f32_32x32x16_bf16 v[0:15], a[224:227], a[128:131], 0
    s_add_u32 s44, s43, 0
    buffer_store_dwordx4 v[160:163], v245, s[20:23], s44 offen offset:0 sc0 sc1
    ds_read_b128 a[192:195], v240 offset:32768
    v_mfma_f32_32x32x16_bf16 v[0:15], a[228:231], a[132:135], v[0:15]
    ds_read_b128 a[196:199], v240 offset:33792
    v_subrev_u32 v249, 0x8000, v249
    ds_write_b128 v249, v[160:163] offset:0
    v_mfma_f32_32x32x16_bf16 v[0:15], a[232:235], a[136:139], v[0:15]
    s_add_u32 s44, s43, 0
    buffer_store_dwordx4 v[164:167], v245, s[20:23], s44 offen offset:128 sc0 sc1
    ds_read_b128 a[200:203], v240 offset:34816
    v_mfma_f32_32x32x16_bf16 v[0:15], a[236:239], a[140:143], v[0:15]
    ds_read_b128 a[204:207], v240 offset:35840
    ds_write_b128 v249, v[164:167] offset:128
    ds_write_b128 v249, v[168:171] offset:1024
    s_waitcnt lgkmcnt(7)
    v_mfma_f32_32x32x16_bf16 v[0:15], a[240:243], a[144:147], v[0:15]
    ds_read_b128 a[208:211], v240 offset:36864
    ds_read_b128 v[32:35], v241 offset:8192
    ds_write_b128 v249, v[172:175] offset:1152
    v_mfma_f32_32x32x16_bf16 v[0:15], a[244:247], a[148:151], v[0:15]
    s_add_u32 s44, s43, 0
    buffer_store_dwordx4 v[168:171], v245, s[20:23], s44 offen offset:1024 sc0 sc1
    ds_read_b128 a[212:215], v240 offset:37888
    ds_read_b128 v[36:39], v241 offset:9216
    v_mfma_f32_32x32x16_bf16 v[0:15], a[248:251], a[152:155], v[0:15]
    ds_read_b128 a[216:219], v240 offset:38912
    ds_read_b128 v[40:43], v241 offset:10240
    ds_write_b128 v249, a[80:83] offset:8192
    v_mfma_f32_32x32x16_bf16 v[0:15], a[252:255], a[156:159], v[0:15]
    ds_read_b128 a[220:223], v240 offset:39936
    ds_read_b128 v[44:47], v241 offset:11264
    s_waitcnt lgkmcnt(12)
    v_mfma_f32_32x32x16_bf16 v[64:79], a[192:195], a[160:163], 0
    s_add_u32 s44, s43, 0
    buffer_store_dwordx4 v[172:175], v245, s[20:23], s44 offen offset:1152 sc0 sc1
    ds_read_b128 a[224:227], v240 offset:40960
    ds_read_b128 v[48:51], v241 offset:12288
    v_mfma_f32_32x32x16_bf16 v[64:79], a[196:199], a[164:167], v[64:79]
    ds_read_b128 a[228:231], v240 offset:41984
    ds_read_b128 v[52:55], v241 offset:13312
    ds_write_b128 v249, a[84:87] offset:8320
    ds_write_b128 v249, a[88:91] offset:9216
    v_mfma_f32_32x32x16_bf16 v[64:79], a[200:203], a[168:171], v[64:79]
    ds_read_b128 a[232:235], v240 offset:43008
    ds_read_b128 v[56:59], v241 offset:14336
    ds_write_b128 v249, a[92:95] offset:9344
    v_mfma_f32_32x32x16_bf16 v[64:79], a[204:207], a[172:175], v[64:79]
    s_add_u32 s44, s43, 8192
    buffer_store_dwordx4 a[80:83], v245, s[20:23], s44 offen offset:0 sc0 sc1
    ds_read_b128 a[236:239], v240 offset:44032
    ds_read_b128 v[60:63], v241 offset:15360
    s_waitcnt lgkmcnt(12)
    v_mfma_f32_32x32x16_bf16 v[64:79], a[208:211], a[176:179], v[64:79]
    ds_read_b128 a[240:243], v240 offset:45056
    v_max3_f32 v228, v0, v1, v2
    v_max3_f32 v228, v228, v3, v4
    v_max3_f32 v228, v228, v5, v6
    v_max3_f32 v228, v228, v7, v8
    v_max3_f32 v228, v228, v9, v10
    v_max3_f32 v228, v228, v11, v12
    v_max3_f32 v228, v228, v13, v14
    v_mfma_f32_32x32x16_bf16 v[64:79], a[212:215], a[180:183], v[64:79]
    s_add_u32 s44, s43, 8192
    buffer_store_dwordx4 a[84:87], v245, s[20:23], s44 offen offset:128 sc0 sc1
    ds_read_b128 a[244:247], v240 offset:46080
    v_max_f32 v228, v228, v15
    v_exp_f32 v208, v0
    v_mfma_f32_32x32x16_bf16 v[64:79], a[216:219], a[184:187], v[64:79]
    ds_read_b128 a[248:251], v240 offset:47104
    v_exp_f32 v209, v1
    v_exp_f32 v210, v2
    v_add_f32 v232, v208, v209
    v_exp_f32 v211, v3
    v_cvt_pk_bf16_f32 v220, v208, v209
    v_mfma_f32_32x32x16_bf16 v[64:79], a[220:223], a[188:191], v[64:79]
    ds_read_b128 a[252:255], v240 offset:48128
    v_exp_f32 v212, v4
    v_add_f32 v232, v232, v210
    v_exp_f32 v213, v5
    v_add_f32 v232, v232, v211
    s_waitcnt lgkmcnt(5)
    v_mfma_f32_32x32x16_bf16 v[80:95], a[224:227], a[160:163], 0
    s_add_u32 s44, s43, 8192
    buffer_store_dwordx4 a[88:91], v245, s[20:23], s44 offen offset:1024 sc0 sc1
    ds_read_b128 a[192:195], v240 offset:49152
    ds_read_b128 a[196:199], v240 offset:50176
    v_cvt_pk_bf16_f32 v221, v210, v211
    v_exp_f32 v208, v6
    v_mfma_f32_32x32x16_bf16 v[80:95], a[228:231], a[164:167], v[80:95]
    ds_read_b128 a[200:203], v240 offset:51200
    v_add_f32 v232, v232, v212
    v_exp_f32 v209, v7
    v_add_f32 v232, v232, v213
    v_cvt_pk_bf16_f32 v222, v212, v213
    v_exp_f32 v210, v8
    v_mfma_f32_32x32x16_bf16 v[80:95], a[232:235], a[168:171], v[80:95]
    ds_read_b128 a[204:207], v240 offset:52224
    v_add_f32 v232, v232, v208
    v_exp_f32 v211, v9
    v_add_f32 v232, v232, v209
    v_cvt_pk_bf16_f32 v223, v208, v209
    v_exp_f32 v212, v10
    v_mfma_f32_32x32x16_bf16 v[80:95], a[236:239], a[172:175], v[80:95]
    s_add_u32 s44, s43, 8192
    buffer_store_dwordx4 a[92:95], v245, s[20:23], s44 offen offset:1152 sc0 sc1
    ds_read_b128 a[208:211], v240 offset:53248
    ds_read_b128 a[212:215], v240 offset:54272
    v_add_f32 v232, v232, v210
    s_waitcnt lgkmcnt(6)
    v_mfma_f32_32x32x16_bf16 v[80:95], a[240:243], a[176:179], v[80:95]
    ds_read_b128 a[216:219], v240 offset:55296
    v_exp_f32 v213, v11
    v_add_f32 v232, v232, v211
    v_cvt_pk_bf16_f32 v224, v210, v211
    v_exp_f32 v208, v12
    v_add_f32 v232, v232, v212
    v_mfma_f32_32x32x16_bf16 v[80:95], a[244:247], a[180:183], v[80:95]
    ds_read_b128 a[220:223], v240 offset:56320
    v_exp_f32 v209, v13
    v_add_f32 v232, v232, v213
    v_cvt_pk_bf16_f32 v225, v212, v213
    v_exp_f32 v210, v14
    v_add_f32 v232, v232, v208
    v_mfma_f32_32x32x16_bf16 v[80:95], a[248:251], a[184:187], v[80:95]
    v_exp_f32 v211, v15
    v_add_f32 v232, v232, v209
    v_cvt_pk_bf16_f32 v226, v208, v209
    v_add_f32 v232, v232, v210
    v_cvt_pk_bf16_f32 v227, v210, v211
    v_add_f32 v232, v232, v211
    v_max3_f32 v229, v64, v65, v66
    v_mfma_f32_32x32x16_bf16 v[80:95], a[252:255], a[188:191], v[80:95]
    v_max3_f32 v229, v229, v67, v68
    v_max3_f32 v229, v229, v69, v70
    v_max3_f32 v229, v229, v71, v72
    v_max3_f32 v229, v229, v73, v74
    v_max3_f32 v229, v229, v75, v76
    s_waitcnt vmcnt(8) lgkmcnt(0)
    s_barrier
    v_mfma_f32_32x32x16_bf16 v[96:111], a[192:195], a[160:163], v[128:143]
    s_add_u32 s48, s46, s34
    s_add_u32 s49, s47, s34
    s_add_u32 s50, s50, 1
    v_max3_f32 v229, v229, v77, v78
    v_max_f32 v229, v229, v79
    v_exp_f32 v208, v64
    v_mfma_f32_32x32x16_bf16 v[96:111], a[196:199], a[164:167], v[96:111]
    s_cmp_ge_u32 s50, 17
    s_cselect_b32 s46, s35, s51
    s_cselect_b32 s4, 0xffffd000, 0
    s_cselect_b32 s34, 0xff002000, 0
    s_cselect_b32 s5, 0x2000, 0
    v_exp_f32 v209, v65
    v_exp_f32 v210, v66
    v_mfma_f32_32x32x16_bf16 v[96:111], a[200:203], a[168:171], v[96:111]
    s_sub_u32 s35, s35, s5
    s_add_u32 s4, s4, s46
    s_cmp_le_u32 s50, s55
    s_cselect_b32 s47, 268435456, s4
    s_cselect_b32 s3, 1, 2
    v_add_f32 v233, v208, v209
    v_exp_f32 v211, v67
    v_mfma_f32_32x32x16_bf16 v[96:111], a[204:207], a[172:175], v[96:111]
    s_lshl_b32 s3, s3, 14
    s_add_u32 s51, s51, s3
    v_cvt_pk_bf16_f32 v144, v208, v209
    v_exp_f32 v212, v68
    v_add_f32 v233, v233, v210
    v_exp_f32 v213, v69
    v_mfma_f32_32x32x16_bf16 v[96:111], a[208:211], a[176:179], v[96:111]
    s_add_u32 m0, s52, 65536
    s_nop 0
    buffer_load_dwordx4 v242, s[16:19], s46 offen offset:0 sc1 lds
    v_add_f32 v233, v233, v211
    v_cvt_pk_bf16_f32 v145, v210, v211
    v_exp_f32 v208, v70
    v_add_f32 v233, v233, v212
    v_mfma_f32_32x32x16_bf16 v[96:111], a[212:215], a[180:183], v[96:111]
    buffer_load_dwordx4 v242, s[16:19], s46 offen offset:1024 sc1 lds
    v_exp_f32 v209, v71
    v_add_f32 v233, v233, v213
    v_cvt_pk_bf16_f32 v146, v212, v213
    v_exp_f32 v210, v72
    v_mfma_f32_32x32x16_bf16 v[96:111], a[216:219], a[184:187], v[96:111]
    buffer_load_dwordx4 v242, s[16:19], s46 offen offset:2048 sc1 lds
    v_add_f32 v233, v233, v208
    v_exp_f32 v211, v73
    v_add_f32 v233, v233, v209
    v_cvt_pk_bf16_f32 v147, v208, v209
    v_mfma_f32_32x32x16_bf16 v[96:111], a[220:223], a[188:191], v[96:111]
    buffer_load_dwordx4 v242, s[16:19], s46 offen offset:3072 sc1 lds
    s_add_u32 m0, s52, 81920
    v_exp_f32 v212, v74
    v_add_f32 v233, v233, v210
    v_exp_f32 v213, v75
    v_mfma_f32_32x32x16_bf16 v[112:127], v[32:35], a[128:131], v[128:143]
    ds_read_b128 a[192:195], v240 offset:0
    buffer_load_dwordx4 v243, s[16:19], s47 offen offset:0 sc1 lds
    v_add_f32 v233, v233, v211
    v_cvt_pk_bf16_f32 v148, v210, v211
    v_exp_f32 v208, v76
    v_mfma_f32_32x32x16_bf16 v[112:127], v[36:39], a[132:135], v[112:127]
    ds_read_b128 a[196:199], v240 offset:1024
    buffer_load_dwordx4 v243, s[16:19], s47 offen offset:1024 sc1 lds
    v_add_f32 v233, v233, v212
    v_exp_f32 v209, v77
    v_add_f32 v233, v233, v213
    v_mfma_f32_32x32x16_bf16 v[112:127], v[40:43], a[136:139], v[112:127]
    ds_read_b128 a[200:203], v240 offset:2048
    buffer_load_dwordx4 v243, s[16:19], s47 offen offset:2048 sc1 lds
    v_cvt_pk_bf16_f32 v149, v212, v213
    v_exp_f32 v210, v78
    v_add_f32 v233, v233, v208
    v_exp_f32 v211, v79
    v_mfma_f32_32x32x16_bf16 v[112:127], v[44:47], a[140:143], v[112:127]
    ds_read_b128 a[204:207], v240 offset:3072
    buffer_load_dwordx4 v243, s[16:19], s47 offen offset:3072 sc1 lds
    s_add_u32 m0, s52, 32768
    v_add_f32 v233, v233, v209
    v_cvt_pk_bf16_f32 v150, v208, v209
    v_add_f32 v233, v233, v210
    v_mfma_f32_32x32x16_bf16 v[112:127], v[48:51], a[144:147], v[112:127]
    ds_read_b128 a[208:211], v240 offset:4096
    buffer_load_dwordx4 v242, s[20:23], s48 offen offset:0 sc1 lds
    v_cvt_pk_bf16_f32 v151, v210, v211
    v_add_f32 v233, v233, v211
    v_max3_f32 v229, v229, v80, v81
    v_max3_f32 v229, v229, v82, v83
    v_mfma_f32_32x32x16_bf16 v[112:127], v[52:55], a[148:151], v[112:127]
    ds_read_b128 a[212:215], v240 offset:5120
    buffer_load_dwordx4 v242, s[20:23], s48 offen offset:1024 sc1 lds
    v_max3_f32 v229, v229, v84, v85
    v_max3_f32 v229, v229, v86, v87
    v_max3_f32 v229, v229, v88, v89
    v_max3_f32 v229, v229, v90, v91
    v_max3_f32 v229, v229, v92, v93
    v_mfma_f32_32x32x16_bf16 v[112:127], v[56:59], a[152:155], v[112:127]
    ds_read_b128 a[216:219], v240 offset:6144
    ds_read_b128 a[220:223], v240 offset:7168
    buffer_load_dwordx4 v242, s[20:23], s48 offen offset:2048 sc1 lds
    v_max3_f32 v229, v229, v94, v95
    v_max3_f32 v229, v229, v96, v97
    v_max3_f32 v229, v229, v98, v99
    v_mfma_f32_32x32x16_bf16 v[112:127], v[60:63], a[156:159], v[112:127]
    buffer_load_dwordx4 v242, s[20:23], s48 offen offset:3072 sc1 lds
    v_max3_f32 v229, v229, v100, v101
    v_max3_f32 v229, v229, v102, v103
    v_max3_f32 v229, v229, v104, v105
    v_max3_f32 v229, v229, v106, v107
    v_max3_f32 v229, v229, v108, v109
    v_max3_f32 v229, v229, v110, v111
    v_mov_b32 v230, 0xc2200000
    s_mov_b32 s3, 0x41c00000
    s_nop 7
    v_max3_f32 v228, v228, v112, v113
    v_max3_f32 v228, v228, v114, v115
    v_max3_f32 v228, v228, v116, v117
    v_max3_f32 v228, v228, v118, v119
    v_max3_f32 v228, v228, v120, v121
    v_max3_f32 v228, v228, v122, v123
    v_max3_f32 v228, v228, v124, v125
    v_max3_f32 v228, v228, v126, v127
    v_mov_b32 v218, v228
    v_mov_b32 v219, v229
    s_nop 1
    v_permlane32_swap_b32 v228, v218
    v_permlane32_swap_b32 v229, v219
    s_nop 1
    v_max_f32 v228, v228, v218
    v_max_f32 v229, v229, v219
    v_med3_f32 v218, v228, v230, s3
    v_med3_f32 v219, v229, v230, s3
    v_cmp_neq_f32 vcc, v218, v228
    v_cmp_neq_f32 s[4:5], v219, v229
    s_nop 3
    s_or_b64 vcc, vcc, s[4:5]
    s_cbranch_vccnz K2_fx1
    s_branch K2_D1e
K2_D1_2:
    ds_read_b128 a[224:227], v241 offset:0
    ds_read_b128 a[228:231], v241 offset:1024
    ds_read_b128 a[232:235], v241 offset:2048
    ds_read_b128 a[236:239], v241 offset:3072
    ds_read_b128 a[240:243], v241 offset:4096
    ds_read_b128 a[244:247], v241 offset:5120
    ds_read_b128 a[248:251], v241 offset:6144
    ds_read_b128 a[252:255], v241 offset:7168
    s_waitcnt lgkmcnt(4)
    v_mfma_f32_32x32x16_bf16 v[0:15], a[224:227], a[128:131], 0
    s_add_u32 s44, s43, 0
    buffer_store_dwordx4 v[160:163], v245, s[20:23], s44 offen offset:0 sc0 sc1
    ds_read_b128 a[192:195], v240 offset:32768
    v_mfma_f32_32x32x16_bf16 v[0:15], a[228:231], a[132:135], v[0:15]
    ds_read_b128 a[196:199], v240 offset:33792
    v_subrev_u32 v249, 0x8000, v249
    ds_write_b128 v249, v[160:163] offset:0
    v_mfma_f32_32x32x16_bf16 v[0:15], a[232:235], a[136:139], v[0:15]
    s_add_u32 s44, s43, 0
    buffer_store_dwordx4 v[164:167], v245, s[20:23], s44 offen offset:128 sc0 sc1
    ds_read_b128 a[200:203], v240 offset:34816
    v_mfma_f32_32x32x16_bf16 v[0:15], a[236:239], a[140:143], v[0:15]
    ds_read_b128 a[204:207], v240 offset:35840
    ds_write_b128 v249, v[164:167] offset:128
    ds_write_b128 v249, v[168:171] offset:1024
    s_waitcnt lgkmcnt(7)
    v_mfma_f32_32x32x16_bf16 v[0:15], a[240:243], a[144:147], v[0:15]
    ds_read_b128 a[208:211], v240 offset:36864
    ds_read_b128 v[32:35], v241 offset:16384
    ds_write_b128 v249, v[172:175] offset:1152
    v_mfma_f32_32x32x16_bf16 v[0:15], a[244:247], a[148:151], v[0:15]
    s_add_u32 s44, s43, 0
    buffer_store_dwordx4 v[168:171], v245, s[20:23], s44 offen offset:1024 sc0 sc1
    ds_read_b128 a[212:215], v240 offset:37888
    ds_read_b128 v[36:39], v241 offset:17408
    v_mfma_f32_32x32x16_bf16 v[0:15], a[248:251], a[152:155], v[0:15]
    ds_read_b128 a[216:219], v240 offset:38912
    ds_read_b128 v[40:43], v241 offset:18432
    ds_write_b128 v249, a[80:83] offset:8192
    v_mfma_f32_32x32x16_bf16 v[0:15], a[252:255], a[156:159], v[0:15]
    ds_read_b128 a[220:223], v240 offset:39936
    ds_read_b128 v[44:47], v241 offset:19456
    s_waitcnt lgkmcnt(12)
    v_mfma_f32_32x32x16_bf16 v[64:79], a[192:195], a[160:163], 0
    s_add_u32 s44, s43, 0
    buffer_store_dwordx4 v[172:175], v245, s[20:23], s44 offen offset:1152 sc0 sc1
    ds_read_b128 a[224:227], v240 offset:40960
    ds_read_b128 v[48:51], v241 offset:20480
    v_mfma_f32_32x32x16_bf16 v[64:79], a[196:199], a[164:167], v[64:79]
    ds_read_b128 a[228:231], v240 offset:41984
    ds_read_b128 v[52:55], v241 offset:21504
    ds_write_b128 v249, a[84:87] offset:8320
    ds_write_b128 v249, a[88:91] offset:9216
    v_mfma_f32_32x32x16_bf16 v[64:79], a[200:203], a[168:171], v[64:79]
    ds_read_b128 a[232:235], v240 offset:43008
    ds_read_b128 v[56:59], v241 offset:22528
    ds_write_b128 v249, a[92:95] offset:9344
    v_mfma_f32_32x32x16_bf16 v[64:79], a[204:207], a[172:175], v[64:79]
    s_add_u32 s44, s43, 8192
    buffer_store_dwordx4 a[80:83], v245, s[20:23], s44 offen offset:0 sc0 sc1
    ds_read_b128 a[236:239], v240 offset:44032
    ds_read_b128 v[60:63], v241 offset:23552
    s_waitcnt lgkmcnt(12)
    v_mfma_f32_32x32x16_bf16 v[64:79], a[208:211], a[176:179], v[64:79]
    ds_read_b128 a[240:243], v240 offset:45056
    v_max3_f32 v228, v0, v1, v2
    v_max3_f32 v228, v228, v3, v4
    v_max3_f32 v228, v228, v5, v6
    v_max3_f32 v228, v228, v7, v8
    v_max3_f32 v228, v228, v9, v10
    v_max3_f32 v228, v228, v11, v12
    v_max3_f32 v228, v228, v13, v14
    v_mfma_f32_32x32x16_bf16 v[64:79], a[212:215], a[180:183], v[64:79]
    s_add_u32 s44, s43, 8192
    buffer_store_dwordx4 a[84:87], v245, s[20:23], s44 offen offset:128 sc0 sc1
    ds_read_b128 a[244:247], v240 offset:46080
    v_max_f32 v228, v228, v15
    v_exp_f32 v208, v0
    v_mfma_f32_32x32x16_bf16 v[64:79], a[216:219], a[184:187], v[64:79]
    ds_read_b128 a[248:251], v240 offset:47104
    v_exp_f32 v209, v1
    v_exp_f32 v210, v2
    v_add_f32 v232, v208, v209
    v_exp_f32 v211, v3
    v_cvt_pk_bf16_f32 v220, v208, v209
    v_mfma_f32_32x32x16_bf16 v[64:79], a[220:223], a[188:191], v[64:79]
    ds_read_b128 a[252:255], v240 offset:48128
    v_exp_f32 v212, v4
    v_add_f32 v232, v232, v210
    v_exp_f32 v213, v5
    v_add_f32 v232, v232, v211
    s_waitcnt lgkmcnt(5)
    v_mfma_f32_32x32x16_bf16 v[80:95], a[224:227], a[160:163], v[128:143]
    s_add_u32 s44, s43, 8192
    buffer_store_dwordx4 a[88:91], v245, s[20:23], s44 offen offset:1024 sc0 sc1
    ds_read_b128 a[192:195], v241 offset:8192
    ds_read_b128 a[196:199], v241 offset:9216
    v_cvt_pk_bf16_f32 v221, v210, v211
    v_exp_f32 v208, v6
    v_mfma_f32_32x32x16_bf16 v[80:95], a[228:231], a[164:167], v[80:95]
    ds_read_b128 a[200:203], v241 offset:10240
    v_add_f32 v232, v232, v212
    v_exp_f32 v209, v7
    v_add_f32 v232, v232, v213
    v_cvt_pk_bf16_f32 v222, v212, v213
    v_exp_f32 v210, v8
    v_mfma_f32_32x32x16_bf16 v[80:95], a[232:235], a[168:171], v[80:95]
    ds_read_b128 a[204:207], v241 offset:11264
    v_add_f32 v232, v232, v208
    v_exp_f32 v211, v9
    v_add_f32 v232, v232, v209
    v_cvt_pk_bf16_f32 v223, v208, v209
    v_exp_f32 v212, v10
    v_mfma_f32_32x32x16_bf16 v[80:95], a[236:239], a[172:175], v[80:95]
    s_add_u32 s44, s43, 8192
    buffer_store_dwordx4 a[92:95], v245, s[20:23], s44 offen offset:1152 sc0 sc1
    ds_read_b128 a[208:211], v241 offset:12288
    ds_read_b128 a[212:215], v241 offset:13312
    v_add_f32 v232, v232, v210
    s_waitcnt lgkmcnt(6)
    v_mfma_f32_32x32x16_bf16 v[80:95], a[240:243], a[176:179], v[80:95]
    ds_read_b128 a[216:219], v241 offset:14336
    v_exp_f32 v213, v11
    v_add_f32 v232, v232, v211
    v_cvt_pk_bf16_f32 v224, v210, v211
    v_exp_f32 v208, v12
    v_add_f32 v232, v232, v212
    v_mfma_f32_32x32x16_bf16 v[80:95], a[244:247], a[180:183], v[80:95]
    ds_read_b128 a[220:223], v241 offset:15360
    v_exp_f32 v209, v13
    v_add_f32 v232, v232, v213
    v_cvt_pk_bf16_f32 v225, v212, v213
    v_exp_f32 v210, v14
    v_add_f32 v232, v232, v208
    v_mfma_f32_32x32x16_bf16 v[80:95], a[248:251], a[184:187], v[80:95]
    v_exp_f32 v211, v15
    v_add_f32 v232, v232, v209
    v_cvt_pk_bf16_f32 v226, v208, v209
    v_add_f32 v232, v232, v210
    v_cvt_pk_bf16_f32 v227, v210, v211
    v_add_f32 v232, v232, v211
    v_max3_f32 v229, v64, v65, v66
    v_mfma_f32_32x32x16_bf16 v[80:95], a[252:255], a[188:191], v[80:95]
    v_max3_f32 v229, v229, v67, v68
    v_max3_f32 v229, v229, v69, v70
    v_max3_f32 v229, v229, v71, v72
    v_max3_f32 v229, v229, v73, v74
    v_max3_f32 v229, v229, v75, v76
    s_waitcnt vmcnt(8) lgkmcnt(0)
    s_barrier
    v_mfma_f32_32x32x16_bf16 v[96:111], a[192:195], a[128:131], 0
    s_add_u32 s48, s46, s34
    s_add_u32 s49, s47, s34
    s_add_u32 s50, s50, 1
    v_max3_f32 v229, v229, v77, v78
    v_max_f32 v229, v229, v79
    v_exp_f32 v208, v64
    v_mfma_f32_32x32x16_bf16 v[96:111], a[196:199], a[132:135], v[96:111]
    s_cmp_ge_u32 s50, 17
    s_cselect_b32 s46, s35, s51
    s_cselect_b32 s4, 0xffffd000, 0
    s_cselect_b32 s34, 0xff002000, 0
    s_cselect_b32 s5, 0x2000, 0
    v_exp_f32 v209, v65
    v_exp_f32 v210, v66
    v_mfma_f32_32x32x16_bf16 v[96:111], a[200:203], a[136:139], v[96:111]
    s_sub_u32 s35, s35, s5
    s_add_u32 s4, s4, s46
    s_cmp_le_u32 s50, s55
    s_cselect_b32 s47, 268435456, s4
    s_cselect_b32 s3, 1, 2
    v_add_f32 v233, v208, v209
    v_exp_f32 v211, v67
    v_mfma_f32_32x32x16_bf16 v[96:111], a[204:207], a[140:143], v[96:111]
    s_lshl_b32 s3, s3, 14
    s_add_u32 s51, s51, s3
    v_cvt_pk_bf16_f32 v144, v208, v209
    v_exp_f32 v212, v68
    v_add_f32 v233, v233, v210
    v_exp_f32 v213, v69
    v_mfma_f32_32x32x16_bf16 v[96:111], a[208:211], a[144:147], v[96:111]
    s_add_u32 m0, s52, 65536
    s_nop 0
    buffer_load_dwordx4 v242, s[16:19], s46 offen offset:0 sc1 lds
    v_add_f32 v233, v233, v211
    v_cvt_pk_bf16_f32 v145, v210, v211
    v_exp_f32 v208, v70
    v_add_f32 v233, v233, v212
    v_mfma_f32_32x32x16_bf16 v[96:111], a[212:215], a[148:151], v[96:111]
    buffer_load_dwordx4 v242, s[16:19], s46 offen offset:1024 sc1 lds
    v_exp_f32 v209, v71
    v_add_f32 v233, v233, v213
    v_cvt_pk_bf16_f32 v146, v212, v213
    v_exp_f32 v210, v72
    v_mfma_f32_32x32x16_bf16 v[96:111], a[216:219], a[152:155], v[96:111]
    buffer_load_dwordx4 v242, s[16:19], s46 offen offset:2048 sc1 lds
    v_add_f32 v233, v233, v208
    v_exp_f32 v211, v73
    v_add_f32 v233, v233, v209
    v_cvt_pk_bf16_f32 v147, v208, v209
    v_mfma_f32_32x32x16_bf16 v[96:111], a[220:223], a[156:159], v[96:111]
    buffer_load_dwordx4 v242, s[16:19], s46 offen offset:3072 sc1 lds
    s_add_u32 m0, s52, 81920
    v_exp_f32 v212, v74
    v_add_f32 v233, v233, v210
    v_exp_f32 v213, v75
    v_mfma_f32_32x32x16_bf16 v[112:127], v[32:35], a[128:131], v[128:143]
    ds_read_b128 a[192:195], v240 offset:0
    buffer_load_dwordx4 v243, s[16:19], s47 offen offset:0 sc1 lds
    v_add_f32 v233, v233, v211
    v_cvt_pk_bf16_f32 v148, v210, v211
    v_exp_f32 v208, v76
    v_mfma_f32_32x32x16_bf16 v[112:127], v[36:39], a[132:135], v[112:127]
    ds_read_b128 a[196:199], v240 offset:1024
    buffer_load_dwordx4 v243, s[16:19], s47 offen offset:1024 sc1 lds
    v_add_f32 v233, v233, v212
    v_exp_f32 v209, v77
    v_add_f32 v233, v233, v213
    v_mfma_f32_32x32x16_bf16 v[112:127], v[40:43], a[136:139], v[112:127]
    ds_read_b128 a[200:203], v240 offset:2048
    buffer_load_dwordx4 v243, s[16:19], s47 offen offset:2048 sc1 lds
    v_cvt_pk_bf16_f32 v149, v212, v213
    v_exp_f32 v210, v78
    v_add_f32 v233, v233, v208
    v_exp_f32 v211, v79
    v_mfma_f32_32x32x16_bf16 v[112:127], v[44:47], a[140:143], v[112:127]
    ds_read_b128 a[204:207], v240 offset:3072
    buffer_load_dwordx4 v243, s[16:19], s47 offen offset:3072 sc1 lds
    s_add_u32 m0, s52, 32768
    v_add_f32 v233, v233, v209
    v_cvt_pk_bf16_f32 v150, v208, v209
    v_add_f32 v233, v233, v210
    v_mfma_f32_32x32x16_bf16 v[112:127], v[48:51], a[144:147], v[112:127]
    ds_read_b128 a[208:211], v240 offset:4096
    buffer_load_dwordx4 v242, s[20:23], s48 offen offset:0 sc1 lds
    v_cvt_pk_bf16_f32 v151, v210, v211
    v_add_f32 v233, v233, v211
    v_max3_f32 v229, v229, v80, v81
    v_max3_f32 v229, v229, v82, v83
    v_mfma_f32_32x32x16_bf16 v[112:127], v[52:55], a[148:151], v[112:127]
    ds_read_b128 a[212:215], v240 offset:5120
    buffer_load_dwordx4 v242, s[20:23], s48 offen offset:1024 sc1 lds
    v_max3_f32 v229, v229, v84, v85
    v_max3_f32 v229, v229, v86, v87
    v_max3_f32 v229, v229, v88, v89
    v_max3_f32 v229, v229, v90, v91
    v_max3_f32 v229, v229, v92, v93
    v_mfma_f32_32x32x16_bf16 v[112:127], v[56:59], a[152:155], v[112:127]
    ds_read_b128 a[216:219], v240 offset:6144
    ds_read_b128 a[220:223], v240 offset:7168
    buffer_load_dwordx4 v242, s[20:23], s48 offen offset:2048 sc1 lds
    v_max3_f32 v229, v229, v94, v95
    v_max3_f32 v228, v228, v96, v97
    v_max3_f32 v228, v228, v98, v99
    v_mfma_f32_32x32x16_bf16 v[112:127], v[60:63], a[156:159], v[112:127]
    buffer_load_dwordx4 v242, s[20:23], s48 offen offset:3072 sc1 lds
    v_max3_f32 v228, v228, v100, v101
    v_max3_f32 v228, v228, v102, v103
    v_max3_f32 v228, v228, v104, v105
    v_max3_f32 v228, v228, v106, v107
    v_max3_f32 v228, v228, v108, v109
    v_max3_f32 v228, v228, v110, v111
    v_mov_b32 v230, 0xc2200000
    s_mov_b32 s3, 0x41c00000
    s_nop 7
    v_max3_f32 v228, v228, v112, v113
    v_max3_f32 v228, v228, v114, v115
    v_max3_f32 v228, v228, v116, v117
    v_max3_f32 v228, v228, v118, v119
    v_max3_f32 v228, v228, v120, v121
    v_max3_f32 v228, v228, v122, v123
    v_max3_f32 v228, v228, v124, v125
    v_max3_f32 v228, v228, v126, v127
    v_mov_b32 v218, v228
    v_mov_b32 v219, v229
    s_nop 1
    v_permlane32_swap_b32 v228, v218
    v_permlane32_swap_b32 v229, v219
    s_nop 1
    v_max_f32 v228, v228, v218
    v_max_f32 v229, v229, v219
    v_med3_f32 v218, v228, v230, s3
    v_med3_f32 v219, v229, v230, s3
    v_cmp_neq_f32 vcc, v218, v228
    v_cmp_neq_f32 s[4:5], v219, v229
    s_nop 3
    s_or_b64 vcc, vcc, s[4:5]
    s_cbranch_vccnz K2_fx2
    s_branch K2_D1e
K2_D1_3:
    ds_read_b128 a[224:227], v241 offset:0
    ds_read_b128 a[228:231], v241 offset:1024
    ds_read_b128 a[232:235], v241 offset:2048
    ds_read_b128 a[236:239], v241 offset:3072
    ds_read_b128 a[240:243], v241 offset:4096
    ds_read_b128 a[244:247], v241 offset:5120
    ds_read_b128 a[248:251], v241 offset:6144
    ds_read_b128 a[252:255], v241 offset:7168
    s_waitcnt lgkmcnt(4)
    v_mfma_f32_32x32x16_bf16 v[0:15], a[224:227], a[128:131], 0
    s_add_u32 s44, s43, 0
    buffer_store_dwordx4 v[160:163], v245, s[20:23], s44 offen offset:0 sc0 sc1
    ds_read_b128 a[192:195], v240 offset:32768
    v_mfma_f32_32x32x16_bf16 v[0:15], a[228:231], a[132:135], v[0:15]
    ds_read_b128 a[196:199], v240 offset:33792
    v_subrev_u32 v249, 0x8000, v249
    ds_write_b128 v249, v[160:163] offset:0
    v_mfma_f32_32x32x16_bf16 v[0:15], a[232:235], a[136:139], v[0:15]
    s_add_u32 s44, s43, 0
    buffer_store_dwordx4 v[164:167], v245, s[20:23], s44 offen offset:128 sc0 sc1
    ds_read_b128 a[200:203], v240 offset:34816
    v_mfma_f32_32x32x16_bf16 v[0:15], a[236:239], a[140:143], v[0:15]
    ds_read_b128 a[204:207], v240 offset:35840
    ds_write_b128 v249, v[164:167] offset:128
    ds_write_b128 v249, v[168:171] offset:1024
    s_waitcnt lgkmcnt(7)
    v_mfma_f32_32x32x16_bf16 v[0:15], a[240:243], a[144:147], v[0:15]
    ds_read_b128 a[208:211], v240 offset:36864
    ds_read_b128 v[32:35], v241 offset:24576
    ds_write_b128 v249, v[172:175] offset:1152
    v_mfma_f32_32x32x16_bf16 v[0:15], a[244:247], a[148:151], v[0:15]
    s_add_u32 s44, s43, 0
    buffer_store_dwordx4 v[168:171], v245, s[20:23], s44 offen offset:1024 sc0 sc1
    ds_read_b128 a[212:215], v240 offset:37888
    ds_read_b128 v[36:39], v241 offset:25600
    v_mfma_f32_32x32x16_bf16 v[0:15], a[248:251], a[152:155], v[0:15]
    ds_read_b128 a[216:219], v240 offset:38912
    ds_read_b128 v[40:43], v241 offset:26624
    ds_write_b128 v249, a[80:83] offset:8192
    v_mfma_f32_32x32x16_bf16 v[0:15], a[252:255], a[156:159], v[0:15]
    ds_read_b128 a[220:223], v240 offset:39936
    ds_read_b128 v[44:47], v241 offset:27648
    s_waitcnt lgkmcnt(12)
    v_mfma_f32_32x32x16_bf16 v[64:79], a[192:195], a[160:163], v[128:143]
    s_add_u32 s44, s43, 0
    buffer_store_dwordx4 v[172:175], v245, s[20:23], s44 offen offset:1152 sc0 sc1
    ds_read_b128 a[224:227], v241 offset:8192
    ds_read_b128 v[48:51], v241 offset:28672
    v_mfma_f32_32x32x16_bf16 v[64:79], a[196:199], a[164:167], v[64:79]
    ds_read_b128 a[228:231], v241 offset:9216
    ds_read_b128 v[52:55], v241 offset:29696
    ds_write_b128 v249, a[84:87] offset:8320
    ds_write_b128 v249, a[88:91] offset:9216
    v_mfma_f32_32x32x16_bf16 v[64:79], a[200:203], a[168:171], v[64:79]
    ds_read_b128 a[232:235], v241 offset:10240
    ds_read_b128 v[56:59], v241 offset:30720
    ds_write_b128 v249, a[92:95] offset:9344
    v_mfma_f32_32x32x16_bf16 v[64:79], a[204:207], a[172:175], v[64:79]
    s_add_u32 s44, s43, 8192
    buffer_store_dwordx4 a[80:83], v245, s[20:23], s44 offen offset:0 sc0 sc1
    ds_read_b128 a[236:239], v241 offset:11264
    ds_read_b128 v[60:63], v241 offset:31744
    s_waitcnt lgkmcnt(12)
    v_mfma_f32_32x32x16_bf16 v[64:79], a[208:211], a[176:179], v[64:79]
    ds_read_b128 a[240:243], v241 offset:12288
    v_max3_f32 v228, v0, v1, v2
    v_max3_f32 v228, v228, v3, v4
    v_max3_f32 v228, v228, v5, v6
    v_max3_f32 v228, v228, v7, v8
    v_max3_f32 v228, v228, v9, v10
    v_max3_f32 v228, v228, v11, v12
    v_max3_f32 v228, v228, v13, v14
    v_mfma_f32_32x32x16_bf16 v[64:79], a[212:215], a[180:183], v[64:79]
    s_add_u32 s44, s43, 8192
    buffer_store_dwordx4 a[84:87], v245, s[20:23], s44 offen offset:128 sc0 sc1
    ds_read_b128 a[244:247], v241 offset:13312
    v_max_f32 v228, v228, v15
    v_exp_f32 v208, v0
    v_mfma_f32_32x32x16_bf16 v[64:79], a[216:219], a[184:187], v[64:79]
    ds_read_b128 a[248:251], v241 offset:14336
    v_exp_f32 v209, v1
    v_exp_f32 v210, v2
    v_add_f32 v232, v208, v209
    v_exp_f32 v211, v3
    v_cvt_pk_bf16_f32 v220, v208, v209
    v_mfma_f32_32x32x16_bf16 v[64:79], a[220:223], a[188:191], v[64:79]
    ds_read_b128 a[252:255], v241 offset:15360
    v_exp_f32 v212, v4
    v_add_f32 v232, v232, v210
    v_exp_f32 v213, v5
    v_add_f32 v232, v232, v211
    s_waitcnt lgkmcnt(5)
    v_mfma_f32_32x32x16_bf16 v[80:95], a[224:227], a[128:131], 0
    s_add_u32 s44, s43, 8192
    buffer_store_dwordx4 a[88:91], v245, s[20:23], s44 offen offset:1024 sc0 sc1
    ds_read_b128 a[192:195], v241 offset:16384
    ds_read_b128 a[196:199], v241 offset:17408
    v_cvt_pk_bf16_f32 v221, v210, v211
    v_exp_f32 v208, v6
    v_mfma_f32_32x32x16_bf16 v[80:95], a[228:231], a[132:135], v[80:95]
    ds_read_b128 a[200:203], v241 offset:18432
    v_add_f32 v232, v232, v212
    v_exp_f32 v209, v7
    v_add_f32 v232, v232, v213
    v_cvt_pk_bf16_f32 v222, v212, v213
    v_exp_f32 v210, v8
    v_mfma_f32_32x32x16_bf16 v[80:95], a[232:235], a[136:139], v[80:95]
    ds_read_b128 a[204:207], v241 offset:19456
    v_add_f32 v232, v232, v208
    v_exp_f32 v211, v9
    v_add_f32 v232, v232, v209
    v_cvt_pk_bf16_f32 v223, v208, v209
    v_exp_f32 v212, v10
    v_mfma_f32_32x32x16_bf16 v[80:95], a[236:239], a[140:143], v[80:95]
    s_add_u32 s44, s43, 8192
    buffer_store_dwordx4 a[92:95], v245, s[20:23], s44 offen offset:1152 sc0 sc1
    ds_read_b128 a[208:211], v241 offset:20480
    ds_read_b128 a[212:215], v241 offset:21504
    v_add_f32 v232, v232, v210
    s_waitcnt lgkmcnt(6)
    v_mfma_f32_32x32x16_bf16 v[80:95], a[240:243], a[144:147], v[80:95]
    ds_read_b128 a[216:219], v241 offset:22528
    v_exp_f32 v213, v11
    v_add_f32 v232, v232, v211
    v_cvt_pk_bf16_f32 v224, v210, v211
    v_exp_f32 v208, v12
    v_add_f32 v232, v232, v212
    v_mfma_f32_32x32x16_bf16 v[80:95], a[244:247], a[148:151], v[80:95]
    ds_read_b128 a[220:223], v241 offset:23552
    v_exp_f32 v209, v13
    v_add_f32 v232, v232, v213
    v_cvt_pk_bf16_f32 v225, v212, v213
    v_exp_f32 v210, v14
    v_add_f32 v232, v232, v208
    v_mfma_f32_32x32x16_bf16 v[80:95], a[248:251], a[152:155], v[80:95]
    v_exp_f32 v211, v15
    v_add_f32 v232, v232, v209
    v_cvt_pk_bf16_f32 v226, v208, v209
    v_add_f32 v232, v232, v210
    v_cvt_pk_bf16_f32 v227, v210, v211
    v_add_f32 v232, v232, v211
    v_max3_f32 v229, v64, v65, v66
    v_mfma_f32_32x32x16_bf16 v[80:95], a[252:255], a[156:159], v[80:95]
    v_max3_f32 v229, v229, v67, v68
    v_max3_f32 v229, v229, v69, v70
    v_max3_f32 v229, v229, v71, v72
    v_max3_f32 v229, v229, v73, v74
    v_max3_f32 v229, v229, v75, v76
    s_waitcnt vmcnt(8) lgkmcnt(0)
    s_barrier
    v_mfma_f32_32x32x16_bf16 v[96:111], a[192:195], a[128:131], 0
    s_add_u32 s48, s46, s34
    s_add_u32 s49, s47, s34
    s_add_u32 s50, s50, 1
    v_max3_f32 v229, v229, v77, v78
    v_max_f32 v229, v229, v79
    v_exp_f32 v208, v64
    v_mfma_f32_32x32x16_bf16 v[96:111], a[196:199], a[132:135], v[96:111]
    s_cmp_ge_u32 s50, 17
    s_cselect_b32 s46, s35, s51
    s_cselect_b32 s4, 0xffffd000, 0
    s_cselect_b32 s34, 0xff002000, 0
    s_cselect_b32 s5, 0x2000, 0
    v_exp_f32 v209, v65
    v_exp_f32 v210, v66
    v_mfma_f32_32x32x16_bf16 v[96:111], a[200:203], a[136:139], v[96:111]
    s_sub_u32 s35, s35, s5
    s_add_u32 s4, s4, s46
    s_cmp_le_u32 s50, s55
    s_cselect_b32 s47, 268435456, s4
    s_cselect_b32 s3, 1, 2
    v_add_f32 v233, v208, v209
    v_exp_f32 v211, v67
    v_mfma_f32_32x32x16_bf16 v[96:111], a[204:207], a[140:143], v[96:111]
    s_lshl_b32 s3, s3, 14
    s_add_u32 s51, s51, s3
    v_cvt_pk_bf16_f32 v144, v208, v209
    v_exp_f32 v212, v68
    v_add_f32 v233, v233, v210
    v_exp_f32 v213, v69
    v_mfma_f32_32x32x16_bf16 v[96:111], a[208:211], a[144:147], v[96:111]
    s_add_u32 m0, s52, 65536
    s_nop 0
    buffer_load_dwordx4 v242, s[16:19], s46 offen offset:0 sc1 lds
    v_add_f32 v233, v233, v211
    v_cvt_pk_bf16_f32 v145, v210, v211
    v_exp_f32 v208, v70
    v_add_f32 v233, v233, v212
    v_mfma_f32_32x32x16_bf16 v[96:111], a[212:215], a[148:151], v[96:111]
    buffer_load_dwordx4 v242, s[16:19], s46 offen offset:1024 sc1 lds
    v_exp_f32 v209, v71
    v_add_f32 v233, v233, v213
    v_cvt_pk_bf16_f32 v146, v212, v213
    v_exp_f32 v210, v72
    v_mfma_f32_32x32x16_bf16 v[96:111], a[216:219], a[152:155], v[96:111]
    buffer_load_dwordx4 v242, s[16:19], s46 offen offset:2048 sc1 lds
    v_add_f32 v233, v233, v208
    v_exp_f32 v211, v73
    v_add_f32 v233, v233, v209
    v_cvt_pk_bf16_f32 v147, v208, v209
    v_mfma_f32_32x32x16_bf16 v[96:111], a[220:223], a[156:159], v[96:111]
    buffer_load_dwordx4 v242, s[16:19], s46 offen offset:3072 sc1 lds
    s_add_u32 m0, s52, 81920
    v_exp_f32 v212, v74
    v_add_f32 v233, v233, v210
    v_exp_f32 v213, v75
    v_mfma_f32_32x32x16_bf16 v[112:127], v[32:35], a[128:131], v[128:143]
    ds_read_b128 a[192:195], v240 offset:0
    buffer_load_dwordx4 v243, s[16:19], s47 offen offset:0 sc1 lds
    v_add_f32 v233, v233, v211
    v_cvt_pk_bf16_f32 v148, v210, v211
    v_exp_f32 v208, v76
    v_mfma_f32_32x32x16_bf16 v[112:127], v[36:39], a[132:135], v[112:127]
    ds_read_b128 a[196:199], v240 offset:1024
    buffer_load_dwordx4 v243, s[16:19], s47 offen offset:1024 sc1 lds
    v_add_f32 v233, v233, v212
    v_exp_f32 v209, v77
    v_add_f32 v233, v233, v213
    v_mfma_f32_32x32x16_bf16 v[112:127], v[40:43], a[136:139], v[112:127]
    ds_read_b128 a[200:203], v240 offset:2048
    buffer_load_dwordx4 v243, s[16:19], s47 offen offset:2048 sc1 lds
    v_cvt_pk_bf16_f32 v149, v212, v213
    v_exp_f32 v210, v78
    v_add_f32 v233, v233, v208
    v_exp_f32 v211, v79
    v_mfma_f32_32x32x16_bf16 v[112:127], v[44:47], a[140:143], v[112:127]
    ds_read_b128 a[204:207], v240 offset:3072
    buffer_load_dwordx4 v243, s[16:19], s47 offen offset:3072 sc1 lds
    s_add_u32 m0, s52, 32768
    v_add_f32 v233, v233, v209
    v_cvt_pk_bf16_f32 v150, v208, v209
    v_add_f32 v233, v233, v210
    v_mfma_f32_32x32x16_bf16 v[112:127], v[48:51], a[144:147], v[112:127]
    ds_read_b128 a[208:211], v240 offset:4096
    buffer_load_dwordx4 v242, s[20:23], s48 offen offset:0 sc1 lds
    v_cvt_pk_bf16_f32 v151, v210, v211
    v_add_f32 v233, v233, v211
    v_max3_f32 v228, v228, v80, v81
    v_max3_f32 v228, v228, v82, v83
    v_mfma_f32_32x32x16_bf16 v[112:127], v[52:55], a[148:151], v[112:127]
    ds_read_b128 a[212:215], v240 offset:5120
    buffer_load_dwordx4 v242, s[20:23], s48 offen offset:1024 sc1 lds
    v_max3_f32 v228, v228, v84, v85
    v_max3_f32 v228, v228, v86, v87
    v_max3_f32 v228, v228, v88, v89
    v_max3_f32 v228, v228, v90, v91
    v_max3_f32 v228, v228, v92, v93
    v_mfma_f32_32x32x16_bf16 v[112:127], v[56:59], a[152:155], v[112:127]
    ds_read_b128 a[216:219], v240 offset:6144
    ds_read_b128 a[220:223], v240 offset:7168
    buffer_load_dwordx4 v242, s[20:23], s48 offen offset:2048 sc1 lds
    v_max3_f32 v228, v228, v94, v95
    v_max3_f32 v228, v228, v96, v97
    v_max3_f32 v228, v228, v98, v99
    v_mfma_f32_32x32x16_bf16 v[112:127], v[60:63], a[156:159], v[112:127]
    buffer_load_dwordx4 v242, s[20:23], s48 offen offset:3072 sc1 lds
    v_max3_f32 v228, v228, v100, v101
    v_max3_f32 v228, v228, v102, v103
    v_max3_f32 v228, v228, v104, v105
    v_max3_f32 v228, v228, v106, v107
    v_max3_f32 v228, v228, v108, v109
    v_max3_f32 v228, v228, v110, v111
    v_mov_b32 v230, 0xc2200000
    s_mov_b32 s3, 0x41c00000
    s_nop 7
    v_max3_f32 v228, v228, v112, v113
    v_max3_f32 v228, v228, v114, v115
    v_max3_f32 v228, v228, v116, v117
    v_max3_f32 v228, v228, v118, v119
    v_max3_f32 v228, v228, v120, v121
    v_max3_f32 v228, v228, v122, v123
    v_max3_f32 v228, v228, v124, v125
    v_max3_f32 v228, v228, v126, v127
    v_mov_b32 v218, v228
    v_mov_b32 v219, v229
    s_nop 1
    v_permlane32_swap_b32 v228, v218
    v_permlane32_swap_b32 v229, v219
    s_nop 1
    v_max_f32 v228, v228, v218
    v_max_f32 v229, v229, v219
    v_med3_f32 v218, v228, v230, s3
    v_med3_f32 v219, v229, v230, s3
    v_cmp_neq_f32 vcc, v218, v228
    v_cmp_neq_f32 s[4:5], v219, v229
    s_nop 3
    s_or_b64 vcc, vcc, s[4:5]
    s_cbranch_vccnz K2_fx3
    s_branch K2_D1e
K2_D2:
    s_cmp_eq_u32 s94, 1
    s_cbranch_scc1 K2_D2_1
    s_cmp_eq_u32 s94, 2
    s_cbranch_scc1 K2_D2_2
    s_cmp_eq_u32 s94, 3
    s_cbranch_scc1 K2_D2_3
K2_D2_0:
    s_waitcnt lgkmcnt(4)
    v_mfma_f32_32x32x16_bf16 a[0:15], a[192:195], v[220:223], 0
    ds_read_b128 a[224:227], v246 offset:0
    v_add_f32 v217, v217, v214
    v_add_f32 v217, v217, v215
    v_add_f32 v216, v216, v232
    v_add_f32 v217, v217, v233
    v_exp_f32 v208, v80
    v_mfma_f32_32x32x16_bf16 a[16:31], a[196:199], v[220:223], 0
    s_add_u32 m0, s52, 16384
    ds_read_b128 a[228:231], v246 offset:1024
    v_exp_f32 v209, v81
    v_exp_f32 v210, v82
    v_mfma_f32_32x32x16_bf16 a[32:47], a[200:203], v[220:223], 0
    ds_read_b128 a[232:235], v246 offset:2048
    v_add_f32 v234, v208, v209
    v_exp_f32 v211, v83
    v_cvt_pk_bf16_f32 v152, v208, v209
    v_mfma_f32_32x32x16_bf16 a[48:63], a[204:207], v[220:223], 0
    ds_read_b128 a[236:239], v246 offset:3072
    v_exp_f32 v212, v84
    v_add_f32 v234, v234, v210
    v_exp_f32 v213, v85
    s_waitcnt lgkmcnt(4)
    v_mfma_f32_32x32x16_bf16 a[0:15], a[208:211], v[224:227], a[0:15]
    ds_read_b128 a[240:243], v246 offset:4096
    v_add_f32 v234, v234, v211
    v_cvt_pk_bf16_f32 v153, v210, v211
    v_exp_f32 v208, v86
    v_add_f32 v234, v234, v212
    v_mfma_f32_32x32x16_bf16 a[16:31], a[212:215], v[224:227], a[16:31]
    ds_read_b128 a[244:247], v246 offset:5120
    v_exp_f32 v209, v87
    v_add_f32 v234, v234, v213
    v_cvt_pk_bf16_f32 v154, v212, v213
    v_exp_f32 v210, v88
    v_mfma_f32_32x32x16_bf16 a[32:47], a[216:219], v[224:227], a[32:47]
    buffer_load_dwordx4 v243, s[16:19], s47 offen offset:0 sc1 lds
    ds_read_b128 a[248:251], v246 offset:6144
    v_add_f32 v234, v234, v208
    v_exp_f32 v211, v89
    v_mfma_f32_32x32x16_bf16 a[48:63], a[220:223], v[224:227], a[48:63]
    ds_read_b128 a[252:255], v246 offset:7168
    v_add_f32 v234, v234, v209
    v_cvt_pk_bf16_f32 v155, v208, v209
    v_exp_f32 v212, v90
    s_waitcnt lgkmcnt(4)
    v_mfma_f32_32x32x16_bf16 a[64:79], a[224:227], v[144:147], 0
    ds_read_b128 a[192:195], v246 offset:16384
    v_add_f32 v234, v234, v210
    v_exp_f32 v213, v91
    v_add_f32 v234, v234, v211
    v_cvt_pk_bf16_f32 v156, v210, v211
    v_mfma_f32_32x32x16_bf16 a[80:95], a[228:231], v[144:147], 0
    ds_read_b128 a[196:199], v246 offset:17408
    v_exp_f32 v208, v92
    v_add_f32 v234, v234, v212
    v_exp_f32 v209, v93
    v_mfma_f32_32x32x16_bf16 a[96:111], a[232:235], v[144:147], 0
    ds_read_b128 a[200:203], v246 offset:18432
    v_add_f32 v234, v234, v213
    v_cvt_pk_bf16_f32 v157, v212, v213
    v_exp_f32 v210, v94
    v_add_f32 v234, v234, v208
    v_mfma_f32_32x32x16_bf16 a[112:127], a[236:239], v[144:147], 0
    buffer_load_dwordx4 v243, s[16:19], s47 offen offset:1024 sc1 lds
    ds_read_b128 a[204:207], v246 offset:19456
    v_exp_f32 v211, v95
    s_waitcnt lgkmcnt(4)
    v_mfma_f32_32x32x16_bf16 a[64:79], a[240:243], v[148:151], a[64:79]
    ds_read_b128 a[208:211], v246 offset:20480
    v_add_f32 v234, v234, v209
    v_cvt_pk_bf16_f32 v158, v208, v209
    v_add_f32 v234, v234, v210
    v_cvt_pk_bf16_f32 v159, v210, v211
    v_add_f32 v234, v234, v211
    v_add_f32 v217, v217, v234
    v_mfma_f32_32x32x16_bf16 a[80:95], a[244:247], v[148:151], a[80:95]
    ds_read_b128 a[212:215], v246 offset:21504
    v_exp_f32 v208, v0
    v_exp_f32 v209, v1
    v_exp_f32 v210, v2
    v_mfma_f32_32x32x16_bf16 a[96:111], a[248:251], v[148:151], a[96:111]
    ds_read_b128 a[216:219], v246 offset:22528
    v_add_f32 v214, v208, v209
    v_exp_f32 v211, v3
    v_cvt_pk_bf16_f32 v128, v208, v209
    v_mfma_f32_32x32x16_bf16 a[112:127], a[252:255], v[148:151], a[112:127]
    ds_read_b128 a[220:223], v246 offset:23552
    v_exp_f32 v212, v4
    v_add_f32 v214, v214, v210
    v_exp_f32 v213, v5
    s_waitcnt lgkmcnt(4)
    v_mfma_f32_32x32x16_bf16 a[64:79], a[192:195], v[160:163], a[64:79]
    ds_read_b128 v[96:99], v246 offset:24576
    v_add_f32 v214, v214, v211
    v_cvt_pk_bf16_f32 v129, v210, v211
    v_exp_f32 v208, v6
    v_add_f32 v214, v214, v212
    v_mfma_f32_32x32x16_bf16 a[80:95], a[196:199], v[160:163], a[80:95]
    buffer_load_dwordx4 v243, s[16:19], s47 offen offset:2048 sc1 lds
    ds_read_b128 v[100:103], v246 offset:25600
    v_exp_f32 v209, v7
    v_add_f32 v214, v214, v213
    v_mfma_f32_32x32x16_bf16 a[96:111], a[200:203], v[160:163], a[96:111]
    ds_read_b128 v[104:107], v246 offset:26624
    v_cvt_pk_bf16_f32 v130, v212, v213
    v_exp_f32 v210, v8
    v_add_f32 v214, v214, v208
    v_exp_f32 v211, v9
    v_mfma_f32_32x32x16_bf16 a[112:127], a[204:207], v[160:163], a[112:127]
    ds_read_b128 v[108:111], v246 offset:27648
    v_add_f32 v214, v214, v209
    v_cvt_pk_bf16_f32 v131, v208, v209
    v_exp_f32 v212, v10
    s_waitcnt lgkmcnt(4)
    v_mfma_f32_32x32x16_bf16 a[64:79], a[208:211], v[164:167], a[64:79]
    ds_read_b128 v[112:115], v246 offset:28672
    v_add_f32 v214, v214, v210
    v_exp_f32 v213, v11
    v_add_f32 v214, v214, v211
    v_cvt_pk_bf16_f32 v132, v210, v211
    v_mfma_f32_32x32x16_bf16 a[80:95], a[212:215], v[164:167], a[80:95]
    ds_read_b128 v[116:119], v246 offset:29696
    v_exp_f32 v208, v12
    v_add_f32 v214, v214, v212
    v_exp_f32 v209, v13
    v_mfma_f32_32x32x16_bf16 a[96:111], a[216:219], v[164:167], a[96:111]
    buffer_load_dwordx4 v243, s[16:19], s47 offen offset:3072 sc1 lds
    ds_read_b128 v[120:123], v246 offset:30720
    v_add_f32 v214, v214, v213
    v_cvt_pk_bf16_f32 v133, v212, v213
    v_mfma_f32_32x32x16_bf16 a[112:127], a[220:223], v[164:167], a[112:127]
    ds_read_b128 v[124:127], v246 offset:31744
    v_exp_f32 v210, v14
    v_add_f32 v214, v214, v208
    v_exp_f32 v211, v15
    s_waitcnt lgkmcnt(4)
    v_mfma_f32_32x32x16_bf16 a[64:79], v[96:99], v[168:171], a[64:79]
    ds_read_b128 a[224:227], v246 offset:8192
    ds_read_b128 a[228:231], v246 offset:9216
    v_add_f32 v214, v214, v209
    v_cvt_pk_bf16_f32 v134, v208, v209
    v_exp_f32 v212, v16
    v_mfma_f32_32x32x16_bf16 a[80:95], v[100:103], v[168:171], a[80:95]
    ds_read_b128 a[232:235], v246 offset:10240
    v_add_f32 v214, v214, v210
    v_exp_f32 v213, v17
    v_add_f32 v214, v214, v211
    v_cvt_pk_bf16_f32 v135, v210, v211
    v_mfma_f32_32x32x16_bf16 a[96:111], v[104:107], v[168:171], a[96:111]
    ds_read_b128 a[236:239], v246 offset:11264
    v_exp_f32 v208, v18
    v_add_f32 v215, v212, v213
    v_exp_f32 v209, v19
    v_cvt_pk_bf16_f32 v136, v212, v213
    v_mfma_f32_32x32x16_bf16 a[112:127], v[108:111], v[168:171], a[112:127]
    ds_read_b128 a[240:243], v246 offset:12288
    ds_read_b128 a[244:247], v246 offset:13312
    v_exp_f32 v210, v20
    v_add_f32 v215, v215, v208
    s_waitcnt lgkmcnt(6)
    v_mfma_f32_32x32x16_bf16 a[64:79], v[112:115], v[172:175], a[64:79]
    ds_read_b128 a[248:251], v246 offset:14336
    v_exp_f32 v211, v21
    v_add_f32 v215, v215, v209
    v_cvt_pk_bf16_f32 v137, v208, v209
    v_exp_f32 v212, v22
    v_mfma_f32_32x32x16_bf16 a[80:95], v[116:119], v[172:175], a[80:95]
    ds_read_b128 a[252:255], v246 offset:15360
    v_add_f32 v215, v215, v210
    v_exp_f32 v213, v23
    v_add_f32 v215, v215, v211
    v_cvt_pk_bf16_f32 v138, v210, v211
    v_mfma_f32_32x32x16_bf16 a[96:111], v[120:123], v[172:175], a[96:111]
    v_exp_f32 v208, v24
    v_add_f32 v215, v215, v212
    v_exp_f32 v209, v25
    v_add_f32 v215, v215, v213
    v_mfma_f32_32x32x16_bf16 a[112:127], v[124:127], v[172:175], a[112:127]
    s_waitcnt vmcnt(16) lgkmcnt(0)
    s_barrier
    s_cmp_lg_u32 s94, 0
    s_cbranch_scc1 nf_28
    s_lshl_b32 s3, s32, 6
    s_lshl_b32 s4, s33, 3
    s_add_u32 s3, s3, s4
    s_add_u32 s3, s3, 2048
    s_add_u32 s3, s3, 2048
    buffer_store_dwordx2 v[250:251], off, s[64:67], s3 sc0 sc1
nf_28:
    v_mfma_f32_32x32x16_bf16 a[64:79], a[224:227], v[152:155], a[64:79]
    s_add_u32 m0, s52, 98304
    ds_read_b128 a[192:195], v241 offset:0
    v_cvt_pk_bf16_f32 v139, v212, v213
    v_exp_f32 v210, v26
    v_add_f32 v215, v215, v208
    v_mfma_f32_32x32x16_bf16 a[80:95], a[228:231], v[152:155], a[80:95]
    buffer_load_dwordx4 v242, s[20:23], s48 offen offset:0 sc1 lds
    ds_read_b128 a[196:199], v241 offset:1024
    v_exp_f32 v211, v27
    v_add_f32 v215, v215, v209
    v_mfma_f32_32x32x16_bf16 a[96:111], a[232:235], v[152:155], a[96:111]
    buffer_load_dwordx4 v242, s[20:23], s48 offen offset:1024 sc1 lds
    ds_read_b128 a[200:203], v241 offset:2048
    v_cvt_pk_bf16_f32 v140, v208, v209
    v_exp_f32 v212, v28
    v_mfma_f32_32x32x16_bf16 a[112:127], a[236:239], v[152:155], a[112:127]
    ds_read_b128 a[204:207], v241 offset:3072
    v_add_f32 v215, v215, v210
    v_exp_f32 v213, v29
    v_add_f32 v215, v215, v211
    v_cvt_pk_bf16_f32 v141, v210, v211
    v_mfma_f32_32x32x16_bf16 a[64:79], a[240:243], v[156:159], a[64:79]
    buffer_load_dwordx4 v242, s[20:23], s48 offen offset:2048 sc1 lds
    ds_read_b128 a[208:211], v241 offset:4096
    v_exp_f32 v208, v30
    v_add_f32 v215, v215, v212
    v_mfma_f32_32x32x16_bf16 a[80:95], a[244:247], v[156:159], a[80:95]
    buffer_load_dwordx4 v242, s[20:23], s48 offen offset:3072 sc1 lds
    ds_read_b128 a[212:215], v241 offset:5120
    v_exp_f32 v209, v31
    v_add_f32 v215, v215, v213
    v_mfma_f32_32x32x16_bf16 a[96:111], a[248:251], v[156:159], a[96:111]
    ds_read_b128 a[216:219], v241 offset:6144
    ds_read_b128 a[220:223], v241 offset:7168
    v_cvt_pk_bf16_f32 v142, v212, v213
    v_add_f32 v215, v215, v208
    v_cvt_pk_bf16_f32 v143, v208, v209
    v_add_f32 v215, v215, v209
    v_mfma_f32_32x32x16_bf16 a[112:127], a[252:255], v[156:159], a[112:127]
    s_mov_b32 s54, 2
    s_branch K2_disp
K2_D2_1:
    s_waitcnt lgkmcnt(4)
    v_mfma_f32_32x32x16_bf16 a[0:15], a[192:195], v[220:223], 0
    ds_read_b128 a[224:227], v246 offset:0
    v_add_f32 v217, v217, v214
    v_add_f32 v216, v216, v215
    v_add_f32 v216, v216, v232
    v_add_f32 v217, v217, v233
    v_exp_f32 v208, v80
    v_mfma_f32_32x32x16_bf16 a[16:31], a[196:199], v[220:223], 0
    s_add_u32 m0, s52, 16384
    ds_read_b128 a[228:231], v246 offset:1024
    v_exp_f32 v209, v81
    v_exp_f32 v210, v82
    v_mfma_f32_32x32x16_bf16 a[32:47], a[200:203], v[220:223], 0
    ds_read_b128 a[232:235], v246 offset:2048
    v_add_f32 v234, v208, v209
    v_exp_f32 v211, v83
    v_cvt_pk_bf16_f32 v152, v208, v209
    v_mfma_f32_32x32x16_bf16 a[48:63], a[204:207], v[220:223], 0
    ds_read_b128 a[236:239], v246 offset:3072
    v_exp_f32 v212, v84
    v_add_f32 v234, v234, v210
    v_exp_f32 v213, v85
    s_waitcnt lgkmcnt(4)
    v_mfma_f32_32x32x16_bf16 a[0:15], a[208:211], v[224:227], a[0:15]
    ds_read_b128 a[240:243], v246 offset:4096
    v_add_f32 v234, v234, v211
    v_cvt_pk_bf16_f32 v153, v210, v211
    v_exp_f32 v208, v86
    v_add_f32 v234, v234, v212
    v_mfma_f32_32x32x16_bf16 a[16:31], a[212:215], v[224:227], a[16:31]
    ds_read_b128 a[244:247], v246 offset:5120
    v_exp_f32 v209, v87
    v_add_f32 v234, v234, v213
    v_cvt_pk_bf16_f32 v154, v212, v213
    v_exp_f32 v210, v88
    v_mfma_f32_32x32x16_bf16 a[32:47], a[216:219], v[224:227], a[32:47]
    buffer_load_dwordx4 v243, s[16:19], s47 offen offset:0 sc1 lds
    ds_read_b128 a[248:251], v246 offset:6144
    v_add_f32 v234, v234, v208
    v_exp_f32 v211, v89
    v_mfma_f32_32x32x16_bf16 a[48:63], a[220:223], v[224:227], a[48:63]
    ds_read_b128 a[252:255], v246 offset:7168
    v_add_f32 v234, v234, v209
    v_cvt_pk_bf16_f32 v155, v208, v209
    v_exp_f32 v212, v90
    s_waitcnt lgkmcnt(4)
    v_mfma_f32_32x32x16_bf16 a[64:79], a[224:227], v[144:147], 0
    ds_read_b128 a[192:195], v246 offset:16384
    v_add_f32 v234, v234, v210
    v_exp_f32 v213, v91
    v_add_f32 v234, v234, v211
    v_cvt_pk_bf16_f32 v156, v210, v211
    v_mfma_f32_32x32x16_bf16 a[80:95], a[228:231], v[144:147], 0
    ds_read_b128 a[196:199], v246 offset:17408
    v_exp_f32 v208, v92
    v_add_f32 v234, v234, v212
    v_exp_f32 v209, v93
    v_mfma_f32_32x32x16_bf16 a[96:111], a[232:235], v[144:147], 0
    ds_read_b128 a[200:203], v246 offset:18432
    v_add_f32 v234, v234, v213
    v_cvt_pk_bf16_f32 v157, v212, v213
    v_exp_f32 v210, v94
    v_add_f32 v234, v234, v208
    v_mfma_f32_32x32x16_bf16 a[112:127], a[236:239], v[144:147], 0
    buffer_load_dwordx4 v243, s[16:19], s47 offen offset:1024 sc1 lds
    ds_read_b128 a[204:207], v246 offset:19456
    v_exp_f32 v211, v95
    s_waitcnt lgkmcnt(4)
    v_mfma_f32_32x32x16_bf16 a[64:79], a[240:243], v[148:151], a[64:79]
    ds_read_b128 a[208:211], v246 offset:20480
    v_add_f32 v234, v234, v209
    v_cvt_pk_bf16_f32 v158, v208, v209
    v_add_f32 v234, v234, v210
    v_cvt_pk_bf16_f32 v159, v210, v211
    v_add_f32 v234, v234, v211
    v_add_f32 v217, v217, v234
    v_mfma_f32_32x32x16_bf16 a[80:95], a[244:247], v[148:151], a[80:95]
    ds_read_b128 a[212:215], v246 offset:21504
    v_exp_f32 v208, v0
    v_exp_f32 v209, v1
    v_exp_f32 v210, v2
    v_mfma_f32_32x32x16_bf16 a[96:111], a[248:251], v[148:151], a[96:111]
    ds_read_b128 a[216:219], v246 offset:22528
    v_add_f32 v214, v208, v209
    v_exp_f32 v211, v3
    v_cvt_pk_bf16_f32 v128, v208, v209
    v_mfma_f32_32x32x16_bf16 a[112:127], a[252:255], v[148:151], a[112:127]
    ds_read_b128 a[220:223], v246 offset:23552
    v_exp_f32 v212, v4
    v_add_f32 v214, v214, v210
    v_exp_f32 v213, v5
    s_waitcnt lgkmcnt(4)
    v_mfma_f32_32x32x16_bf16 a[64:79], a[192:195], v[160:163], a[64:79]
    ds_read_b128 v[96:99], v241 offset:40960
    v_add_f32 v214, v214, v211
    v_cvt_pk_bf16_f32 v129, v210, v211
    v_exp_f32 v208, v6
    v_add_f32 v214, v214, v212
    v_mfma_f32_32x32x16_bf16 a[80:95], a[196:199], v[160:163], a[80:95]
    buffer_load_dwordx4 v243, s[16:19], s47 offen offset:2048 sc1 lds
    ds_read_b128 v[100:103], v241 offset:41984
    v_exp_f32 v209, v7
    v_add_f32 v214, v214, v213
    v_mfma_f32_32x32x16_bf16 a[96:111], a[200:203], v[160:163], a[96:111]
    ds_read_b128 v[104:107], v241 offset:43008
    v_cvt_pk_bf16_f32 v130, v212, v213
    v_exp_f32 v210, v8
    v_add_f32 v214, v214, v208
    v_exp_f32 v211, v9
    v_mfma_f32_32x32x16_bf16 a[112:127], a[204:207], v[160:163], a[112:127]
    ds_read_b128 v[108:111], v241 offset:44032
    v_add_f32 v214, v214, v209
    v_cvt_pk_bf16_f32 v131, v208, v209
    v_exp_f32 v212, v10
    s_waitcnt lgkmcnt(4)
    v_mfma_f32_32x32x16_bf16 a[64:79], a[208:211], v[164:167], a[64:79]
    ds_read_b128 v[112:115], v241 offset:45056
    v_add_f32 v214, v214, v210
    v_exp_f32 v213, v11
    v_add_f32 v214, v214, v211
    v_cvt_pk_bf16_f32 v132, v210, v211
    v_mfma_f32_32x32x16_bf16 a[80:95], a[212:215], v[164:167], a[80:95]
    ds_read_b128 v[116:119], v241 offset:46080
    v_exp_f32 v208, v12
    v_add_f32 v214, v214, v212
    v_exp_f32 v209, v13
    v_mfma_f32_32x32x16_bf16 a[96:111], a[216:219], v[164:167], a[96:111]
    buffer_load_dwordx4 v243, s[16:19], s47 offen offset:3072 sc1 lds
    ds_read_b128 v[120:123], v241 offset:47104
    v_add_f32 v214, v214, v213
    v_cvt_pk_bf16_f32 v133, v212, v213
    v_mfma_f32_32x32x16_bf16 a[112:127], a[220:223], v[164:167], a[112:127]
    ds_read_b128 v[124:127], v241 offset:48128
    v_exp_f32 v210, v14
    v_add_f32 v214, v214, v208
    v_exp_f32 v211, v15
    s_waitcnt lgkmcnt(4)
    v_mfma_f32_32x32x16_bf16 a[0:15], v[96:99], v[168:171], a[0:15]
    ds_read_b128 a[224:227], v246 offset:8192
    ds_read_b128 a[228:231], v246 offset:9216
    v_add_f32 v214, v214, v209
    v_cvt_pk_bf16_f32 v134, v208, v209
    v_exp_f32 v212, v16
    v_mfma_f32_32x32x16_bf16 a[16:31], v[100:103], v[168:171], a[16:31]
    ds_read_b128 a[232:235], v246 offset:10240
    v_add_f32 v214, v214, v210
    v_exp_f32 v213, v17
    v_add_f32 v214, v214, v211
    v_cvt_pk_bf16_f32 v135, v210, v211
    v_mfma_f32_32x32x16_bf16 a[32:47], v[104:107], v[168:171], a[32:47]
    ds_read_b128 a[236:239], v246 offset:11264
    v_exp_f32 v208, v18
    v_add_f32 v215, v212, v213
    v_exp_f32 v209, v19
    v_cvt_pk_bf16_f32 v136, v212, v213
    v_mfma_f32_32x32x16_bf16 a[48:63], v[108:111], v[168:171], a[48:63]
    ds_read_b128 a[240:243], v246 offset:12288
    ds_read_b128 a[244:247], v246 offset:13312
    v_exp_f32 v210, v20
    v_add_f32 v215, v215, v208
    s_waitcnt lgkmcnt(6)
    v_mfma_f32_32x32x16_bf16 a[0:15], v[112:115], v[172:175], a[0:15]
    ds_read_b128 a[248:251], v246 offset:14336
    v_exp_f32 v211, v21
    v_add_f32 v215, v215, v209
    v_cvt_pk_bf16_f32 v137, v208, v209
    v_exp_f32 v212, v22
    v_mfma_f32_32x32x16_bf16 a[16:31], v[116:119], v[172:175], a[16:31]
    ds_read_b128 a[252:255], v246 offset:15360
    v_add_f32 v215, v215, v210
    v_exp_f32 v213, v23
    v_add_f32 v215, v215, v211
    v_cvt_pk_bf16_f32 v138, v210, v211
    v_mfma_f32_32x32x16_bf16 a[32:47], v[120:123], v[172:175], a[32:47]
    v_exp_f32 v208, v24
    v_add_f32 v215, v215, v212
    v_exp_f32 v209, v25
    v_add_f32 v215, v215, v213
    v_mfma_f32_32x32x16_bf16 a[48:63], v[124:127], v[172:175], a[48:63]
    s_waitcnt vmcnt(16) lgkmcnt(0)
    s_barrier
    s_cmp_lg_u32 s94, 0
    s_cbranch_scc1 nf_29
    s_lshl_b32 s3, s32, 6
    s_lshl_b32 s4, s33, 3
    s_add_u32 s3, s3, s4
    s_add_u32 s3, s3, 2048
    s_add_u32 s3, s3, 2048
    buffer_store_dwordx2 v[250:251], off, s[64:67], s3 sc0 sc1
nf_29:
    v_mfma_f32_32x32x16_bf16 a[64:79], a[224:227], v[152:155], a[64:79]
    s_add_u32 m0, s52, 98304
    ds_read_b128 a[192:195], v241 offset:0
    v_cvt_pk_bf16_f32 v139, v212, v213
    v_exp_f32 v210, v26
    v_add_f32 v215, v215, v208
    v_mfma_f32_32x32x16_bf16 a[80:95], a[228:231], v[152:155], a[80:95]
    buffer_load_dwordx4 v242, s[20:23], s48 offen offset:0 sc1 lds
    ds_read_b128 a[196:199], v241 offset:1024
    v_exp_f32 v211, v27
    v_add_f32 v215, v215, v209
    v_mfma_f32_32x32x16_bf16 a[96:111], a[232:235], v[152:155], a[96:111]
    buffer_load_dwordx4 v242, s[20:23], s48 offen offset:1024 sc1 lds
    ds_read_b128 a[200:203], v241 offset:2048
    v_cvt_pk_bf16_f32 v140, v208, v209
    v_exp_f32 v212, v28
    v_mfma_f32_32x32x16_bf16 a[112:127], a[236:239], v[152:155], a[112:127]
    ds_read_b128 a[204:207], v241 offset:3072
    v_add_f32 v215, v215, v210
    v_exp_f32 v213, v29
    v_add_f32 v215, v215, v211
    v_cvt_pk_bf16_f32 v141, v210, v211
    v_mfma_f32_32x32x16_bf16 a[64:79], a[240:243], v[156:159], a[64:79]
    buffer_load_dwordx4 v242, s[20:23], s48 offen offset:2048 sc1 lds
    ds_read_b128 a[208:211], v241 offset:4096
    v_exp_f32 v208, v30
    v_add_f32 v215, v215, v212
    v_mfma_f32_32x32x16_bf16 a[80:95], a[244:247], v[156:159], a[80:95]
    buffer_load_dwordx4 v242, s[20:23], s48 offen offset:3072 sc1 lds
    ds_read_b128 a[212:215], v241 offset:5120
    v_exp_f32 v209, v31
    v_add_f32 v215, v215, v213
    v_mfma_f32_32x32x16_bf16 a[96:111], a[248:251], v[156:159], a[96:111]
    ds_read_b128 a[216:219], v241 offset:6144
    ds_read_b128 a[220:223], v241 offset:7168
    v_cvt_pk_bf16_f32 v142, v212, v213
    v_add_f32 v215, v215, v208
    v_cvt_pk_bf16_f32 v143, v208, v209
    v_add_f32 v215, v215, v209
    v_mfma_f32_32x32x16_bf16 a[112:127], a[252:255], v[156:159], a[112:127]
    s_mov_b32 s54, 2
    s_branch K2_disp
K2_D2_2:
    s_waitcnt lgkmcnt(4)
    v_mfma_f32_32x32x16_bf16 a[0:15], a[192:195], v[220:223], 0
    ds_read_b128 a[224:227], v246 offset:0
    v_add_f32 v216, v216, v214
    v_add_f32 v216, v216, v215
    v_add_f32 v216, v216, v232
    v_add_f32 v217, v217, v233
    v_exp_f32 v208, v80
    v_mfma_f32_32x32x16_bf16 a[16:31], a[196:199], v[220:223], 0
    s_add_u32 m0, s52, 16384
    ds_read_b128 a[228:231], v246 offset:1024
    v_exp_f32 v209, v81
    v_exp_f32 v210, v82
    v_mfma_f32_32x32x16_bf16 a[32:47], a[200:203], v[220:223], 0
    ds_read_b128 a[232:235], v246 offset:2048
    v_add_f32 v234, v208, v209
    v_exp_f32 v211, v83
    v_cvt_pk_bf16_f32 v152, v208, v209
    v_mfma_f32_32x32x16_bf16 a[48:63], a[204:207], v[220:223], 0
    ds_read_b128 a[236:239], v246 offset:3072
    v_exp_f32 v212, v84
    v_add_f32 v234, v234, v210
    v_exp_f32 v213, v85
    s_waitcnt lgkmcnt(4)
    v_mfma_f32_32x32x16_bf16 a[0:15], a[208:211], v[224:227], a[0:15]
    ds_read_b128 a[240:243], v246 offset:4096
    v_add_f32 v234, v234, v211
    v_cvt_pk_bf16_f32 v153, v210, v211
    v_exp_f32 v208, v86
    v_add_f32 v234, v234, v212
    v_mfma_f32_32x32x16_bf16 a[16:31], a[212:215], v[224:227], a[16:31]
    ds_read_b128 a[244:247], v246 offset:5120
    v_exp_f32 v209, v87
    v_add_f32 v234, v234, v213
    v_cvt_pk_bf16_f32 v154, v212, v213
    v_exp_f32 v210, v88
    v_mfma_f32_32x32x16_bf16 a[32:47], a[216:219], v[224:227], a[32:47]
    buffer_load_dwordx4 v243, s[16:19], s47 offen offset:0 sc1 lds
    ds_read_b128 a[248:251], v246 offset:6144
    v_add_f32 v234, v234, v208
    v_exp_f32 v211, v89
    v_mfma_f32_32x32x16_bf16 a[48:63], a[220:223], v[224:227], a[48:63]
    ds_read_b128 a[252:255], v246 offset:7168
    v_add_f32 v234, v234, v209
    v_cvt_pk_bf16_f32 v155, v208, v209
    v_exp_f32 v212, v90
    s_waitcnt lgkmcnt(4)
    v_mfma_f32_32x32x16_bf16 a[64:79], a[224:227], v[144:147], 0
    ds_read_b128 a[192:195], v241 offset:40960
    v_add_f32 v234, v234, v210
    v_exp_f32 v213, v91
    v_add_f32 v234, v234, v211
    v_cvt_pk_bf16_f32 v156, v210, v211
    v_mfma_f32_32x32x16_bf16 a[80:95], a[228:231], v[144:147], 0
    ds_read_b128 a[196:199], v241 offset:41984
    v_exp_f32 v208, v92
    v_add_f32 v234, v234, v212
    v_exp_f32 v209, v93
    v_mfma_f32_32x32x16_bf16 a[96:111], a[232:235], v[144:147], 0
    ds_read_b128 a[200:203], v241 offset:43008
    v_add_f32 v234, v234, v213
    v_cvt_pk_bf16_f32 v157, v212, v213
    v_exp_f32 v210, v94
    v_add_f32 v234, v234, v208
    v_mfma_f32_32x32x16_bf16 a[112:127], a[236:239], v[144:147], 0
    buffer_load_dwordx4 v243, s[16:19], s47 offen offset:1024 sc1 lds
    ds_read_b128 a[204:207], v241 offset:44032
    v_exp_f32 v211, v95
    s_waitcnt lgkmcnt(4)
    v_mfma_f32_32x32x16_bf16 a[64:79], a[240:243], v[148:151], a[64:79]
    ds_read_b128 a[208:211], v241 offset:45056
    v_add_f32 v234, v234, v209
    v_cvt_pk_bf16_f32 v158, v208, v209
    v_add_f32 v234, v234, v210
    v_cvt_pk_bf16_f32 v159, v210, v211
    v_add_f32 v234, v234, v211
    v_add_f32 v217, v217, v234
    v_mfma_f32_32x32x16_bf16 a[80:95], a[244:247], v[148:151], a[80:95]
    ds_read_b128 a[212:215], v241 offset:46080
    v_exp_f32 v208, v0
    v_exp_f32 v209, v1
    v_exp_f32 v210, v2
    v_mfma_f32_32x32x16_bf16 a[96:111], a[248:251], v[148:151], a[96:111]
    ds_read_b128 a[216:219], v241 offset:47104
    v_add_f32 v214, v208, v209
    v_exp_f32 v211, v3
    v_cvt_pk_bf16_f32 v128, v208, v209
    v_mfma_f32_32x32x16_bf16 a[112:127], a[252:255], v[148:151], a[112:127]
    ds_read_b128 a[220:223], v241 offset:48128
    v_exp_f32 v212, v4
    v_add_f32 v214, v214, v210
    v_exp_f32 v213, v5
    s_waitcnt lgkmcnt(4)
    v_mfma_f32_32x32x16_bf16 a[0:15], a[192:195], v[160:163], a[0:15]
    ds_read_b128 v[96:99], v241 offset:49152
    v_add_f32 v214, v214, v211
    v_cvt_pk_bf16_f32 v129, v210, v211
    v_exp_f32 v208, v6
    v_add_f32 v214, v214, v212
    v_mfma_f32_32x32x16_bf16 a[16:31], a[196:199], v[160:163], a[16:31]
    buffer_load_dwordx4 v243, s[16:19], s47 offen offset:2048 sc1 lds
    ds_read_b128 v[100:103], v241 offset:50176
    v_exp_f32 v209, v7
    v_add_f32 v214, v214, v213
    v_mfma_f32_32x32x16_bf16 a[32:47], a[200:203], v[160:163], a[32:47]
    ds_read_b128 v[104:107], v241 offset:51200
    v_cvt_pk_bf16_f32 v130, v212, v213
    v_exp_f32 v210, v8
    v_add_f32 v214, v214, v208
    v_exp_f32 v211, v9
    v_mfma_f32_32x32x16_bf16 a[48:63], a[204:207], v[160:163], a[48:63]
    ds_read_b128 v[108:111], v241 offset:52224
    v_add_f32 v214, v214, v209
    v_cvt_pk_bf16_f32 v131, v208, v209
    v_exp_f32 v212, v10
    s_waitcnt lgkmcnt(4)
    v_mfma_f32_32x32x16_bf16 a[0:15], a[208:211], v[164:167], a[0:15]
    ds_read_b128 v[112:115], v241 offset:53248
    v_add_f32 v214, v214, v210
    v_exp_f32 v213, v11
    v_add_f32 v214, v214, v211
    v_cvt_pk_bf16_f32 v132, v210, v211
    v_mfma_f32_32x32x16_bf16 a[16:31], a[212:215], v[164:167], a[16:31]
    ds_read_b128 v[116:119], v241 offset:54272
    v_exp_f32 v208, v12
    v_add_f32 v214, v214, v212
    v_exp_f32 v209, v13
    v_mfma_f32_32x32x16_bf16 a[32:47], a[216:219], v[164:167], a[32:47]
    buffer_load_dwordx4 v243, s[16:19], s47 offen offset:3072 sc1 lds
    ds_read_b128 v[120:123], v241 offset:55296
    v_add_f32 v214, v214, v213
    v_cvt_pk_bf16_f32 v133, v212, v213
    v_mfma_f32_32x32x16_bf16 a[48:63], a[220:223], v[164:167], a[48:63]
    ds_read_b128 v[124:127], v241 offset:56320
    v_exp_f32 v210, v14
    v_add_f32 v214, v214, v208
    v_exp_f32 v211, v15
    s_waitcnt lgkmcnt(4)
    v_mfma_f32_32x32x16_bf16 a[0:15], v[96:99], v[168:171], a[0:15]
    ds_read_b128 a[224:227], v246 offset:8192
    ds_read_b128 a[228:231], v246 offset:9216
    v_add_f32 v214, v214, v209
    v_cvt_pk_bf16_f32 v134, v208, v209
    v_exp_f32 v212, v16
    v_mfma_f32_32x32x16_bf16 a[16:31], v[100:103], v[168:171], a[16:31]
    ds_read_b128 a[232:235], v246 offset:10240
    v_add_f32 v214, v214, v210
    v_exp_f32 v213, v17
    v_add_f32 v214, v214, v211
    v_cvt_pk_bf16_f32 v135, v210, v211
    v_mfma_f32_32x32x16_bf16 a[32:47], v[104:107], v[168:171], a[32:47]
    ds_read_b128 a[236:239], v246 offset:11264
    v_exp_f32 v208, v18
    v_add_f32 v215, v212, v213
    v_exp_f32 v209, v19
    v_cvt_pk_bf16_f32 v136, v212, v213
    v_mfma_f32_32x32x16_bf16 a[48:63], v[108:111], v[168:171], a[48:63]
    ds_read_b128 a[240:243], v246 offset:12288
    ds_read_b128 a[244:247], v246 offset:13312
    v_exp_f32 v210, v20
    v_add_f32 v215, v215, v208
    s_waitcnt lgkmcnt(6)
    v_mfma_f32_32x32x16_bf16 a[0:15], v[112:115], v[172:175], a[0:15]
    ds_read_b128 a[248:251], v246 offset:14336
    v_exp_f32 v211, v21
    v_add_f32 v215, v215, v209
    v_cvt_pk_bf16_f32 v137, v208, v209
    v_exp_f32 v212, v22
    v_mfma_f32_32x32x16_bf16 a[16:31], v[116:119], v[172:175], a[16:31]
    ds_read_b128 a[252:255], v246 offset:15360
    v_add_f32 v215, v215, v210
    v_exp_f32 v213, v23
    v_add_f32 v215, v215, v211
    v_cvt_pk_bf16_f32 v138, v210, v211
    v_mfma_f32_32x32x16_bf16 a[32:47], v[120:123], v[172:175], a[32:47]
    v_exp_f32 v208, v24
    v_add_f32 v215, v215, v212
    v_exp_f32 v209, v25
    v_add_f32 v215, v215, v213
    v_mfma_f32_32x32x16_bf16 a[48:63], v[124:127], v[172:175], a[48:63]
    s_waitcnt vmcnt(16) lgkmcnt(0)
    s_barrier
    s_cmp_lg_u32 s94, 0
    s_cbranch_scc1 nf_30
    s_lshl_b32 s3, s32, 6
    s_lshl_b32 s4, s33, 3
    s_add_u32 s3, s3, s4
    s_add_u32 s3, s3, 2048
    s_add_u32 s3, s3, 2048
    buffer_store_dwordx2 v[250:251], off, s[64:67], s3 sc0 sc1
nf_30:
    v_mfma_f32_32x32x16_bf16 a[64:79], a[224:227], v[152:155], a[64:79]
    s_add_u32 m0, s52, 98304
    ds_read_b128 a[192:195], v241 offset:0
    v_cvt_pk_bf16_f32 v139, v212, v213
    v_exp_f32 v210, v26
    v_add_f32 v215, v215, v208
    v_mfma_f32_32x32x16_bf16 a[80:95], a[228:231], v[152:155], a[80:95]
    buffer_load_dwordx4 v242, s[20:23], s48 offen offset:0 sc1 lds
    ds_read_b128 a[196:199], v241 offset:1024
    v_exp_f32 v211, v27
    v_add_f32 v215, v215, v209
    v_mfma_f32_32x32x16_bf16 a[96:111], a[232:235], v[152:155], a[96:111]
    buffer_load_dwordx4 v242, s[20:23], s48 offen offset:1024 sc1 lds
    ds_read_b128 a[200:203], v241 offset:2048
    v_cvt_pk_bf16_f32 v140, v208, v209
    v_exp_f32 v212, v28
    v_mfma_f32_32x32x16_bf16 a[112:127], a[236:239], v[152:155], a[112:127]
    ds_read_b128 a[204:207], v241 offset:3072
    v_add_f32 v215, v215, v210
    v_exp_f32 v213, v29
    v_add_f32 v215, v215, v211
    v_cvt_pk_bf16_f32 v141, v210, v211
    v_mfma_f32_32x32x16_bf16 a[64:79], a[240:243], v[156:159], a[64:79]
    buffer_load_dwordx4 v242, s[20:23], s48 offen offset:2048 sc1 lds
    ds_read_b128 a[208:211], v241 offset:4096
    v_exp_f32 v208, v30
    v_add_f32 v215, v215, v212
    v_mfma_f32_32x32x16_bf16 a[80:95], a[244:247], v[156:159], a[80:95]
    buffer_load_dwordx4 v242, s[20:23], s48 offen offset:3072 sc1 lds
    ds_read_b128 a[212:215], v241 offset:5120
    v_exp_f32 v209, v31
    v_add_f32 v215, v215, v213
    v_mfma_f32_32x32x16_bf16 a[96:111], a[248:251], v[156:159], a[96:111]
    ds_read_b128 a[216:219], v241 offset:6144
    ds_read_b128 a[220:223], v241 offset:7168
    v_cvt_pk_bf16_f32 v142, v212, v213
    v_add_f32 v215, v215, v208
    v_cvt_pk_bf16_f32 v143, v208, v209
    v_add_f32 v215, v215, v209
    v_mfma_f32_32x32x16_bf16 a[112:127], a[252:255], v[156:159], a[112:127]
    s_mov_b32 s54, 2
    s_branch K2_disp
K2_D2_3:
    s_waitcnt lgkmcnt(4)
    v_mfma_f32_32x32x16_bf16 a[0:15], a[192:195], v[220:223], 0
    ds_read_b128 a[224:227], v246 offset:0
    v_add_f32 v216, v216, v214
    v_add_f32 v216, v216, v215
    v_add_f32 v216, v216, v232
    v_add_f32 v217, v217, v233
    v_exp_f32 v208, v80
    v_mfma_f32_32x32x16_bf16 a[16:31], a[196:199], v[220:223], 0
    s_add_u32 m0, s52, 16384
    ds_read_b128 a[228:231], v246 offset:1024
    v_exp_f32 v209, v81
    v_exp_f32 v210, v82
    v_mfma_f32_32x32x16_bf16 a[32:47], a[200:203], v[220:223], 0
    ds_read_b128 a[232:235], v246 offset:2048
    v_add_f32 v234, v208, v209
    v_exp_f32 v211, v83
    v_cvt_pk_bf16_f32 v152, v208, v209
    v_mfma_f32_32x32x16_bf16 a[48:63], a[204:207], v[220:223], 0
    ds_read_b128 a[236:239], v246 offset:3072
    v_exp_f32 v212, v84
    v_add_f32 v234, v234, v210
    v_exp_f32 v213, v85
    s_waitcnt lgkmcnt(4)
    v_mfma_f32_32x32x16_bf16 a[0:15], a[208:211], v[224:227], a[0:15]
    ds_read_b128 a[240:243], v246 offset:4096
    v_add_f32 v234, v234, v211
    v_cvt_pk_bf16_f32 v153, v210, v211
    v_exp_f32 v208, v86
    v_add_f32 v234, v234, v212
    v_mfma_f32_32x32x16_bf16 a[16:31], a[212:215], v[224:227], a[16:31]
    ds_read_b128 a[244:247], v246 offset:5120
    v_exp_f32 v209, v87
    v_add_f32 v234, v234, v213
    v_cvt_pk_bf16_f32 v154, v212, v213
    v_exp_f32 v210, v88
    v_mfma_f32_32x32x16_bf16 a[32:47], a[216:219], v[224:227], a[32:47]
    buffer_load_dwordx4 v243, s[16:19], s47 offen offset:0 sc1 lds
    ds_read_b128 a[248:251], v246 offset:6144
    v_add_f32 v234, v234, v208
    v_exp_f32 v211, v89
    v_mfma_f32_32x32x16_bf16 a[48:63], a[220:223], v[224:227], a[48:63]
    ds_read_b128 a[252:255], v246 offset:7168
    v_add_f32 v234, v234, v209
    v_cvt_pk_bf16_f32 v155, v208, v209
    v_exp_f32 v212, v90
    s_waitcnt lgkmcnt(4)
    v_mfma_f32_32x32x16_bf16 a[64:79], a[224:227], v[144:147], 0
    ds_read_b128 a[192:195], v241 offset:49152
    v_add_f32 v234, v234, v210
    v_exp_f32 v213, v91
    v_add_f32 v234, v234, v211
    v_cvt_pk_bf16_f32 v156, v210, v211
    v_mfma_f32_32x32x16_bf16 a[80:95], a[228:231], v[144:147], 0
    ds_read_b128 a[196:199], v241 offset:50176
    v_exp_f32 v208, v92
    v_add_f32 v234, v234, v212
    v_exp_f32 v209, v93
    v_mfma_f32_32x32x16_bf16 a[96:111], a[232:235], v[144:147], 0
    ds_read_b128 a[200:203], v241 offset:51200
    v_add_f32 v234, v234, v213
    v_cvt_pk_bf16_f32 v157, v212, v213
    v_exp_f32 v210, v94
    v_add_f32 v234, v234, v208
    v_mfma_f32_32x32x16_bf16 a[112:127], a[236:239], v[144:147], 0
    buffer_load_dwordx4 v243, s[16:19], s47 offen offset:1024 sc1 lds
    ds_read_b128 a[204:207], v241 offset:52224
    v_exp_f32 v211, v95
    s_waitcnt lgkmcnt(4)
    v_mfma_f32_32x32x16_bf16 a[64:79], a[240:243], v[148:151], a[64:79]
    ds_read_b128 a[208:211], v241 offset:53248
    v_add_f32 v234, v234, v209
    v_cvt_pk_bf16_f32 v158, v208, v209
    v_add_f32 v234, v234, v210
    v_cvt_pk_bf16_f32 v159, v210, v211
    v_add_f32 v234, v234, v211
    v_add_f32 v216, v216, v234
    v_mfma_f32_32x32x16_bf16 a[80:95], a[244:247], v[148:151], a[80:95]
    ds_read_b128 a[212:215], v241 offset:54272
    v_exp_f32 v208, v0
    v_exp_f32 v209, v1
    v_exp_f32 v210, v2
    v_mfma_f32_32x32x16_bf16 a[96:111], a[248:251], v[148:151], a[96:111]
    ds_read_b128 a[216:219], v241 offset:55296
    v_add_f32 v214, v208, v209
    v_exp_f32 v211, v3
    v_cvt_pk_bf16_f32 v128, v208, v209
    v_mfma_f32_32x32x16_bf16 a[112:127], a[252:255], v[148:151], a[112:127]
    ds_read_b128 a[220:223], v241 offset:56320
    v_exp_f32 v212, v4
    v_add_f32 v214, v214, v210
    v_exp_f32 v213, v5
    s_waitcnt lgkmcnt(4)
    v_mfma_f32_32x32x16_bf16 a[0:15], a[192:195], v[160:163], a[0:15]
    ds_read_b128 v[96:99], v241 offset:57344
    v_add_f32 v214, v214, v211
    v_cvt_pk_bf16_f32 v129, v210, v211
    v_exp_f32 v208, v6
    v_add_f32 v214, v214, v212
    v_mfma_f32_32x32x16_bf16 a[16:31], a[196:199], v[160:163], a[16:31]
    buffer_load_dwordx4 v243, s[16:19], s47 offen offset:2048 sc1 lds
    ds_read_b128 v[100:103], v241 offset:58368
    v_exp_f32 v209, v7
    v_add_f32 v214, v214, v213
    v_mfma_f32_32x32x16_bf16 a[32:47], a[200:203], v[160:163], a[32:47]
    ds_read_b128 v[104:107], v241 offset:59392
    v_cvt_pk_bf16_f32 v130, v212, v213
    v_exp_f32 v210, v8
    v_add_f32 v214, v214, v208
    v_exp_f32 v211, v9
    v_mfma_f32_32x32x16_bf16 a[48:63], a[204:207], v[160:163], a[48:63]
    ds_read_b128 v[108:111], v241 offset:60416
    v_add_f32 v214, v214, v209
    v_cvt_pk_bf16_f32 v131, v208, v209
    v_exp_f32 v212, v10
    s_waitcnt lgkmcnt(4)
    v_mfma_f32_32x32x16_bf16 a[0:15], a[208:211], v[164:167], a[0:15]
    ds_read_b128 v[112:115], v241 offset:61440
    v_add_f32 v214, v214, v210
    v_exp_f32 v213, v11
    v_add_f32 v214, v214, v211
    v_cvt_pk_bf16_f32 v132, v210, v211
    v_mfma_f32_32x32x16_bf16 a[16:31], a[212:215], v[164:167], a[16:31]
    ds_read_b128 v[116:119], v241 offset:62464
    v_exp_f32 v208, v12
    v_add_f32 v214, v214, v212
    v_exp_f32 v209, v13
    v_mfma_f32_32x32x16_bf16 a[32:47], a[216:219], v[164:167], a[32:47]
    buffer_load_dwordx4 v243, s[16:19], s47 offen offset:3072 sc1 lds
    ds_read_b128 v[120:123], v241 offset:63488
    v_add_f32 v214, v214, v213
    v_cvt_pk_bf16_f32 v133, v212, v213
    v_mfma_f32_32x32x16_bf16 a[48:63], a[220:223], v[164:167], a[48:63]
    ds_read_b128 v[124:127], v241 offset:64512
    v_exp_f32 v210, v14
    v_add_f32 v214, v214, v208
    v_exp_f32 v211, v15
    s_waitcnt lgkmcnt(4)
    v_mfma_f32_32x32x16_bf16 a[0:15], v[96:99], v[168:171], a[0:15]
    ds_read_b128 a[224:227], v241 offset:40960
    ds_read_b128 a[228:231], v241 offset:41984
    v_add_f32 v214, v214, v209
    v_cvt_pk_bf16_f32 v134, v208, v209
    v_exp_f32 v212, v16
    v_mfma_f32_32x32x16_bf16 a[16:31], v[100:103], v[168:171], a[16:31]
    ds_read_b128 a[232:235], v241 offset:43008
    v_add_f32 v214, v214, v210
    v_exp_f32 v213, v17
    v_add_f32 v214, v214, v211
    v_cvt_pk_bf16_f32 v135, v210, v211
    v_mfma_f32_32x32x16_bf16 a[32:47], v[104:107], v[168:171], a[32:47]
    ds_read_b128 a[236:239], v241 offset:44032
    v_exp_f32 v208, v18
    v_add_f32 v215, v212, v213
    v_exp_f32 v209, v19
    v_cvt_pk_bf16_f32 v136, v212, v213
    v_mfma_f32_32x32x16_bf16 a[48:63], v[108:111], v[168:171], a[48:63]
    ds_read_b128 a[240:243], v241 offset:45056
    ds_read_b128 a[244:247], v241 offset:46080
    v_exp_f32 v210, v20
    v_add_f32 v215, v215, v208
    s_waitcnt lgkmcnt(6)
    v_mfma_f32_32x32x16_bf16 a[0:15], v[112:115], v[172:175], a[0:15]
    ds_read_b128 a[248:251], v241 offset:47104
    v_exp_f32 v211, v21
    v_add_f32 v215, v215, v209
    v_cvt_pk_bf16_f32 v137, v208, v209
    v_exp_f32 v212, v22
    v_mfma_f32_32x32x16_bf16 a[16:31], v[116:119], v[172:175], a[16:31]
    ds_read_b128 a[252:255], v241 offset:48128
    v_add_f32 v215, v215, v210
    v_exp_f32 v213, v23
    v_add_f32 v215, v215, v211
    v_cvt_pk_bf16_f32 v138, v210, v211
    v_mfma_f32_32x32x16_bf16 a[32:47], v[120:123], v[172:175], a[32:47]
    v_exp_f32 v208, v24
    v_add_f32 v215, v215, v212
    v_exp_f32 v209, v25
    v_add_f32 v215, v215, v213
    v_mfma_f32_32x32x16_bf16 a[48:63], v[124:127], v[172:175], a[48:63]
    s_waitcnt vmcnt(16) lgkmcnt(0)
    s_barrier
    s_cmp_lg_u32 s94, 0
    s_cbranch_scc1 nf_31
    s_lshl_b32 s3, s32, 6
    s_lshl_b32 s4, s33, 3
    s_add_u32 s3, s3, s4
    s_add_u32 s3, s3, 2048
    s_add_u32 s3, s3, 2048
    buffer_store_dwordx2 v[250:251], off, s[64:67], s3 sc0 sc1
nf_31:
    v_mfma_f32_32x32x16_bf16 a[0:15], a[224:227], v[152:155], a[0:15]
    s_add_u32 m0, s52, 98304
    ds_read_b128 a[192:195], v241 offset:0
    v_cvt_pk_bf16_f32 v139, v212, v213
    v_exp_f32 v210, v26
    v_add_f32 v215, v215, v208
    v_mfma_f32_32x32x16_bf16 a[16:31], a[228:231], v[152:155], a[16:31]
    buffer_load_dwordx4 v242, s[20:23], s48 offen offset:0 sc1 lds
    ds_read_b128 a[196:199], v241 offset:1024
    v_exp_f32 v211, v27
    v_add_f32 v215, v215, v209
    v_mfma_f32_32x32x16_bf16 a[32:47], a[232:235], v[152:155], a[32:47]
    buffer_load_dwordx4 v242, s[20:23], s48 offen offset:1024 sc1 lds
    ds_read_b128 a[200:203], v241 offset:2048
    v_cvt_pk_bf16_f32 v140, v208, v209
    v_exp_f32 v212, v28
    v_mfma_f32_32x32x16_bf16 a[48:63], a[236:239], v[152:155], a[48:63]
    ds_read_b128 a[204:207], v241 offset:3072
    v_add_f32 v215, v215, v210
    v_exp_f32 v213, v29
    v_add_f32 v215, v215, v211
    v_cvt_pk_bf16_f32 v141, v210, v211
    v_mfma_f32_32x32x16_bf16 a[0:15], a[240:243], v[156:159], a[0:15]
    buffer_load_dwordx4 v242, s[20:23], s48 offen offset:2048 sc1 lds
    ds_read_b128 a[208:211], v241 offset:4096
    v_exp_f32 v208, v30
    v_add_f32 v215, v215, v212
    v_mfma_f32_32x32x16_bf16 a[16:31], a[244:247], v[156:159], a[16:31]
    buffer_load_dwordx4 v242, s[20:23], s48 offen offset:3072 sc1 lds
    ds_read_b128 a[212:215], v241 offset:5120
    v_exp_f32 v209, v31
    v_add_f32 v215, v215, v213
    v_mfma_f32_32x32x16_bf16 a[32:47], a[248:251], v[156:159], a[32:47]
    ds_read_b128 a[216:219], v241 offset:6144
    ds_read_b128 a[220:223], v241 offset:7168
    v_cvt_pk_bf16_f32 v142, v212, v213
    v_add_f32 v215, v215, v208
    v_cvt_pk_bf16_f32 v143, v208, v209
    v_add_f32 v215, v215, v209
    v_mfma_f32_32x32x16_bf16 a[48:63], a[252:255], v[156:159], a[48:63]
    s_mov_b32 s54, 2
    s_branch K2_disp
K2_D1e:
    s_lshr_b32 s3, s2, 3
    s_lshl_b32 s3, s3, 2
    s_add_u32 s3, s3, s94
    s_cmp_ge_u32 s3, 3
    s_cbranch_scc1 ct_32
    s_getpc_b64 s[4:5]
pc_33:
    s_add_u32 s4, s4, K2_disp-pc_33
    s_addc_u32 s5, s5, 0
    s_lshl_b32 s3, s3, 13
    v_lshl_add_u32 v236, v238, 3, s3
    global_load_dword v254, v236, s[4:5]
ct_32:
    s_and_b32 s59, s33, 1
    s_lshl_b32 s59, s59, 1
    s_add_u32 s59, s59, 1
    s_add_u32 s8, s92, 0x7000000
    s_addc_u32 s9, s93, 0
    s_mov_b32 s10, 0x400000
    s_mov_b32 s11, 0x00020000
    s_lshl_b32 s31, 42, s59
    s_lshl_b32 s3, 10, s55
    s_or_b32 s31, s31, s3
    s_or_b32 s31, s31, 86020
    s_cmp_eq_u32 s33, 0
    s_cselect_b32 s95, 63, s55
    s_cbranch_scc1 K2_SIa1
    s_branch K2_SHa1
.p2align 6
K2_Lsh:
    s_waitcnt lgkmcnt(4)
    v_mfma_f32_32x32x16_bf16 v[64:79], a[192:195], a[128:131], v[176:191]
    ds_read_b128 a[224:227], v241 offset:8192
    v_exp_f32 v208, v32
    v_exp_f32 v209, v33
    v_mfma_f32_32x32x16_bf16 v[80:95], a[192:195], a[160:163], v[192:207]
    ds_read_b128 a[228:231], v241 offset:9216
    s_add_u32 m0, s52, 114688
    v_exp_f32 v210, v34
    v_add_f32 v214, v214, v208
    v_exp_f32 v211, v35
    v_mfma_f32_32x32x16_bf16 v[64:79], a[196:199], a[132:135], v[64:79]
    buffer_load_dwordx4 v243, s[20:23], s49 offen offset:0 sc1 lds
    v_add_f32 v214, v214, v209
    v_cvt_pk_bf16_f32 v160, v208, v209
    v_mfma_f32_32x32x16_bf16 v[80:95], a[196:199], a[164:167], v[80:95]
    ds_read_b128 a[232:235], v241 offset:10240
    v_exp_f32 v212, v36
    v_add_f32 v214, v214, v210
    v_exp_f32 v213, v37
    v_mfma_f32_32x32x16_bf16 v[64:79], a[200:203], a[136:139], v[64:79]
    ds_read_b128 a[236:239], v241 offset:11264
    v_add_f32 v214, v214, v211
    v_cvt_pk_bf16_f32 v161, v210, v211
    v_exp_f32 v208, v38
    v_mfma_f32_32x32x16_bf16 v[80:95], a[200:203], a[168:171], v[80:95]
    buffer_load_dwordx4 v243, s[20:23], s49 offen offset:1024 sc1 lds
    v_add_f32 v214, v214, v212
    v_exp_f32 v209, v39
    v_mfma_f32_32x32x16_bf16 v[64:79], a[204:207], a[140:143], v[64:79]
    ds_read_b128 a[240:243], v241 offset:12288
    v_add_f32 v214, v214, v213
    v_cvt_pk_bf16_f32 v162, v212, v213
    v_exp_f32 v210, v40
    v_add_f32 v214, v214, v208
    v_mfma_f32_32x32x16_bf16 v[80:95], a[204:207], a[172:175], v[80:95]
    ds_read_b128 a[244:247], v241 offset:13312
    v_exp_f32 v211, v41
    v_add_f32 v214, v214, v209
    s_waitcnt lgkmcnt(6)
    v_mfma_f32_32x32x16_bf16 v[64:79], a[208:211], a[144:147], v[64:79]
    buffer_load_dwordx4 v243, s[20:23], s49 offen offset:2048 sc1 lds
    v_cvt_pk_bf16_f32 v163, v208, v209
    v_exp_f32 v212, v42
    v_mfma_f32_32x32x16_bf16 v[80:95], a[208:211], a[176:179], v[80:95]
    ds_read_b128 a[248:251], v241 offset:14336
    v_add_f32 v214, v214, v210
    v_exp_f32 v213, v43
    v_add_f32 v214, v214, v211
    v_cvt_pk_bf16_f32 v164, v210, v211
    v_mfma_f32_32x32x16_bf16 v[64:79], a[212:215], a[148:151], v[64:79]
    ds_read_b128 a[252:255], v241 offset:15360
    v_exp_f32 v208, v44
    v_add_f32 v214, v214, v212
    v_exp_f32 v209, v45
    v_mfma_f32_32x32x16_bf16 v[80:95], a[212:215], a[180:183], v[80:95]
    buffer_load_dwordx4 v243, s[20:23], s49 offen offset:3072 sc1 lds
    v_add_f32 v214, v214, v213
    v_cvt_pk_bf16_f32 v165, v212, v213
    v_mfma_f32_32x32x16_bf16 v[64:79], a[216:219], a[152:155], v[64:79]
    s_add_u32 s48, s46, s34
    s_add_u32 s49, s47, s34
    s_add_u32 s50, s50, 1
    v_exp_f32 v210, v46
    v_add_f32 v214, v214, v208
    v_mfma_f32_32x32x16_bf16 v[80:95], a[216:219], a[184:187], v[80:95]
    s_cmp_ge_u32 s50, 17
    s_cselect_b32 s46, s35, s51
    s_cselect_b32 s4, 0xffffd000, 0
    s_cselect_b32 s34, 0xff002000, 0
    s_cselect_b32 s5, 0x2000, 0
    v_mfma_f32_32x32x16_bf16 v[64:79], a[220:223], a[156:159], v[64:79]
    s_sub_u32 s35, s35, s5
    s_add_u32 s4, s4, s46
    s_cmp_le_u32 s50, s55
    s_cselect_b32 s47, 268435456, s4
    s_cselect_b32 s3, 1, 2
    v_exp_f32 v211, v47
    v_mfma_f32_32x32x16_bf16 v[80:95], a[220:223], a[188:191], v[80:95]
    s_lshl_b32 s3, s3, 14
    s_add_u32 s51, s51, s3
    s_waitcnt vmcnt(16) lgkmcnt(0)
    s_barrier
    v_mfma_f32_32x32x16_bf16 v[96:111], a[224:227], a[128:131], v[176:191]
    ds_read_b128 a[192:195], v240 offset:32768
    s_add_u32 m0, s52, 65536
    v_add_f32 v214, v214, v209
    v_cvt_pk_bf16_f32 v166, v208, v209
    v_mfma_f32_32x32x16_bf16 v[112:127], a[224:227], a[160:163], v[192:207]
    buffer_load_dwordx4 v242, s[16:19], s46 offen offset:0 sc1 lds
    v_exp_f32 v212, v48
    v_add_f32 v214, v214, v210
    v_mfma_f32_32x32x16_bf16 v[96:111], a[228:231], a[132:135], v[96:111]
    ds_read_b128 a[196:199], v240 offset:33792
    v_exp_f32 v213, v49
    v_add_f32 v214, v214, v211
    v_cvt_pk_bf16_f32 v167, v210, v211
    v_exp_f32 v208, v50
    v_mfma_f32_32x32x16_bf16 v[112:127], a[228:231], a[164:167], v[112:127]
    v_add_f32 v215, v215, v212
    v_exp_f32 v209, v51
    v_add_f32 v215, v215, v213
    v_cvt_pk_bf16_f32 v168, v212, v213
    v_mfma_f32_32x32x16_bf16 v[96:111], a[232:235], a[136:139], v[96:111]
    ds_read_b128 a[200:203], v240 offset:34816
    v_exp_f32 v210, v52
    v_add_f32 v215, v215, v208
    v_exp_f32 v211, v53
    v_mfma_f32_32x32x16_bf16 v[112:127], a[232:235], a[168:171], v[112:127]
    buffer_load_dwordx4 v242, s[16:19], s46 offen offset:1024 sc1 lds
    v_add_f32 v215, v215, v209
    v_cvt_pk_bf16_f32 v169, v208, v209
    v_mfma_f32_32x32x16_bf16 v[96:111], a[236:239], a[140:143], v[96:111]
    ds_read_b128 a[204:207], v240 offset:35840
    v_exp_f32 v212, v54
    v_add_f32 v215, v215, v210
    v_exp_f32 v213, v55
    v_mfma_f32_32x32x16_bf16 v[112:127], a[236:239], a[172:175], v[112:127]
    v_add_f32 v215, v215, v211
    v_cvt_pk_bf16_f32 v170, v210, v211
    v_exp_f32 v208, v56
    v_add_f32 v215, v215, v212
    v_mfma_f32_32x32x16_bf16 v[96:111], a[240:243], a[144:147], v[96:111]
    ds_read_b128 a[208:211], v240 offset:36864
    v_exp_f32 v209, v57
    v_add_f32 v215, v215, v213
    v_cvt_pk_bf16_f32 v171, v212, v213
    v_mfma_f32_32x32x16_bf16 v[112:127], a[240:243], a[176:179], v[112:127]
    buffer_load_dwordx4 v242, s[16:19], s46 offen offset:2048 sc1 lds
    v_exp_f32 v210, v58
    v_add_f32 v215, v215, v208
    v_mfma_f32_32x32x16_bf16 v[96:111], a[244:247], a[148:151], v[96:111]
    ds_read_b128 a[212:215], v240 offset:37888
    v_exp_f32 v211, v59
    v_add_f32 v215, v215, v209
    v_cvt_pk_bf16_f32 v172, v208, v209
    v_exp_f32 v212, v60
    v_mfma_f32_32x32x16_bf16 v[112:127], a[244:247], a[180:183], v[112:127]
    v_add_f32 v215, v215, v210
    v_exp_f32 v213, v61
    v_add_f32 v215, v215, v211
    v_cvt_pk_bf16_f32 v173, v210, v211
    v_mfma_f32_32x32x16_bf16 v[96:111], a[248:251], a[152:155], v[96:111]
    ds_read_b128 a[216:219], v240 offset:38912
    v_exp_f32 v208, v62
    v_add_f32 v215, v215, v212
    v_exp_f32 v209, v63
    v_mfma_f32_32x32x16_bf16 v[112:127], a[248:251], a[184:187], v[112:127]
    buffer_load_dwordx4 v242, s[16:19], s46 offen offset:3072 sc1 lds
    v_add_f32 v215, v215, v213
    v_cvt_pk_bf16_f32 v174, v212, v213
    v_mfma_f32_32x32x16_bf16 v[96:111], a[252:255], a[156:159], v[96:111]
    ds_read_b128 a[220:223], v240 offset:39936
    v_add_f32 v215, v215, v208
    v_cvt_pk_bf16_f32 v175, v208, v209
    v_add_f32 v215, v215, v209
    v_max_f32 v218, v214, v215
    v_cmp_lt_f32 vcc, s53, v218
    v_mfma_f32_32x32x16_bf16 v[112:127], a[252:255], a[188:191], v[112:127]
    s_cbranch_vccnz rs_34
rr_35:
    s_waitcnt lgkmcnt(4)
    v_mfma_f32_32x32x16_bf16 a[0:15], a[192:195], v[128:131], a[0:15]
    ds_read_b128 a[224:227], v240 offset:40960
    v_add_f32 v216, v216, v214
    v_add_f32 v217, v217, v215
    v_exp_f32 v208, v64
    v_mfma_f32_32x32x16_bf16 a[64:79], a[192:195], v[136:139], a[64:79]
    ds_read_b128 a[228:231], v240 offset:41984
    s_add_u32 m0, s52, 81920
    v_exp_f32 v209, v65
    v_exp_f32 v210, v66
    v_mfma_f32_32x32x16_bf16 a[16:31], a[196:199], v[128:131], a[16:31]
    buffer_load_dwordx4 v243, s[16:19], s47 offen offset:0 sc1 lds
    v_add_f32 v214, v208, v209
    v_mfma_f32_32x32x16_bf16 a[80:95], a[196:199], v[136:139], a[80:95]
    ds_read_b128 a[232:235], v240 offset:43008
    v_exp_f32 v211, v67
    v_cvt_pk_bf16_f32 v144, v208, v209
    v_exp_f32 v212, v68
    v_mfma_f32_32x32x16_bf16 a[32:47], a[200:203], v[128:131], a[32:47]
    ds_read_b128 a[236:239], v240 offset:44032
    v_add_f32 v214, v214, v210
    v_exp_f32 v213, v69
    v_add_f32 v214, v214, v211
    v_mfma_f32_32x32x16_bf16 a[96:111], a[200:203], v[136:139], a[96:111]
    buffer_load_dwordx4 v243, s[16:19], s47 offen offset:1024 sc1 lds
    v_cvt_pk_bf16_f32 v145, v210, v211
    v_exp_f32 v208, v70
    v_mfma_f32_32x32x16_bf16 a[48:63], a[204:207], v[128:131], a[48:63]
    ds_read_b128 a[240:243], v240 offset:45056
    v_add_f32 v214, v214, v212
    v_exp_f32 v209, v71
    v_mfma_f32_32x32x16_bf16 a[112:127], a[204:207], v[136:139], a[112:127]
    ds_read_b128 a[244:247], v240 offset:46080
    v_add_f32 v214, v214, v213
    v_cvt_pk_bf16_f32 v146, v212, v213
    v_exp_f32 v210, v72
    s_waitcnt lgkmcnt(6)
    v_mfma_f32_32x32x16_bf16 a[0:15], a[208:211], v[132:135], a[0:15]
    buffer_load_dwordx4 v243, s[16:19], s47 offen offset:2048 sc1 lds
    v_add_f32 v214, v214, v208
    v_mfma_f32_32x32x16_bf16 a[64:79], a[208:211], v[140:143], a[64:79]
    ds_read_b128 a[248:251], v240 offset:47104
    v_exp_f32 v211, v73
    v_add_f32 v214, v214, v209
    v_cvt_pk_bf16_f32 v147, v208, v209
    v_mfma_f32_32x32x16_bf16 a[16:31], a[212:215], v[132:135], a[16:31]
    ds_read_b128 a[252:255], v240 offset:48128
    v_exp_f32 v212, v74
    v_add_f32 v214, v214, v210
    v_exp_f32 v213, v75
    v_mfma_f32_32x32x16_bf16 a[80:95], a[212:215], v[140:143], a[80:95]
    buffer_load_dwordx4 v243, s[16:19], s47 offen offset:3072 sc1 lds
    v_add_f32 v214, v214, v211
    v_cvt_pk_bf16_f32 v148, v210, v211
    v_mfma_f32_32x32x16_bf16 a[32:47], a[216:219], v[132:135], a[32:47]
    v_exp_f32 v208, v76
    v_add_f32 v214, v214, v212
    v_exp_f32 v209, v77
    v_mfma_f32_32x32x16_bf16 a[96:111], a[216:219], v[140:143], a[96:111]
    v_add_f32 v214, v214, v213
    v_cvt_pk_bf16_f32 v149, v212, v213
    v_exp_f32 v210, v78
    v_add_f32 v214, v214, v208
    v_mfma_f32_32x32x16_bf16 a[48:63], a[220:223], v[132:135], a[48:63]
    v_exp_f32 v211, v79
    v_add_f32 v214, v214, v209
    v_cvt_pk_bf16_f32 v150, v208, v209
    v_exp_f32 v212, v80
    v_mfma_f32_32x32x16_bf16 a[112:127], a[220:223], v[140:143], a[112:127]
    s_waitcnt vmcnt(16) lgkmcnt(0)
    s_barrier
    v_mfma_f32_32x32x16_bf16 a[0:15], a[224:227], v[160:163], a[0:15]
    ds_read_b128 a[192:195], v240 offset:0
    s_add_u32 m0, s52, 32768
    v_add_f32 v214, v214, v210
    v_exp_f32 v213, v81
    v_mfma_f32_32x32x16_bf16 a[64:79], a[224:227], v[168:171], a[64:79]
    buffer_load_dwordx4 v242, s[20:23], s48 offen offset:0 sc1 lds
    v_add_f32 v214, v214, v211
    v_cvt_pk_bf16_f32 v151, v210, v211
    v_mfma_f32_32x32x16_bf16 a[16:31], a[228:231], v[160:163], a[16:31]
    ds_read_b128 a[196:199], v240 offset:1024
    v_exp_f32 v208, v82
    v_add_f32 v215, v212, v213
    v_exp_f32 v209, v83
    v_mfma_f32_32x32x16_bf16 a[80:95], a[228:231], v[168:171], a[80:95]
    v_cvt_pk_bf16_f32 v152, v212, v213
    v_exp_f32 v210, v84
    v_add_f32 v215, v215, v208
    v_mfma_f32_32x32x16_bf16 a[32:47], a[232:235], v[160:163], a[32:47]
    ds_read_b128 a[200:203], v240 offset:2048
    v_exp_f32 v211, v85
    v_add_f32 v215, v215, v209
    v_cvt_pk_bf16_f32 v153, v208, v209
    v_mfma_f32_32x32x16_bf16 a[96:111], a[232:235], v[168:171], a[96:111]
    buffer_load_dwordx4 v242, s[20:23], s48 offen offset:1024 sc1 lds
    v_exp_f32 v212, v86
    v_add_f32 v215, v215, v210
    v_mfma_f32_32x32x16_bf16 a[48:63], a[236:239], v[160:163], a[48:63]
    ds_read_b128 a[204:207], v240 offset:3072
    v_exp_f32 v213, v87
    v_add_f32 v215, v215, v211
    v_cvt_pk_bf16_f32 v154, v210, v211
    v_mfma_f32_32x32x16_bf16 a[112:127], a[236:239], v[168:171], a[112:127]
    v_exp_f32 v208, v88
    v_add_f32 v215, v215, v212
    v_exp_f32 v209, v89
    v_mfma_f32_32x32x16_bf16 a[0:15], a[240:243], v[164:167], a[0:15]
    ds_read_b128 a[208:211], v240 offset:4096
    v_add_f32 v215, v215, v213
    v_cvt_pk_bf16_f32 v155, v212, v213
    v_exp_f32 v210, v90
    v_mfma_f32_32x32x16_bf16 a[64:79], a[240:243], v[172:175], a[64:79]
    buffer_load_dwordx4 v242, s[20:23], s48 offen offset:2048 sc1 lds
    v_add_f32 v215, v215, v208
    v_exp_f32 v211, v91
    v_mfma_f32_32x32x16_bf16 a[16:31], a[244:247], v[164:167], a[16:31]
    ds_read_b128 a[212:215], v240 offset:5120
    v_add_f32 v215, v215, v209
    v_cvt_pk_bf16_f32 v156, v208, v209
    v_exp_f32 v212, v92
    v_mfma_f32_32x32x16_bf16 a[80:95], a[244:247], v[172:175], a[80:95]
    v_add_f32 v215, v215, v210
    v_exp_f32 v213, v93
    v_add_f32 v215, v215, v211
    v_cvt_pk_bf16_f32 v157, v210, v211
    v_mfma_f32_32x32x16_bf16 a[32:47], a[248:251], v[164:167], a[32:47]
    ds_read_b128 a[216:219], v240 offset:6144
    v_exp_f32 v208, v94
    v_add_f32 v215, v215, v212
    v_mfma_f32_32x32x16_bf16 a[96:111], a[248:251], v[172:175], a[96:111]
    buffer_load_dwordx4 v242, s[20:23], s48 offen offset:3072 sc1 lds
    v_exp_f32 v209, v95
    v_add_f32 v215, v215, v213
    v_mfma_f32_32x32x16_bf16 a[48:63], a[252:255], v[164:167], a[48:63]
    ds_read_b128 a[220:223], v240 offset:7168
    v_cvt_pk_bf16_f32 v158, v212, v213
    v_add_f32 v215, v215, v208
    v_cvt_pk_bf16_f32 v159, v208, v209
    v_add_f32 v215, v215, v209
    v_mfma_f32_32x32x16_bf16 a[112:127], a[252:255], v[172:175], a[112:127]
    s_add_u32 s54, s54, 1
    s_cmp_eq_u32 s54, s55
    s_cbranch_scc1 K2_SIa1
K2_SHa1:
    s_waitcnt lgkmcnt(4)
    v_mfma_f32_32x32x16_bf16 v[0:15], a[192:195], a[128:131], v[176:191]
    ds_read_b128 a[224:227], v240 offset:8192
    v_exp_f32 v208, v96
    v_exp_f32 v209, v97
    v_mfma_f32_32x32x16_bf16 v[16:31], a[192:195], a[160:163], v[192:207]
    ds_read_b128 a[228:231], v240 offset:9216
    s_add_u32 m0, s52, 49152
    v_exp_f32 v210, v98
    v_add_f32 v214, v214, v208
    v_exp_f32 v211, v99
    v_mfma_f32_32x32x16_bf16 v[0:15], a[196:199], a[132:135], v[0:15]
    buffer_load_dwordx4 v243, s[20:23], s49 offen offset:0 sc1 lds
    v_add_f32 v214, v214, v209
    v_cvt_pk_bf16_f32 v160, v208, v209
    v_mfma_f32_32x32x16_bf16 v[16:31], a[196:199], a[164:167], v[16:31]
    ds_read_b128 a[232:235], v240 offset:10240
    v_exp_f32 v212, v100
    v_add_f32 v214, v214, v210
    v_exp_f32 v213, v101
    v_mfma_f32_32x32x16_bf16 v[0:15], a[200:203], a[136:139], v[0:15]
    ds_read_b128 a[236:239], v240 offset:11264
    v_add_f32 v214, v214, v211
    v_cvt_pk_bf16_f32 v161, v210, v211
    v_exp_f32 v208, v102
    v_mfma_f32_32x32x16_bf16 v[16:31], a[200:203], a[168:171], v[16:31]
    buffer_load_dwordx4 v243, s[20:23], s49 offen offset:1024 sc1 lds
    v_add_f32 v214, v214, v212
    v_exp_f32 v209, v103
    v_mfma_f32_32x32x16_bf16 v[0:15], a[204:207], a[140:143], v[0:15]
    ds_read_b128 a[240:243], v240 offset:12288
    v_add_f32 v214, v214, v213
    v_cvt_pk_bf16_f32 v162, v212, v213
    v_exp_f32 v210, v104
    v_add_f32 v214, v214, v208
    v_mfma_f32_32x32x16_bf16 v[16:31], a[204:207], a[172:175], v[16:31]
    ds_read_b128 a[244:247], v240 offset:13312
    v_exp_f32 v211, v105
    v_add_f32 v214, v214, v209
    s_waitcnt lgkmcnt(6)
    v_mfma_f32_32x32x16_bf16 v[0:15], a[208:211], a[144:147], v[0:15]
    buffer_load_dwordx4 v243, s[20:23], s49 offen offset:2048 sc1 lds
    v_cvt_pk_bf16_f32 v163, v208, v209
    v_exp_f32 v212, v106
    v_mfma_f32_32x32x16_bf16 v[16:31], a[208:211], a[176:179], v[16:31]
    ds_read_b128 a[248:251], v240 offset:14336
    v_add_f32 v214, v214, v210
    v_exp_f32 v213, v107
    v_add_f32 v214, v214, v211
    v_cvt_pk_bf16_f32 v164, v210, v211
    v_mfma_f32_32x32x16_bf16 v[0:15], a[212:215], a[148:151], v[0:15]
    ds_read_b128 a[252:255], v240 offset:15360
    v_exp_f32 v208, v108
    v_add_f32 v214, v214, v212
    v_exp_f32 v209, v109
    v_mfma_f32_32x32x16_bf16 v[16:31], a[212:215], a[180:183], v[16:31]
    buffer_load_dwordx4 v243, s[20:23], s49 offen offset:3072 sc1 lds
    v_add_f32 v214, v214, v213
    v_cvt_pk_bf16_f32 v165, v212, v213
    v_mfma_f32_32x32x16_bf16 v[0:15], a[216:219], a[152:155], v[0:15]
    s_add_u32 s48, s46, s34
    s_add_u32 s49, s47, s34
    s_add_u32 s50, s50, 1
    v_exp_f32 v210, v110
    v_add_f32 v214, v214, v208
    v_mfma_f32_32x32x16_bf16 v[16:31], a[216:219], a[184:187], v[16:31]
    s_cmp_ge_u32 s50, 17
    s_cselect_b32 s46, s35, s51
    s_cselect_b32 s4, 0xffffd000, 0
    s_cselect_b32 s34, 0xff002000, 0
    s_cselect_b32 s5, 0x2000, 0
    v_mfma_f32_32x32x16_bf16 v[0:15], a[220:223], a[156:159], v[0:15]
    s_sub_u32 s35, s35, s5
    s_add_u32 s4, s4, s46
    s_cmp_le_u32 s50, s55
    s_cselect_b32 s47, 268435456, s4
    s_cselect_b32 s3, 1, 2
    v_exp_f32 v211, v111
    v_mfma_f32_32x32x16_bf16 v[16:31], a[220:223], a[188:191], v[16:31]
    s_lshl_b32 s3, s3, 14
    s_add_u32 s51, s51, s3
    s_waitcnt vmcnt(16) lgkmcnt(0)
    s_barrier
    v_mfma_f32_32x32x16_bf16 v[32:47], a[224:227], a[128:131], v[176:191]
    ds_read_b128 a[192:195], v241 offset:32768
    s_add_u32 m0, s52, 0
    v_add_f32 v214, v214, v209
    v_cvt_pk_bf16_f32 v166, v208, v209
    v_mfma_f32_32x32x16_bf16 v[48:63], a[224:227], a[160:163], v[192:207]
    buffer_load_dwordx4 v242, s[16:19], s46 offen offset:0 sc1 lds
    v_exp_f32 v212, v112
    v_add_f32 v214, v214, v210
    v_mfma_f32_32x32x16_bf16 v[32:47], a[228:231], a[132:135], v[32:47]
    ds_read_b128 a[196:199], v241 offset:33792
    v_exp_f32 v213, v113
    v_add_f32 v214, v214, v211
    v_cvt_pk_bf16_f32 v167, v210, v211
    v_exp_f32 v208, v114
    v_mfma_f32_32x32x16_bf16 v[48:63], a[228:231], a[164:167], v[48:63]
    v_add_f32 v215, v215, v212
    v_exp_f32 v209, v115
    v_add_f32 v215, v215, v213
    v_cvt_pk_bf16_f32 v168, v212, v213
    v_mfma_f32_32x32x16_bf16 v[32:47], a[232:235], a[136:139], v[32:47]
    ds_read_b128 a[200:203], v241 offset:34816
    v_exp_f32 v210, v116
    v_add_f32 v215, v215, v208
    v_exp_f32 v211, v117
    v_mfma_f32_32x32x16_bf16 v[48:63], a[232:235], a[168:171], v[48:63]
    buffer_load_dwordx4 v242, s[16:19], s46 offen offset:1024 sc1 lds
    v_add_f32 v215, v215, v209
    v_cvt_pk_bf16_f32 v169, v208, v209
    v_mfma_f32_32x32x16_bf16 v[32:47], a[236:239], a[140:143], v[32:47]
    ds_read_b128 a[204:207], v241 offset:35840
    v_exp_f32 v212, v118
    v_add_f32 v215, v215, v210
    v_exp_f32 v213, v119
    v_mfma_f32_32x32x16_bf16 v[48:63], a[236:239], a[172:175], v[48:63]
    v_add_f32 v215, v215, v211
    v_cvt_pk_bf16_f32 v170, v210, v211
    v_exp_f32 v208, v120
    v_add_f32 v215, v215, v212
    v_mfma_f32_32x32x16_bf16 v[32:47], a[240:243], a[144:147], v[32:47]
    ds_read_b128 a[208:211], v241 offset:36864
    v_exp_f32 v209, v121
    v_add_f32 v215, v215, v213
    v_cvt_pk_bf16_f32 v171, v212, v213
    v_mfma_f32_32x32x16_bf16 v[48:63], a[240:243], a[176:179], v[48:63]
    buffer_load_dwordx4 v242, s[16:19], s46 offen offset:2048 sc1 lds
    v_exp_f32 v210, v122
    v_add_f32 v215, v215, v208
    v_mfma_f32_32x32x16_bf16 v[32:47], a[244:247], a[148:151], v[32:47]
    ds_read_b128 a[212:215], v241 offset:37888
    v_exp_f32 v211, v123
    v_add_f32 v215, v215, v209
    v_cvt_pk_bf16_f32 v172, v208, v209
    v_exp_f32 v212, v124
    v_mfma_f32_32x32x16_bf16 v[48:63], a[244:247], a[180:183], v[48:63]
    v_add_f32 v215, v215, v210
    v_exp_f32 v213, v125
    v_add_f32 v215, v215, v211
    v_cvt_pk_bf16_f32 v173, v210, v211
    v_mfma_f32_32x32x16_bf16 v[32:47], a[248:251], a[152:155], v[32:47]
    ds_read_b128 a[216:219], v241 offset:38912
    v_exp_f32 v208, v126
    v_add_f32 v215, v215, v212
    v_exp_f32 v209, v127
    v_mfma_f32_32x32x16_bf16 v[48:63], a[248:251], a[184:187], v[48:63]
    buffer_load_dwordx4 v242, s[16:19], s46 offen offset:3072 sc1 lds
    v_add_f32 v215, v215, v213
    v_cvt_pk_bf16_f32 v174, v212, v213
    v_mfma_f32_32x32x16_bf16 v[32:47], a[252:255], a[156:159], v[32:47]
    ds_read_b128 a[220:223], v241 offset:39936
    v_add_f32 v215, v215, v208
    v_cvt_pk_bf16_f32 v175, v208, v209
    v_add_f32 v215, v215, v209
    v_max_f32 v218, v214, v215
    v_cmp_lt_f32 vcc, s53, v218
    v_mfma_f32_32x32x16_bf16 v[48:63], a[252:255], a[188:191], v[48:63]
    s_cbranch_vccnz rs_38
rr_39:
    s_cmp_eq_u32 s54, 1
    s_cbranch_scc1 K2_D2
K2_SHb1:
    s_waitcnt lgkmcnt(4)
    v_mfma_f32_32x32x16_bf16 a[0:15], a[192:195], v[144:147], a[0:15]
    ds_read_b128 a[224:227], v241 offset:40960
    v_add_f32 v216, v216, v214
    v_add_f32 v217, v217, v215
    v_exp_f32 v208, v0
    v_mfma_f32_32x32x16_bf16 a[64:79], a[192:195], v[152:155], a[64:79]
    ds_read_b128 a[228:231], v241 offset:41984
    s_add_u32 m0, s52, 16384
    v_exp_f32 v209, v1
    v_exp_f32 v210, v2
    v_mfma_f32_32x32x16_bf16 a[16:31], a[196:199], v[144:147], a[16:31]
    buffer_load_dwordx4 v243, s[16:19], s47 offen offset:0 sc1 lds
    v_add_f32 v214, v208, v209
    v_mfma_f32_32x32x16_bf16 a[80:95], a[196:199], v[152:155], a[80:95]
    ds_read_b128 a[232:235], v241 offset:43008
    v_exp_f32 v211, v3
    v_cvt_pk_bf16_f32 v128, v208, v209
    v_exp_f32 v212, v4
    v_mfma_f32_32x32x16_bf16 a[32:47], a[200:203], v[144:147], a[32:47]
    ds_read_b128 a[236:239], v241 offset:44032
    v_add_f32 v214, v214, v210
    v_exp_f32 v213, v5
    v_add_f32 v214, v214, v211
    v_mfma_f32_32x32x16_bf16 a[96:111], a[200:203], v[152:155], a[96:111]
    buffer_load_dwordx4 v243, s[16:19], s47 offen offset:1024 sc1 lds
    v_cvt_pk_bf16_f32 v129, v210, v211
    v_exp_f32 v208, v6
    v_mfma_f32_32x32x16_bf16 a[48:63], a[204:207], v[144:147], a[48:63]
    ds_read_b128 a[240:243], v241 offset:45056
    v_add_f32 v214, v214, v212
    v_exp_f32 v209, v7
    v_mfma_f32_32x32x16_bf16 a[112:127], a[204:207], v[152:155], a[112:127]
    ds_read_b128 a[244:247], v241 offset:46080
    v_add_f32 v214, v214, v213
    v_cvt_pk_bf16_f32 v130, v212, v213
    v_exp_f32 v210, v8
    s_waitcnt lgkmcnt(6)
    v_mfma_f32_32x32x16_bf16 a[0:15], a[208:211], v[148:151], a[0:15]
    buffer_load_dwordx4 v243, s[16:19], s47 offen offset:2048 sc1 lds
    v_add_f32 v214, v214, v208
    v_mfma_f32_32x32x16_bf16 a[64:79], a[208:211], v[156:159], a[64:79]
    ds_read_b128 a[248:251], v241 offset:47104
    v_exp_f32 v211, v9
    v_add_f32 v214, v214, v209
    v_cvt_pk_bf16_f32 v131, v208, v209
    v_mfma_f32_32x32x16_bf16 a[16:31], a[212:215], v[148:151], a[16:31]
    ds_read_b128 a[252:255], v241 offset:48128
    v_exp_f32 v212, v10
    v_add_f32 v214, v214, v210
    v_exp_f32 v213, v11
    v_mfma_f32_32x32x16_bf16 a[80:95], a[212:215], v[156:159], a[80:95]
    buffer_load_dwordx4 v243, s[16:19], s47 offen offset:3072 sc1 lds
    v_add_f32 v214, v214, v211
    v_cvt_pk_bf16_f32 v132, v210, v211
    v_mfma_f32_32x32x16_bf16 a[32:47], a[216:219], v[148:151], a[32:47]
    v_exp_f32 v208, v12
    v_add_f32 v214, v214, v212
    v_exp_f32 v209, v13
    v_mfma_f32_32x32x16_bf16 a[96:111], a[216:219], v[156:159], a[96:111]
    v_add_f32 v214, v214, v213
    v_cvt_pk_bf16_f32 v133, v212, v213
    v_exp_f32 v210, v14
    v_add_f32 v214, v214, v208
    v_mfma_f32_32x32x16_bf16 a[48:63], a[220:223], v[148:151], a[48:63]
    v_exp_f32 v211, v15
    v_add_f32 v214, v214, v209
    v_cvt_pk_bf16_f32 v134, v208, v209
    v_exp_f32 v212, v16
    v_mfma_f32_32x32x16_bf16 a[112:127], a[220:223], v[156:159], a[112:127]
    s_waitcnt vmcnt(16) lgkmcnt(0)
    s_barrier
    v_mfma_f32_32x32x16_bf16 a[0:15], a[224:227], v[160:163], a[0:15]
    ds_read_b128 a[192:195], v241 offset:0
    s_add_u32 m0, s52, 98304
    v_add_f32 v214, v214, v210
    v_exp_f32 v213, v17
    v_mfma_f32_32x32x16_bf16 a[64:79], a[224:227], v[168:171], a[64:79]
    buffer_load_dwordx4 v242, s[20:23], s48 offen offset:0 sc1 lds
    v_add_f32 v214, v214, v211
    v_cvt_pk_bf16_f32 v135, v210, v211
    v_mfma_f32_32x32x16_bf16 a[16:31], a[228:231], v[160:163], a[16:31]
    ds_read_b128 a[196:199], v241 offset:1024
    v_exp_f32 v208, v18
    v_add_f32 v215, v212, v213
    v_exp_f32 v209, v19
    v_mfma_f32_32x32x16_bf16 a[80:95], a[228:231], v[168:171], a[80:95]
    v_cvt_pk_bf16_f32 v136, v212, v213
    v_exp_f32 v210, v20
    v_add_f32 v215, v215, v208
    v_mfma_f32_32x32x16_bf16 a[32:47], a[232:235], v[160:163], a[32:47]
    ds_read_b128 a[200:203], v241 offset:2048
    v_exp_f32 v211, v21
    v_add_f32 v215, v215, v209
    v_cvt_pk_bf16_f32 v137, v208, v209
    v_mfma_f32_32x32x16_bf16 a[96:111], a[232:235], v[168:171], a[96:111]
    buffer_load_dwordx4 v242, s[20:23], s48 offen offset:1024 sc1 lds
    v_exp_f32 v212, v22
    v_add_f32 v215, v215, v210
    v_mfma_f32_32x32x16_bf16 a[48:63], a[236:239], v[160:163], a[48:63]
    ds_read_b128 a[204:207], v241 offset:3072
    v_exp_f32 v213, v23
    v_add_f32 v215, v215, v211
    v_cvt_pk_bf16_f32 v138, v210, v211
    v_mfma_f32_32x32x16_bf16 a[112:127], a[236:239], v[168:171], a[112:127]
    v_exp_f32 v208, v24
    v_add_f32 v215, v215, v212
    v_exp_f32 v209, v25
    v_mfma_f32_32x32x16_bf16 a[0:15], a[240:243], v[164:167], a[0:15]
    ds_read_b128 a[208:211], v241 offset:4096
    v_add_f32 v215, v215, v213
    v_cvt_pk_bf16_f32 v139, v212, v213
    v_exp_f32 v210, v26
    v_mfma_f32_32x32x16_bf16 a[64:79], a[240:243], v[172:175], a[64:79]
    buffer_load_dwordx4 v242, s[20:23], s48 offen offset:2048 sc1 lds
    v_add_f32 v215, v215, v208
    v_exp_f32 v211, v27
    v_mfma_f32_32x32x16_bf16 a[16:31], a[244:247], v[164:167], a[16:31]
    ds_read_b128 a[212:215], v241 offset:5120
    v_add_f32 v215, v215, v209
    v_cvt_pk_bf16_f32 v140, v208, v209
    v_exp_f32 v212, v28
    v_mfma_f32_32x32x16_bf16 a[80:95], a[244:247], v[172:175], a[80:95]
    v_add_f32 v215, v215, v210
    v_exp_f32 v213, v29
    v_add_f32 v215, v215, v211
    v_cvt_pk_bf16_f32 v141, v210, v211
    v_mfma_f32_32x32x16_bf16 a[32:47], a[248:251], v[164:167], a[32:47]
    ds_read_b128 a[216:219], v241 offset:6144
    v_exp_f32 v208, v30
    v_add_f32 v215, v215, v212
    v_mfma_f32_32x32x16_bf16 a[96:111], a[248:251], v[172:175], a[96:111]
    buffer_load_dwordx4 v242, s[20:23], s48 offen offset:3072 sc1 lds
    v_exp_f32 v209, v31
    v_add_f32 v215, v215, v213
    v_mfma_f32_32x32x16_bf16 a[48:63], a[252:255], v[164:167], a[48:63]
    ds_read_b128 a[220:223], v241 offset:7168
    v_cvt_pk_bf16_f32 v142, v212, v213
    v_add_f32 v215, v215, v208
    v_cvt_pk_bf16_f32 v143, v208, v209
    v_add_f32 v215, v215, v209
    v_mfma_f32_32x32x16_bf16 a[112:127], a[252:255], v[172:175], a[112:127]
    s_add_u32 s54, s54, 1
    s_bitcmp1_b32 s31, s54
    s_cbranch_scc0 K2_Lsh
    s_branch K2_disp
.p2align 6
K2_Lsi:
    s_waitcnt lgkmcnt(4)
    v_mfma_f32_32x32x16_bf16 v[64:79], a[192:195], a[128:131], v[176:191]
    ds_read_b128 a[224:227], v241 offset:8192
    ds_read_b128 a[228:231], v241 offset:9216
    v_exp_f32 v208, v32
    v_exp_f32 v209, v33
    v_mfma_f32_32x32x16_bf16 v[64:79], a[196:199], a[132:135], v[64:79]
    ds_read_b128 a[232:235], v241 offset:10240
    s_add_u32 m0, s52, 114688
    v_exp_f32 v210, v34
    v_add_f32 v214, v214, v208
    v_exp_f32 v211, v35
    v_mfma_f32_32x32x16_bf16 v[64:79], a[200:203], a[136:139], v[64:79]
    ds_read_b128 a[236:239], v241 offset:11264
    v_add_f32 v214, v214, v209
    v_cvt_pk_bf16_f32 v160, v208, v209
    v_exp_f32 v212, v36
    v_add_f32 v214, v214, v210
    v_mfma_f32_32x32x16_bf16 v[64:79], a[204:207], a[140:143], v[64:79]
    ds_read_b128 a[240:243], v241 offset:12288
    buffer_load_dwordx4 v243, s[20:23], s49 offen offset:0 sc1 lds
    v_exp_f32 v213, v37
    s_waitcnt lgkmcnt(5)
    v_mfma_f32_32x32x16_bf16 v[64:79], a[208:211], a[144:147], v[64:79]
    ds_read_b128 a[244:247], v241 offset:13312
    v_add_f32 v214, v214, v211
    v_cvt_pk_bf16_f32 v161, v210, v211
    v_exp_f32 v208, v38
    v_mfma_f32_32x32x16_bf16 v[64:79], a[212:215], a[148:151], v[64:79]
    ds_read_b128 a[248:251], v241 offset:14336
    ds_read_b128 a[252:255], v241 offset:15360
    v_add_f32 v214, v214, v212
    v_exp_f32 v209, v39
    v_add_f32 v214, v214, v213
    v_cvt_pk_bf16_f32 v162, v212, v213
    v_mfma_f32_32x32x16_bf16 v[64:79], a[216:219], a[152:155], v[64:79]
    ds_read_b128 a[192:195], v241 offset:16384
    v_exp_f32 v210, v40
    v_add_f32 v214, v214, v208
    v_exp_f32 v211, v41
    v_mfma_f32_32x32x16_bf16 v[64:79], a[220:223], a[156:159], v[64:79]
    ds_read_b128 a[196:199], v241 offset:17408
    v_add_f32 v214, v214, v209
    v_cvt_pk_bf16_f32 v163, v208, v209
    v_exp_f32 v212, v42
    s_waitcnt lgkmcnt(6)
    v_mfma_f32_32x32x16_bf16 v[80:95], a[224:227], a[128:131], v[176:191]
    ds_read_b128 a[200:203], v241 offset:18432
    buffer_load_dwordx4 v243, s[20:23], s49 offen offset:1024 sc1 lds
    v_add_f32 v214, v214, v210
    v_exp_f32 v213, v43
    v_mfma_f32_32x32x16_bf16 v[80:95], a[228:231], a[132:135], v[80:95]
    ds_read_b128 a[204:207], v241 offset:19456
    v_add_f32 v214, v214, v211
    v_cvt_pk_bf16_f32 v164, v210, v211
    v_exp_f32 v208, v44
    v_add_f32 v214, v214, v212
    v_mfma_f32_32x32x16_bf16 v[80:95], a[232:235], a[136:139], v[80:95]
    ds_read_b128 a[208:211], v241 offset:20480
    ds_read_b128 a[212:215], v241 offset:21504
    v_exp_f32 v209, v45
    v_add_f32 v214, v214, v213
    v_cvt_pk_bf16_f32 v165, v212, v213
    v_mfma_f32_32x32x16_bf16 v[80:95], a[236:239], a[140:143], v[80:95]
    ds_read_b128 a[216:219], v241 offset:22528
    v_exp_f32 v210, v46
    v_add_f32 v214, v214, v208
    v_exp_f32 v211, v47
    s_waitcnt lgkmcnt(7)
    v_mfma_f32_32x32x16_bf16 v[80:95], a[240:243], a[144:147], v[80:95]
    ds_read_b128 a[220:223], v241 offset:23552
    v_add_f32 v214, v214, v209
    v_cvt_pk_bf16_f32 v166, v208, v209
    v_exp_f32 v212, v48
    v_add_f32 v214, v214, v210
    v_mfma_f32_32x32x16_bf16 v[80:95], a[244:247], a[148:151], v[80:95]
    ds_read_b128 a[224:227], v241 offset:24576
    buffer_load_dwordx4 v243, s[20:23], s49 offen offset:2048 sc1 lds
    v_exp_f32 v213, v49
    v_mfma_f32_32x32x16_bf16 v[80:95], a[248:251], a[152:155], v[80:95]
    ds_read_b128 a[228:231], v241 offset:25600
    v_add_f32 v214, v214, v211
    v_cvt_pk_bf16_f32 v167, v210, v211
    v_exp_f32 v208, v50
    v_add_f32 v215, v215, v212
    v_mfma_f32_32x32x16_bf16 v[80:95], a[252:255], a[156:159], v[80:95]
    ds_read_b128 a[232:235], v241 offset:26624
    ds_read_b128 a[236:239], v241 offset:27648
    v_exp_f32 v209, v51
    v_add_f32 v215, v215, v213
    v_cvt_pk_bf16_f32 v168, v212, v213
    s_waitcnt lgkmcnt(8)
    v_mfma_f32_32x32x16_bf16 v[96:111], a[192:195], a[128:131], v[176:191]
    ds_read_b128 a[240:243], v241 offset:28672
    v_exp_f32 v210, v52
    v_add_f32 v215, v215, v208
    v_exp_f32 v211, v53
    v_mfma_f32_32x32x16_bf16 v[96:111], a[196:199], a[132:135], v[96:111]
    ds_read_b128 a[244:247], v241 offset:29696
    v_add_f32 v215, v215, v209
    v_cvt_pk_bf16_f32 v169, v208, v209
    v_exp_f32 v212, v54
    v_add_f32 v215, v215, v210
    v_mfma_f32_32x32x16_bf16 v[96:111], a[200:203], a[136:139], v[96:111]
    ds_read_b128 a[248:251], v241 offset:30720
    buffer_load_dwordx4 v243, s[20:23], s49 offen offset:3072 sc1 lds
    v_exp_f32 v213, v55
    v_add_f32 v215, v215, v211
    v_mfma_f32_32x32x16_bf16 v[96:111], a[204:207], a[140:143], v[96:111]
    ds_read_b128 a[252:255], v241 offset:31744
    v_cvt_pk_bf16_f32 v170, v210, v211
    v_exp_f32 v208, v56
    v_add_f32 v215, v215, v212
    s_waitcnt lgkmcnt(8)
    v_mfma_f32_32x32x16_bf16 v[96:111], a[208:211], a[144:147], v[96:111]
    s_add_u32 s48, s46, s34
    s_add_u32 s49, s47, s34
    s_add_u32 s50, s50, 1
    v_exp_f32 v209, v57
    v_add_f32 v215, v215, v213
    v_mfma_f32_32x32x16_bf16 v[96:111], a[212:215], a[148:151], v[96:111]
    s_cmp_ge_u32 s50, 17
    s_cselect_b32 s46, s35, s51
    s_cselect_b32 s4, 0xffffd000, 0
    s_cselect_b32 s34, 0xff002000, 0
    s_cselect_b32 s5, 0x2000, 0
    v_cvt_pk_bf16_f32 v171, v212, v213
    v_mfma_f32_32x32x16_bf16 v[96:111], a[216:219], a[152:155], v[96:111]
    s_sub_u32 s35, s35, s5
    s_add_u32 s4, s4, s46
    s_cmp_le_u32 s50, s55
    s_cselect_b32 s47, 268435456, s4
    s_cselect_b32 s3, 1, 2
    v_exp_f32 v210, v58
    v_mfma_f32_32x32x16_bf16 v[96:111], a[220:223], a[156:159], v[96:111]
    s_lshl_b32 s3, s3, 14
    s_add_u32 s51, s51, s3
    s_waitcnt vmcnt(16) lgkmcnt(0)
    s_barrier
    v_mfma_f32_32x32x16_bf16 v[112:127], a[224:227], a[128:131], v[176:191]
    ds_read_b128 a[192:195], v240 offset:32768
    s_add_u32 m0, s52, 65536
    v_add_f32 v215, v215, v208
    v_exp_f32 v211, v59
    v_add_f32 v215, v215, v209
    v_mfma_f32_32x32x16_bf16 v[112:127], a[228:231], a[132:135], v[112:127]
    ds_read_b128 a[196:199], v240 offset:33792
    buffer_load_dwordx4 v242, s[16:19], s46 offen offset:0 sc1 lds
    v_cvt_pk_bf16_f32 v172, v208, v209
    v_exp_f32 v212, v60
    v_mfma_f32_32x32x16_bf16 v[112:127], a[232:235], a[136:139], v[112:127]
    ds_read_b128 a[200:203], v240 offset:34816
    v_add_f32 v215, v215, v210
    v_exp_f32 v213, v61
    v_add_f32 v215, v215, v211
    v_cvt_pk_bf16_f32 v173, v210, v211
    v_mfma_f32_32x32x16_bf16 v[112:127], a[236:239], a[140:143], v[112:127]
    ds_read_b128 a[204:207], v240 offset:35840
    buffer_load_dwordx4 v242, s[16:19], s46 offen offset:1024 sc1 lds
    v_exp_f32 v208, v62
    v_mfma_f32_32x32x16_bf16 v[112:127], a[240:243], a[144:147], v[112:127]
    ds_read_b128 a[208:211], v240 offset:36864
    buffer_load_dwordx4 v242, s[16:19], s46 offen offset:2048 sc1 lds
    v_add_f32 v215, v215, v212
    v_exp_f32 v209, v63
    v_mfma_f32_32x32x16_bf16 v[112:127], a[244:247], a[148:151], v[112:127]
    ds_read_b128 a[212:215], v240 offset:37888
    v_add_f32 v215, v215, v213
    v_cvt_pk_bf16_f32 v174, v212, v213
    v_add_f32 v215, v215, v208
    v_cvt_pk_bf16_f32 v175, v208, v209
    v_add_f32 v215, v215, v209
    v_mfma_f32_32x32x16_bf16 v[112:127], a[248:251], a[152:155], v[112:127]
    ds_read_b128 a[216:219], v240 offset:38912
    ds_read_b128 a[220:223], v240 offset:39936
    buffer_load_dwordx4 v242, s[16:19], s46 offen offset:3072 sc1 lds
    v_max_f32 v218, v214, v215
    v_cmp_lt_f32 vcc, s53, v218
    v_mfma_f32_32x32x16_bf16 v[112:127], a[252:255], a[156:159], v[112:127]
    s_cbranch_vccnz rs_36
rr_37:
    s_waitcnt lgkmcnt(4)
    v_mfma_f32_32x32x16_bf16 a[0:15], a[192:195], v[128:131], a[0:15]
    ds_read_b128 a[224:227], v240 offset:40960
    ds_read_b128 a[228:231], v240 offset:41984
    v_add_f32 v216, v216, v214
    v_add_f32 v216, v216, v215
    v_exp_f32 v208, v64
    v_mfma_f32_32x32x16_bf16 a[16:31], a[196:199], v[128:131], a[16:31]
    ds_read_b128 a[232:235], v240 offset:43008
    s_add_u32 m0, s52, 81920
    v_exp_f32 v209, v65
    v_exp_f32 v210, v66
    v_mfma_f32_32x32x16_bf16 a[32:47], a[200:203], v[128:131], a[32:47]
    ds_read_b128 a[236:239], v240 offset:44032
    v_add_f32 v214, v208, v209
    v_exp_f32 v211, v67
    v_cvt_pk_bf16_f32 v144, v208, v209
    v_mfma_f32_32x32x16_bf16 a[48:63], a[204:207], v[128:131], a[48:63]
    ds_read_b128 a[240:243], v240 offset:45056
    buffer_load_dwordx4 v243, s[16:19], s47 offen offset:0 sc1 lds
    v_exp_f32 v212, v68
    s_waitcnt lgkmcnt(5)
    v_mfma_f32_32x32x16_bf16 a[0:15], a[208:211], v[132:135], a[0:15]
    ds_read_b128 a[244:247], v240 offset:46080
    v_add_f32 v214, v214, v210
    v_exp_f32 v213, v69
    v_add_f32 v214, v214, v211
    v_mfma_f32_32x32x16_bf16 a[16:31], a[212:215], v[132:135], a[16:31]
    ds_read_b128 a[248:251], v240 offset:47104
    ds_read_b128 a[252:255], v240 offset:48128
    v_cvt_pk_bf16_f32 v145, v210, v211
    v_exp_f32 v208, v70
    v_mfma_f32_32x32x16_bf16 a[32:47], a[216:219], v[132:135], a[32:47]
    ds_read_b128 a[192:195], v240 offset:49152
    v_add_f32 v214, v214, v212
    v_exp_f32 v209, v71
    v_add_f32 v214, v214, v213
    v_cvt_pk_bf16_f32 v146, v212, v213
    v_mfma_f32_32x32x16_bf16 a[48:63], a[220:223], v[132:135], a[48:63]
    ds_read_b128 a[196:199], v240 offset:50176
    v_exp_f32 v210, v72
    v_add_f32 v214, v214, v208
    s_waitcnt lgkmcnt(6)
    v_mfma_f32_32x32x16_bf16 a[0:15], a[224:227], v[136:139], a[0:15]
    ds_read_b128 a[200:203], v240 offset:51200
    buffer_load_dwordx4 v243, s[16:19], s47 offen offset:1024 sc1 lds
    v_exp_f32 v211, v73
    v_add_f32 v214, v214, v209
    v_mfma_f32_32x32x16_bf16 a[16:31], a[228:231], v[136:139], a[16:31]
    ds_read_b128 a[204:207], v240 offset:52224
    v_cvt_pk_bf16_f32 v147, v208, v209
    v_exp_f32 v212, v74
    v_add_f32 v214, v214, v210
    v_mfma_f32_32x32x16_bf16 a[32:47], a[232:235], v[136:139], a[32:47]
    ds_read_b128 a[208:211], v240 offset:53248
    ds_read_b128 a[212:215], v240 offset:54272
    v_exp_f32 v213, v75
    v_add_f32 v214, v214, v211
    v_cvt_pk_bf16_f32 v148, v210, v211
    v_mfma_f32_32x32x16_bf16 a[48:63], a[236:239], v[136:139], a[48:63]
    ds_read_b128 a[216:219], v240 offset:55296
    v_exp_f32 v208, v76
    v_add_f32 v214, v214, v212
    s_waitcnt lgkmcnt(7)
    v_mfma_f32_32x32x16_bf16 a[0:15], a[240:243], v[140:143], a[0:15]
    ds_read_b128 a[220:223], v240 offset:56320
    v_exp_f32 v209, v77
    v_add_f32 v214, v214, v213
    v_cvt_pk_bf16_f32 v149, v212, v213
    v_exp_f32 v210, v78
    v_mfma_f32_32x32x16_bf16 a[16:31], a[244:247], v[140:143], a[16:31]
    ds_read_b128 a[224:227], v240 offset:57344
    buffer_load_dwordx4 v243, s[16:19], s47 offen offset:2048 sc1 lds
    v_add_f32 v214, v214, v208
    v_mfma_f32_32x32x16_bf16 a[32:47], a[248:251], v[140:143], a[32:47]
    ds_read_b128 a[228:231], v240 offset:58368
    v_exp_f32 v211, v79
    v_add_f32 v214, v214, v209
    v_cvt_pk_bf16_f32 v150, v208, v209
    v_exp_f32 v212, v80
    v_mfma_f32_32x32x16_bf16 a[48:63], a[252:255], v[140:143], a[48:63]
    ds_read_b128 a[232:235], v240 offset:59392
    ds_read_b128 a[236:239], v240 offset:60416
    v_add_f32 v214, v214, v210
    s_waitcnt lgkmcnt(8)
    v_mfma_f32_32x32x16_bf16 a[0:15], a[192:195], v[160:163], a[0:15]
    ds_read_b128 a[240:243], v240 offset:61440
    v_exp_f32 v213, v81
    v_add_f32 v214, v214, v211
    v_cvt_pk_bf16_f32 v151, v210, v211
    v_exp_f32 v208, v82
    v_mfma_f32_32x32x16_bf16 a[16:31], a[196:199], v[160:163], a[16:31]
    ds_read_b128 a[244:247], v240 offset:62464
    v_add_f32 v215, v212, v213
    v_exp_f32 v209, v83
    v_cvt_pk_bf16_f32 v152, v212, v213
    v_mfma_f32_32x32x16_bf16 a[32:47], a[200:203], v[160:163], a[32:47]
    ds_read_b128 a[248:251], v240 offset:63488
    buffer_load_dwordx4 v243, s[16:19], s47 offen offset:3072 sc1 lds
    v_exp_f32 v210, v84
    v_mfma_f32_32x32x16_bf16 a[48:63], a[204:207], v[160:163], a[48:63]
    ds_read_b128 a[252:255], v240 offset:64512
    v_add_f32 v215, v215, v208
    v_exp_f32 v211, v85
    v_add_f32 v215, v215, v209
    s_waitcnt lgkmcnt(8)
    v_mfma_f32_32x32x16_bf16 a[0:15], a[208:211], v[164:167], a[0:15]
    v_cvt_pk_bf16_f32 v153, v208, v209
    v_exp_f32 v212, v86
    v_add_f32 v215, v215, v210
    v_exp_f32 v213, v87
    v_mfma_f32_32x32x16_bf16 a[16:31], a[212:215], v[164:167], a[16:31]
    v_add_f32 v215, v215, v211
    v_cvt_pk_bf16_f32 v154, v210, v211
    v_exp_f32 v208, v88
    v_add_f32 v215, v215, v212
    v_mfma_f32_32x32x16_bf16 a[32:47], a[216:219], v[164:167], a[32:47]
    v_exp_f32 v209, v89
    v_add_f32 v215, v215, v213
    v_cvt_pk_bf16_f32 v155, v212, v213
    v_exp_f32 v210, v90
    v_mfma_f32_32x32x16_bf16 a[48:63], a[220:223], v[164:167], a[48:63]
    v_add_f32 v215, v215, v208
    s_waitcnt vmcnt(16) lgkmcnt(0)
    s_barrier
    v_mfma_f32_32x32x16_bf16 a[0:15], a[224:227], v[168:171], a[0:15]
    ds_read_b128 a[192:195], v240 offset:0
    s_add_u32 m0, s52, 32768
    v_exp_f32 v211, v91
    v_add_f32 v215, v215, v209
    v_cvt_pk_bf16_f32 v156, v208, v209
    v_mfma_f32_32x32x16_bf16 a[16:31], a[228:231], v[168:171], a[16:31]
    ds_read_b128 a[196:199], v240 offset:1024
    buffer_load_dwordx4 v242, s[20:23], s48 offen offset:0 sc1 lds
    v_exp_f32 v212, v92
    v_mfma_f32_32x32x16_bf16 a[32:47], a[232:235], v[168:171], a[32:47]
    ds_read_b128 a[200:203], v240 offset:2048
    v_add_f32 v215, v215, v210
    v_exp_f32 v213, v93
    v_add_f32 v215, v215, v211
    v_cvt_pk_bf16_f32 v157, v210, v211
    v_mfma_f32_32x32x16_bf16 a[48:63], a[236:239], v[168:171], a[48:63]
    ds_read_b128 a[204:207], v240 offset:3072
    buffer_load_dwordx4 v242, s[20:23], s48 offen offset:1024 sc1 lds
    v_exp_f32 v208, v94
    v_mfma_f32_32x32x16_bf16 a[0:15], a[240:243], v[172:175], a[0:15]
    ds_read_b128 a[208:211], v240 offset:4096
    buffer_load_dwordx4 v242, s[20:23], s48 offen offset:2048 sc1 lds
    v_add_f32 v215, v215, v212
    v_exp_f32 v209, v95
    v_mfma_f32_32x32x16_bf16 a[16:31], a[244:247], v[172:175], a[16:31]
    ds_read_b128 a[212:215], v240 offset:5120
    v_add_f32 v215, v215, v213
    v_cvt_pk_bf16_f32 v158, v212, v213
    v_add_f32 v215, v215, v208
    v_cvt_pk_bf16_f32 v159, v208, v209
    v_mfma_f32_32x32x16_bf16 a[32:47], a[248:251], v[172:175], a[32:47]
    ds_read_b128 a[216:219], v240 offset:6144
    ds_read_b128 a[220:223], v240 offset:7168
    buffer_load_dwordx4 v242, s[20:23], s48 offen offset:3072 sc1 lds
    v_add_f32 v215, v215, v209
    v_mfma_f32_32x32x16_bf16 a[48:63], a[252:255], v[172:175], a[48:63]
    s_add_u32 s54, s54, 1
K2_SIa1:
    s_waitcnt lgkmcnt(4)
    v_mfma_f32_32x32x16_bf16 v[0:15], a[192:195], a[128:131], v[176:191]
    ds_read_b128 a[224:227], v240 offset:8192
    ds_read_b128 a[228:231], v240 offset:9216
    v_exp_f32 v208, v96
    v_exp_f32 v209, v97
    v_mfma_f32_32x32x16_bf16 v[0:15], a[196:199], a[132:135], v[0:15]
    ds_read_b128 a[232:235], v240 offset:10240
    s_add_u32 m0, s52, 49152
    v_exp_f32 v210, v98
    v_add_f32 v214, v214, v208
    v_exp_f32 v211, v99
    v_mfma_f32_32x32x16_bf16 v[0:15], a[200:203], a[136:139], v[0:15]
    ds_read_b128 a[236:239], v240 offset:11264
    v_add_f32 v214, v214, v209
    v_cvt_pk_bf16_f32 v160, v208, v209
    v_exp_f32 v212, v100
    v_add_f32 v214, v214, v210
    v_mfma_f32_32x32x16_bf16 v[0:15], a[204:207], a[140:143], v[0:15]
    ds_read_b128 a[240:243], v240 offset:12288
    buffer_load_dwordx4 v243, s[20:23], s49 offen offset:0 sc1 lds
    v_exp_f32 v213, v101
    s_waitcnt lgkmcnt(5)
    v_mfma_f32_32x32x16_bf16 v[0:15], a[208:211], a[144:147], v[0:15]
    ds_read_b128 a[244:247], v240 offset:13312
    v_add_f32 v214, v214, v211
    v_cvt_pk_bf16_f32 v161, v210, v211
    v_exp_f32 v208, v102
    v_mfma_f32_32x32x16_bf16 v[0:15], a[212:215], a[148:151], v[0:15]
    ds_read_b128 a[248:251], v240 offset:14336
    ds_read_b128 a[252:255], v240 offset:15360
    v_add_f32 v214, v214, v212
    v_exp_f32 v209, v103
    v_add_f32 v214, v214, v213
    v_cvt_pk_bf16_f32 v162, v212, v213
    v_mfma_f32_32x32x16_bf16 v[0:15], a[216:219], a[152:155], v[0:15]
    ds_read_b128 a[192:195], v240 offset:16384
    v_exp_f32 v210, v104
    v_add_f32 v214, v214, v208
    v_exp_f32 v211, v105
    v_mfma_f32_32x32x16_bf16 v[0:15], a[220:223], a[156:159], v[0:15]
    ds_read_b128 a[196:199], v240 offset:17408
    v_add_f32 v214, v214, v209
    v_cvt_pk_bf16_f32 v163, v208, v209
    v_exp_f32 v212, v106
    s_waitcnt lgkmcnt(6)
    v_mfma_f32_32x32x16_bf16 v[16:31], a[224:227], a[128:131], v[176:191]
    ds_read_b128 a[200:203], v240 offset:18432
    buffer_load_dwordx4 v243, s[20:23], s49 offen offset:1024 sc1 lds
    v_add_f32 v214, v214, v210
    v_exp_f32 v213, v107
    v_mfma_f32_32x32x16_bf16 v[16:31], a[228:231], a[132:135], v[16:31]
    ds_read_b128 a[204:207], v240 offset:19456
    v_add_f32 v214, v214, v211
    v_cvt_pk_bf16_f32 v164, v210, v211
    v_exp_f32 v208, v108
    v_add_f32 v214, v214, v212
    v_mfma_f32_32x32x16_bf16 v[16:31], a[232:235], a[136:139], v[16:31]
    ds_read_b128 a[208:211], v240 offset:20480
    ds_read_b128 a[212:215], v240 offset:21504
    v_exp_f32 v209, v109
    v_add_f32 v214, v214, v213
    v_cvt_pk_bf16_f32 v165, v212, v213
    v_mfma_f32_32x32x16_bf16 v[16:31], a[236:239], a[140:143], v[16:31]
    ds_read_b128 a[216:219], v240 offset:22528
    v_exp_f32 v210, v110
    v_add_f32 v214, v214, v208
    v_exp_f32 v211, v111
    s_waitcnt lgkmcnt(7)
    v_mfma_f32_32x32x16_bf16 v[16:31], a[240:243], a[144:147], v[16:31]
    ds_read_b128 a[220:223], v240 offset:23552
    v_add_f32 v214, v214, v209
    v_cvt_pk_bf16_f32 v166, v208, v209
    v_exp_f32 v212, v112
    v_add_f32 v214, v214, v210
    v_mfma_f32_32x32x16_bf16 v[16:31], a[244:247], a[148:151], v[16:31]
    ds_read_b128 a[224:227], v240 offset:24576
    buffer_load_dwordx4 v243, s[20:23], s49 offen offset:2048 sc1 lds
    v_exp_f32 v213, v113
    v_mfma_f32_32x32x16_bf16 v[16:31], a[248:251], a[152:155], v[16:31]
    ds_read_b128 a[228:231], v240 offset:25600
    v_add_f32 v214, v214, v211
    v_cvt_pk_bf16_f32 v167, v210, v211
    v_exp_f32 v208, v114
    v_add_f32 v215, v215, v212
    v_mfma_f32_32x32x16_bf16 v[16:31], a[252:255], a[156:159], v[16:31]
    ds_read_b128 a[232:235], v240 offset:26624
    ds_read_b128 a[236:239], v240 offset:27648
    v_exp_f32 v209, v115
    v_add_f32 v215, v215, v213
    v_cvt_pk_bf16_f32 v168, v212, v213
    s_waitcnt lgkmcnt(8)
    v_mfma_f32_32x32x16_bf16 v[32:47], a[192:195], a[128:131], v[176:191]
    ds_read_b128 a[240:243], v240 offset:28672
    v_exp_f32 v210, v116
    v_add_f32 v215, v215, v208
    v_exp_f32 v211, v117
    v_mfma_f32_32x32x16_bf16 v[32:47], a[196:199], a[132:135], v[32:47]
    ds_read_b128 a[244:247], v240 offset:29696
    v_add_f32 v215, v215, v209
    v_cvt_pk_bf16_f32 v169, v208, v209
    v_exp_f32 v212, v118
    v_add_f32 v215, v215, v210
    v_mfma_f32_32x32x16_bf16 v[32:47], a[200:203], a[136:139], v[32:47]
    ds_read_b128 a[248:251], v240 offset:30720
    buffer_load_dwordx4 v243, s[20:23], s49 offen offset:3072 sc1 lds
    v_exp_f32 v213, v119
    v_add_f32 v215, v215, v211
    v_mfma_f32_32x32x16_bf16 v[32:47], a[204:207], a[140:143], v[32:47]
    ds_read_b128 a[252:255], v240 offset:31744
    v_cvt_pk_bf16_f32 v170, v210, v211
    v_exp_f32 v208, v120
    v_add_f32 v215, v215, v212
    s_waitcnt lgkmcnt(8)
    v_mfma_f32_32x32x16_bf16 v[32:47], a[208:211], a[144:147], v[32:47]
    s_add_u32 s48, s46, s34
    s_add_u32 s49, s47, s34
    s_add_u32 s50, s50, 1
    v_exp_f32 v209, v121
    v_add_f32 v215, v215, v213
    v_mfma_f32_32x32x16_bf16 v[32:47], a[212:215], a[148:151], v[32:47]
    s_cmp_ge_u32 s50, 17
    s_cselect_b32 s46, s35, s51
    s_cselect_b32 s4, 0xffffd000, 0
    s_cselect_b32 s34, 0xff002000, 0
    s_cselect_b32 s5, 0x2000, 0
    v_cvt_pk_bf16_f32 v171, v212, v213
    v_mfma_f32_32x32x16_bf16 v[32:47], a[216:219], a[152:155], v[32:47]
    s_sub_u32 s35, s35, s5
    s_add_u32 s4, s4, s46
    s_cmp_le_u32 s50, s55
    s_cselect_b32 s47, 268435456, s4
    s_cselect_b32 s3, 1, 2
    v_exp_f32 v210, v122
    v_mfma_f32_32x32x16_bf16 v[32:47], a[220:223], a[156:159], v[32:47]
    s_lshl_b32 s3, s3, 14
    s_add_u32 s51, s51, s3
    s_waitcnt vmcnt(16) lgkmcnt(0)
    s_barrier
    v_mfma_f32_32x32x16_bf16 v[48:63], a[224:227], a[128:131], v[176:191]
    ds_read_b128 a[192:195], v241 offset:32768
    s_add_u32 m0, s52, 0
    v_add_f32 v215, v215, v208
    v_exp_f32 v211, v123
    v_add_f32 v215, v215, v209
    v_mfma_f32_32x32x16_bf16 v[48:63], a[228:231], a[132:135], v[48:63]
    ds_read_b128 a[196:199], v241 offset:33792
    buffer_load_dwordx4 v242, s[16:19], s46 offen offset:0 sc1 lds
    v_cvt_pk_bf16_f32 v172, v208, v209
    v_exp_f32 v212, v124
    v_mfma_f32_32x32x16_bf16 v[48:63], a[232:235], a[136:139], v[48:63]
    ds_read_b128 a[200:203], v241 offset:34816
    v_add_f32 v215, v215, v210
    v_exp_f32 v213, v125
    v_add_f32 v215, v215, v211
    v_cvt_pk_bf16_f32 v173, v210, v211
    v_mfma_f32_32x32x16_bf16 v[48:63], a[236:239], a[140:143], v[48:63]
    ds_read_b128 a[204:207], v241 offset:35840
    buffer_load_dwordx4 v242, s[16:19], s46 offen offset:1024 sc1 lds
    v_exp_f32 v208, v126
    v_mfma_f32_32x32x16_bf16 v[48:63], a[240:243], a[144:147], v[48:63]
    ds_read_b128 a[208:211], v241 offset:36864
    buffer_load_dwordx4 v242, s[16:19], s46 offen offset:2048 sc1 lds
    v_add_f32 v215, v215, v212
    v_exp_f32 v209, v127
    v_mfma_f32_32x32x16_bf16 v[48:63], a[244:247], a[148:151], v[48:63]
    ds_read_b128 a[212:215], v241 offset:37888
    v_add_f32 v215, v215, v213
    v_cvt_pk_bf16_f32 v174, v212, v213
    v_add_f32 v215, v215, v208
    v_cvt_pk_bf16_f32 v175, v208, v209
    v_add_f32 v215, v215, v209
    v_mfma_f32_32x32x16_bf16 v[48:63], a[248:251], a[152:155], v[48:63]
    ds_read_b128 a[216:219], v241 offset:38912
    ds_read_b128 a[220:223], v241 offset:39936
    buffer_load_dwordx4 v242, s[16:19], s46 offen offset:3072 sc1 lds
    v_max_f32 v218, v214, v215
    v_cmp_lt_f32 vcc, s53, v218
    v_mfma_f32_32x32x16_bf16 v[48:63], a[252:255], a[156:159], v[48:63]
    s_cbranch_vccnz rs_40
rr_41:
    s_cmp_eq_u32 s54, 15
    s_cbranch_scc1 pes_42
per_43:
    s_cmp_eq_u32 s54, 1
    s_cbranch_scc1 K2_D2
    s_cmp_eq_u32 s54, s95
    s_cbranch_scc1 K2_SHb1
K2_SIb1:
    s_waitcnt lgkmcnt(4)
    v_mfma_f32_32x32x16_bf16 a[0:15], a[192:195], v[144:147], a[0:15]
    ds_read_b128 a[224:227], v241 offset:40960
    ds_read_b128 a[228:231], v241 offset:41984
    v_add_f32 v216, v216, v214
    v_add_f32 v216, v216, v215
    v_exp_f32 v208, v0
    v_mfma_f32_32x32x16_bf16 a[16:31], a[196:199], v[144:147], a[16:31]
    ds_read_b128 a[232:235], v241 offset:43008
    s_add_u32 m0, s52, 16384
    v_exp_f32 v209, v1
    v_exp_f32 v210, v2
    v_mfma_f32_32x32x16_bf16 a[32:47], a[200:203], v[144:147], a[32:47]
    ds_read_b128 a[236:239], v241 offset:44032
    v_add_f32 v214, v208, v209
    v_exp_f32 v211, v3
    v_cvt_pk_bf16_f32 v128, v208, v209
    v_mfma_f32_32x32x16_bf16 a[48:63], a[204:207], v[144:147], a[48:63]
    ds_read_b128 a[240:243], v241 offset:45056
    buffer_load_dwordx4 v243, s[16:19], s47 offen offset:0 sc1 lds
    v_exp_f32 v212, v4
    s_waitcnt lgkmcnt(5)
    v_mfma_f32_32x32x16_bf16 a[0:15], a[208:211], v[148:151], a[0:15]
    ds_read_b128 a[244:247], v241 offset:46080
    v_add_f32 v214, v214, v210
    v_exp_f32 v213, v5
    v_add_f32 v214, v214, v211
    v_mfma_f32_32x32x16_bf16 a[16:31], a[212:215], v[148:151], a[16:31]
    ds_read_b128 a[248:251], v241 offset:47104
    ds_read_b128 a[252:255], v241 offset:48128
    v_cvt_pk_bf16_f32 v129, v210, v211
    v_exp_f32 v208, v6
    v_mfma_f32_32x32x16_bf16 a[32:47], a[216:219], v[148:151], a[32:47]
    ds_read_b128 a[192:195], v241 offset:49152
    v_add_f32 v214, v214, v212
    v_exp_f32 v209, v7
    v_add_f32 v214, v214, v213
    v_cvt_pk_bf16_f32 v130, v212, v213
    v_mfma_f32_32x32x16_bf16 a[48:63], a[220:223], v[148:151], a[48:63]
    ds_read_b128 a[196:199], v241 offset:50176
    v_exp_f32 v210, v8
    v_add_f32 v214, v214, v208
    s_waitcnt lgkmcnt(6)
    v_mfma_f32_32x32x16_bf16 a[0:15], a[224:227], v[152:155], a[0:15]
    ds_read_b128 a[200:203], v241 offset:51200
    buffer_load_dwordx4 v243, s[16:19], s47 offen offset:1024 sc1 lds
    v_exp_f32 v211, v9
    v_add_f32 v214, v214, v209
    v_mfma_f32_32x32x16_bf16 a[16:31], a[228:231], v[152:155], a[16:31]
    ds_read_b128 a[204:207], v241 offset:52224
    v_cvt_pk_bf16_f32 v131, v208, v209
    v_exp_f32 v212, v10
    v_add_f32 v214, v214, v210
    v_mfma_f32_32x32x16_bf16 a[32:47], a[232:235], v[152:155], a[32:47]
    ds_read_b128 a[208:211], v241 offset:53248
    ds_read_b128 a[212:215], v241 offset:54272
    v_exp_f32 v213, v11
    v_add_f32 v214, v214, v211
    v_cvt_pk_bf16_f32 v132, v210, v211
    v_mfma_f32_32x32x16_bf16 a[48:63], a[236:239], v[152:155], a[48:63]
    ds_read_b128 a[216:219], v241 offset:55296
    v_exp_f32 v208, v12
    v_add_f32 v214, v214, v212
    s_waitcnt lgkmcnt(7)
    v_mfma_f32_32x32x16_bf16 a[0:15], a[240:243], v[156:159], a[0:15]
    ds_read_b128 a[220:223], v241 offset:56320
    v_exp_f32 v209, v13
    v_add_f32 v214, v214, v213
    v_cvt_pk_bf16_f32 v133, v212, v213
    v_exp_f32 v210, v14
    v_mfma_f32_32x32x16_bf16 a[16:31], a[244:247], v[156:159], a[16:31]
    ds_read_b128 a[224:227], v241 offset:57344
    buffer_load_dwordx4 v243, s[16:19], s47 offen offset:2048 sc1 lds
    v_add_f32 v214, v214, v208
    v_mfma_f32_32x32x16_bf16 a[32:47], a[248:251], v[156:159], a[32:47]
    ds_read_b128 a[228:231], v241 offset:58368
    v_exp_f32 v211, v15
    v_add_f32 v214, v214, v209
    v_cvt_pk_bf16_f32 v134, v208, v209
    v_exp_f32 v212, v16
    v_mfma_f32_32x32x16_bf16 a[48:63], a[252:255], v[156:159], a[48:63]
    ds_read_b128 a[232:235], v241 offset:59392
    ds_read_b128 a[236:239], v241 offset:60416
    v_add_f32 v214, v214, v210
    s_waitcnt lgkmcnt(8)
    v_mfma_f32_32x32x16_bf16 a[0:15], a[192:195], v[160:163], a[0:15]
    ds_read_b128 a[240:243], v241 offset:61440
    v_exp_f32 v213, v17
    v_add_f32 v214, v214, v211
    v_cvt_pk_bf16_f32 v135, v210, v211
    v_exp_f32 v208, v18
    v_mfma_f32_32x32x16_bf16 a[16:31], a[196:199], v[160:163], a[16:31]
    ds_read_b128 a[244:247], v241 offset:62464
    v_add_f32 v215, v212, v213
    v_exp_f32 v209, v19
    v_cvt_pk_bf16_f32 v136, v212, v213
    v_mfma_f32_32x32x16_bf16 a[32:47], a[200:203], v[160:163], a[32:47]
    ds_read_b128 a[248:251], v241 offset:63488
    buffer_load_dwordx4 v243, s[16:19], s47 offen offset:3072 sc1 lds
    v_exp_f32 v210, v20
    v_mfma_f32_32x32x16_bf16 a[48:63], a[204:207], v[160:163], a[48:63]
    ds_read_b128 a[252:255], v241 offset:64512
    v_add_f32 v215, v215, v208
    v_exp_f32 v211, v21
    v_add_f32 v215, v215, v209
    s_waitcnt lgkmcnt(8)
    v_mfma_f32_32x32x16_bf16 a[0:15], a[208:211], v[164:167], a[0:15]
    v_cvt_pk_bf16_f32 v137, v208, v209
    v_exp_f32 v212, v22
    v_add_f32 v215, v215, v210
    v_exp_f32 v213, v23
    v_mfma_f32_32x32x16_bf16 a[16:31], a[212:215], v[164:167], a[16:31]
    v_add_f32 v215, v215, v211
    v_cvt_pk_bf16_f32 v138, v210, v211
    v_exp_f32 v208, v24
    v_add_f32 v215, v215, v212
    v_mfma_f32_32x32x16_bf16 a[32:47], a[216:219], v[164:167], a[32:47]
    v_exp_f32 v209, v25
    v_add_f32 v215, v215, v213
    v_cvt_pk_bf16_f32 v139, v212, v213
    v_exp_f32 v210, v26
    v_mfma_f32_32x32x16_bf16 a[48:63], a[220:223], v[164:167], a[48:63]
    v_add_f32 v215, v215, v208
    s_waitcnt vmcnt(16) lgkmcnt(0)
    s_barrier
    v_mfma_f32_32x32x16_bf16 a[0:15], a[224:227], v[168:171], a[0:15]
    ds_read_b128 a[192:195], v241 offset:0
    s_add_u32 m0, s52, 98304
    v_exp_f32 v211, v27
    v_add_f32 v215, v215, v209
    v_cvt_pk_bf16_f32 v140, v208, v209
    v_mfma_f32_32x32x16_bf16 a[16:31], a[228:231], v[168:171], a[16:31]
    ds_read_b128 a[196:199], v241 offset:1024
    buffer_load_dwordx4 v242, s[20:23], s48 offen offset:0 sc1 lds
    v_exp_f32 v212, v28
    v_mfma_f32_32x32x16_bf16 a[32:47], a[232:235], v[168:171], a[32:47]
    ds_read_b128 a[200:203], v241 offset:2048
    v_add_f32 v215, v215, v210
    v_exp_f32 v213, v29
    v_add_f32 v215, v215, v211
    v_cvt_pk_bf16_f32 v141, v210, v211
    v_mfma_f32_32x32x16_bf16 a[48:63], a[236:239], v[168:171], a[48:63]
    ds_read_b128 a[204:207], v241 offset:3072
    buffer_load_dwordx4 v242, s[20:23], s48 offen offset:1024 sc1 lds
    v_exp_f32 v208, v30
    v_mfma_f32_32x32x16_bf16 a[0:15], a[240:243], v[172:175], a[0:15]
    ds_read_b128 a[208:211], v241 offset:4096
    buffer_load_dwordx4 v242, s[20:23], s48 offen offset:2048 sc1 lds
    v_add_f32 v215, v215, v212
    v_exp_f32 v209, v31
    v_mfma_f32_32x32x16_bf16 a[16:31], a[244:247], v[172:175], a[16:31]
    ds_read_b128 a[212:215], v241 offset:5120
    v_add_f32 v215, v215, v213
    v_cvt_pk_bf16_f32 v142, v212, v213
    v_add_f32 v215, v215, v208
    v_cvt_pk_bf16_f32 v143, v208, v209
    v_mfma_f32_32x32x16_bf16 a[32:47], a[248:251], v[172:175], a[32:47]
    ds_read_b128 a[216:219], v241 offset:6144
    ds_read_b128 a[220:223], v241 offset:7168
    buffer_load_dwordx4 v242, s[20:23], s48 offen offset:3072 sc1 lds
    v_add_f32 v215, v215, v209
    v_mfma_f32_32x32x16_bf16 a[48:63], a[252:255], v[172:175], a[48:63]
    s_add_u32 s54, s54, 1
    s_bitcmp1_b32 s31, s54
    s_cbranch_scc0 K2_Lsi
K2_disp:
    s_sub_u32 s6, s54, s59
    s_sub_u32 s7, s54, s55
    s_cmp_eq_u32 s7, 1
    s_cbranch_scc1 hk_48
hk_48r:
    s_cmp_eq_u32 s7, 3
    s_cbranch_scc1 hk_49
hk_49r:
    s_cmp_eq_u32 s6, 1
    s_cbranch_scc1 hk_50
hk_50r:
    s_cmp_eq_u32 s6, 3
    s_cbranch_scc1 hk_51
hk_51r:
    s_cmp_eq_u32 s6, 5
    s_cbranch_scc1 hk_52
hk_52r:
    s_cmp_eq_u32 s54, 12
    s_cbranch_scc1 hk_53
hk_53r:
    s_cmp_eq_u32 s54, 14
    s_cbranch_scc1 hk_54
hk_54r:
    s_cmp_lt_u32 s54, s55
    s_cbranch_scc1 K2_Lsh
    s_cmp_lg_u32 s54, 16
    s_cbranch_scc1 K2_Lsi
    s_branch K2_fin
hk_48:
    s_nop 7
    s_nop 3
    v_mov_b32 v220, v217
    s_nop 1
    v_permlane32_swap_b32 v217, v220
    s_nop 1
    v_add_f32 v217, v217, v220
    v_rcp_f32 v236, v217
    s_add_u32 s4, s57, 4096
    v_accvgpr_read_b32 v220, a64
    v_accvgpr_read_b32 v221, a65
    v_accvgpr_read_b32 v222, a66
    v_accvgpr_read_b32 v223, a67
    v_accvgpr_read_b32 v224, a68
    v_accvgpr_read_b32 v225, a69
    v_accvgpr_read_b32 v226, a70
    v_accvgpr_read_b32 v227, a71
    v_pk_mul_f32 v[220:221], v[220:221], v[236:237] op_sel_hi:[1,0]
    v_pk_mul_f32 v[222:223], v[222:223], v[236:237] op_sel_hi:[1,0]
    v_pk_mul_f32 v[224:225], v[224:225], v[236:237] op_sel_hi:[1,0]
    v_pk_mul_f32 v[226:227], v[226:227], v[236:237] op_sel_hi:[1,0]
    v_cvt_pk_bf16_f32 v220, v220, v221
    v_cvt_pk_bf16_f32 v221, v222, v223
    v_cvt_pk_bf16_f32 v222, v224, v225
    v_cvt_pk_bf16_f32 v223, v226, v227
    buffer_store_dwordx4 v[220:223], v238, s[12:15], s57 offen offset:0 sc0 sc1
    v_accvgpr_read_b32 v228, a72
    v_accvgpr_read_b32 v229, a73
    v_accvgpr_read_b32 v230, a74
    v_accvgpr_read_b32 v231, a75
    v_accvgpr_read_b32 v232, a76
    v_accvgpr_read_b32 v233, a77
    v_accvgpr_read_b32 v234, a78
    v_accvgpr_read_b32 v235, a79
    v_pk_mul_f32 v[228:229], v[228:229], v[236:237] op_sel_hi:[1,0]
    v_pk_mul_f32 v[230:231], v[230:231], v[236:237] op_sel_hi:[1,0]
    v_pk_mul_f32 v[232:233], v[232:233], v[236:237] op_sel_hi:[1,0]
    v_pk_mul_f32 v[234:235], v[234:235], v[236:237] op_sel_hi:[1,0]
    v_cvt_pk_bf16_f32 v228, v228, v229
    v_cvt_pk_bf16_f32 v229, v230, v231
    v_cvt_pk_bf16_f32 v230, v232, v233
    v_cvt_pk_bf16_f32 v231, v234, v235
    buffer_store_dwordx4 v[228:231], v238, s[12:15], s57 offen offset:1024 sc0 sc1
    v_accvgpr_read_b32 v220, a80
    v_accvgpr_read_b32 v221, a81
    v_accvgpr_read_b32 v222, a82
    v_accvgpr_read_b32 v223, a83
    v_accvgpr_read_b32 v224, a84
    v_accvgpr_read_b32 v225, a85
    v_accvgpr_read_b32 v226, a86
    v_accvgpr_read_b32 v227, a87
    v_pk_mul_f32 v[220:221], v[220:221], v[236:237] op_sel_hi:[1,0]
    v_pk_mul_f32 v[222:223], v[222:223], v[236:237] op_sel_hi:[1,0]
    v_pk_mul_f32 v[224:225], v[224:225], v[236:237] op_sel_hi:[1,0]
    v_pk_mul_f32 v[226:227], v[226:227], v[236:237] op_sel_hi:[1,0]
    v_cvt_pk_bf16_f32 v220, v220, v221
    v_cvt_pk_bf16_f32 v221, v222, v223
    v_cvt_pk_bf16_f32 v222, v224, v225
    v_cvt_pk_bf16_f32 v223, v226, v227
    buffer_store_dwordx4 v[220:223], v238, s[12:15], s57 offen offset:2048 sc0 sc1
    v_accvgpr_read_b32 v228, a88
    v_accvgpr_read_b32 v229, a89
    v_accvgpr_read_b32 v230, a90
    v_accvgpr_read_b32 v231, a91
    v_accvgpr_read_b32 v232, a92
    v_accvgpr_read_b32 v233, a93
    v_accvgpr_read_b32 v234, a94
    v_accvgpr_read_b32 v235, a95
    v_pk_mul_f32 v[228:229], v[228:229], v[236:237] op_sel_hi:[1,0]
    v_pk_mul_f32 v[230:231], v[230:231], v[236:237] op_sel_hi:[1,0]
    v_pk_mul_f32 v[232:233], v[232:233], v[236:237] op_sel_hi:[1,0]
    v_pk_mul_f32 v[234:235], v[234:235], v[236:237] op_sel_hi:[1,0]
    v_cvt_pk_bf16_f32 v228, v228, v229
    v_cvt_pk_bf16_f32 v229, v230, v231
    v_cvt_pk_bf16_f32 v230, v232, v233
    v_cvt_pk_bf16_f32 v231, v234, v235
    buffer_store_dwordx4 v[228:231], v238, s[12:15], s57 offen offset:3072 sc0 sc1
    v_accvgpr_read_b32 v220, a96
    v_accvgpr_read_b32 v221, a97
    v_accvgpr_read_b32 v222, a98
    v_accvgpr_read_b32 v223, a99
    v_accvgpr_read_b32 v224, a100
    v_accvgpr_read_b32 v225, a101
    v_accvgpr_read_b32 v226, a102
    v_accvgpr_read_b32 v227, a103
    v_pk_mul_f32 v[220:221], v[220:221], v[236:237] op_sel_hi:[1,0]
    v_pk_mul_f32 v[222:223], v[222:223], v[236:237] op_sel_hi:[1,0]
    v_pk_mul_f32 v[224:225], v[224:225], v[236:237] op_sel_hi:[1,0]
    v_pk_mul_f32 v[226:227], v[226:227], v[236:237] op_sel_hi:[1,0]
    v_cvt_pk_bf16_f32 v220, v220, v221
    v_cvt_pk_bf16_f32 v221, v222, v223
    v_cvt_pk_bf16_f32 v222, v224, v225
    v_cvt_pk_bf16_f32 v223, v226, v227
    buffer_store_dwordx4 v[220:223], v238, s[12:15], s4 offen offset:0 sc0 sc1
    v_accvgpr_read_b32 v228, a104
    v_accvgpr_read_b32 v229, a105
    v_accvgpr_read_b32 v230, a106
    v_accvgpr_read_b32 v231, a107
    v_accvgpr_read_b32 v232, a108
    v_accvgpr_read_b32 v233, a109
    v_accvgpr_read_b32 v234, a110
    v_accvgpr_read_b32 v235, a111
    v_pk_mul_f32 v[228:229], v[228:229], v[236:237] op_sel_hi:[1,0]
    v_pk_mul_f32 v[230:231], v[230:231], v[236:237] op_sel_hi:[1,0]
    v_pk_mul_f32 v[232:233], v[232:233], v[236:237] op_sel_hi:[1,0]
    v_pk_mul_f32 v[234:235], v[234:235], v[236:237] op_sel_hi:[1,0]
    v_cvt_pk_bf16_f32 v228, v228, v229
    v_cvt_pk_bf16_f32 v229, v230, v231
    v_cvt_pk_bf16_f32 v230, v232, v233
    v_cvt_pk_bf16_f32 v231, v234, v235
    buffer_store_dwordx4 v[228:231], v238, s[12:15], s4 offen offset:1024 sc0 sc1
    v_accvgpr_read_b32 v220, a112
    v_accvgpr_read_b32 v221, a113
    v_accvgpr_read_b32 v222, a114
    v_accvgpr_read_b32 v223, a115
    v_accvgpr_read_b32 v224, a116
    v_accvgpr_read_b32 v225, a117
    v_accvgpr_read_b32 v226, a118
    v_accvgpr_read_b32 v227, a119
    v_pk_mul_f32 v[220:221], v[220:221], v[236:237] op_sel_hi:[1,0]
    v_pk_mul_f32 v[222:223], v[222:223], v[236:237] op_sel_hi:[1,0]
    v_pk_mul_f32 v[224:225], v[224:225], v[236:237] op_sel_hi:[1,0]
    v_pk_mul_f32 v[226:227], v[226:227], v[236:237] op_sel_hi:[1,0]
    v_cvt_pk_bf16_f32 v220, v220, v221
    v_cvt_pk_bf16_f32 v221, v222, v223
    v_cvt_pk_bf16_f32 v222, v224, v225
    v_cvt_pk_bf16_f32 v223, v226, v227
    buffer_store_dwordx4 v[220:223], v238, s[12:15], s4 offen offset:2048 sc0 sc1
    v_accvgpr_read_b32 v228, a120
    v_accvgpr_read_b32 v229, a121
    v_accvgpr_read_b32 v230, a122
    v_accvgpr_read_b32 v231, a123
    v_accvgpr_read_b32 v232, a124
    v_accvgpr_read_b32 v233, a125
    v_accvgpr_read_b32 v234, a126
    v_accvgpr_read_b32 v235, a127
    v_pk_mul_f32 v[228:229], v[228:229], v[236:237] op_sel_hi:[1,0]
    v_pk_mul_f32 v[230:231], v[230:231], v[236:237] op_sel_hi:[1,0]
    v_pk_mul_f32 v[232:233], v[232:233], v[236:237] op_sel_hi:[1,0]
    v_pk_mul_f32 v[234:235], v[234:235], v[236:237] op_sel_hi:[1,0]
    v_cvt_pk_bf16_f32 v228, v228, v229
    v_cvt_pk_bf16_f32 v229, v230, v231
    v_cvt_pk_bf16_f32 v230, v232, v233
    v_cvt_pk_bf16_f32 v231, v234, v235
    buffer_store_dwordx4 v[228:231], v238, s[12:15], s4 offen offset:3072 sc0 sc1
    s_branch hk_48r
hk_49:
    buffer_store_dwordx2 v[250:251], off, s[64:67], s58 sc0 sc1
    s_branch hk_49r
hk_50:
    v_lshrrev_b32 v224, 4, v238
    v_lshrrev_b32 v220, 4, v224
    v_and_b32 v221, 15, v224
    v_lshlrev_b32 v223, 2, v220
    v_xor_b32 v221, v221, v223
    v_lshlrev_b32 v221, 4, v221
    v_lshl_add_u32 v244, v220, 10, v221
    s_lshl_b32 s28, s94, 13
    s_add_u32 s28, s28, 131072
    s_lshl_b32 s29, s2, 14
    s_lshl_b32 s3, s94, 8
    s_add_u32 s29, s29, s3
    s_mov_b32 s24, s78
    s_mov_b32 s25, s79
    s_mov_b32 s26, 0x400000
    s_mov_b32 s27, 0x00020000
    s_add_u32 m0, s28, 0
    s_add_u32 s3, s29, 0
    buffer_load_dwordx4 v244, s[24:27], s3 offen lds
    s_add_u32 m0, s28, 1024
    s_add_u32 s3, s29, 4096
    buffer_load_dwordx4 v244, s[24:27], s3 offen lds
    s_add_u32 m0, s28, 2048
    s_add_u32 s3, s29, 8192
    buffer_load_dwordx4 v244, s[24:27], s3 offen lds
    s_add_u32 m0, s28, 3072
    s_add_u32 s3, s29, 12288
    buffer_load_dwordx4 v244, s[24:27], s3 offen lds
    s_mov_b32 s24, s86
    s_mov_b32 s25, s87
    s_mov_b32 s26, 0x1c0000
    s_mov_b32 s27, 0x00020000
    s_add_u32 m0, s28, 4096
    s_add_u32 s3, s29, 0
    buffer_load_dwordx4 v244, s[24:27], s3 offen lds
    s_add_u32 m0, s28, 5120
    s_add_u32 s3, s29, 4096
    buffer_load_dwordx4 v244, s[24:27], s3 offen lds
    s_add_u32 m0, s28, 6144
    s_add_u32 s3, s29, 8192
    buffer_load_dwordx4 v244, s[24:27], s3 offen lds
    s_add_u32 m0, s28, 7168
    s_add_u32 s3, s29, 12288
    buffer_load_dwordx4 v244, s[24:27], s3 offen lds
    v_bfe_u32 v220, v224, 2, 2
    v_lshrrev_b32 v222, 5, v224
    v_lshl_add_u32 v223, v222, 2, v220
    v_lshlrev_b32 v223, 8, v223
    v_bfe_u32 v221, v224, 4, 1
    v_lshl_add_u32 v223, v221, 5, v223
    v_and_b32 v221, 3, v224
    v_lshl_add_u32 v223, v221, 3, v223
    v_lshl_add_u32 v223, v220, 6, v223
    v_add_u32 v245, s28, v223
    v_xor_b32 v246, 64, v245
    v_xor_b32 v247, 128, v245
    v_xor_b32 v248, 192, v245
    s_branch hk_50r
hk_51:
    ds_read_b64_tr_b16 v[220:221], v245 offset:0
    ds_read_b64_tr_b16 v[222:223], v245 offset:2048
    ds_read_b64_tr_b16 v[224:225], v246 offset:0
    ds_read_b64_tr_b16 v[226:227], v246 offset:2048
    ds_read_b64_tr_b16 v[228:229], v247 offset:0
    ds_read_b64_tr_b16 v[230:231], v247 offset:2048
    ds_read_b64_tr_b16 v[232:233], v248 offset:0
    ds_read_b64_tr_b16 v[234:235], v248 offset:2048
    s_add_u32 s24, s92, 0x7000000
    s_addc_u32 s25, s93, 0
    s_mov_b32 s26, 0x400000
    s_mov_b32 s27, 0x00020000
    s_xor_b32 s4, s2, 0
    s_cmp_ge_u32 s4, 256
    s_cselect_b32 s26, 0, s26
    s_mul_i32 s29, s94, 1048576
    s_lshl_b32 s3, s4, 11
    s_add_u32 s29, s29, s3
    s_add_u32 s28, s29, 524288
    s_waitcnt lgkmcnt(0)
    buffer_store_dwordx4 v[220:223], v238, s[24:27], s29 offen offset:0 sc0 sc1
    buffer_store_dwordx4 v[224:227], v238, s[24:27], s29 offen offset:1024 sc0 sc1
    buffer_store_dwordx4 v[228:231], v238, s[24:27], s28 offen offset:0 sc0 sc1
    buffer_store_dwordx4 v[232:235], v238, s[24:27], s28 offen offset:1024 sc0 sc1
    s_nop 1
    ds_read_b64_tr_b16 v[220:221], v245 offset:4096
    ds_read_b64_tr_b16 v[222:223], v245 offset:6144
    ds_read_b64_tr_b16 v[224:225], v246 offset:4096
    ds_read_b64_tr_b16 v[226:227], v246 offset:6144
    ds_read_b64_tr_b16 v[228:229], v247 offset:4096
    ds_read_b64_tr_b16 v[230:231], v247 offset:6144
    ds_read_b64_tr_b16 v[232:233], v248 offset:4096
    ds_read_b64_tr_b16 v[234:235], v248 offset:6144
    s_add_u32 s24, s92, 0x7400000
    s_addc_u32 s25, s93, 0
    s_mov_b32 s26, 0x1c0000
    s_mov_b32 s27, 0x00020000
    s_xor_b32 s4, s2, 0
    s_cmp_ge_u32 s4, 112
    s_cselect_b32 s26, 0, s26
    s_mul_i32 s29, s94, 458752
    s_lshl_b32 s3, s4, 11
    s_add_u32 s29, s29, s3
    s_add_u32 s28, s29, 229376
    s_waitcnt lgkmcnt(0)
    buffer_store_dwordx4 v[220:223], v238, s[24:27], s29 offen offset:0 sc0 sc1
    buffer_store_dwordx4 v[224:227], v238, s[24:27], s29 offen offset:1024 sc0 sc1
    buffer_store_dwordx4 v[228:231], v238, s[24:27], s28 offen offset:0 sc0 sc1
    buffer_store_dwordx4 v[232:235], v238, s[24:27], s28 offen offset:1024 sc0 sc1
    s_nop 1
    v_lshrrev_b32 v220, 7, v238
    v_mul_u32_u24 v220, 3584, v220
    v_and_b32 v221, 0x70, v238
    v_add_u32 v244, v220, v221
    s_lshl_b32 s28, s94, 13
    s_add_u32 s28, s28, 131072
    s_lshr_b32 s3, s2, 3
    s_mul_i32 s29, s3, 57344
    s_and_b32 s3, s2, 7
    s_lshl_b32 s3, s3, 1
    s_lshr_b32 s4, s94, 1
    s_add_u32 s30, s3, s4
    s_mul_i32 s3, s30, 224
    s_add_u32 s29, s29, s3
    s_and_b32 s3, s94, 1
    s_lshl_b32 s3, s3, 7
    s_add_u32 s29, s29, s3
    s_mov_b32 s24, s82
    s_mov_b32 s25, s83
    s_mov_b32 s26, 0x1c0000
    s_mov_b32 s27, 0x00020000
    s_add_u32 m0, s28, 0
    s_add_u32 s3, s29, 0
    buffer_load_dwordx4 v244, s[24:27], s3 offen lds
    s_add_u32 m0, s28, 1024
    s_add_u32 s3, s29, 28672
    buffer_load_dwordx4 v244, s[24:27], s3 offen lds
    s_mov_b32 s24, s84
    s_mov_b32 s25, s85
    s_mov_b32 s26, 0x1c0000
    s_mov_b32 s27, 0x00020000
    s_add_u32 m0, s28, 2048
    s_add_u32 s3, s29, 0
    buffer_load_dwordx4 v244, s[24:27], s3 offen lds
    s_add_u32 m0, s28, 3072
    s_add_u32 s3, s29, 28672
    buffer_load_dwordx4 v244, s[24:27], s3 offen lds
    v_lshrrev_b32 v224, 4, v238
    v_bfe_u32 v220, v224, 2, 2
    v_lshrrev_b32 v222, 5, v224
    v_lshl_add_u32 v223, v222, 2, v220
    v_lshlrev_b32 v223, 7, v223
    v_bfe_u32 v221, v224, 4, 1
    v_lshl_add_u32 v223, v221, 4, v223
    v_and_b32 v221, 1, v224
    v_lshl_add_u32 v223, v221, 3, v223
    v_bfe_u32 v221, v224, 1, 1
    v_lshl_add_u32 v223, v221, 11, v223
    v_add_u32 v245, s28, v223
    s_add_u32 s45, s45, 2048
    v_lshrrev_b32 v239, 1, v238
    v_and_b32 v239, 56, v239
    buffer_load_dwordx2 v[252:253], v239, s[64:67], s45 offen sc1
    s_branch hk_51r
hk_52:
    v_cmp_ne_u64 vcc, s[96:97], v[252:253]
    s_cbranch_vccnz spin_45
ok_44:
    ds_read_b64_tr_b16 v[220:221], v245 offset:0
    ds_read_b64_tr_b16 v[222:223], v245 offset:1024
    ds_read_b64_tr_b16 v[224:225], v245 offset:32
    ds_read_b64_tr_b16 v[226:227], v245 offset:1056
    ds_read_b64_tr_b16 v[228:229], v245 offset:64
    ds_read_b64_tr_b16 v[230:231], v245 offset:1088
    ds_read_b64_tr_b16 v[232:233], v245 offset:96
    ds_read_b64_tr_b16 v[234:235], v245 offset:1120
    s_add_u32 s24, s92, 0x7600000
    s_addc_u32 s25, s93, 0
    s_mov_b32 s26, 0x380000
    s_mov_b32 s27, 0x00020000
    s_mul_i32 s29, s30, 229376
    s_and_b32 s3, s94, 1
    s_lshl_b32 s4, s3, 10
    s_sub_u32 s4, 4096, s4
    s_lshr_b32 s5, s2, 3
    s_mul_i32 s4, s4, s5
    s_add_u32 s29, s29, s4
    s_lshl_b32 s4, s3, 17
    s_add_u32 s29, s29, s4
    s_lshl_b32 s3, s3, 30
    s_add_u32 s28, s29, s3
    s_waitcnt lgkmcnt(0)
    buffer_store_dwordx4 v[220:223], v238, s[24:27], s29 offen offset:0 sc0 sc1
    buffer_store_dwordx4 v[224:227], v238, s[24:27], s29 offen offset:1024 sc0 sc1
    buffer_store_dwordx4 v[228:231], v238, s[24:27], s29 offen offset:2048 sc0 sc1
    buffer_store_dwordx4 v[232:235], v238, s[24:27], s28 offen offset:3072 sc0 sc1
    s_nop 1
    s_lshl_b32 s3, s94, 11
    s_lshl_b32 s4, s2, 3
    s_add_u32 s3, s3, s4
    s_add_u32 s3, s3, 32768
    buffer_store_dwordx2 v[250:251], off, s[64:67], s3 sc0 sc1
    s_branch hk_52r
hk_53:
    s_lshl_b32 s3, s30, 9
    s_lshr_b32 s4, s2, 3
    s_lshl_b32 s4, s4, 4
    s_add_u32 s3, s3, s4
    s_and_b32 s4, s94, 1
    s_lshl_b32 s4, s4, 3
    s_add_u32 s3, s3, s4
    s_add_u32 s3, s3, 57344
    buffer_store_dwordx2 v[250:251], off, s[64:67], s3 sc0 sc1
    v_lshrrev_b32 v221, 4, v238
    s_bfe_u32 s42, s2, 0x30003
    s_and_b32 s3, s2, 7
    s_xor_b32 s3, s3, 7
    s_lshl_b32 s3, s3, 2
    s_lshr_b32 s4, s2, 6
    s_add_u32 s41, s3, s4
    v_lshrrev_b32 v224, 5, v221
    s_lshl_b32 s40, s94, 12
    v_add_u32 v244, s40, v238
    v_add_u32 v245, 0x10000, v244
    v_add_u32 v246, 0x20000, v244
    s_mul_i32 s43, s94, 131072
    s_mul_i32 s3, s42, 524288
    s_add_u32 s43, s43, s3
    s_mul_i32 s44, s41, 262144
    s_mul_i32 s3, s94, 65536
    s_add_u32 s44, s44, s3
    s_xor_b32 s5, s41, 0
    s_add_u32 s5, s5, 32
    s_sub_u32 s5, s5, s41
    s_mul_i32 s3, s5, 262144
    s_add_u32 s45, s44, s3
    v_and_b32 v225, 31, v221
    v_lshlrev_b32 v225, 10, v225
    v_lshl_add_u32 v247, v224, 4, v225
    s_and_b32 s3, s94, 1
    s_mul_i32 s3, s3, s5
    s_add_u32 s60, s3, s41
    s_lshr_b32 s3, s94, 1
    s_lshl_b32 s4, s42, 1
    s_add_u32 s61, s3, s4
    s_lshl_b32 s62, s60, 15
    s_lshl_b32 s3, s61, 6
    s_add_u32 s63, s62, s3
    s_lshl_b32 s3, s61, 11
    s_add_u32 s62, s62, s3
    s_lshl_b32 s39, s41, 12
    s_lshl_b32 s3, s94, 6
    s_add_u32 s39, s39, s3
    s_add_u32 s39, s39, 65536
    s_lshl_b32 s3, s5, 12
    s_add_u32 s38, s39, s3
    s_lshr_b32 s3, s42, 1
    s_lshl_b32 s36, s3, 11
    s_lshl_b32 s3, s94, 9
    s_add_u32 s36, s36, s3
    s_add_u32 s36, s36, 32768
    v_lshrrev_b32 v239, 1, v238
    v_and_b32 v239, 504, v239
    buffer_load_dwordx2 v[252:253], v239, s[64:67], s36 offen sc1
    s_branch hk_53r
hk_54:
    v_cmp_ne_u64 vcc, s[96:97], v[252:253]
    s_cbranch_vccnz spin_20
ok_19:
    s_lshl_b32 s3, s32, 19
    s_sub_u32 s3, s43, s3
    s_sub_u32 s3, s3, s40
    s_add_u32 s35, s3, 0x7002000
    s_add_u32 s43, s43, 24576
    s_lshr_b32 s3, s2, 3
    s_lshl_b32 s3, s3, 2
    s_add_u32 s3, s3, s94
    s_cmp_ge_u32 s3, 3
    s_cbranch_scc1 ct_46
    s_getpc_b64 s[4:5]
pc_47:
    s_add_u32 s4, s4, K2_fin-pc_47
    s_addc_u32 s5, s5, 0
    s_lshl_b32 s3, s3, 13
    v_lshl_add_u32 v220, v238, 3, s3
    global_load_dword v254, v220, s[4:5]
ct_46:
    s_branch hk_54r
K2_fin:
    s_waitcnt vmcnt(8)
    s_barrier
    ds_read_b128 a[192:195], v240 offset:32768
    ds_read_b128 a[196:199], v240 offset:33792
    ds_read_b128 a[200:203], v240 offset:34816
    ds_read_b128 a[204:207], v240 offset:35840
    ds_read_b128 a[208:211], v240 offset:36864
    ds_read_b128 a[212:215], v240 offset:37888
    ds_read_b128 a[216:219], v240 offset:38912
    ds_read_b128 a[220:223], v240 offset:39936
    s_cmp_lg_u32 s33, 7
    s_cbranch_scc1 K2_nf2
    s_waitcnt vmcnt(0)
    buffer_store_dwordx2 v[250:251], off, s[64:67], s58 sc0 sc1
K2_nf2:
    v_max3_f32 v220, v32, v33, v34
    v_max3_f32 v220, v220, v35, v36
    s_add_u32 m0, s52, 114688
    v_max3_f32 v220, v220, v37, v38
    buffer_load_dwordx4 v243, s[20:23], s49 offen offset:0 sc1 lds
    v_max3_f32 v220, v220, v39, v40
    v_max3_f32 v220, v220, v41, v42
    buffer_load_dwordx4 v243, s[20:23], s49 offen offset:1024 sc1 lds
    v_max3_f32 v220, v220, v43, v44
    buffer_load_dwordx4 v243, s[20:23], s49 offen offset:2048 sc1 lds
    v_max3_f32 v220, v220, v45, v46
    buffer_load_dwordx4 v243, s[20:23], s49 offen offset:3072 sc1 lds
    v_max_f32 v220, v220, v47
    v_max3_f32 v220, v220, v48, v49
    s_add_u32 m0, s40, 131072
    v_max3_f32 v220, v220, v50, v51
    buffer_load_dwordx4 v238, s[8:11], s43 offen offset:0 sc1 lds
    v_max3_f32 v220, v220, v52, v53
    v_max3_f32 v220, v220, v54, v55
    buffer_load_dwordx4 v238, s[8:11], s43 offen offset:1024 sc1 lds
    v_max3_f32 v220, v220, v56, v57
    buffer_load_dwordx4 v238, s[8:11], s43 offen offset:2048 sc1 lds
    v_max3_f32 v220, v220, v58, v59
    buffer_load_dwordx4 v238, s[8:11], s43 offen offset:3072 sc1 lds
    s_add_u32 s43, s43, 4096
    v_max3_f32 v220, v220, v60, v61
    v_max3_f32 v220, v220, v62, v63
    s_add_u32 m0, s40, 147456
    v_exp_f32 v220, v220
    buffer_load_dwordx4 v238, s[8:11], s43 offen offset:0 sc1 lds
    v_max_f32 v218, v214, v215
    v_mul_f32 v220, 0x42800000, v220
    buffer_load_dwordx4 v238, s[8:11], s43 offen offset:1024 sc1 lds
    v_max_f32 v218, v218, v220
    buffer_load_dwordx4 v238, s[8:11], s43 offen offset:2048 sc1 lds
    v_cmp_lt_f32 vcc, s53, v218
    buffer_load_dwordx4 v238, s[8:11], s43 offen offset:3072 sc1 lds
    s_add_u32 s43, s43, 4096
    s_cbranch_vccnz K2_rsf
K2_retf:
    s_lshl_b32 s3, s56, 1
    s_sub_u32 s3, s94, s3
    s_lshl_b32 s3, s3, 1
    s_add_u32 s3, s3, 57
    s_lshl_b32 s4, s3, 18
    s_add_u32 s57, s57, s4
    s_lshl_b32 s4, s3, 12
    s_add_u32 s58, s58, s4
    v_cmp_ne_u64 vcc, s[96:97], v[252:253]
    s_mov_b32 s37, 1
    s_cbranch_vccnz K2_FbN
    s_mov_b32 s37, 0
    s_waitcnt lgkmcnt(4)
    v_mfma_f32_32x32x16_bf16 a[0:15], a[192:195], v[128:131], a[0:15]
    ds_read_b128 a[224:227], v240 offset:40960
    ds_read_b128 a[228:231], v240 offset:41984
    v_exp_f32 v208, v32
    v_exp_f32 v209, v33
    v_exp_f32 v210, v34
    v_mfma_f32_32x32x16_bf16 a[16:31], a[196:199], v[128:131], a[16:31]
    ds_read_b128 a[232:235], v240 offset:43008
    buffer_load_dwordx4 a[64:67], v238, s[12:15], s44 offen offset:0 sc1
    v_add_f32 v214, v214, v208
    v_exp_f32 v211, v35
    v_mfma_f32_32x32x16_bf16 a[32:47], a[200:203], v[128:131], a[32:47]
    ds_read_b128 a[236:239], v240 offset:44032
    v_add_f32 v214, v214, v209
    v_cvt_pk_bf16_f32 v160, v208, v209
    v_exp_f32 v212, v36
    v_add_f32 v214, v214, v210
    v_mfma_f32_32x32x16_bf16 a[48:63], a[204:207], v[128:131], a[48:63]
    ds_read_b128 a[240:243], v240 offset:45056
    buffer_load_dwordx4 a[68:71], v238, s[12:15], s44 offen offset:1024 sc1
    v_exp_f32 v213, v37
    v_add_f32 v214, v214, v211
    s_waitcnt lgkmcnt(5)
    v_mfma_f32_32x32x16_bf16 a[0:15], a[208:211], v[132:135], a[0:15]
    ds_read_b128 a[244:247], v240 offset:46080
    v_cvt_pk_bf16_f32 v161, v210, v211
    v_exp_f32 v208, v38
    v_add_f32 v214, v214, v212
    v_exp_f32 v209, v39
    v_mfma_f32_32x32x16_bf16 a[16:31], a[212:215], v[132:135], a[16:31]
    ds_read_b128 a[248:251], v240 offset:47104
    ds_read_b128 a[252:255], v240 offset:48128
    v_add_f32 v214, v214, v213
    v_cvt_pk_bf16_f32 v162, v212, v213
    v_exp_f32 v210, v40
    v_add_f32 v214, v214, v208
    v_mfma_f32_32x32x16_bf16 a[32:47], a[216:219], v[132:135], a[32:47]
    ds_read_b128 a[192:195], v240 offset:49152
    buffer_load_dwordx4 a[72:75], v238, s[12:15], s44 offen offset:2048 sc1
    v_exp_f32 v211, v41
    v_add_f32 v214, v214, v209
    v_cvt_pk_bf16_f32 v163, v208, v209
    v_mfma_f32_32x32x16_bf16 a[48:63], a[220:223], v[132:135], a[48:63]
    ds_read_b128 a[196:199], v240 offset:50176
    v_exp_f32 v212, v42
    v_add_f32 v214, v214, v210
    v_exp_f32 v213, v43
    s_waitcnt lgkmcnt(6)
    v_mfma_f32_32x32x16_bf16 a[0:15], a[224:227], v[136:139], a[0:15]
    ds_read_b128 a[200:203], v240 offset:51200
    buffer_load_dwordx4 a[76:79], v238, s[12:15], s44 offen offset:3072 sc1
    s_add_u32 s44, s44, 4096
    v_add_f32 v214, v214, v211
    v_cvt_pk_bf16_f32 v164, v210, v211
    v_mfma_f32_32x32x16_bf16 a[16:31], a[228:231], v[136:139], a[16:31]
    ds_read_b128 a[204:207], v240 offset:52224
    v_exp_f32 v208, v44
    v_add_f32 v214, v214, v212
    v_exp_f32 v209, v45
    v_add_f32 v214, v214, v213
    v_mfma_f32_32x32x16_bf16 a[32:47], a[232:235], v[136:139], a[32:47]
    ds_read_b128 a[208:211], v240 offset:53248
    ds_read_b128 a[212:215], v240 offset:54272
    v_cvt_pk_bf16_f32 v165, v212, v213
    v_exp_f32 v210, v46
    v_add_f32 v214, v214, v208
    v_exp_f32 v211, v47
    v_mfma_f32_32x32x16_bf16 a[48:63], a[236:239], v[136:139], a[48:63]
    ds_read_b128 a[216:219], v240 offset:55296
    v_add_f32 v214, v214, v209
    v_cvt_pk_bf16_f32 v166, v208, v209
    v_exp_f32 v212, v48
    s_waitcnt lgkmcnt(7)
    v_mfma_f32_32x32x16_bf16 a[0:15], a[240:243], v[140:143], a[0:15]
    ds_read_b128 a[220:223], v240 offset:56320
    buffer_load_dwordx4 a[80:83], v238, s[12:15], s44 offen offset:0 sc1
    v_add_f32 v214, v214, v210
    v_exp_f32 v213, v49
    v_add_f32 v214, v214, v211
    v_mfma_f32_32x32x16_bf16 a[16:31], a[244:247], v[140:143], a[16:31]
    ds_read_b128 a[224:227], v240 offset:57344
    buffer_load_dwordx4 a[84:87], v238, s[12:15], s44 offen offset:1024 sc1
    v_cvt_pk_bf16_f32 v167, v210, v211
    v_exp_f32 v208, v50
    v_mfma_f32_32x32x16_bf16 a[32:47], a[248:251], v[140:143], a[32:47]
    ds_read_b128 a[228:231], v240 offset:58368
    v_add_f32 v215, v215, v212
    v_exp_f32 v209, v51
    v_add_f32 v215, v215, v213
    v_cvt_pk_bf16_f32 v168, v212, v213
    v_exp_f32 v210, v52
    v_mfma_f32_32x32x16_bf16 a[48:63], a[252:255], v[140:143], a[48:63]
    ds_read_b128 a[232:235], v240 offset:59392
    ds_read_b128 a[236:239], v240 offset:60416
    v_add_f32 v215, v215, v208
    v_exp_f32 v211, v53
    v_add_f32 v215, v215, v209
    v_cvt_pk_bf16_f32 v169, v208, v209
    s_waitcnt lgkmcnt(8)
    v_mfma_f32_32x32x16_bf16 a[0:15], a[192:195], v[160:163], a[0:15]
    ds_read_b128 a[240:243], v240 offset:61440
    buffer_load_dwordx4 a[88:91], v238, s[12:15], s44 offen offset:2048 sc1
    v_exp_f32 v212, v54
    v_add_f32 v215, v215, v210
    v_exp_f32 v213, v55
    v_mfma_f32_32x32x16_bf16 a[16:31], a[196:199], v[160:163], a[16:31]
    ds_read_b128 a[244:247], v240 offset:62464
    v_add_f32 v215, v215, v211
    v_cvt_pk_bf16_f32 v170, v210, v211
    v_exp_f32 v208, v56
    v_add_f32 v215, v215, v212
    v_exp_f32 v209, v57
    v_mfma_f32_32x32x16_bf16 a[32:47], a[200:203], v[160:163], a[32:47]
    ds_read_b128 a[248:251], v240 offset:63488
    buffer_load_dwordx4 a[92:95], v238, s[12:15], s44 offen offset:3072 sc1
    s_add_u32 s44, s44, 4096
    v_add_f32 v215, v215, v213
    v_cvt_pk_bf16_f32 v171, v212, v213
    v_exp_f32 v210, v58
    v_mfma_f32_32x32x16_bf16 a[48:63], a[204:207], v[160:163], a[48:63]
    ds_read_b128 a[252:255], v240 offset:64512
    v_add_f32 v215, v215, v208
    v_exp_f32 v211, v59
    v_add_f32 v215, v215, v209
    v_cvt_pk_bf16_f32 v172, v208, v209
    s_waitcnt lgkmcnt(8)
    v_mfma_f32_32x32x16_bf16 a[0:15], a[208:211], v[164:167], a[0:15]
    buffer_load_dwordx4 a[96:99], v238, s[12:15], s44 offen offset:0 sc1
    v_exp_f32 v212, v60
    v_add_f32 v215, v215, v210
    v_exp_f32 v213, v61
    v_add_f32 v215, v215, v211
    v_mfma_f32_32x32x16_bf16 a[16:31], a[212:215], v[164:167], a[16:31]
    buffer_load_dwordx4 a[100:103], v238, s[12:15], s44 offen offset:1024 sc1
    v_cvt_pk_bf16_f32 v173, v210, v211
    v_exp_f32 v208, v62
    v_add_f32 v215, v215, v212
    v_exp_f32 v209, v63
    v_mfma_f32_32x32x16_bf16 a[32:47], a[216:219], v[164:167], a[32:47]
    buffer_load_dwordx4 a[104:107], v238, s[12:15], s44 offen offset:2048 sc1
    v_add_f32 v215, v215, v213
    v_cvt_pk_bf16_f32 v174, v212, v213
    v_add_f32 v215, v215, v208
    v_cvt_pk_bf16_f32 v175, v208, v209
    v_add_f32 v215, v215, v209
    v_mfma_f32_32x32x16_bf16 a[48:63], a[220:223], v[164:167], a[48:63]
    s_waitcnt vmcnt(63) lgkmcnt(0)
    s_barrier
    v_mfma_f32_32x32x16_bf16 a[0:15], a[224:227], v[168:171], a[0:15]
    buffer_load_dwordx4 a[108:111], v238, s[12:15], s44 offen offset:3072 sc1
    s_add_u32 s44, s44, 4096
    v_mfma_f32_32x32x16_bf16 a[16:31], a[228:231], v[168:171], a[16:31]
    v_add_f32 v216, v216, v214
    v_add_f32 v216, v216, v215
    v_mfma_f32_32x32x16_bf16 a[32:47], a[232:235], v[168:171], a[32:47]
    buffer_load_dwordx4 a[112:115], v238, s[12:15], s44 offen offset:0 sc1
    v_mfma_f32_32x32x16_bf16 a[48:63], a[236:239], v[168:171], a[48:63]
    buffer_load_dwordx4 a[116:119], v238, s[12:15], s44 offen offset:1024 sc1
    v_mfma_f32_32x32x16_bf16 a[0:15], a[240:243], v[172:175], a[0:15]
    buffer_load_dwordx4 a[120:123], v238, s[12:15], s44 offen offset:2048 sc1
    v_mfma_f32_32x32x16_bf16 a[16:31], a[244:247], v[172:175], a[16:31]
    buffer_load_dwordx4 a[124:127], v238, s[12:15], s44 offen offset:3072 sc1
    s_add_u32 s44, s44, 4096
    v_mfma_f32_32x32x16_bf16 a[32:47], a[248:251], v[172:175], a[32:47]
    v_mfma_f32_32x32x16_bf16 a[48:63], a[252:255], v[172:175], a[48:63]
K2_Fe:
    s_nop 7
    s_nop 3
    v_mov_b32 v220, v216
    s_nop 1
    v_permlane32_swap_b32 v216, v220
    s_nop 1
    v_add_f32 v216, v216, v220
    v_rcp_f32 v236, v216
    s_add_u32 s4, s57, 4096
    v_accvgpr_read_b32 v220, a0
    v_accvgpr_read_b32 v221, a1
    v_accvgpr_read_b32 v222, a2
    v_accvgpr_read_b32 v223, a3
    v_accvgpr_read_b32 v224, a4
    v_accvgpr_read_b32 v225, a5
    v_accvgpr_read_b32 v226, a6
    v_accvgpr_read_b32 v227, a7
    v_pk_mul_f32 v[220:221], v[220:221], v[236:237] op_sel_hi:[1,0]
    v_pk_mul_f32 v[222:223], v[222:223], v[236:237] op_sel_hi:[1,0]
    v_pk_mul_f32 v[224:225], v[224:225], v[236:237] op_sel_hi:[1,0]
    v_pk_mul_f32 v[226:227], v[226:227], v[236:237] op_sel_hi:[1,0]
    v_cvt_pk_bf16_f32 v220, v220, v221
    v_cvt_pk_bf16_f32 v221, v222, v223
    v_cvt_pk_bf16_f32 v222, v224, v225
    v_cvt_pk_bf16_f32 v223, v226, v227
    buffer_store_dwordx4 v[220:223], v238, s[12:15], s57 offen offset:0 sc0 sc1
    v_accvgpr_read_b32 v228, a8
    v_accvgpr_read_b32 v229, a9
    v_accvgpr_read_b32 v230, a10
    v_accvgpr_read_b32 v231, a11
    v_accvgpr_read_b32 v232, a12
    v_accvgpr_read_b32 v233, a13
    v_accvgpr_read_b32 v234, a14
    v_accvgpr_read_b32 v235, a15
    v_pk_mul_f32 v[228:229], v[228:229], v[236:237] op_sel_hi:[1,0]
    v_pk_mul_f32 v[230:231], v[230:231], v[236:237] op_sel_hi:[1,0]
    v_pk_mul_f32 v[232:233], v[232:233], v[236:237] op_sel_hi:[1,0]
    v_pk_mul_f32 v[234:235], v[234:235], v[236:237] op_sel_hi:[1,0]
    v_cvt_pk_bf16_f32 v228, v228, v229
    v_cvt_pk_bf16_f32 v229, v230, v231
    v_cvt_pk_bf16_f32 v230, v232, v233
    v_cvt_pk_bf16_f32 v231, v234, v235
    buffer_store_dwordx4 v[228:231], v238, s[12:15], s57 offen offset:1024 sc0 sc1
    v_accvgpr_read_b32 v220, a16
    v_accvgpr_read_b32 v221, a17
    v_accvgpr_read_b32 v222, a18
    v_accvgpr_read_b32 v223, a19
    v_accvgpr_read_b32 v224, a20
    v_accvgpr_read_b32 v225, a21
    v_accvgpr_read_b32 v226, a22
    v_accvgpr_read_b32 v227, a23
    v_pk_mul_f32 v[220:221], v[220:221], v[236:237] op_sel_hi:[1,0]
    v_pk_mul_f32 v[222:223], v[222:223], v[236:237] op_sel_hi:[1,0]
    v_pk_mul_f32 v[224:225], v[224:225], v[236:237] op_sel_hi:[1,0]
    v_pk_mul_f32 v[226:227], v[226:227], v[236:237] op_sel_hi:[1,0]
    v_cvt_pk_bf16_f32 v220, v220, v221
    v_cvt_pk_bf16_f32 v221, v222, v223
    v_cvt_pk_bf16_f32 v222, v224, v225
    v_cvt_pk_bf16_f32 v223, v226, v227
    buffer_store_dwordx4 v[220:223], v238, s[12:15], s57 offen offset:2048 sc0 sc1
    v_accvgpr_read_b32 v228, a24
    v_accvgpr_read_b32 v229, a25
    v_accvgpr_read_b32 v230, a26
    v_accvgpr_read_b32 v231, a27
    v_accvgpr_read_b32 v232, a28
    v_accvgpr_read_b32 v233, a29
    v_accvgpr_read_b32 v234, a30
    v_accvgpr_read_b32 v235, a31
    v_pk_mul_f32 v[228:229], v[228:229], v[236:237] op_sel_hi:[1,0]
    v_pk_mul_f32 v[230:231], v[230:231], v[236:237] op_sel_hi:[1,0]
    v_pk_mul_f32 v[232:233], v[232:233], v[236:237] op_sel_hi:[1,0]
    v_pk_mul_f32 v[234:235], v[234:235], v[236:237] op_sel_hi:[1,0]
    v_cvt_pk_bf16_f32 v228, v228, v229
    v_cvt_pk_bf16_f32 v229, v230, v231
    v_cvt_pk_bf16_f32 v230, v232, v233
    v_cvt_pk_bf16_f32 v231, v234, v235
    buffer_store_dwordx4 v[228:231], v238, s[12:15], s57 offen offset:3072 sc0 sc1
    v_accvgpr_read_b32 v220, a32
    v_accvgpr_read_b32 v221, a33
    v_accvgpr_read_b32 v222, a34
    v_accvgpr_read_b32 v223, a35
    v_accvgpr_read_b32 v224, a36
    v_accvgpr_read_b32 v225, a37
    v_accvgpr_read_b32 v226, a38
    v_accvgpr_read_b32 v227, a39
    v_pk_mul_f32 v[220:221], v[220:221], v[236:237] op_sel_hi:[1,0]
    v_pk_mul_f32 v[222:223], v[222:223], v[236:237] op_sel_hi:[1,0]
    v_pk_mul_f32 v[224:225], v[224:225], v[236:237] op_sel_hi:[1,0]
    v_pk_mul_f32 v[226:227], v[226:227], v[236:237] op_sel_hi:[1,0]
    v_cvt_pk_bf16_f32 v220, v220, v221
    v_cvt_pk_bf16_f32 v221, v222, v223
    v_cvt_pk_bf16_f32 v222, v224, v225
    v_cvt_pk_bf16_f32 v223, v226, v227
    buffer_store_dwordx4 v[220:223], v238, s[12:15], s4 offen offset:0 sc0 sc1
    v_accvgpr_read_b32 v228, a40
    v_accvgpr_read_b32 v229, a41
    v_accvgpr_read_b32 v230, a42
    v_accvgpr_read_b32 v231, a43
    v_accvgpr_read_b32 v232, a44
    v_accvgpr_read_b32 v233, a45
    v_accvgpr_read_b32 v234, a46
    v_accvgpr_read_b32 v235, a47
    v_pk_mul_f32 v[228:229], v[228:229], v[236:237] op_sel_hi:[1,0]
    v_pk_mul_f32 v[230:231], v[230:231], v[236:237] op_sel_hi:[1,0]
    v_pk_mul_f32 v[232:233], v[232:233], v[236:237] op_sel_hi:[1,0]
    v_pk_mul_f32 v[234:235], v[234:235], v[236:237] op_sel_hi:[1,0]
    v_cvt_pk_bf16_f32 v228, v228, v229
    v_cvt_pk_bf16_f32 v229, v230, v231
    v_cvt_pk_bf16_f32 v230, v232, v233
    v_cvt_pk_bf16_f32 v231, v234, v235
    buffer_store_dwordx4 v[228:231], v238, s[12:15], s4 offen offset:1024 sc0 sc1
    v_accvgpr_read_b32 v220, a48
    v_accvgpr_read_b32 v221, a49
    v_accvgpr_read_b32 v222, a50
    v_accvgpr_read_b32 v223, a51
    v_accvgpr_read_b32 v224, a52
    v_accvgpr_read_b32 v225, a53
    v_accvgpr_read_b32 v226, a54
    v_accvgpr_read_b32 v227, a55
    v_pk_mul_f32 v[220:221], v[220:221], v[236:237] op_sel_hi:[1,0]
    v_pk_mul_f32 v[222:223], v[222:223], v[236:237] op_sel_hi:[1,0]
    v_pk_mul_f32 v[224:225], v[224:225], v[236:237] op_sel_hi:[1,0]
    v_pk_mul_f32 v[226:227], v[226:227], v[236:237] op_sel_hi:[1,0]
    v_cvt_pk_bf16_f32 v220, v220, v221
    v_cvt_pk_bf16_f32 v221, v222, v223
    v_cvt_pk_bf16_f32 v222, v224, v225
    v_cvt_pk_bf16_f32 v223, v226, v227
    buffer_store_dwordx4 v[220:223], v238, s[12:15], s4 offen offset:2048 sc0 sc1
    v_accvgpr_read_b32 v228, a56
    v_accvgpr_read_b32 v229, a57
    v_accvgpr_read_b32 v230, a58
    v_accvgpr_read_b32 v231, a59
    v_accvgpr_read_b32 v232, a60
    v_accvgpr_read_b32 v233, a61
    v_accvgpr_read_b32 v234, a62
    v_accvgpr_read_b32 v235, a63
    v_pk_mul_f32 v[228:229], v[228:229], v[236:237] op_sel_hi:[1,0]
    v_pk_mul_f32 v[230:231], v[230:231], v[236:237] op_sel_hi:[1,0]
    v_pk_mul_f32 v[232:233], v[232:233], v[236:237] op_sel_hi:[1,0]
    v_pk_mul_f32 v[234:235], v[234:235], v[236:237] op_sel_hi:[1,0]
    v_cvt_pk_bf16_f32 v228, v228, v229
    v_cvt_pk_bf16_f32 v229, v230, v231
    v_cvt_pk_bf16_f32 v230, v232, v233
    v_cvt_pk_bf16_f32 v231, v234, v235
    buffer_store_dwordx4 v[228:231], v238, s[12:15], s4 offen offset:3072 sc0 sc1
    s_add_u32 m0, s40, 32768
    s_nop 0
    buffer_load_dwordx4 v238, s[8:11], s43 offen offset:0 sc1 lds
    buffer_load_dwordx4 v238, s[8:11], s43 offen offset:1024 sc1 lds
    buffer_load_dwordx4 v238, s[8:11], s43 offen offset:2048 sc1 lds
    buffer_load_dwordx4 v238, s[8:11], s43 offen offset:3072 sc1 lds
    s_add_u32 s43, s43, 4096
    s_cmp_eq_u32 s37, 1
    s_cbranch_scc1 K3_y
    buffer_load_dwordx4 a[128:131], v238, s[12:15], s44 offen offset:0 sc1
    buffer_load_dwordx4 a[132:135], v238, s[12:15], s44 offen offset:1024 sc1
    buffer_load_dwordx4 a[136:139], v238, s[12:15], s44 offen offset:2048 sc1
    buffer_load_dwordx4 a[140:143], v238, s[12:15], s44 offen offset:3072 sc1
    s_add_u32 s44, s44, 4096
    buffer_load_dwordx4 a[144:147], v238, s[12:15], s44 offen offset:0 sc1
    buffer_load_dwordx4 a[148:151], v238, s[12:15], s44 offen offset:1024 sc1
    buffer_load_dwordx4 a[152:155], v238, s[12:15], s44 offen offset:2048 sc1
    buffer_load_dwordx4 a[156:159], v238, s[12:15], s44 offen offset:3072 sc1
    s_add_u32 s44, s44, 4096
    s_waitcnt vmcnt(12)
    buffer_store_dwordx2 v[250:251], off, s[64:67], s58 sc0 sc1
    s_branch K3_z
K3_y:
    s_waitcnt vmcnt(4)
    buffer_store_dwordx2 v[250:251], off, s[64:67], s58 sc0 sc1
    v_lshrrev_b32 v239, 1, v238
    v_and_b32 v239, 56, v239
    buffer_load_dwordx2 v[252:253], v239, s[64:67], s39 offen sc1
    s_waitcnt vmcnt(0)
    v_cmp_ne_u64 vcc, s[96:97], v[252:253]
    s_cbranch_vccnz spin_22
ok_21:
    buffer_load_dwordx4 a[64:67], v238, s[12:15], s44 offen offset:0 sc1
    buffer_load_dwordx4 a[68:71], v238, s[12:15], s44 offen offset:1024 sc1
    buffer_load_dwordx4 a[72:75], v238, s[12:15], s44 offen offset:2048 sc1
    buffer_load_dwordx4 a[76:79], v238, s[12:15], s44 offen offset:3072 sc1
    s_add_u32 s44, s44, 4096
    buffer_load_dwordx4 a[80:83], v238, s[12:15], s44 offen offset:0 sc1
    buffer_load_dwordx4 a[84:87], v238, s[12:15], s44 offen offset:1024 sc1
    buffer_load_dwordx4 a[88:91], v238, s[12:15], s44 offen offset:2048 sc1
    buffer_load_dwordx4 a[92:95], v238, s[12:15], s44 offen offset:3072 sc1
    s_add_u32 s44, s44, 4096
    buffer_load_dwordx4 a[96:99], v238, s[12:15], s44 offen offset:0 sc1
    buffer_load_dwordx4 a[100:103], v238, s[12:15], s44 offen offset:1024 sc1
    buffer_load_dwordx4 a[104:107], v238, s[12:15], s44 offen offset:2048 sc1
    buffer_load_dwordx4 a[108:111], v238, s[12:15], s44 offen offset:3072 sc1
    s_add_u32 s44, s44, 4096
    buffer_load_dwordx4 a[112:115], v238, s[12:15], s44 offen offset:0 sc1
    buffer_load_dwordx4 a[116:119], v238, s[12:15], s44 offen offset:1024 sc1
    buffer_load_dwordx4 a[120:123], v238, s[12:15], s44 offen offset:2048 sc1
    buffer_load_dwordx4 a[124:127], v238, s[12:15], s44 offen offset:3072 sc1
    s_add_u32 s44, s44, 4096
    buffer_load_dwordx4 a[128:131], v238, s[12:15], s44 offen offset:0 sc1
    buffer_load_dwordx4 a[132:135], v238, s[12:15], s44 offen offset:1024 sc1
    buffer_load_dwordx4 a[136:139], v238, s[12:15], s44 offen offset:2048 sc1
    buffer_load_dwordx4 a[140:143], v238, s[12:15], s44 offen offset:3072 sc1
    s_add_u32 s44, s44, 4096
    buffer_load_dwordx4 a[144:147], v238, s[12:15], s44 offen offset:0 sc1
    buffer_load_dwordx4 a[148:151], v238, s[12:15], s44 offen offset:1024 sc1
    buffer_load_dwordx4 a[152:155], v238, s[12:15], s44 offen offset:2048 sc1
    buffer_load_dwordx4 a[156:159], v238, s[12:15], s44 offen offset:3072 sc1
    s_add_u32 s44, s44, 4096
K3_z:
    buffer_load_dwordx4 a[160:163], v238, s[12:15], s44 offen offset:0 sc1
    buffer_load_dwordx4 a[164:167], v238, s[12:15], s44 offen offset:1024 sc1
    buffer_load_dwordx4 a[168:171], v238, s[12:15], s44 offen offset:2048 sc1
    buffer_load_dwordx4 a[172:175], v238, s[12:15], s44 offen offset:3072 sc1
    s_add_u32 s44, s44, 4096
    buffer_load_dwordx4 a[176:179], v238, s[12:15], s44 offen offset:0 sc1
    buffer_load_dwordx4 a[180:183], v238, s[12:15], s44 offen offset:1024 sc1
    buffer_load_dwordx4 a[184:187], v238, s[12:15], s44 offen offset:2048 sc1
    buffer_load_dwordx4 a[188:191], v238, s[12:15], s44 offen offset:3072 sc1
    s_add_u32 s44, s44, 4096
    buffer_load_dwordx4 a[192:195], v238, s[12:15], s44 offen offset:0 sc1
    buffer_load_dwordx4 a[196:199], v238, s[12:15], s44 offen offset:1024 sc1
    buffer_load_dwordx4 a[200:203], v238, s[12:15], s44 offen offset:2048 sc1
    buffer_load_dwordx4 a[204:207], v238, s[12:15], s44 offen offset:3072 sc1
    s_add_u32 s44, s44, 4096
    buffer_load_dwordx4 a[208:211], v238, s[12:15], s44 offen offset:0 sc1
    buffer_load_dwordx4 a[212:215], v238, s[12:15], s44 offen offset:1024 sc1
    buffer_load_dwordx4 a[216:219], v238, s[12:15], s44 offen offset:2048 sc1
    buffer_load_dwordx4 a[220:223], v238, s[12:15], s44 offen offset:3072 sc1
    s_add_u32 s44, s44, 4096
    buffer_load_dwordx4 a[224:227], v238, s[12:15], s44 offen offset:0 sc1
    buffer_load_dwordx4 a[228:231], v238, s[12:15], s44 offen offset:1024 sc1
    buffer_load_dwordx4 a[232:235], v238, s[12:15], s44 offen offset:2048 sc1
    buffer_load_dwordx4 a[236:239], v238, s[12:15], s44 offen offset:3072 sc1
    s_add_u32 s44, s44, 4096
    buffer_load_dwordx4 a[240:243], v238, s[12:15], s44 offen offset:0 sc1
    buffer_load_dwordx4 a[244:247], v238, s[12:15], s44 offen offset:1024 sc1
    buffer_load_dwordx4 a[248:251], v238, s[12:15], s44 offen offset:2048 sc1
    buffer_load_dwordx4 a[252:255], v238, s[12:15], s44 offen offset:3072 sc1
    s_add_u32 s44, s44, 4096
    buffer_load_dwordx4 a[0:3], v238, s[12:15], s44 offen offset:0 sc1
    buffer_load_dwordx4 a[4:7], v238, s[12:15], s44 offen offset:1024 sc1
    buffer_load_dwordx4 a[8:11], v238, s[12:15], s44 offen offset:2048 sc1
    buffer_load_dwordx4 a[12:15], v238, s[12:15], s44 offen offset:3072 sc1
    s_add_u32 s44, s44, 4096
    buffer_load_dwordx4 a[16:19], v238, s[12:15], s44 offen offset:0 sc1
    buffer_load_dwordx4 a[20:23], v238, s[12:15], s44 offen offset:1024 sc1
    s_lshr_b32 s3, s2, 3
    s_lshl_b32 s3, s3, 2
    s_add_u32 s3, s3, s94
    s_cmp_ge_u32 s3, 2
    s_cbranch_scc1 ct_23
    s_getpc_b64 s[4:5]
pc_24:
    s_add_u32 s4, s4, K4_code-pc_24
    s_addc_u32 s5, s5, 0
    s_lshl_b32 s3, s3, 13
    v_lshl_add_u32 v220, v238, 3, s3
    global_load_dword v254, v220, s[4:5]
ct_23:
    v_lshrrev_b32 v96, 7, v238
    v_bfe_u32 v97, v238, 4, 3
    s_mul_i32 s3, s2, 1171
    s_lshr_b32 s3, s3, 16
    s_mul_i32 s4, s3, 56
    s_sub_u32 s4, s2, s4
    s_cmp_ge_u32 s4, 28
    s_cselect_b32 s28, s84, s82
    s_cselect_b32 s29, s85, s83
    s_cselect_b32 s5, 28, 0
    s_mov_b32 s30, 1835008
    s_mov_b32 s31, 0x00020000
    s_sub_u32 s5, s4, s5
    s_lshl_b32 s5, s5, 7
    s_lshl_b32 s3, s3, 2
    s_add_u32 s3, s3, s94
    s_mul_i32 s6, s3, 114688
    s_add_u32 s5, s5, s6
    s_mul_i32 s37, s3, 14336
    s_lshl_b32 s4, s4, 8
    s_add_u32 s37, s37, s4
    v_mul_u32_u24 v96, 3584, v96
    v_lshl_add_u32 v96, v97, 4, v96
    buffer_load_dwordx4 v[192:195], v96, s[28:31], s5 offen
    s_add_u32 s5, s5, 28672
    buffer_load_dwordx4 v[196:199], v96, s[28:31], s5 offen
    s_add_u32 s5, s5, 28672
    buffer_load_dwordx4 v[200:203], v96, s[28:31], s5 offen
    s_add_u32 s5, s5, 28672
    buffer_load_dwordx4 v[204:207], v96, s[28:31], s5 offen
    s_add_u32 s5, s5, 28672
    s_mov_b32 s16, s68
    s_mov_b32 s17, s69
    s_mov_b32 s18, 0x200000
    s_mov_b32 s19, 0x00020000
    s_add_u32 s20, s92, 0x5000000
    s_addc_u32 s21, s93, 0
    s_mov_b32 s22, 0x200000
    s_mov_b32 s23, 0x00020000
    s_add_u32 s24, s92, 0x5200000
    s_addc_u32 s25, s93, 0
    s_mov_b32 s26, 0x40000
    s_mov_b32 s27, 0x00020000
    s_add_u32 s32, s92, 0x5300000
    s_addc_u32 s33, s93, 0
    s_mov_b32 s34, 0x38000
    s_mov_b32 s35, 0x00020000
    buffer_load_dwordx4 v[108:111], v247, s[16:19], s63 offen
    buffer_load_dwordx4 v[112:115], v247, s[16:19], s63 offen offset:32
    v_lshrrev_b32 v239, 1, v238
    v_and_b32 v239, 56, v239
    buffer_load_dwordx2 v[252:253], v239, s[64:67], s38 offen sc1
    buffer_load_dwordx4 a[24:27], v238, s[12:15], s44 offen offset:2048 sc1
    buffer_load_dwordx4 a[28:31], v238, s[12:15], s44 offen offset:3072 sc1
    s_add_u32 s44, s44, 4096
    buffer_load_dwordx4 a[32:35], v238, s[12:15], s44 offen offset:0 sc1
    buffer_load_dwordx4 a[36:39], v238, s[12:15], s44 offen offset:1024 sc1
    buffer_load_dwordx4 a[40:43], v238, s[12:15], s44 offen offset:2048 sc1
    buffer_load_dwordx4 a[44:47], v238, s[12:15], s44 offen offset:3072 sc1
    s_add_u32 s44, s44, 4096
    buffer_load_dwordx4 a[48:51], v238, s[12:15], s44 offen offset:0 sc1
    buffer_load_dwordx4 a[52:55], v238, s[12:15], s44 offen offset:1024 sc1
    buffer_load_dwordx4 a[56:59], v238, s[12:15], s44 offen offset:2048 sc1
    buffer_load_dwordx4 a[60:63], v238, s[12:15], s44 offen offset:3072 sc1
    s_add_u32 s44, s44, 4096
    s_waitcnt vmcnt(10)
    v_cmp_ne_u64 vcc, s[96:97], v[252:253]
    s_cbranch_vccnz spin_26
ok_25:
    buffer_load_dwordx4 v[128:131], v238, s[12:15], s45 offen offset:0 sc1
    buffer_load_dwordx4 v[132:135], v238, s[12:15], s45 offen offset:1024 sc1
    buffer_load_dwordx4 v[136:139], v238, s[12:15], s45 offen offset:2048 sc1
    buffer_load_dwordx4 v[140:143], v238, s[12:15], s45 offen offset:3072 sc1
    s_add_u32 s45, s45, 4096
    buffer_load_dwordx4 v[144:147], v238, s[12:15], s45 offen offset:0 sc1
    buffer_load_dwordx4 v[148:151], v238, s[12:15], s45 offen offset:1024 sc1
    s_waitcnt vmcnt(63)
    ds_read_b128 v[64:67], v244 offset:0
    ds_read_b128 v[68:71], v244 offset:1024
    ds_read_b128 v[72:75], v244 offset:2048
    ds_read_b128 v[76:79], v244 offset:3072
    s_waitcnt vmcnt(4) lgkmcnt(0)
    v_mfma_f32_32x32x16_bf16 v[0:15], v[64:67], a[64:67], 0
    ds_read_b128 v[80:83], v244 offset:16384
    buffer_load_dwordx4 v[152:155], v238, s[12:15], s45 offen offset:2048 sc1
    v_mfma_f32_32x32x16_bf16 v[16:31], v[64:67], v[128:131], 0
    ds_read_b128 v[84:87], v244 offset:17408
    buffer_load_dwordx4 v[156:159], v238, s[12:15], s45 offen offset:3072 sc1
    s_add_u32 s45, s45, 4096
    v_mfma_f32_32x32x16_bf16 v[32:47], v[68:71], a[64:67], 0
    ds_read_b128 v[88:91], v244 offset:18432
    buffer_load_dwordx4 v[160:163], v238, s[12:15], s45 offen offset:0 sc1
    v_mfma_f32_32x32x16_bf16 v[48:63], v[68:71], v[128:131], 0
    ds_read_b128 v[92:95], v244 offset:19456
    buffer_load_dwordx4 v[164:167], v238, s[12:15], s45 offen offset:1024 sc1
    v_mfma_f32_32x32x16_bf16 v[0:15], v[72:75], a[68:71], v[0:15]
    buffer_load_dwordx4 v[168:171], v238, s[12:15], s45 offen offset:2048 sc1
    v_mfma_f32_32x32x16_bf16 v[16:31], v[72:75], v[132:135], v[16:31]
    v_mfma_f32_32x32x16_bf16 v[32:47], v[76:79], a[68:71], v[32:47]
    v_mfma_f32_32x32x16_bf16 v[48:63], v[76:79], v[132:135], v[48:63]
    s_waitcnt vmcnt(7) lgkmcnt(0)
    v_mfma_f32_32x32x16_bf16 v[0:15], v[80:83], a[72:75], v[0:15]
    ds_read_b128 v[64:67], v245 offset:0
    buffer_load_dwordx4 v[172:175], v238, s[12:15], s45 offen offset:3072 sc1
    s_add_u32 s45, s45, 4096
    v_mfma_f32_32x32x16_bf16 v[16:31], v[80:83], v[136:139], v[16:31]
    ds_read_b128 v[68:71], v245 offset:1024
    buffer_load_dwordx4 v[176:179], v238, s[12:15], s45 offen offset:0 sc1
    v_mfma_f32_32x32x16_bf16 v[32:47], v[84:87], a[72:75], v[32:47]
    ds_read_b128 v[72:75], v245 offset:2048
    buffer_load_dwordx4 v[180:183], v238, s[12:15], s45 offen offset:1024 sc1
    v_mfma_f32_32x32x16_bf16 v[48:63], v[84:87], v[136:139], v[48:63]
    ds_read_b128 v[76:79], v245 offset:3072
    buffer_load_dwordx4 v[184:187], v238, s[12:15], s45 offen offset:2048 sc1
    v_mfma_f32_32x32x16_bf16 v[0:15], v[88:91], a[76:79], v[0:15]
    buffer_load_dwordx4 v[188:191], v238, s[12:15], s45 offen offset:3072 sc1
    s_add_u32 s45, s45, 4096
    v_mfma_f32_32x32x16_bf16 v[16:31], v[88:91], v[140:143], v[16:31]
    v_mfma_f32_32x32x16_bf16 v[32:47], v[92:95], a[76:79], v[32:47]
    v_mfma_f32_32x32x16_bf16 v[48:63], v[92:95], v[140:143], v[48:63]
    s_waitcnt vmcnt(10) lgkmcnt(0)
    v_mfma_f32_32x32x16_bf16 v[0:15], v[64:67], a[80:83], v[0:15]
    ds_read_b128 v[80:83], v245 offset:16384
    buffer_load_dwordx4 v[128:131], v238, s[12:15], s45 offen offset:0 sc1
    v_mfma_f32_32x32x16_bf16 v[16:31], v[64:67], v[144:147], v[16:31]
    ds_read_b128 v[84:87], v245 offset:17408
    buffer_load_dwordx4 v[132:135], v238, s[12:15], s45 offen offset:1024 sc1
    v_mfma_f32_32x32x16_bf16 v[32:47], v[68:71], a[80:83], v[32:47]
    ds_read_b128 v[88:91], v245 offset:18432
    s_add_u32 m0, s40, 49152
    s_nop 0
    buffer_load_dwordx4 v238, s[8:11], s43 offen offset:0 sc1 lds
    v_mfma_f32_32x32x16_bf16 v[48:63], v[68:71], v[144:147], v[48:63]
    ds_read_b128 v[92:95], v245 offset:19456
    buffer_load_dwordx4 v238, s[8:11], s43 offen offset:1024 sc1 lds
    v_mfma_f32_32x32x16_bf16 v[0:15], v[72:75], a[84:87], v[0:15]
    buffer_load_dwordx4 v238, s[8:11], s43 offen offset:2048 sc1 lds
    v_mfma_f32_32x32x16_bf16 v[16:31], v[72:75], v[148:151], v[16:31]
    buffer_load_dwordx4 v238, s[8:11], s43 offen offset:3072 sc1 lds
    s_add_u32 s43, s43, 4096
    v_mfma_f32_32x32x16_bf16 v[32:47], v[76:79], a[84:87], v[32:47]
    v_mfma_f32_32x32x16_bf16 v[48:63], v[76:79], v[148:151], v[48:63]
    s_waitcnt vmcnt(14) lgkmcnt(0)
    v_mfma_f32_32x32x16_bf16 v[0:15], v[80:83], a[88:91], v[0:15]
    ds_read_b128 v[64:67], v245 offset:32768
    buffer_load_dwordx4 v[136:139], v238, s[12:15], s45 offen offset:2048 sc1
    v_mfma_f32_32x32x16_bf16 v[16:31], v[80:83], v[152:155], v[16:31]
    ds_read_b128 v[68:71], v245 offset:33792
    buffer_load_dwordx4 v[140:143], v238, s[12:15], s45 offen offset:3072 sc1
    s_add_u32 s45, s45, 4096
    v_mfma_f32_32x32x16_bf16 v[32:47], v[84:87], a[88:91], v[32:47]
    ds_read_b128 v[72:75], v245 offset:34816
    s_add_u32 m0, s40, 0
    s_nop 0
    buffer_load_dwordx4 v238, s[8:11], s43 offen offset:0 sc1 lds
    v_mfma_f32_32x32x16_bf16 v[48:63], v[84:87], v[152:155], v[48:63]
    ds_read_b128 v[76:79], v245 offset:35840
    buffer_load_dwordx4 v238, s[8:11], s43 offen offset:1024 sc1 lds
    v_mfma_f32_32x32x16_bf16 v[0:15], v[88:91], a[92:95], v[0:15]
    buffer_load_dwordx4 v238, s[8:11], s43 offen offset:2048 sc1 lds
    v_mfma_f32_32x32x16_bf16 v[16:31], v[88:91], v[156:159], v[16:31]
    v_mfma_f32_32x32x16_bf16 v[32:47], v[92:95], a[92:95], v[32:47]
    v_mfma_f32_32x32x16_bf16 v[48:63], v[92:95], v[156:159], v[48:63]
    s_waitcnt vmcnt(17) lgkmcnt(0)
    v_mfma_f32_32x32x16_bf16 v[0:15], v[64:67], a[96:99], v[0:15]
    ds_read_b128 v[80:83], v245 offset:49152
    buffer_load_dwordx4 v238, s[8:11], s43 offen offset:3072 sc1 lds
    s_add_u32 s43, s43, 4096
    v_mfma_f32_32x32x16_bf16 v[16:31], v[64:67], v[160:163], v[16:31]
    ds_read_b128 v[84:87], v245 offset:50176
    buffer_load_dwordx4 v[144:147], v238, s[12:15], s45 offen offset:0 sc1
    s_waitcnt vmcnt(42)
    v_mfma_f32_32x32x16_bf16 v[32:47], v[68:71], a[96:99], v[32:47]
    ds_read_b128 v[88:91], v245 offset:51200
    buffer_load_dwordx4 v[148:151], v238, s[12:15], s45 offen offset:1024 sc1
    v_mfma_f32_32x32x16_bf16 v[48:63], v[68:71], v[160:163], v[48:63]
    ds_read_b128 v[92:95], v245 offset:52224
    s_add_u32 m0, s40, 16384
    s_nop 0
    buffer_load_dwordx4 v238, s[8:11], s43 offen offset:0 sc1 lds
    v_mfma_f32_32x32x16_bf16 v[0:15], v[72:75], a[100:103], v[0:15]
    buffer_load_dwordx4 v238, s[8:11], s43 offen offset:1024 sc1 lds
    v_lshlrev_b32 v208, 16, v192
    v_and_b32 v209, 0xffff0000, v192
    v_mfma_f32_32x32x16_bf16 v[16:31], v[72:75], v[164:167], v[16:31]
    v_lshlrev_b32 v210, 16, v193
    v_and_b32 v211, 0xffff0000, v193
    v_lshlrev_b32 v212, 16, v194
    v_and_b32 v213, 0xffff0000, v194
    v_lshlrev_b32 v214, 16, v195
    v_and_b32 v215, 0xffff0000, v195
    v_mfma_f32_32x32x16_bf16 v[32:47], v[76:79], a[100:103], v[32:47]
    v_lshlrev_b32 v216, 16, v196
    v_and_b32 v217, 0xffff0000, v196
    v_add_f32 v208, v208, v216
    v_add_f32 v209, v209, v217
    v_lshlrev_b32 v216, 16, v197
    v_mfma_f32_32x32x16_bf16 v[48:63], v[76:79], v[164:167], v[48:63]
    v_and_b32 v217, 0xffff0000, v197
    v_add_f32 v210, v210, v216
    v_add_f32 v211, v211, v217
    v_lshlrev_b32 v216, 16, v198
    v_and_b32 v217, 0xffff0000, v198
    v_add_f32 v212, v212, v216
    s_waitcnt vmcnt(20) lgkmcnt(0)
    v_mfma_f32_32x32x16_bf16 v[0:15], v[80:83], a[104:107], v[0:15]
    ds_read_b128 v[64:67], v246 offset:0
    buffer_load_dwordx4 v238, s[8:11], s43 offen offset:2048 sc1 lds
    v_add_f32 v213, v213, v217
    v_mfma_f32_32x32x16_bf16 v[16:31], v[80:83], v[168:171], v[16:31]
    ds_read_b128 v[68:71], v246 offset:1024
    buffer_load_dwordx4 v238, s[8:11], s43 offen offset:3072 sc1 lds
    s_add_u32 s43, s43, 4096
    v_mfma_f32_32x32x16_bf16 v[32:47], v[84:87], a[104:107], v[32:47]
    ds_read_b128 v[72:75], v246 offset:2048
    buffer_load_dwordx4 v[152:155], v238, s[12:15], s45 offen offset:2048 sc1
    v_lshlrev_b32 v216, 16, v199
    v_mfma_f32_32x32x16_bf16 v[48:63], v[84:87], v[168:171], v[48:63]
    ds_read_b128 v[76:79], v246 offset:3072
    buffer_load_dwordx4 v[156:159], v238, s[12:15], s45 offen offset:3072 sc1
    s_add_u32 s45, s45, 4096
    v_mfma_f32_32x32x16_bf16 v[0:15], v[88:91], a[108:111], v[0:15]
    s_add_u32 m0, s40, 65536
    s_nop 0
    buffer_load_dwordx4 v238, s[8:11], s43 offen offset:0 sc1 lds
    v_mfma_f32_32x32x16_bf16 v[16:31], v[88:91], v[172:175], v[16:31]
    v_and_b32 v217, 0xffff0000, v199
    v_add_f32 v214, v214, v216
    v_add_f32 v215, v215, v217
    v_lshlrev_b32 v216, 16, v200
    v_and_b32 v217, 0xffff0000, v200
    v_add_f32 v208, v208, v216
    v_mfma_f32_32x32x16_bf16 v[32:47], v[92:95], a[108:111], v[32:47]
    v_add_f32 v209, v209, v217
    v_lshlrev_b32 v216, 16, v201
    v_and_b32 v217, 0xffff0000, v201
    v_add_f32 v210, v210, v216
    v_add_f32 v211, v211, v217
    v_lshlrev_b32 v216, 16, v202
    v_mfma_f32_32x32x16_bf16 v[48:63], v[92:95], v[172:175], v[48:63]
    v_and_b32 v217, 0xffff0000, v202
    v_add_f32 v212, v212, v216
    v_add_f32 v213, v213, v217
    v_lshlrev_b32 v216, 16, v203
    v_and_b32 v217, 0xffff0000, v203
    v_add_f32 v214, v214, v216
    s_waitcnt vmcnt(23) lgkmcnt(0)
    v_mfma_f32_32x32x16_bf16 v[0:15], v[64:67], a[112:115], v[0:15]
    ds_read_b128 v[80:83], v246 offset:16384
    buffer_load_dwordx4 v238, s[8:11], s43 offen offset:1024 sc1 lds
    v_add_f32 v215, v215, v217
    v_mfma_f32_32x32x16_bf16 v[16:31], v[64:67], v[176:179], v[16:31]
    ds_read_b128 v[84:87], v246 offset:17408
    buffer_load_dwordx4 v238, s[8:11], s43 offen offset:2048 sc1 lds
    v_mfma_f32_32x32x16_bf16 v[32:47], v[68:71], a[112:115], v[32:47]
    ds_read_b128 v[88:91], v246 offset:18432
    buffer_load_dwordx4 v238, s[8:11], s43 offen offset:3072 sc1 lds
    s_add_u32 s43, s43, 4096
    v_mfma_f32_32x32x16_bf16 v[48:63], v[68:71], v[176:179], v[48:63]
    ds_read_b128 v[92:95], v246 offset:19456
    buffer_load_dwordx4 v[160:163], v238, s[12:15], s45 offen offset:0 sc1
    v_lshlrev_b32 v216, 16, v204
    v_mfma_f32_32x32x16_bf16 v[0:15], v[72:75], a[116:119], v[0:15]
    buffer_load_dwordx4 v[164:167], v238, s[12:15], s45 offen offset:1024 sc1
    v_and_b32 v217, 0xffff0000, v204
    v_mfma_f32_32x32x16_bf16 v[16:31], v[72:75], v[180:183], v[16:31]
    v_add_f32 v208, v208, v216
    v_add_f32 v209, v209, v217
    v_lshlrev_b32 v216, 16, v205
    v_and_b32 v217, 0xffff0000, v205
    v_add_f32 v210, v210, v216
    v_add_f32 v211, v211, v217
    v_mfma_f32_32x32x16_bf16 v[32:47], v[76:79], a[116:119], v[32:47]
    v_lshlrev_b32 v216, 16, v206
    v_and_b32 v217, 0xffff0000, v206
    v_add_f32 v212, v212, v216
    v_add_f32 v213, v213, v217
    v_lshlrev_b32 v216, 16, v207
    v_mfma_f32_32x32x16_bf16 v[48:63], v[76:79], v[180:183], v[48:63]
    v_and_b32 v217, 0xffff0000, v207
    v_add_f32 v214, v214, v216
    v_add_f32 v215, v215, v217
    s_nop 1
    v_add_f32_dpp v208, v208, v208 row_ror:8 row_mask:0xf bank_mask:0xf
    v_add_f32_dpp v209, v209, v209 row_ror:8 row_mask:0xf bank_mask:0xf
    s_waitcnt vmcnt(26) lgkmcnt(0)
    v_mfma_f32_32x32x16_bf16 v[0:15], v[80:83], a[120:123], v[0:15]
    ds_read_b128 v[64:67], v244 offset:32768
    s_add_u32 m0, s40, 81920
    s_nop 0
    buffer_load_dwordx4 v238, s[8:11], s43 offen offset:0 sc1 lds
    v_mfma_f32_32x32x16_bf16 v[16:31], v[80:83], v[184:187], v[16:31]
    ds_read_b128 v[68:71], v244 offset:33792
    buffer_load_dwordx4 v238, s[8:11], s43 offen offset:1024 sc1 lds
    v_add_f32_dpp v210, v210, v210 row_ror:8 row_mask:0xf bank_mask:0xf
    v_mfma_f32_32x32x16_bf16 v[32:47], v[84:87], a[120:123], v[32:47]
    ds_read_b128 v[72:75], v244 offset:34816
    buffer_load_dwordx4 v238, s[8:11], s43 offen offset:2048 sc1 lds
    v_mfma_f32_32x32x16_bf16 v[48:63], v[84:87], v[184:187], v[48:63]
    ds_read_b128 v[76:79], v244 offset:35840
    buffer_load_dwordx4 v238, s[8:11], s43 offen offset:3072 sc1 lds
    s_add_u32 s43, s43, 4096
    v_mfma_f32_32x32x16_bf16 v[0:15], v[88:91], a[124:127], v[0:15]
    buffer_load_dwordx4 v[168:171], v238, s[12:15], s45 offen offset:2048 sc1
    v_add_f32_dpp v211, v211, v211 row_ror:8 row_mask:0xf bank_mask:0xf
    v_add_f32_dpp v212, v212, v212 row_ror:8 row_mask:0xf bank_mask:0xf
    v_mfma_f32_32x32x16_bf16 v[16:31], v[88:91], v[188:191], v[16:31]
    v_add_f32_dpp v213, v213, v213 row_ror:8 row_mask:0xf bank_mask:0xf
    v_add_f32_dpp v214, v214, v214 row_ror:8 row_mask:0xf bank_mask:0xf
    v_add_f32_dpp v215, v215, v215 row_ror:8 row_mask:0xf bank_mask:0xf
    v_mov_b32 v192, v208
    v_mov_b32 v193, v209
    v_mov_b32 v194, v210
    v_mfma_f32_32x32x16_bf16 v[32:47], v[92:95], a[124:127], v[32:47]
    v_mov_b32 v195, v211
    v_mov_b32 v196, v212
    v_mov_b32 v197, v213
    v_mov_b32 v198, v214
    v_mov_b32 v199, v215
    v_mfma_f32_32x32x16_bf16 v[48:63], v[92:95], v[188:191], v[48:63]
    s_nop 1
    v_permlane16_swap_b32 v208, v192
    v_permlane16_swap_b32 v209, v193
    v_permlane16_swap_b32 v210, v194
    v_permlane16_swap_b32 v211, v195
    v_permlane16_swap_b32 v212, v196
    s_waitcnt vmcnt(25) lgkmcnt(0)
    v_mfma_f32_32x32x16_bf16 v[0:15], v[64:67], a[128:131], v[0:15]
    ds_read_b128 v[80:83], v244 offset:49152
    buffer_load_dwordx4 v[172:175], v238, s[12:15], s45 offen offset:3072 sc1
    s_add_u32 s45, s45, 4096
    v_mfma_f32_32x32x16_bf16 v[16:31], v[64:67], v[128:131], v[16:31]
    ds_read_b128 v[84:87], v244 offset:50176
    s_add_u32 m0, s40, 98304
    s_nop 0
    buffer_load_dwordx4 v238, s[8:11], s43 offen offset:0 sc1 lds
    v_mfma_f32_32x32x16_bf16 v[32:47], v[68:71], a[128:131], v[32:47]
    ds_read_b128 v[88:91], v244 offset:51200
    buffer_load_dwordx4 v238, s[8:11], s43 offen offset:1024 sc1 lds
    v_permlane16_swap_b32 v213, v197
    v_permlane16_swap_b32 v214, v198
    v_mfma_f32_32x32x16_bf16 v[48:63], v[68:71], v[128:131], v[48:63]
    ds_read_b128 v[92:95], v244 offset:52224
    buffer_load_dwordx4 v238, s[8:11], s43 offen offset:2048 sc1 lds
    v_permlane16_swap_b32 v215, v199
    v_mfma_f32_32x32x16_bf16 v[0:15], v[72:75], a[132:135], v[0:15]
    buffer_load_dwordx4 v238, s[8:11], s43 offen offset:3072 sc1 lds
    s_add_u32 s43, s43, 4096
    s_nop 1
    v_add_f32 v208, v208, v192
    v_mfma_f32_32x32x16_bf16 v[16:31], v[72:75], v[132:135], v[16:31]
    buffer_load_dwordx4 v[176:179], v238, s[12:15], s45 offen offset:0 sc1
    v_add_f32 v209, v209, v193
    v_add_f32 v210, v210, v194
    v_mfma_f32_32x32x16_bf16 v[32:47], v[76:79], a[132:135], v[32:47]
    v_add_f32 v211, v211, v195
    v_add_f32 v212, v212, v196
    v_add_f32 v213, v213, v197
    v_add_f32 v214, v214, v198
    v_add_f32 v215, v215, v199
    v_mov_b32 v192, v208
    v_mov_b32 v193, v209
    v_mfma_f32_32x32x16_bf16 v[48:63], v[76:79], v[132:135], v[48:63]
    v_mov_b32 v194, v210
    v_mov_b32 v195, v211
    v_mov_b32 v196, v212
    v_mov_b32 v197, v213
    v_mov_b32 v198, v214
    v_mov_b32 v199, v215
    s_waitcnt vmcnt(25) lgkmcnt(0)
    v_mfma_f32_32x32x16_bf16 v[0:15], v[80:83], a[136:139], v[0:15]
    ds_read_b128 v[64:67], v244 offset:0
    buffer_load_dwordx4 v[180:183], v238, s[12:15], s45 offen offset:1024 sc1
    s_nop 1
    v_permlane32_swap_b32 v208, v192
    v_mfma_f32_32x32x16_bf16 v[16:31], v[80:83], v[136:139], v[16:31]
    ds_read_b128 v[68:71], v244 offset:1024
    s_add_u32 m0, s40, 114688
    s_nop 0
    buffer_load_dwordx4 v238, s[8:11], s43 offen offset:0 sc1 lds
    v_mfma_f32_32x32x16_bf16 v[32:47], v[84:87], a[136:139], v[32:47]
    ds_read_b128 v[72:75], v244 offset:2048
    buffer_load_dwordx4 v238, s[8:11], s43 offen offset:1024 sc1 lds
    v_permlane32_swap_b32 v209, v193
    v_permlane32_swap_b32 v210, v194
    v_mfma_f32_32x32x16_bf16 v[48:63], v[84:87], v[136:139], v[48:63]
    ds_read_b128 v[76:79], v244 offset:3072
    buffer_load_dwordx4 v238, s[8:11], s43 offen offset:2048 sc1 lds
    v_permlane32_swap_b32 v211, v195
    v_permlane32_swap_b32 v212, v196
    v_permlane32_swap_b32 v213, v197
    v_mfma_f32_32x32x16_bf16 v[0:15], v[88:91], a[140:143], v[0:15]
    buffer_load_dwordx4 v238, s[8:11], s43 offen offset:3072 sc1 lds
    s_add_u32 s43, s43, 4096
    v_permlane32_swap_b32 v214, v198
    v_permlane32_swap_b32 v215, v199
    v_mfma_f32_32x32x16_bf16 v[16:31], v[88:91], v[140:143], v[16:31]
    s_nop 1
    v_add_f32 v208, v208, v192
    v_add_f32 v209, v209, v193
    v_add_f32 v210, v210, v194
    v_add_f32 v211, v211, v195
    v_add_f32 v212, v212, v196
    v_add_f32 v213, v213, v197
    v_mfma_f32_32x32x16_bf16 v[32:47], v[92:95], a[140:143], v[32:47]
    v_add_f32 v214, v214, v198
    v_add_f32 v215, v215, v199
    v_lshlrev_b32 v216, 1, v238
    v_mfma_f32_32x32x16_bf16 v[48:63], v[92:95], v[140:143], v[48:63]
    s_mov_b64 exec, 0xff
    buffer_store_dwordx4 v[208:211], v216, s[32:35], s37 offen sc0 sc1
    buffer_store_dwordx4 v[212:215], v216, s[32:35], s37 offen offset:16 sc0 sc1
    s_mov_b64 exec, -1
    s_nop 3
    s_waitcnt vmcnt(26) lgkmcnt(0)
    v_mfma_f32_32x32x16_bf16 v[0:15], v[64:67], a[144:147], v[0:15]
    ds_read_b128 v[80:83], v244 offset:16384
    buffer_load_dwordx4 v[184:187], v238, s[12:15], s45 offen offset:2048 sc1
    v_mfma_f32_32x32x16_bf16 v[16:31], v[64:67], v[144:147], v[16:31]
    ds_read_b128 v[84:87], v244 offset:17408
    buffer_load_dwordx4 v[188:191], v238, s[12:15], s45 offen offset:3072 sc1
    s_add_u32 s45, s45, 4096
    v_mfma_f32_32x32x16_bf16 v[32:47], v[68:71], a[144:147], v[32:47]
    ds_read_b128 v[88:91], v244 offset:18432
    s_add_u32 m0, s40, 131072
    s_nop 0
    buffer_load_dwordx4 v238, s[8:11], s43 offen offset:0 sc1 lds
    v_mfma_f32_32x32x16_bf16 v[48:63], v[68:71], v[144:147], v[48:63]
    ds_read_b128 v[92:95], v244 offset:19456
    buffer_load_dwordx4 v238, s[8:11], s43 offen offset:1024 sc1 lds
    v_mfma_f32_32x32x16_bf16 v[0:15], v[72:75], a[148:151], v[0:15]
    buffer_load_dwordx4 v238, s[8:11], s43 offen offset:2048 sc1 lds
    v_mfma_f32_32x32x16_bf16 v[16:31], v[72:75], v[148:151], v[16:31]
    v_mfma_f32_32x32x16_bf16 v[32:47], v[76:79], a[148:151], v[32:47]
    v_mfma_f32_32x32x16_bf16 v[48:63], v[76:79], v[148:151], v[48:63]
    s_waitcnt vmcnt(25) lgkmcnt(0)
    v_mfma_f32_32x32x16_bf16 v[0:15], v[80:83], a[152:155], v[0:15]
    ds_read_b128 v[64:67], v245 offset:0
    buffer_load_dwordx4 v238, s[8:11], s43 offen offset:3072 sc1 lds
    s_add_u32 s43, s43, 4096
    v_mfma_f32_32x32x16_bf16 v[16:31], v[80:83], v[152:155], v[16:31]
    ds_read_b128 v[68:71], v245 offset:1024
    buffer_load_dwordx4 v[128:131], v238, s[12:15], s45 offen offset:0 sc1
    v_mfma_f32_32x32x16_bf16 v[32:47], v[84:87], a[152:155], v[32:47]
    ds_read_b128 v[72:75], v245 offset:2048
    buffer_load_dwordx4 v[132:135], v238, s[12:15], s45 offen offset:1024 sc1
    v_mfma_f32_32x32x16_bf16 v[48:63], v[84:87], v[152:155], v[48:63]
    ds_read_b128 v[76:79], v245 offset:3072
    s_add_u32 m0, s40, 147456
    s_nop 0
    buffer_load_dwordx4 v238, s[8:11], s43 offen offset:0 sc1 lds
    v_mfma_f32_32x32x16_bf16 v[0:15], v[88:91], a[156:159], v[0:15]
    buffer_load_dwordx4 v238, s[8:11], s43 offen offset:1024 sc1 lds
    v_mfma_f32_32x32x16_bf16 v[16:31], v[88:91], v[156:159], v[16:31]
    v_mfma_f32_32x32x16_bf16 v[32:47], v[92:95], a[156:159], v[32:47]
    v_mfma_f32_32x32x16_bf16 v[48:63], v[92:95], v[156:159], v[48:63]
    s_waitcnt vmcnt(24) lgkmcnt(0)
    v_mfma_f32_32x32x16_bf16 v[0:15], v[64:67], a[160:163], v[0:15]
    ds_read_b128 v[80:83], v245 offset:16384
    buffer_load_dwordx4 v238, s[8:11], s43 offen offset:2048 sc1 lds
    v_mfma_f32_32x32x16_bf16 v[16:31], v[64:67], v[160:163], v[16:31]
    ds_read_b128 v[84:87], v245 offset:17408
    buffer_load_dwordx4 v238, s[8:11], s43 offen offset:3072 sc1 lds
    s_add_u32 s43, s43, 4096
    v_mfma_f32_32x32x16_bf16 v[32:47], v[68:71], a[160:163], v[32:47]
    ds_read_b128 v[88:91], v245 offset:18432
    buffer_load_dwordx4 v[136:139], v238, s[12:15], s45 offen offset:2048 sc1
    v_mfma_f32_32x32x16_bf16 v[48:63], v[68:71], v[160:163], v[48:63]
    ds_read_b128 v[92:95], v245 offset:19456
    buffer_load_dwordx4 v[140:143], v238, s[12:15], s45 offen offset:3072 sc1
    s_add_u32 s45, s45, 4096
    v_mfma_f32_32x32x16_bf16 v[0:15], v[72:75], a[164:167], v[0:15]
    s_add_u32 m0, s40, 32768
    s_nop 0
    buffer_load_dwordx4 v238, s[8:11], s43 offen offset:0 sc1 lds
    v_mfma_f32_32x32x16_bf16 v[16:31], v[72:75], v[164:167], v[16:31]
    v_mfma_f32_32x32x16_bf16 v[32:47], v[76:79], a[164:167], v[32:47]
    v_mfma_f32_32x32x16_bf16 v[48:63], v[76:79], v[164:167], v[48:63]
    s_waitcnt vmcnt(23) lgkmcnt(0)
    v_mfma_f32_32x32x16_bf16 v[0:15], v[80:83], a[168:171], v[0:15]
    ds_read_b128 v[64:67], v245 offset:32768
    buffer_load_dwordx4 v238, s[8:11], s43 offen offset:1024 sc1 lds
    v_mfma_f32_32x32x16_bf16 v[16:31], v[80:83], v[168:171], v[16:31]
    ds_read_b128 v[68:71], v245 offset:33792
    buffer_load_dwordx4 v238, s[8:11], s43 offen offset:2048 sc1 lds
    v_mfma_f32_32x32x16_bf16 v[32:47], v[84:87], a[168:171], v[32:47]
    ds_read_b128 v[72:75], v245 offset:34816
    buffer_load_dwordx4 v238, s[8:11], s43 offen offset:3072 sc1 lds
    s_add_u32 s43, s43, 4096
    v_mfma_f32_32x32x16_bf16 v[48:63], v[84:87], v[168:171], v[48:63]
    ds_read_b128 v[76:79], v245 offset:35840
    buffer_load_dwordx4 v[144:147], v238, s[12:15], s45 offen offset:0 sc1
    v_mfma_f32_32x32x16_bf16 v[0:15], v[88:91], a[172:175], v[0:15]
    buffer_load_dwordx4 v[148:151], v238, s[12:15], s45 offen offset:1024 sc1
    v_mfma_f32_32x32x16_bf16 v[16:31], v[88:91], v[172:175], v[16:31]
    v_mfma_f32_32x32x16_bf16 v[32:47], v[92:95], a[172:175], v[32:47]
    v_mfma_f32_32x32x16_bf16 v[48:63], v[92:95], v[172:175], v[48:63]
    s_waitcnt vmcnt(22) lgkmcnt(0)
    v_mfma_f32_32x32x16_bf16 v[0:15], v[64:67], a[176:179], v[0:15]
    ds_read_b128 v[80:83], v245 offset:49152
    s_add_u32 m0, s40, 49152
    s_nop 0
    buffer_load_dwordx4 v238, s[8:11], s43 offen offset:0 sc1 lds
    v_mfma_f32_32x32x16_bf16 v[16:31], v[64:67], v[176:179], v[16:31]
    ds_read_b128 v[84:87], v245 offset:50176
    buffer_load_dwordx4 v238, s[8:11], s43 offen offset:1024 sc1 lds
    v_mfma_f32_32x32x16_bf16 v[32:47], v[68:71], a[176:179], v[32:47]
    ds_read_b128 v[88:91], v245 offset:51200
    buffer_load_dwordx4 v238, s[8:11], s43 offen offset:2048 sc1 lds
    v_mfma_f32_32x32x16_bf16 v[48:63], v[68:71], v[176:179], v[48:63]
    ds_read_b128 v[92:95], v245 offset:52224
    buffer_load_dwordx4 v238, s[8:11], s43 offen offset:3072 sc1 lds
    s_add_u32 s43, s43, 4096
    v_mfma_f32_32x32x16_bf16 v[0:15], v[72:75], a[180:183], v[0:15]
    buffer_load_dwordx4 v[152:155], v238, s[12:15], s45 offen offset:2048 sc1
    v_mfma_f32_32x32x16_bf16 v[16:31], v[72:75], v[180:183], v[16:31]
    buffer_load_dwordx4 v[156:159], v238, s[12:15], s45 offen offset:3072 sc1
    s_add_u32 s45, s45, 4096
    v_mfma_f32_32x32x16_bf16 v[32:47], v[76:79], a[180:183], v[32:47]
    v_mfma_f32_32x32x16_bf16 v[48:63], v[76:79], v[180:183], v[48:63]
    s_waitcnt vmcnt(20) lgkmcnt(0)
    v_mfma_f32_32x32x16_bf16 v[0:15], v[80:83], a[184:187], v[0:15]
    ds_read_b128 v[64:67], v246 offset:0
    s_add_u32 m0, s40, 0
    s_nop 0
    buffer_load_dwordx4 v238, s[8:11], s43 offen offset:0 sc1 lds
    v_mfma_f32_32x32x16_bf16 v[16:31], v[80:83], v[184:187], v[16:31]
    ds_read_b128 v[68:71], v246 offset:1024
    buffer_load_dwordx4 v238, s[8:11], s43 offen offset:1024 sc1 lds
    v_mfma_f32_32x32x16_bf16 v[32:47], v[84:87], a[184:187], v[32:47]
    ds_read_b128 v[72:75], v246 offset:2048
    buffer_load_dwordx4 v238, s[8:11], s43 offen offset:2048 sc1 lds
    v_mfma_f32_32x32x16_bf16 v[48:63], v[84:87], v[184:187], v[48:63]
    ds_read_b128 v[76:79], v246 offset:3072
    buffer_load_dwordx4 v238, s[8:11], s43 offen offset:3072 sc1 lds
    s_add_u32 s43, s43, 4096
    v_mfma_f32_32x32x16_bf16 v[0:15], v[88:91], a[188:191], v[0:15]
    buffer_load_dwordx4 v[160:163], v238, s[12:15], s45 offen offset:0 sc1
    v_mfma_f32_32x32x16_bf16 v[16:31], v[88:91], v[188:191], v[16:31]
    v_mfma_f32_32x32x16_bf16 v[32:47], v[92:95], a[188:191], v[32:47]
    v_mfma_f32_32x32x16_bf16 v[48:63], v[92:95], v[188:191], v[48:63]
    s_waitcnt vmcnt(19) lgkmcnt(0)
    v_mfma_f32_32x32x16_bf16 v[0:15], v[64:67], a[192:195], v[0:15]
    ds_read_b128 v[80:83], v246 offset:16384
    buffer_load_dwordx4 v[164:167], v238, s[12:15], s45 offen offset:1024 sc1
    v_mfma_f32_32x32x16_bf16 v[16:31], v[64:67], v[128:131], v[16:31]
    ds_read_b128 v[84:87], v246 offset:17408
    s_add_u32 m0, s40, 16384
    s_nop 0
    buffer_load_dwordx4 v238, s[8:11], s43 offen offset:0 sc1 lds
    v_mfma_f32_32x32x16_bf16 v[32:47], v[68:71], a[192:195], v[32:47]
    ds_read_b128 v[88:91], v246 offset:18432
    buffer_load_dwordx4 v238, s[8:11], s43 offen offset:1024 sc1 lds
    v_mfma_f32_32x32x16_bf16 v[48:63], v[68:71], v[128:131], v[48:63]
    ds_read_b128 v[92:95], v246 offset:19456
    buffer_load_dwordx4 v238, s[8:11], s43 offen offset:2048 sc1 lds
    v_mfma_f32_32x32x16_bf16 v[0:15], v[72:75], a[196:199], v[0:15]
    buffer_load_dwordx4 v238, s[8:11], s43 offen offset:3072 sc1 lds
    s_add_u32 s43, s43, 4096
    v_mfma_f32_32x32x16_bf16 v[16:31], v[72:75], v[132:135], v[16:31]
    v_mfma_f32_32x32x16_bf16 v[32:47], v[76:79], a[196:199], v[32:47]
    v_mfma_f32_32x32x16_bf16 v[48:63], v[76:79], v[132:135], v[48:63]
    s_waitcnt vmcnt(18) lgkmcnt(0)
    v_mfma_f32_32x32x16_bf16 v[0:15], v[80:83], a[200:203], v[0:15]
    ds_read_b128 v[64:67], v244 offset:32768
    buffer_load_dwordx4 v[168:171], v238, s[12:15], s45 offen offset:2048 sc1
    v_mfma_f32_32x32x16_bf16 v[16:31], v[80:83], v[136:139], v[16:31]
    ds_read_b128 v[68:71], v244 offset:33792
    buffer_load_dwordx4 v[172:175], v238, s[12:15], s45 offen offset:3072 sc1
    s_add_u32 s45, s45, 4096
    v_mfma_f32_32x32x16_bf16 v[32:47], v[84:87], a[200:203], v[32:47]
    ds_read_b128 v[72:75], v244 offset:34816
    s_add_u32 m0, s40, 65536
    s_nop 0
    buffer_load_dwordx4 v238, s[8:11], s43 offen offset:0 sc1 lds
    v_mfma_f32_32x32x16_bf16 v[48:63], v[84:87], v[136:139], v[48:63]
    ds_read_b128 v[76:79], v244 offset:35840
    buffer_load_dwordx4 v238, s[8:11], s43 offen offset:1024 sc1 lds
    v_mfma_f32_32x32x16_bf16 v[0:15], v[88:91], a[204:207], v[0:15]
    buffer_load_dwordx4 v238, s[8:11], s43 offen offset:2048 sc1 lds
    v_mfma_f32_32x32x16_bf16 v[16:31], v[88:91], v[140:143], v[16:31]
    v_mfma_f32_32x32x16_bf16 v[32:47], v[92:95], a[204:207], v[32:47]
    v_mfma_f32_32x32x16_bf16 v[48:63], v[92:95], v[140:143], v[48:63]
    s_waitcnt vmcnt(17) lgkmcnt(0)
    v_mfma_f32_32x32x16_bf16 v[0:15], v[64:67], a[208:211], v[0:15]
    ds_read_b128 v[80:83], v244 offset:49152
    buffer_load_dwordx4 v238, s[8:11], s43 offen offset:3072 sc1 lds
    s_add_u32 s43, s43, 4096
    v_mfma_f32_32x32x16_bf16 v[16:31], v[64:67], v[144:147], v[16:31]
    ds_read_b128 v[84:87], v244 offset:50176
    buffer_load_dwordx4 v[176:179], v238, s[12:15], s45 offen offset:0 sc1
    v_mfma_f32_32x32x16_bf16 v[32:47], v[68:71], a[208:211], v[32:47]
    ds_read_b128 v[88:91], v244 offset:51200
    buffer_load_dwordx4 v[180:183], v238, s[12:15], s45 offen offset:1024 sc1
    v_mfma_f32_32x32x16_bf16 v[48:63], v[68:71], v[144:147], v[48:63]
    ds_read_b128 v[92:95], v244 offset:52224
    s_add_u32 m0, s40, 81920
    s_nop 0
    buffer_load_dwordx4 v238, s[8:11], s43 offen offset:0 sc1 lds
    v_mfma_f32_32x32x16_bf16 v[0:15], v[72:75], a[212:215], v[0:15]
    buffer_load_dwordx4 v238, s[8:11], s43 offen offset:1024 sc1 lds
    v_mfma_f32_32x32x16_bf16 v[16:31], v[72:75], v[148:151], v[16:31]
    v_lshrrev_b32 v206, 4, v238
    s_and_b32 s3, s2, 3
    v_mfma_f32_32x32x16_bf16 v[32:47], v[76:79], a[212:215], v[32:47]
    s_lshl_b32 s3, s3, 2
    s_bfe_u32 s4, s2, 0x20003
    s_add_u32 s55, s3, s4
    v_mfma_f32_32x32x16_bf16 v[48:63], v[76:79], v[148:151], v[48:63]
    s_bfe_u32 s3, s2, 0x10002
    s_lshl_b32 s3, s3, 3
    s_waitcnt vmcnt(16) lgkmcnt(0)
    v_mfma_f32_32x32x16_bf16 v[0:15], v[80:83], a[216:219], v[0:15]
    ds_read_b128 v[64:67], v244 offset:0
    buffer_load_dwordx4 v238, s[8:11], s43 offen offset:2048 sc1 lds
    v_mfma_f32_32x32x16_bf16 v[16:31], v[80:83], v[152:155], v[16:31]
    ds_read_b128 v[68:71], v244 offset:1024
    buffer_load_dwordx4 v238, s[8:11], s43 offen offset:3072 sc1 lds
    s_add_u32 s43, s43, 4096
    v_mfma_f32_32x32x16_bf16 v[32:47], v[84:87], a[216:219], v[32:47]
    ds_read_b128 v[72:75], v244 offset:2048
    buffer_load_dwordx4 v[184:187], v238, s[12:15], s45 offen offset:2048 sc1
    v_mfma_f32_32x32x16_bf16 v[48:63], v[84:87], v[152:155], v[48:63]
    ds_read_b128 v[76:79], v244 offset:3072
    buffer_load_dwordx4 v[188:191], v238, s[12:15], s45 offen offset:3072 sc1
    s_add_u32 s45, s45, 4096
    v_mfma_f32_32x32x16_bf16 v[0:15], v[88:91], a[220:223], v[0:15]
    s_add_u32 m0, s40, 98304
    s_nop 0
    buffer_load_dwordx4 v238, s[8:11], s43 offen offset:0 sc1 lds
    v_mfma_f32_32x32x16_bf16 v[16:31], v[88:91], v[156:159], v[16:31]
    s_lshr_b32 s4, s2, 5
    s_add_u32 s54, s3, s4
    v_lshrrev_b32 v205, 5, v206
    v_mfma_f32_32x32x16_bf16 v[32:47], v[92:95], a[220:223], v[32:47]
    v_mov_b32 v199, v238
    v_add_u32 v200, 57344, v238
    v_add_u32 v201, 114688, v238
    v_mfma_f32_32x32x16_bf16 v[48:63], v[92:95], v[156:159], v[48:63]
    s_add_u32 s28, s92, 0x7600000
    s_addc_u32 s29, s93, 0
    s_mov_b32 s30, 0x380000
    s_mov_b32 s31, 0x00020000
    s_waitcnt vmcnt(15) lgkmcnt(0)
    v_mfma_f32_32x32x16_bf16 v[0:15], v[64:67], a[224:227], v[0:15]
    ds_read_b128 v[80:83], v244 offset:16384
    buffer_load_dwordx4 v238, s[8:11], s43 offen offset:1024 sc1 lds
    v_mfma_f32_32x32x16_bf16 v[16:31], v[64:67], v[160:163], v[16:31]
    ds_read_b128 v[84:87], v244 offset:17408
    buffer_load_dwordx4 v238, s[8:11], s43 offen offset:2048 sc1 lds
    v_mfma_f32_32x32x16_bf16 v[32:47], v[68:71], a[224:227], v[32:47]
    ds_read_b128 v[88:91], v244 offset:18432
    buffer_load_dwordx4 v238, s[8:11], s43 offen offset:3072 sc1 lds
    s_add_u32 s43, s43, 4096
    v_mfma_f32_32x32x16_bf16 v[48:63], v[68:71], v[160:163], v[48:63]
    ds_read_b128 v[92:95], v244 offset:19456
    buffer_load_dwordx4 v[128:131], v238, s[12:15], s45 offen offset:0 sc1
    s_mul_i32 s58, s94, 7168
    v_mfma_f32_32x32x16_bf16 v[0:15], v[72:75], a[228:231], v[0:15]
    buffer_load_dwordx4 v[132:135], v238, s[12:15], s45 offen offset:1024 sc1
    s_mul_i32 s4, s55, 229376
    v_mfma_f32_32x32x16_bf16 v[16:31], v[72:75], v[164:167], v[16:31]
    s_add_u32 m0, s40, 114688
    s_nop 0
    buffer_load_dwordx4 v238, s[8:11], s43 offen offset:0 sc1 lds
    v_mfma_f32_32x32x16_bf16 v[32:47], v[76:79], a[228:231], v[32:47]
    s_add_u32 s56, s58, s4
    s_add_u32 s53, s56, 4096
    s_lshl_b32 s49, s55, 9
    s_add_u32 s49, s49, 57344
    v_mfma_f32_32x32x16_bf16 v[48:63], v[76:79], v[164:167], v[48:63]
    v_lshrrev_b32 v239, 1, v238
    v_and_b32 v239, 504, v239
    buffer_load_dwordx2 v[252:253], v239, s[64:67], s49 offen sc1
    s_waitcnt vmcnt(16) lgkmcnt(0)
    v_mfma_f32_32x32x16_bf16 v[0:15], v[80:83], a[232:235], v[0:15]
    ds_read_b128 v[64:67], v245 offset:0
    buffer_load_dwordx4 v238, s[8:11], s43 offen offset:1024 sc1 lds
    v_mfma_f32_32x32x16_bf16 v[16:31], v[80:83], v[168:171], v[16:31]
    ds_read_b128 v[68:71], v245 offset:1024
    buffer_load_dwordx4 v238, s[8:11], s43 offen offset:2048 sc1 lds
    v_mfma_f32_32x32x16_bf16 v[32:47], v[84:87], a[232:235], v[32:47]
    ds_read_b128 v[72:75], v245 offset:2048
    buffer_load_dwordx4 v238, s[8:11], s43 offen offset:3072 sc1 lds
    s_add_u32 s43, s43, 4096
    v_mfma_f32_32x32x16_bf16 v[48:63], v[84:87], v[168:171], v[48:63]
    ds_read_b128 v[76:79], v245 offset:3072
    buffer_load_dwordx4 v[136:139], v238, s[12:15], s45 offen offset:2048 sc1
    v_mfma_f32_32x32x16_bf16 v[0:15], v[88:91], a[236:239], v[0:15]
    buffer_load_dwordx4 v[140:143], v238, s[12:15], s45 offen offset:3072 sc1
    s_add_u32 s45, s45, 4096
    v_mfma_f32_32x32x16_bf16 v[16:31], v[88:91], v[172:175], v[16:31]
    s_and_b32 s3, s94, 1
    s_lshr_b32 s5, s94, 1
    v_mfma_f32_32x32x16_bf16 v[32:47], v[92:95], a[236:239], v[32:47]
    s_lshl_b32 s5, s5, 5
    s_add_u32 s3, s3, s5
    s_lshl_b32 s4, s54, 1
    v_mfma_f32_32x32x16_bf16 v[48:63], v[92:95], v[172:175], v[48:63]
    s_add_u32 s59, s3, s4
    s_lshl_b32 s57, s59, 15
    s_waitcnt vmcnt(15) lgkmcnt(0)
    v_mfma_f32_32x32x16_bf16 v[0:15], v[64:67], a[240:243], v[0:15]
    ds_read_b128 v[80:83], v245 offset:16384
    s_add_u32 m0, s40, 131072
    s_nop 0
    buffer_load_dwordx4 v238, s[8:11], s43 offen offset:0 sc1 lds
    v_mfma_f32_32x32x16_bf16 v[16:31], v[64:67], v[176:179], v[16:31]
    ds_read_b128 v[84:87], v245 offset:17408
    buffer_load_dwordx4 v238, s[8:11], s43 offen offset:1024 sc1 lds
    v_mfma_f32_32x32x16_bf16 v[32:47], v[68:71], a[240:243], v[32:47]
    ds_read_b128 v[88:91], v245 offset:18432
    buffer_load_dwordx4 v238, s[8:11], s43 offen offset:2048 sc1 lds
    v_mfma_f32_32x32x16_bf16 v[48:63], v[68:71], v[176:179], v[48:63]
    ds_read_b128 v[92:95], v245 offset:19456
    buffer_load_dwordx4 v238, s[8:11], s43 offen offset:3072 sc1 lds
    s_add_u32 s43, s43, 4096
    v_mfma_f32_32x32x16_bf16 v[0:15], v[72:75], a[244:247], v[0:15]
    buffer_load_dwordx4 v[144:147], v238, s[12:15], s45 offen offset:0 sc1
    v_mfma_f32_32x32x16_bf16 v[16:31], v[72:75], v[180:183], v[16:31]
    s_lshl_b32 s3, s94, 6
    v_add_u32 v217, s3, v206
    v_mfma_f32_32x32x16_bf16 v[32:47], v[76:79], a[244:247], v[32:47]
    v_cmp_gt_u32 vcc, 112, v217
    v_add_u32 v208, 1680, v217
    v_lshlrev_b32 v202, 2, v217
    v_mfma_f32_32x32x16_bf16 v[48:63], v[76:79], v[180:183], v[48:63]
    v_cndmask_b32 v208, v208, v217, vcc
    v_lshlrev_b32 v203, 2, v208
    s_waitcnt vmcnt(14) lgkmcnt(0)
    v_mfma_f32_32x32x16_bf16 v[0:15], v[80:83], a[248:251], v[0:15]
    ds_read_b128 v[64:67], v245 offset:32768
    buffer_load_dwordx4 v[148:151], v238, s[12:15], s45 offen offset:1024 sc1
    v_mfma_f32_32x32x16_bf16 v[16:31], v[80:83], v[184:187], v[16:31]
    ds_read_b128 v[68:71], v245 offset:33792
    s_add_u32 m0, s40, 147456
    s_nop 0
    buffer_load_dwordx4 v238, s[8:11], s43 offen offset:0 sc1 lds
    v_mfma_f32_32x32x16_bf16 v[32:47], v[84:87], a[248:251], v[32:47]
    ds_read_b128 v[72:75], v245 offset:34816
    buffer_load_dwordx4 v238, s[8:11], s43 offen offset:1024 sc1 lds
    v_mfma_f32_32x32x16_bf16 v[48:63], v[84:87], v[184:187], v[48:63]
    ds_read_b128 v[76:79], v245 offset:35840
    buffer_load_dwordx4 v238, s[8:11], s43 offen offset:2048 sc1 lds
    v_mfma_f32_32x32x16_bf16 v[0:15], v[88:91], a[252:255], v[0:15]
    buffer_load_dwordx4 v238, s[8:11], s43 offen offset:3072 sc1 lds
    s_add_u32 s43, s43, 4096
    v_mfma_f32_32x32x16_bf16 v[16:31], v[88:91], v[188:191], v[16:31]
    v_add_u32 v202, 143360, v202
    v_and_b32 v209, 31, v206
    v_lshlrev_b32 v209, 3, v209
    v_mfma_f32_32x32x16_bf16 v[32:47], v[92:95], a[252:255], v[32:47]
    v_lshl_add_u32 v204, v205, 11, v209
    s_lshl_b32 s50, s59, 12
    s_add_u32 s50, s50, 66560
    s_mov_b32 s51, 8192
    v_mfma_f32_32x32x16_bf16 v[48:63], v[92:95], v[188:191], v[48:63]
    s_waitcnt vmcnt(15)
    v_cmp_ne_u64 vcc, s[96:97], v[252:253]
    s_cbranch_vccnz spin_14
ok_13:
    s_waitcnt vmcnt(12) lgkmcnt(0)
    v_mfma_f32_32x32x16_bf16 v[0:15], v[64:67], a[0:3], v[0:15]
    ds_read_b128 v[80:83], v245 offset:49152
    buffer_load_dwordx4 v[152:155], v238, s[12:15], s45 offen offset:2048 sc1
    v_mfma_f32_32x32x16_bf16 v[16:31], v[64:67], v[128:131], v[16:31]
    ds_read_b128 v[84:87], v245 offset:50176
    buffer_load_dwordx4 v[156:159], v238, s[12:15], s45 offen offset:3072 sc1
    s_add_u32 s45, s45, 4096
    v_mfma_f32_32x32x16_bf16 v[32:47], v[68:71], a[0:3], v[32:47]
    ds_read_b128 v[88:91], v245 offset:51200
    s_add_u32 m0, s40, 32768
    s_nop 0
    buffer_load_dwordx4 v238, s[8:11], s43 offen offset:0 sc1 lds
    v_mfma_f32_32x32x16_bf16 v[48:63], v[68:71], v[128:131], v[48:63]
    ds_read_b128 v[92:95], v245 offset:52224
    buffer_load_dwordx4 v238, s[8:11], s43 offen offset:1024 sc1 lds
    v_mfma_f32_32x32x16_bf16 v[0:15], v[72:75], a[4:7], v[0:15]
    buffer_load_dwordx4 v238, s[8:11], s43 offen offset:2048 sc1 lds
    v_mfma_f32_32x32x16_bf16 v[16:31], v[72:75], v[132:135], v[16:31]
    buffer_load_dwordx4 v238, s[8:11], s43 offen offset:3072 sc1 lds
    s_add_u32 s43, s43, 4096
    v_mfma_f32_32x32x16_bf16 v[32:47], v[76:79], a[4:7], v[32:47]
    v_mfma_f32_32x32x16_bf16 v[48:63], v[76:79], v[132:135], v[48:63]
    s_waitcnt vmcnt(12) lgkmcnt(0)
    v_mfma_f32_32x32x16_bf16 v[0:15], v[80:83], a[8:11], v[0:15]
    ds_read_b128 v[64:67], v246 offset:0
    buffer_load_dwordx4 v[160:163], v238, s[12:15], s45 offen offset:0 sc1
    v_mfma_f32_32x32x16_bf16 v[16:31], v[80:83], v[136:139], v[16:31]
    ds_read_b128 v[68:71], v246 offset:1024
    buffer_load_dwordx4 v[164:167], v238, s[12:15], s45 offen offset:1024 sc1
    v_mfma_f32_32x32x16_bf16 v[32:47], v[84:87], a[8:11], v[32:47]
    ds_read_b128 v[72:75], v246 offset:2048
    s_add_u32 m0, s40, 49152
    s_nop 0
    buffer_load_dwordx4 v238, s[8:11], s43 offen offset:0 sc1 lds
    v_mfma_f32_32x32x16_bf16 v[48:63], v[84:87], v[136:139], v[48:63]
    ds_read_b128 v[76:79], v246 offset:3072
    buffer_load_dwordx4 v238, s[8:11], s43 offen offset:1024 sc1 lds
    v_mfma_f32_32x32x16_bf16 v[0:15], v[88:91], a[12:15], v[0:15]
    buffer_load_dwordx4 v238, s[8:11], s43 offen offset:2048 sc1 lds
    v_mfma_f32_32x32x16_bf16 v[16:31], v[88:91], v[140:143], v[16:31]
    buffer_load_dwordx4 v238, s[8:11], s43 offen offset:3072 sc1 lds
    s_add_u32 s43, s43, 4096
    v_mfma_f32_32x32x16_bf16 v[32:47], v[92:95], a[12:15], v[32:47]
    v_mfma_f32_32x32x16_bf16 v[48:63], v[92:95], v[140:143], v[48:63]
    s_waitcnt vmcnt(12) lgkmcnt(0)
    v_mfma_f32_32x32x16_bf16 v[0:15], v[64:67], a[16:19], v[0:15]
    ds_read_b128 v[80:83], v246 offset:16384
    buffer_load_dwordx4 v[168:171], v238, s[12:15], s45 offen offset:2048 sc1
    v_mfma_f32_32x32x16_bf16 v[16:31], v[64:67], v[144:147], v[16:31]
    ds_read_b128 v[84:87], v246 offset:17408
    buffer_load_dwordx4 v[172:175], v238, s[12:15], s45 offen offset:3072 sc1
    s_add_u32 s45, s45, 4096
    v_mfma_f32_32x32x16_bf16 v[32:47], v[68:71], a[16:19], v[32:47]
    ds_read_b128 v[88:91], v246 offset:18432
    s_add_u32 m0, s40, 0
    s_nop 0
    buffer_load_dwordx4 v238, s[8:11], s43 offen offset:0 sc1 lds
    v_mfma_f32_32x32x16_bf16 v[48:63], v[68:71], v[144:147], v[48:63]
    ds_read_b128 v[92:95], v246 offset:19456
    buffer_load_dwordx4 v238, s[8:11], s43 offen offset:1024 sc1 lds
    v_mfma_f32_32x32x16_bf16 v[0:15], v[72:75], a[20:23], v[0:15]
    buffer_load_dwordx4 v238, s[8:11], s43 offen offset:2048 sc1 lds
    v_mfma_f32_32x32x16_bf16 v[16:31], v[72:75], v[148:151], v[16:31]
    buffer_load_dwordx4 v238, s[8:11], s43 offen offset:3072 sc1 lds
    s_add_u32 s43, s43, 4096
    v_mfma_f32_32x32x16_bf16 v[32:47], v[76:79], a[20:23], v[32:47]
    v_mfma_f32_32x32x16_bf16 v[48:63], v[76:79], v[148:151], v[48:63]
    s_waitcnt vmcnt(12) lgkmcnt(0)
    v_mfma_f32_32x32x16_bf16 v[0:15], v[80:83], a[24:27], v[0:15]
    ds_read_b128 v[64:67], v244 offset:32768
    buffer_load_dwordx4 v[176:179], v238, s[12:15], s45 offen offset:0 sc1
    v_mfma_f32_32x32x16_bf16 v[16:31], v[80:83], v[152:155], v[16:31]
    ds_read_b128 v[68:71], v244 offset:33792
    buffer_load_dwordx4 v[180:183], v238, s[12:15], s45 offen offset:1024 sc1
    v_mfma_f32_32x32x16_bf16 v[32:47], v[84:87], a[24:27], v[32:47]
    ds_read_b128 v[72:75], v244 offset:34816
    s_add_u32 m0, s40, 16384
    s_nop 0
    buffer_load_dwordx4 v238, s[8:11], s43 offen offset:0 sc1 lds
    v_mfma_f32_32x32x16_bf16 v[48:63], v[84:87], v[152:155], v[48:63]
    ds_read_b128 v[76:79], v244 offset:35840
    buffer_load_dwordx4 v238, s[8:11], s43 offen offset:1024 sc1 lds
    v_mfma_f32_32x32x16_bf16 v[0:15], v[88:91], a[28:31], v[0:15]
    buffer_load_dwordx4 v238, s[8:11], s43 offen offset:2048 sc1 lds
    v_mfma_f32_32x32x16_bf16 v[16:31], v[88:91], v[156:159], v[16:31]
    buffer_load_dwordx4 v238, s[8:11], s43 offen offset:3072 sc1 lds
    s_add_u32 s43, s43, 4096
    v_mfma_f32_32x32x16_bf16 v[32:47], v[92:95], a[28:31], v[32:47]
    v_mfma_f32_32x32x16_bf16 v[48:63], v[92:95], v[156:159], v[48:63]
    s_waitcnt vmcnt(12) lgkmcnt(0)
    v_mfma_f32_32x32x16_bf16 v[0:15], v[64:67], a[32:35], v[0:15]
    ds_read_b128 v[80:83], v244 offset:49152
    buffer_load_dwordx4 v[184:187], v238, s[12:15], s45 offen offset:2048 sc1
    v_mfma_f32_32x32x16_bf16 v[16:31], v[64:67], v[160:163], v[16:31]
    ds_read_b128 v[84:87], v244 offset:50176
    buffer_load_dwordx4 v[188:191], v238, s[12:15], s45 offen offset:3072 sc1
    s_add_u32 s45, s45, 4096
    v_mfma_f32_32x32x16_bf16 v[32:47], v[68:71], a[32:35], v[32:47]
    ds_read_b128 v[88:91], v244 offset:51200
    v_mfma_f32_32x32x16_bf16 v[48:63], v[68:71], v[160:163], v[48:63]
    ds_read_b128 v[92:95], v244 offset:52224
    v_mfma_f32_32x32x16_bf16 v[0:15], v[72:75], a[36:39], v[0:15]
    v_mfma_f32_32x32x16_bf16 v[16:31], v[72:75], v[164:167], v[16:31]
    v_mfma_f32_32x32x16_bf16 v[32:47], v[76:79], a[36:39], v[32:47]
    v_mfma_f32_32x32x16_bf16 v[48:63], v[76:79], v[164:167], v[48:63]
    s_waitcnt vmcnt(8) lgkmcnt(0)
    v_mfma_f32_32x32x16_bf16 v[0:15], v[80:83], a[40:43], v[0:15]
    ds_read_b128 v[64:67], v244 offset:0
    v_mfma_f32_32x32x16_bf16 v[16:31], v[80:83], v[168:171], v[16:31]
    ds_read_b128 v[68:71], v244 offset:1024
    v_mfma_f32_32x32x16_bf16 v[32:47], v[84:87], a[40:43], v[32:47]
    ds_read_b128 v[72:75], v244 offset:2048
    v_mfma_f32_32x32x16_bf16 v[48:63], v[84:87], v[168:171], v[48:63]
    ds_read_b128 v[76:79], v244 offset:3072
    v_mfma_f32_32x32x16_bf16 v[0:15], v[88:91], a[44:47], v[0:15]
    v_mfma_f32_32x32x16_bf16 v[16:31], v[88:91], v[172:175], v[16:31]
    v_mfma_f32_32x32x16_bf16 v[32:47], v[92:95], a[44:47], v[32:47]
    v_mfma_f32_32x32x16_bf16 v[48:63], v[92:95], v[172:175], v[48:63]
    s_waitcnt vmcnt(2) lgkmcnt(0)
    ds_read_b128 v[80:83], v244 offset:16384
    ds_read_b128 v[84:87], v244 offset:17408
    ds_read_b128 v[88:91], v244 offset:18432
    ds_read_b128 v[92:95], v244 offset:19456
    v_mfma_f32_32x32x16_bf16 v[0:15], v[64:67], a[48:51], v[0:15]
    s_lshl_b32 s3, s94, 14
    v_add_u32 v221, s3, v238
    v_add_u32 v221, 0x10000, v221
    v_mfma_f32_32x32x16_bf16 v[0:15], v[72:75], a[52:55], v[0:15]
    v_mfma_f32_32x32x16_bf16 v[16:31], v[64:67], v[176:179], v[16:31]
    v_mfma_f32_32x32x16_bf16 v[16:31], v[72:75], v[180:183], v[16:31]
    s_waitcnt vmcnt(0) lgkmcnt(0)
    v_mfma_f32_32x32x16_bf16 v[0:15], v[80:83], a[56:59], v[0:15]
    v_mfma_f32_32x32x16_bf16 v[0:15], v[88:91], a[60:63], v[0:15]
    v_mfma_f32_32x32x16_bf16 v[16:31], v[80:83], v[184:187], v[16:31]
    v_mfma_f32_32x32x16_bf16 v[16:31], v[88:91], v[188:191], v[16:31]
    s_nop 7
    v_mfma_f32_32x32x16_bf16 v[32:47], v[68:71], a[48:51], v[32:47]
    s_nop 1
    ds_write_b128 v245, v[0:3] offset:0
    ds_write_b128 v245, v[4:7] offset:1024
    v_mfma_f32_32x32x16_bf16 v[32:47], v[76:79], a[52:55], v[32:47]
    ds_write_b128 v245, v[8:11] offset:2048
    ds_write_b128 v245, v[12:15] offset:3072
    v_mfma_f32_32x32x16_bf16 v[32:47], v[84:87], a[56:59], v[32:47]
    ds_write_b128 v245, v[16:19] offset:16384
    ds_write_b128 v245, v[20:23] offset:17408
    v_mfma_f32_32x32x16_bf16 v[32:47], v[92:95], a[60:63], v[32:47]
    ds_write_b128 v245, v[24:27] offset:18432
    ds_write_b128 v245, v[28:31] offset:19456
    v_mfma_f32_32x32x16_bf16 v[48:63], v[68:71], v[176:179], v[48:63]
    v_mfma_f32_32x32x16_bf16 v[48:63], v[76:79], v[180:183], v[48:63]
    s_nop 7
    v_mfma_f32_32x32x16_bf16 v[48:63], v[84:87], v[184:187], v[48:63]
    s_nop 1
    ds_write_b128 v245, v[32:35] offset:32768
    ds_write_b128 v245, v[36:39] offset:33792
    v_mfma_f32_32x32x16_bf16 v[48:63], v[92:95], v[188:191], v[48:63]
    ds_write_b128 v245, v[40:43] offset:34816
    ds_write_b128 v245, v[44:47] offset:35840
    s_nop 7
    s_nop 1
    ds_write_b128 v245, v[48:51] offset:49152
    ds_write_b128 v245, v[52:55] offset:50176
    ds_write_b128 v245, v[56:59] offset:51200
    ds_write_b128 v245, v[60:63] offset:52224
    s_waitcnt vmcnt(0) lgkmcnt(0)
    s_barrier
    ds_read_b128 v[0:3], v221 offset:0
    ds_read_b128 v[4:7], v221 offset:1024
    ds_read_b128 v[8:11], v221 offset:2048
    ds_read_b128 v[12:15], v221 offset:3072
    ds_read_b128 v[16:19], v221 offset:4096
    ds_read_b128 v[20:23], v221 offset:5120
    ds_read_b128 v[24:27], v221 offset:6144
    ds_read_b128 v[28:31], v221 offset:7168
    ds_read_b128 v[32:35], v221 offset:8192
    ds_read_b128 v[36:39], v221 offset:9216
    ds_read_b128 v[40:43], v221 offset:10240
    ds_read_b128 v[44:47], v221 offset:11264
    ds_read_b128 v[48:51], v221 offset:12288
    ds_read_b128 v[52:55], v221 offset:13312
    ds_read_b128 v[56:59], v221 offset:14336
    ds_read_b128 v[60:63], v221 offset:15360
    s_cmp_lg_u32 s94, 0
    s_cbranch_scc1 nf_27
    s_mul_i32 s3, s2, 1171
    s_lshr_b32 s3, s3, 16
    s_mul_i32 s4, s3, 56
    s_sub_u32 s4, s2, s4
    s_lshl_b32 s4, s4, 2
    s_add_u32 s3, s3, s4
    s_cmp_ge_u32 s2, 224
    s_cselect_b32 s3, s2, s3
    s_lshl_b32 s3, s3, 3
    s_add_u32 s3, s3, 8192
    buffer_store_dwordx2 v[250:251], off, s[64:67], s3 sc0 sc1
nf_27:
    s_add_u32 m0, s58, 0
    s_nop 0
    buffer_load_dwordx4 v238, s[28:31], s56 offen offset:0 sc1 lds
    buffer_load_dwordx4 v238, s[28:31], s56 offen offset:1024 sc1 lds
    buffer_load_dwordx4 v238, s[28:31], s56 offen offset:2048 sc1 lds
    buffer_load_dwordx4 v238, s[28:31], s56 offen offset:3072 sc1 lds
    s_add_u32 m0, s58, 4096
    s_nop 0
    buffer_load_dwordx4 v238, s[28:31], s53 offen offset:0 sc1 lds
    buffer_load_dwordx4 v238, s[28:31], s53 offen offset:1024 sc1 lds
    buffer_load_dwordx4 v238, s[28:31], s53 offen offset:2048 sc1 lds
    s_add_u32 s56, s56, 28672
    s_add_u32 s53, s53, 28672
    v_permlane32_swap_b32 v108, v110
    v_permlane32_swap_b32 v109, v111
    v_permlane32_swap_b32 v112, v114
    v_permlane32_swap_b32 v113, v115
    s_nop 1
    v_lshlrev_b32 v64, 16, v108
    v_and_b32 v65, 0xffff0000, v108
    v_lshlrev_b32 v66, 16, v109
    v_and_b32 v67, 0xffff0000, v109
    v_lshlrev_b32 v68, 16, v110
    v_and_b32 v69, 0xffff0000, v110
    v_lshlrev_b32 v70, 16, v111
    v_and_b32 v71, 0xffff0000, v111
    v_lshlrev_b32 v72, 16, v112
    v_and_b32 v73, 0xffff0000, v112
    v_lshlrev_b32 v74, 16, v113
    v_and_b32 v75, 0xffff0000, v113
    v_lshlrev_b32 v76, 16, v114
    v_and_b32 v77, 0xffff0000, v114
    v_lshlrev_b32 v78, 16, v115
    v_and_b32 v79, 0xffff0000, v115
    s_waitcnt lgkmcnt(8)
    v_pk_add_f32 v[0:1], v[0:1], v[16:17]
    v_pk_add_f32 v[2:3], v[2:3], v[18:19]
    v_pk_add_f32 v[4:5], v[4:5], v[20:21]
    v_pk_add_f32 v[6:7], v[6:7], v[22:23]
    v_pk_add_f32 v[8:9], v[8:9], v[24:25]
    v_pk_add_f32 v[10:11], v[10:11], v[26:27]
    v_pk_add_f32 v[12:13], v[12:13], v[28:29]
    v_pk_add_f32 v[14:15], v[14:15], v[30:31]
    s_waitcnt lgkmcnt(0)
    v_pk_add_f32 v[32:33], v[32:33], v[48:49]
    v_pk_add_f32 v[34:35], v[34:35], v[50:51]
    v_pk_add_f32 v[36:37], v[36:37], v[52:53]
    v_pk_add_f32 v[38:39], v[38:39], v[54:55]
    v_pk_add_f32 v[40:41], v[40:41], v[56:57]
    v_pk_add_f32 v[42:43], v[42:43], v[58:59]
    v_pk_add_f32 v[44:45], v[44:45], v[60:61]
    v_pk_add_f32 v[46:47], v[46:47], v[62:63]
    v_pk_add_f32 v[0:1], v[0:1], v[32:33]
    v_pk_add_f32 v[2:3], v[2:3], v[34:35]
    v_pk_add_f32 v[4:5], v[4:5], v[36:37]
    v_pk_add_f32 v[6:7], v[6:7], v[38:39]
    v_pk_add_f32 v[8:9], v[8:9], v[40:41]
    v_pk_add_f32 v[10:11], v[10:11], v[42:43]
    v_pk_add_f32 v[12:13], v[12:13], v[44:45]
    v_pk_add_f32 v[14:15], v[14:15], v[46:47]
    v_pk_add_f32 v[0:1], v[0:1], v[64:65]
    v_pk_add_f32 v[2:3], v[2:3], v[66:67]
    v_pk_add_f32 v[4:5], v[4:5], v[68:69]
    v_pk_add_f32 v[6:7], v[6:7], v[70:71]
    v_pk_add_f32 v[8:9], v[8:9], v[72:73]
    v_pk_add_f32 v[10:11], v[10:11], v[74:75]
    v_pk_add_f32 v[12:13], v[12:13], v[76:77]
    v_pk_add_f32 v[14:15], v[14:15], v[78:79]
    v_cvt_pk_bf16_f32 v228, v0, v1
    v_cvt_pk_bf16_f32 v229, v2, v3
    v_cvt_pk_bf16_f32 v230, v4, v5
    v_cvt_pk_bf16_f32 v231, v6, v7
    v_cvt_pk_bf16_f32 v232, v8, v9
    v_cvt_pk_bf16_f32 v233, v10, v11
    v_cvt_pk_bf16_f32 v234, v12, v13
    v_cvt_pk_bf16_f32 v235, v14, v15
    buffer_store_dwordx4 v[228:231], v238, s[20:23], s62 offen sc0 sc1
    buffer_store_dwordx4 v[232:235], v238, s[20:23], s62 offen offset:1024 sc0 sc1
    v_lshlrev_b32 v64, 16, v228
    v_and_b32 v65, 0xffff0000, v228
    v_lshlrev_b32 v66, 16, v229
    v_and_b32 v67, 0xffff0000, v229
    v_lshlrev_b32 v68, 16, v230
    v_and_b32 v69, 0xffff0000, v230
    v_lshlrev_b32 v70, 16, v231
    v_and_b32 v71, 0xffff0000, v231
    v_lshlrev_b32 v72, 16, v232
    v_and_b32 v73, 0xffff0000, v232
    v_lshlrev_b32 v74, 16, v233
    v_and_b32 v75, 0xffff0000, v233
    v_lshlrev_b32 v76, 16, v234
    v_and_b32 v77, 0xffff0000, v234
    v_lshlrev_b32 v78, 16, v235
    v_and_b32 v79, 0xffff0000, v235
    v_add_f32 v32, v64, v65
    v_mul_f32 v33, v64, v64
    v_fmac_f32 v33, v65, v65
    v_add_f32 v32, v32, v66
    v_fmac_f32 v33, v66, v66
    v_add_f32 v32, v32, v67
    v_fmac_f32 v33, v67, v67
    v_add_f32 v32, v32, v68
    v_fmac_f32 v33, v68, v68
    v_add_f32 v32, v32, v69
    v_fmac_f32 v33, v69, v69
    v_add_f32 v32, v32, v70
    v_fmac_f32 v33, v70, v70
    v_add_f32 v32, v32, v71
    v_fmac_f32 v33, v71, v71
    v_add_f32 v32, v32, v72
    v_fmac_f32 v33, v72, v72
    v_add_f32 v32, v32, v73
    v_fmac_f32 v33, v73, v73
    v_add_f32 v32, v32, v74
    v_fmac_f32 v33, v74, v74
    v_add_f32 v32, v32, v75
    v_fmac_f32 v33, v75, v75
    v_add_f32 v32, v32, v76
    v_fmac_f32 v33, v76, v76
    v_add_f32 v32, v32, v77
    v_fmac_f32 v33, v77, v77
    v_add_f32 v32, v32, v78
    v_fmac_f32 v33, v78, v78
    v_add_f32 v32, v32, v79
    v_fmac_f32 v33, v79, v79
    v_mov_b32 v34, v32
    v_mov_b32 v35, v33
    s_nop 1
    v_permlane32_swap_b32 v32, v34
    v_permlane32_swap_b32 v33, v35
    s_nop 1
    v_add_f32 v32, v32, v34
    v_add_f32 v33, v33, v35
    v_lshrrev_b32 v36, 1, v238
    s_lshl_b32 s3, s60, 12
    s_lshl_b32 s4, s61, 8
    s_add_u32 s3, s3, s4
    s_mov_b32 exec_hi, 0
    buffer_store_dwordx2 v[32:33], v36, s[24:27], s3 offen sc0 sc1
    s_mov_b32 exec_hi, -1
K4_code:
    s_add_u32 m0, s58, 28672
    s_nop 0
    buffer_load_dwordx4 v238, s[28:31], s56 offen offset:0 sc1 lds
    buffer_load_dwordx4 v238, s[28:31], s56 offen offset:1024 sc1 lds
    buffer_load_dwordx4 v238, s[28:31], s56 offen offset:2048 sc1 lds
    buffer_load_dwordx4 v238, s[28:31], s56 offen offset:3072 sc1 lds
    s_add_u32 m0, s58, 32768
    s_nop 0
    buffer_load_dwordx4 v238, s[28:31], s53 offen offset:0 sc1 lds
    buffer_load_dwordx4 v238, s[28:31], s53 offen offset:1024 sc1 lds
    buffer_load_dwordx4 v238, s[28:31], s53 offen offset:2048 sc1 lds
    s_add_u32 s56, s56, 28672
    s_add_u32 s53, s53, 28672
    s_lshl_b32 s3, s60, 12
    s_lshl_b32 s4, s61, 3
    s_add_u32 s3, s3, s4
    s_add_u32 s3, s3, 66560
    s_waitcnt vmcnt(7)
    buffer_store_dwordx2 v[250:251], off, s[64:67], s3 sc0 sc1
    s_barrier
    s_add_u32 s12, s92, 0x5000000
    s_addc_u32 s13, s93, 0
    s_mov_b32 s14, 0x200000
    s_mov_b32 s15, 0x00020000
    s_add_u32 s16, s92, 0x5200000
    s_addc_u32 s17, s93, 0
    s_mov_b32 s18, 0x40000
    s_mov_b32 s19, 0x00020000
    s_add_u32 s20, s92, 0x5300000
    s_addc_u32 s21, s93, 0
    s_mov_b32 s22, 0x38000
    s_mov_b32 s23, 0x00020000
    s_add_u32 s24, s92, 0x6000000
    s_addc_u32 s25, s93, 0
    s_mov_b32 s26, 0x700000
    s_mov_b32 s27, 0x00020000
    s_add_u32 m0, s58, 57344
    s_nop 0
    buffer_load_dwordx4 v238, s[28:31], s56 offen offset:0 sc1 lds
    buffer_load_dwordx4 v238, s[28:31], s56 offen offset:1024 sc1 lds
    buffer_load_dwordx4 v238, s[28:31], s56 offen offset:2048 sc1 lds
    buffer_load_dwordx4 v238, s[28:31], s56 offen offset:3072 sc1 lds
    s_add_u32 m0, s58, 61440
    s_nop 0
    buffer_load_dwordx4 v238, s[28:31], s53 offen offset:0 sc1 lds
    buffer_load_dwordx4 v238, s[28:31], s53 offen offset:1024 sc1 lds
    buffer_load_dwordx4 v238, s[28:31], s53 offen offset:2048 sc1 lds
    s_add_u32 s56, s56, 28672
    s_add_u32 s53, s53, 28672
    s_add_u32 m0, s58, 86016
    s_nop 0
    buffer_load_dwordx4 v238, s[28:31], s56 offen offset:0 sc1 lds
    buffer_load_dwordx4 v238, s[28:31], s56 offen offset:1024 sc1 lds
    buffer_load_dwordx4 v238, s[28:31], s56 offen offset:2048 sc1 lds
    buffer_load_dwordx4 v238, s[28:31], s56 offen offset:3072 sc1 lds
    s_add_u32 m0, s58, 90112
    s_nop 0
    buffer_load_dwordx4 v238, s[28:31], s53 offen offset:0 sc1 lds
    buffer_load_dwordx4 v238, s[28:31], s53 offen offset:1024 sc1 lds
    buffer_load_dwordx4 v238, s[28:31], s53 offen offset:2048 sc1 lds
    s_add_u32 s56, s56, 28672
    s_add_u32 s53, s53, 28672
    v_lshrrev_b32 v239, 1, v238
    v_and_b32 v239, 120, v239
    buffer_load_dwordx2 v[252:253], v239, s[64:67], s50 offen sc1
    s_add_u32 m0, s58, 114688
    s_nop 0
    buffer_load_dwordx4 v238, s[28:31], s56 offen offset:0 sc1 lds
    buffer_load_dwordx4 v238, s[28:31], s56 offen offset:1024 sc1 lds
    buffer_load_dwordx4 v238, s[28:31], s56 offen offset:2048 sc1 lds
    buffer_load_dwordx4 v238, s[28:31], s56 offen offset:3072 sc1 lds
    s_add_u32 m0, s58, 118784
    s_nop 0
    buffer_load_dwordx4 v238, s[28:31], s53 offen offset:0 sc1 lds
    buffer_load_dwordx4 v238, s[28:31], s53 offen offset:1024 sc1 lds
    buffer_load_dwordx4 v238, s[28:31], s53 offen offset:2048 sc1 lds
    s_add_u32 s56, s56, 28672
    s_add_u32 s53, s53, 28672
    s_add_u32 s8, s92, 0x7400000
    s_addc_u32 s9, s93, 0
    s_mov_b32 s10, 0x1c0000
    s_mov_b32 s11, 0x00020000
    s_mul_i32 s43, s94, 57344
    s_mul_i32 s3, s42, 229376
    s_add_u32 s43, s43, s3
    s_waitcnt vmcnt(0)
    s_barrier
    ds_read_b128 v[112:115], v199 offset:0
    ds_read_b128 v[116:119], v199 offset:1024
    ds_read_b128 v[120:123], v199 offset:2048
    ds_read_b128 v[124:127], v199 offset:3072
    ds_read_b128 v[128:131], v199 offset:4096
    ds_read_b128 v[132:135], v199 offset:5120
    ds_read_b128 v[136:139], v199 offset:6144
    s_waitcnt vmcnt(7)
    v_cmp_ne_u64 vcc, s[96:97], v[252:253]
    s_cbranch_vccnz spin_58
ok_57:
    buffer_load_dwordx4 a[0:3], v238, s[12:15], s57 offen offset:0 sc1
    buffer_load_dwordx4 a[4:7], v238, s[12:15], s57 offen offset:1024 sc1
    buffer_load_dwordx4 a[8:11], v238, s[12:15], s57 offen offset:2048 sc1
    buffer_load_dwordx4 a[12:15], v238, s[12:15], s57 offen offset:3072 sc1
    s_add_u32 s57, s57, 4096
    buffer_load_dwordx4 a[16:19], v238, s[12:15], s57 offen offset:0 sc1
    buffer_load_dwordx4 a[20:23], v238, s[12:15], s57 offen offset:1024 sc1
    buffer_load_dwordx4 a[24:27], v238, s[12:15], s57 offen offset:2048 sc1
    buffer_load_dwordx4 a[28:31], v238, s[12:15], s57 offen offset:3072 sc1
    s_add_u32 s57, s57, 4096
    buffer_load_dwordx4 a[32:35], v238, s[12:15], s57 offen offset:0 sc1
    buffer_load_dwordx4 a[36:39], v238, s[12:15], s57 offen offset:1024 sc1
    buffer_load_dwordx4 a[40:43], v238, s[12:15], s57 offen offset:2048 sc1
    buffer_load_dwordx4 a[44:47], v238, s[12:15], s57 offen offset:3072 sc1
    s_add_u32 s57, s57, 4096
    buffer_load_dwordx4 a[48:51], v238, s[12:15], s57 offen offset:0 sc1
    buffer_load_dwordx4 a[52:55], v238, s[12:15], s57 offen offset:1024 sc1
    buffer_load_dwordx4 a[56:59], v238, s[12:15], s57 offen offset:2048 sc1
    buffer_load_dwordx4 a[60:63], v238, s[12:15], s57 offen offset:3072 sc1
    s_add_u32 s57, s57, 4096
    s_waitcnt vmcnt(12)
    s_waitcnt lgkmcnt(4)
    v_mfma_f32_32x32x16_bf16 v[0:15], v[112:115], a[0:3], 0
    ds_read_b128 v[140:143], v199 offset:7168
    buffer_load_dwordx4 a[64:67], v238, s[12:15], s57 offen offset:0 sc1
    v_mfma_f32_32x32x16_bf16 v[16:31], v[116:119], a[0:3], 0
    ds_read_b128 v[144:147], v199 offset:8192
    buffer_load_dwordx4 a[68:71], v238, s[12:15], s57 offen offset:1024 sc1
    v_mfma_f32_32x32x16_bf16 v[32:47], v[120:123], a[0:3], 0
    ds_read_b128 v[148:151], v199 offset:9216
    s_waitcnt lgkmcnt(3)
    v_mfma_f32_32x32x16_bf16 v[48:63], v[124:127], a[0:3], 0
    ds_read_b128 v[152:155], v199 offset:10240
    buffer_load_dwordx4 a[72:75], v238, s[12:15], s57 offen offset:2048 sc1
    v_mfma_f32_32x32x16_bf16 v[0:15], v[128:131], a[4:7], v[0:15]
    ds_read_b128 v[156:159], v199 offset:11264
    v_mfma_f32_32x32x16_bf16 v[16:31], v[132:135], a[4:7], v[16:31]
    ds_read_b128 v[160:163], v199 offset:12288
    buffer_load_dwordx4 a[76:79], v238, s[12:15], s57 offen offset:3072 sc1
    s_add_u32 s57, s57, 4096
    v_mfma_f32_32x32x16_bf16 v[32:47], v[136:139], a[4:7], v[32:47]
    ds_read_b128 v[164:167], v199 offset:13312
    s_waitcnt lgkmcnt(4)
    v_mfma_f32_32x32x16_bf16 v[48:63], v[140:143], a[4:7], v[48:63]
    ds_read_b128 v[112:115], v199 offset:14336
    buffer_load_dwordx4 a[80:83], v238, s[12:15], s57 offen offset:0 sc1
    v_mfma_f32_32x32x16_bf16 v[0:15], v[144:147], a[8:11], v[0:15]
    ds_read_b128 v[116:119], v199 offset:15360
    buffer_load_dwordx4 a[84:87], v238, s[12:15], s57 offen offset:1024 sc1
    v_mfma_f32_32x32x16_bf16 v[16:31], v[148:151], a[8:11], v[16:31]
    ds_read_b128 v[120:123], v199 offset:16384
    s_waitcnt lgkmcnt(3)
    v_mfma_f32_32x32x16_bf16 v[32:47], v[152:155], a[8:11], v[32:47]
    ds_read_b128 v[124:127], v199 offset:17408
    buffer_load_dwordx4 a[88:91], v238, s[12:15], s57 offen offset:2048 sc1
    v_mfma_f32_32x32x16_bf16 v[48:63], v[156:159], a[8:11], v[48:63]
    ds_read_b128 v[128:131], v199 offset:18432
    v_mfma_f32_32x32x16_bf16 v[0:15], v[160:163], a[12:15], v[0:15]
    ds_read_b128 v[132:135], v199 offset:19456
    buffer_load_dwordx4 a[92:95], v238, s[12:15], s57 offen offset:3072 sc1
    s_add_u32 s57, s57, 4096
    v_mfma_f32_32x32x16_bf16 v[16:31], v[164:167], a[12:15], v[16:31]
    ds_read_b128 v[136:139], v199 offset:20480
    s_waitcnt lgkmcnt(4)
    v_mfma_f32_32x32x16_bf16 v[32:47], v[112:115], a[12:15], v[32:47]
    ds_read_b128 v[140:143], v199 offset:21504
    ds_read_b128 v[144:147], v199 offset:22528
    buffer_load_dwordx4 a[96:99], v238, s[12:15], s57 offen offset:0 sc1
    v_mfma_f32_32x32x16_bf16 v[48:63], v[116:119], a[12:15], v[48:63]
    ds_read_b128 v[148:151], v199 offset:23552
    ds_read_b128 v[152:155], v199 offset:24576
    buffer_load_dwordx4 a[100:103], v238, s[12:15], s57 offen offset:1024 sc1
    s_waitcnt vmcnt(18)
    v_mfma_f32_32x32x16_bf16 v[0:15], v[120:123], a[16:19], v[0:15]
    ds_read_b128 v[156:159], v199 offset:25600
    s_waitcnt lgkmcnt(5)
    v_mfma_f32_32x32x16_bf16 v[16:31], v[124:127], a[16:19], v[16:31]
    ds_read_b128 v[160:163], v199 offset:26624
    buffer_load_dwordx4 a[104:107], v238, s[12:15], s57 offen offset:2048 sc1
    v_mfma_f32_32x32x16_bf16 v[32:47], v[128:131], a[16:19], v[32:47]
    ds_read_b128 v[164:167], v199 offset:27648
    v_mfma_f32_32x32x16_bf16 v[48:63], v[132:135], a[16:19], v[48:63]
    buffer_load_dwordx4 a[108:111], v238, s[12:15], s57 offen offset:3072 sc1
    s_add_u32 s57, s57, 4096
    v_mfma_f32_32x32x16_bf16 v[0:15], v[136:139], a[20:23], v[0:15]
    s_waitcnt lgkmcnt(4)
    v_mfma_f32_32x32x16_bf16 v[16:31], v[140:143], a[20:23], v[16:31]
    ds_read_b128 v[112:115], v199 offset:28672
    buffer_load_dwordx4 a[112:115], v238, s[12:15], s57 offen offset:0 sc1
    v_mfma_f32_32x32x16_bf16 v[32:47], v[144:147], a[20:23], v[32:47]
    ds_read_b128 v[116:119], v199 offset:29696
    buffer_load_dwordx4 a[116:119], v238, s[12:15], s57 offen offset:1024 sc1
    v_mfma_f32_32x32x16_bf16 v[48:63], v[148:151], a[20:23], v[48:63]
    ds_read_b128 v[120:123], v199 offset:30720
    s_waitcnt lgkmcnt(3)
    v_mfma_f32_32x32x16_bf16 v[0:15], v[152:155], a[24:27], v[0:15]
    ds_read_b128 v[124:127], v199 offset:31744
    buffer_load_dwordx4 a[120:123], v238, s[12:15], s57 offen offset:2048 sc1
    v_mfma_f32_32x32x16_bf16 v[16:31], v[156:159], a[24:27], v[16:31]
    ds_read_b128 v[128:131], v199 offset:32768
    v_mfma_f32_32x32x16_bf16 v[32:47], v[160:163], a[24:27], v[32:47]
    ds_read_b128 v[132:135], v199 offset:33792
    buffer_load_dwordx4 a[124:127], v238, s[12:15], s57 offen offset:3072 sc1
    s_add_u32 s57, s57, 4096
    v_mfma_f32_32x32x16_bf16 v[48:63], v[164:167], a[24:27], v[48:63]
    ds_read_b128 v[136:139], v199 offset:34816
    s_waitcnt lgkmcnt(4)
    v_mfma_f32_32x32x16_bf16 v[0:15], v[112:115], a[28:31], v[0:15]
    ds_read_b128 v[140:143], v199 offset:35840
    s_add_u32 s3, s43, 0
    buffer_load_dwordx4 a[128:131], v238, s[8:11], s3 offen offset:0 sc1
    buffer_load_dwordx4 a[132:135], v238, s[8:11], s3 offen offset:1024 sc1
    v_mfma_f32_32x32x16_bf16 v[16:31], v[116:119], a[28:31], v[16:31]
    ds_read_b128 v[144:147], v199 offset:36864
    v_mfma_f32_32x32x16_bf16 v[32:47], v[120:123], a[28:31], v[32:47]
    ds_read_b128 v[148:151], v199 offset:37888
    s_waitcnt lgkmcnt(3)
    v_mfma_f32_32x32x16_bf16 v[48:63], v[124:127], a[28:31], v[48:63]
    ds_read_b128 v[152:155], v199 offset:38912
    s_add_u32 s3, s43, 2048
    buffer_load_dwordx4 a[136:139], v238, s[8:11], s3 offen offset:0 sc1
    buffer_load_dwordx4 a[140:143], v238, s[8:11], s3 offen offset:1024 sc1
    s_waitcnt vmcnt(24)
    v_mfma_f32_32x32x16_bf16 v[0:15], v[128:131], a[32:35], v[0:15]
    ds_read_b128 v[156:159], v199 offset:39936
    v_mfma_f32_32x32x16_bf16 v[16:31], v[132:135], a[32:35], v[16:31]
    ds_read_b128 v[160:163], v199 offset:40960
    v_mfma_f32_32x32x16_bf16 v[32:47], v[136:139], a[32:35], v[32:47]
    ds_read_b128 v[164:167], v199 offset:41984
    s_waitcnt lgkmcnt(4)
    v_mfma_f32_32x32x16_bf16 v[48:63], v[140:143], a[32:35], v[48:63]
    ds_read_b128 v[112:115], v199 offset:43008
    s_add_u32 s3, s43, 4096
    buffer_load_dwordx4 a[144:147], v238, s[8:11], s3 offen offset:0 sc1
    buffer_load_dwordx4 a[148:151], v238, s[8:11], s3 offen offset:1024 sc1
    v_mfma_f32_32x32x16_bf16 v[0:15], v[144:147], a[36:39], v[0:15]
    ds_read_b128 v[116:119], v199 offset:44032
    v_mfma_f32_32x32x16_bf16 v[16:31], v[148:151], a[36:39], v[16:31]
    ds_read_b128 v[120:123], v199 offset:45056
    s_waitcnt lgkmcnt(3)
    v_mfma_f32_32x32x16_bf16 v[32:47], v[152:155], a[36:39], v[32:47]
    ds_read_b128 v[124:127], v199 offset:46080
    s_add_u32 s3, s43, 6144
    buffer_load_dwordx4 a[152:155], v238, s[8:11], s3 offen offset:0 sc1
    buffer_load_dwordx4 a[156:159], v238, s[8:11], s3 offen offset:1024 sc1
    v_mfma_f32_32x32x16_bf16 v[48:63], v[156:159], a[36:39], v[48:63]
    ds_read_b128 v[128:131], v199 offset:47104
    v_mfma_f32_32x32x16_bf16 v[0:15], v[160:163], a[40:43], v[0:15]
    ds_read_b128 v[132:135], v199 offset:48128
    v_mfma_f32_32x32x16_bf16 v[16:31], v[164:167], a[40:43], v[16:31]
    ds_read_b128 v[136:139], v199 offset:49152
    s_waitcnt lgkmcnt(4)
    v_mfma_f32_32x32x16_bf16 v[32:47], v[112:115], a[40:43], v[32:47]
    ds_read_b128 v[140:143], v199 offset:50176
    ds_read_b128 v[144:147], v199 offset:51200
    s_lshl_b32 s52, s59, 12
    v_mfma_f32_32x32x16_bf16 v[48:63], v[116:119], a[40:43], v[48:63]
    ds_read_b128 v[148:151], v199 offset:52224
    ds_read_b128 v[152:155], v199 offset:53248
    buffer_load_dwordx2 v[168:169], v204, s[16:19], s52 offen offset:0 sc1
    v_mfma_f32_32x32x16_bf16 v[0:15], v[120:123], a[44:47], v[0:15]
    ds_read_b128 v[156:159], v199 offset:54272
    buffer_load_dwordx2 v[170:171], v204, s[16:19], s52 offen offset:256 sc1
    s_waitcnt lgkmcnt(5)
    v_mfma_f32_32x32x16_bf16 v[16:31], v[124:127], a[44:47], v[16:31]
    ds_read_b128 v[160:163], v199 offset:55296
    buffer_load_dwordx2 v[172:173], v204, s[16:19], s52 offen offset:512 sc1
    v_mfma_f32_32x32x16_bf16 v[32:47], v[128:131], a[44:47], v[32:47]
    ds_read_b128 v[164:167], v199 offset:56320
    buffer_load_dwordx2 v[174:175], v204, s[16:19], s52 offen offset:768 sc1
    v_mfma_f32_32x32x16_bf16 v[48:63], v[132:135], a[44:47], v[48:63]
    s_mul_i32 s3, s55, 112
    s_lshr_b32 s3, s3, 6
    s_lshl_b32 s3, s3, 2
    v_and_b32 v239, 15, v206
    v_min_u32 v239, 11, v239
    v_add_u32 v239, s3, v239
    v_bfe_u32 v252, v206, 4, 1
    v_mul_u32_u24 v252, 112, v252
    v_add_u32 v239, v239, v252
    v_min_u32 v239, 223, v239
    v_lshlrev_b32 v239, 3, v239
    buffer_load_dwordx2 v[252:253], v239, s[64:67], s51 offen sc1
    s_waitcnt vmcnt(29)
    v_mfma_f32_32x32x16_bf16 v[0:15], v[136:139], a[48:51], v[0:15]
    s_waitcnt vmcnt(60) lgkmcnt(0)
    s_barrier
    v_mfma_f32_32x32x16_bf16 v[16:31], v[140:143], a[48:51], v[16:31]
    ds_read_b128 v[112:115], v200 offset:0
    buffer_load_dwordx2 v[176:177], v204, s[16:19], s52 offen offset:1024 sc1
    v_mfma_f32_32x32x16_bf16 v[32:47], v[144:147], a[48:51], v[32:47]
    ds_read_b128 v[116:119], v200 offset:1024
    buffer_load_dwordx2 v[178:179], v204, s[16:19], s52 offen offset:1280 sc1
    v_mfma_f32_32x32x16_bf16 v[48:63], v[148:151], a[48:51], v[48:63]
    ds_read_b128 v[120:123], v200 offset:2048
    v_mfma_f32_32x32x16_bf16 v[0:15], v[152:155], a[52:55], v[0:15]
    ds_read_b128 v[124:127], v200 offset:3072
    buffer_load_dwordx2 v[180:181], v204, s[16:19], s52 offen offset:1536 sc1
    v_mfma_f32_32x32x16_bf16 v[16:31], v[156:159], a[52:55], v[16:31]
    ds_read_b128 v[128:131], v200 offset:4096
    v_mfma_f32_32x32x16_bf16 v[32:47], v[160:163], a[52:55], v[32:47]
    ds_read_b128 v[132:135], v200 offset:5120
    buffer_load_dwordx2 v[182:183], v204, s[16:19], s52 offen offset:1792 sc1
    v_mfma_f32_32x32x16_bf16 v[48:63], v[164:167], a[52:55], v[48:63]
    ds_read_b128 v[136:139], v200 offset:6144
    s_add_u32 m0, s58, 0
    s_waitcnt lgkmcnt(4)
    v_mfma_f32_32x32x16_bf16 v[0:15], v[112:115], a[56:59], v[0:15]
    ds_read_b128 v[140:143], v200 offset:7168
    buffer_load_dwordx4 v238, s[28:31], s56 offen offset:0 sc1 lds
    v_mfma_f32_32x32x16_bf16 v[16:31], v[116:119], a[56:59], v[16:31]
    ds_read_b128 v[144:147], v200 offset:8192
    buffer_load_dwordx4 v238, s[28:31], s56 offen offset:1024 sc1 lds
    v_mfma_f32_32x32x16_bf16 v[32:47], v[120:123], a[56:59], v[32:47]
    ds_read_b128 v[148:151], v200 offset:9216
    buffer_load_dwordx4 v238, s[28:31], s56 offen offset:2048 sc1 lds
    s_waitcnt lgkmcnt(3)
    v_mfma_f32_32x32x16_bf16 v[48:63], v[124:127], a[56:59], v[48:63]
    ds_read_b128 v[152:155], v200 offset:10240
    buffer_load_dwordx4 v238, s[28:31], s56 offen offset:3072 sc1 lds
    s_add_u32 m0, s58, 4096
    v_mfma_f32_32x32x16_bf16 v[0:15], v[128:131], a[60:63], v[0:15]
    ds_read_b128 v[156:159], v200 offset:11264
    buffer_load_dwordx4 v238, s[28:31], s53 offen offset:0 sc1 lds
    v_mfma_f32_32x32x16_bf16 v[16:31], v[132:135], a[60:63], v[16:31]
    ds_read_b128 v[160:163], v200 offset:12288
    buffer_load_dwordx4 v238, s[28:31], s53 offen offset:1024 sc1 lds
    v_mfma_f32_32x32x16_bf16 v[32:47], v[136:139], a[60:63], v[32:47]
    ds_read_b128 v[164:167], v200 offset:13312
    buffer_load_dwordx4 v238, s[28:31], s53 offen offset:2048 sc1 lds
    s_add_u32 s56, s56, 28672
    s_add_u32 s53, s53, 28672
    s_waitcnt lgkmcnt(4)
    v_mfma_f32_32x32x16_bf16 v[48:63], v[140:143], a[60:63], v[48:63]
    ds_read_b128 v[112:115], v200 offset:14336
    s_waitcnt vmcnt(11)
    v_cmp_ne_u64 vcc, s[96:97], v[252:253]
    s_cbranch_vccnz spin_60
ok_59:
    s_mul_i32 s52, s55, 448
    s_waitcnt vmcnt(36)
    v_mfma_f32_32x32x16_bf16 v[0:15], v[144:147], a[64:67], v[0:15]
    ds_read_b128 v[116:119], v200 offset:15360
    buffer_load_dword v208, v203, s[20:23], s52 offen sc1
    s_add_u32 s52, s52, 14336
    v_mfma_f32_32x32x16_bf16 v[16:31], v[148:151], a[64:67], v[16:31]
    ds_read_b128 v[120:123], v200 offset:16384
    buffer_load_dword v209, v203, s[20:23], s52 offen sc1
    s_add_u32 s52, s52, 14336
    s_waitcnt lgkmcnt(3)
    v_mfma_f32_32x32x16_bf16 v[32:47], v[152:155], a[64:67], v[32:47]
    ds_read_b128 v[124:127], v200 offset:17408
    buffer_load_dword v210, v203, s[20:23], s52 offen sc1
    s_add_u32 s52, s52, 14336
    v_mfma_f32_32x32x16_bf16 v[48:63], v[156:159], a[64:67], v[48:63]
    ds_read_b128 v[128:131], v200 offset:18432
    buffer_load_dword v211, v203, s[20:23], s52 offen sc1
    s_add_u32 s52, s52, 14336
    v_mfma_f32_32x32x16_bf16 v[0:15], v[160:163], a[68:71], v[0:15]
    ds_read_b128 v[132:135], v200 offset:19456
    buffer_load_dword v212, v203, s[20:23], s52 offen sc1
    s_add_u32 s52, s52, 14336
    v_mfma_f32_32x32x16_bf16 v[16:31], v[164:167], a[68:71], v[16:31]
    ds_read_b128 v[136:139], v200 offset:20480
    s_waitcnt lgkmcnt(4)
    v_mfma_f32_32x32x16_bf16 v[32:47], v[112:115], a[68:71], v[32:47]
    ds_read_b128 v[140:143], v200 offset:21504
    ds_read_b128 v[144:147], v200 offset:22528
    buffer_load_dword v213, v203, s[20:23], s52 offen sc1
    s_add_u32 s52, s52, 14336
    v_mfma_f32_32x32x16_bf16 v[48:63], v[116:119], a[68:71], v[48:63]
    ds_read_b128 v[148:151], v200 offset:23552
    ds_read_b128 v[152:155], v200 offset:24576
    buffer_load_dword v214, v203, s[20:23], s52 offen sc1
    s_add_u32 s52, s52, 14336
    v_mfma_f32_32x32x16_bf16 v[0:15], v[120:123], a[72:75], v[0:15]
    ds_read_b128 v[156:159], v200 offset:25600
    buffer_load_dword v215, v203, s[20:23], s52 offen sc1
    s_add_u32 s52, s52, 14336
    s_waitcnt lgkmcnt(5)
    v_mfma_f32_32x32x16_bf16 v[16:31], v[124:127], a[72:75], v[16:31]
    ds_read_b128 v[160:163], v200 offset:26624
    buffer_load_dword v216, v203, s[20:23], s52 offen sc1
    s_add_u32 s52, s52, 14336
    v_mfma_f32_32x32x16_bf16 v[32:47], v[128:131], a[72:75], v[32:47]
    ds_read_b128 v[164:167], v200 offset:27648
    buffer_load_dword v217, v203, s[20:23], s52 offen sc1
    s_add_u32 s52, s52, 14336
    v_mfma_f32_32x32x16_bf16 v[48:63], v[132:135], a[72:75], v[48:63]
    buffer_load_dword v218, v203, s[20:23], s52 offen sc1
    s_add_u32 s52, s52, 14336
    v_mfma_f32_32x32x16_bf16 v[0:15], v[136:139], a[76:79], v[0:15]
    s_waitcnt lgkmcnt(4)
    v_mfma_f32_32x32x16_bf16 v[16:31], v[140:143], a[76:79], v[16:31]
    ds_read_b128 v[112:115], v200 offset:28672
    buffer_load_dword v219, v203, s[20:23], s52 offen sc1
    s_add_u32 s52, s52, 14336
    v_mfma_f32_32x32x16_bf16 v[32:47], v[144:147], a[76:79], v[32:47]
    ds_read_b128 v[116:119], v200 offset:29696
    buffer_load_dword v220, v203, s[20:23], s52 offen sc1
    s_add_u32 s52, s52, 14336
    v_mfma_f32_32x32x16_bf16 v[48:63], v[148:151], a[76:79], v[48:63]
    ds_read_b128 v[120:123], v200 offset:30720
    buffer_load_dword v221, v203, s[20:23], s52 offen sc1
    s_add_u32 s52, s52, 14336
    s_waitcnt vmcnt(46)
    s_waitcnt lgkmcnt(3)
    v_mfma_f32_32x32x16_bf16 v[0:15], v[152:155], a[80:83], v[0:15]
    ds_read_b128 v[124:127], v200 offset:31744
    v_mfma_f32_32x32x16_bf16 v[16:31], v[156:159], a[80:83], v[16:31]
    ds_read_b128 v[128:131], v200 offset:32768
    buffer_load_dword v222, v203, s[20:23], s52 offen sc1
    s_add_u32 s52, s52, 14336
    v_mfma_f32_32x32x16_bf16 v[32:47], v[160:163], a[80:83], v[32:47]
    ds_read_b128 v[132:135], v200 offset:33792
    buffer_load_dword v223, v203, s[20:23], s52 offen sc1
    v_mfma_f32_32x32x16_bf16 v[48:63], v[164:167], a[80:83], v[48:63]
    ds_read_b128 v[136:139], v200 offset:34816
    s_add_u32 m0, s58, 28672
    s_waitcnt lgkmcnt(4)
    v_mfma_f32_32x32x16_bf16 v[0:15], v[112:115], a[84:87], v[0:15]
    ds_read_b128 v[140:143], v200 offset:35840
    buffer_load_dwordx4 v238, s[28:31], s56 offen offset:0 sc1 lds
    v_mfma_f32_32x32x16_bf16 v[16:31], v[116:119], a[84:87], v[16:31]
    ds_read_b128 v[144:147], v200 offset:36864
    buffer_load_dwordx4 v238, s[28:31], s56 offen offset:1024 sc1 lds
    v_mfma_f32_32x32x16_bf16 v[32:47], v[120:123], a[84:87], v[32:47]
    ds_read_b128 v[148:151], v200 offset:37888
    buffer_load_dwordx4 v238, s[28:31], s56 offen offset:2048 sc1 lds
    s_waitcnt lgkmcnt(3)
    v_mfma_f32_32x32x16_bf16 v[48:63], v[124:127], a[84:87], v[48:63]
    ds_read_b128 v[152:155], v200 offset:38912
    buffer_load_dwordx4 v238, s[28:31], s56 offen offset:3072 sc1 lds
    s_add_u32 m0, s58, 32768
    v_mfma_f32_32x32x16_bf16 v[0:15], v[128:131], a[88:91], v[0:15]
    ds_read_b128 v[156:159], v200 offset:39936
    buffer_load_dwordx4 v238, s[28:31], s53 offen offset:0 sc1 lds
    v_mfma_f32_32x32x16_bf16 v[16:31], v[132:135], a[88:91], v[16:31]
    ds_read_b128 v[160:163], v200 offset:40960
    buffer_load_dwordx4 v238, s[28:31], s53 offen offset:1024 sc1 lds
    v_mfma_f32_32x32x16_bf16 v[32:47], v[136:139], a[88:91], v[32:47]
    ds_read_b128 v[164:167], v200 offset:41984
    buffer_load_dwordx4 v238, s[28:31], s53 offen offset:2048 sc1 lds
    s_add_u32 s56, s56, 28672
    s_add_u32 s53, s53, 28672
    s_waitcnt lgkmcnt(4)
    v_mfma_f32_32x32x16_bf16 v[48:63], v[140:143], a[88:91], v[48:63]
    ds_read_b128 v[112:115], v200 offset:43008
    s_add_u32 s3, s43, 14336
    buffer_load_dwordx4 a[160:163], v238, s[8:11], s3 offen offset:0 sc1
    buffer_load_dwordx4 a[164:167], v238, s[8:11], s3 offen offset:1024 sc1
    v_mfma_f32_32x32x16_bf16 v[0:15], v[144:147], a[92:95], v[0:15]
    ds_read_b128 v[116:119], v200 offset:44032
    s_waitcnt vmcnt(32)
    v_add_f32 v168, v168, v176
    v_add_f32 v169, v169, v177
    v_add_f32 v170, v170, v178
    v_add_f32 v171, v171, v179
    v_add_f32 v172, v172, v180
    v_add_f32 v173, v173, v181
    v_mfma_f32_32x32x16_bf16 v[16:31], v[148:151], a[92:95], v[16:31]
    ds_read_b128 v[120:123], v200 offset:45056
    v_add_f32 v174, v174, v182
    v_add_f32 v175, v175, v183
    v_add_f32 v168, v168, v172
    v_add_f32 v169, v169, v173
    v_add_f32 v170, v170, v174
    s_waitcnt lgkmcnt(3)
    v_mfma_f32_32x32x16_bf16 v[32:47], v[152:155], a[92:95], v[32:47]
    ds_read_b128 v[124:127], v200 offset:46080
    s_add_u32 s3, s43, 16384
    buffer_load_dwordx4 a[168:171], v238, s[8:11], s3 offen offset:0 sc1
    buffer_load_dwordx4 a[172:175], v238, s[8:11], s3 offen offset:1024 sc1
    v_mfma_f32_32x32x16_bf16 v[48:63], v[156:159], a[92:95], v[48:63]
    ds_read_b128 v[128:131], v200 offset:47104
    v_add_f32 v171, v171, v175
    v_add_f32 v168, v168, v170
    v_add_f32 v169, v169, v171
    s_waitcnt vmcnt(55)
    v_mfma_f32_32x32x16_bf16 v[0:15], v[160:163], a[96:99], v[0:15]
    ds_read_b128 v[132:135], v200 offset:48128
    v_mov_b32 v170, v168
    v_mov_b32 v171, v169
    s_nop 1
    v_permlane32_swap_b32 v168, v170
    v_permlane32_swap_b32 v169, v171
    s_nop 1
    v_add_f32 v168, v168, v170
    v_add_f32 v169, v169, v171
    v_mul_f32 v168, 0x3b000000, v168
    v_mfma_f32_32x32x16_bf16 v[16:31], v[164:167], a[96:99], v[16:31]
    ds_read_b128 v[136:139], v200 offset:49152
    v_mul_f32 v169, 0x3b000000, v169
    v_fma_f32 v169, -v168, v168, v169
    v_max_f32 v169, 0, v169
    v_add_f32 v169, 0x3727c5ac, v169
    v_rcp_f32 v186, v169
    v_sub_f32 v184, 0, v168
    s_waitcnt lgkmcnt(4)
    v_mfma_f32_32x32x16_bf16 v[32:47], v[112:115], a[96:99], v[32:47]
    ds_read_b128 v[140:143], v200 offset:50176
    ds_read_b128 v[144:147], v200 offset:51200
    s_add_u32 s3, s43, 18432
    buffer_load_dwordx4 a[176:179], v238, s[8:11], s3 offen offset:0 sc1
    buffer_load_dwordx4 a[180:183], v238, s[8:11], s3 offen offset:1024 sc1
    v_mfma_f32_32x32x16_bf16 v[48:63], v[116:119], a[96:99], v[48:63]
    ds_read_b128 v[148:151], v200 offset:52224
    ds_read_b128 v[152:155], v200 offset:53248
    s_waitcnt vmcnt(13)
    v_add_f32 v208, v208, v216
    v_mfma_f32_32x32x16_bf16 v[0:15], v[120:123], a[100:103], v[0:15]
    ds_read_b128 v[156:159], v200 offset:54272
    v_add_f32 v209, v209, v217
    v_add_f32 v210, v210, v218
    v_add_f32 v211, v211, v219
    s_waitcnt lgkmcnt(5)
    v_mfma_f32_32x32x16_bf16 v[16:31], v[124:127], a[100:103], v[16:31]
    ds_read_b128 v[160:163], v200 offset:55296
    s_add_u32 s3, s43, 20480
    buffer_load_dwordx4 a[184:187], v238, s[8:11], s3 offen offset:0 sc1
    buffer_load_dwordx4 a[188:191], v238, s[8:11], s3 offen offset:1024 sc1
    v_mfma_f32_32x32x16_bf16 v[32:47], v[128:131], a[100:103], v[32:47]
    ds_read_b128 v[164:167], v200 offset:56320
    v_add_f32 v212, v212, v220
    v_add_f32 v213, v213, v221
    v_add_f32 v214, v214, v222
    v_mfma_f32_32x32x16_bf16 v[48:63], v[132:135], a[100:103], v[48:63]
    v_add_f32 v215, v215, v223
    v_add_f32 v208, v208, v212
    v_add_f32 v209, v209, v213
    v_add_f32 v210, v210, v214
    v_add_f32 v211, v211, v215
    v_mfma_f32_32x32x16_bf16 v[0:15], v[136:139], a[104:107], v[0:15]
    v_add_f32 v208, v208, v210
    v_add_f32 v209, v209, v211
    v_add_f32 v208, v208, v209
    ds_write_b32 v202, v208
    s_waitcnt vmcnt(63) lgkmcnt(0)
    s_barrier
    v_mfma_f32_32x32x16_bf16 v[16:31], v[140:143], a[104:107], v[16:31]
    ds_read_b128 v[112:115], v201 offset:0
    s_add_u32 s3, s43, 28672
    buffer_load_dwordx4 a[192:195], v238, s[8:11], s3 offen offset:0 sc1
    buffer_load_dwordx4 a[196:199], v238, s[8:11], s3 offen offset:1024 sc1
    v_mfma_f32_32x32x16_bf16 v[32:47], v[144:147], a[104:107], v[32:47]
    ds_read_b128 v[116:119], v201 offset:1024
    v_mfma_f32_32x32x16_bf16 v[48:63], v[148:151], a[104:107], v[48:63]
    ds_read_b128 v[120:123], v201 offset:2048
    v_mfma_f32_32x32x16_bf16 v[0:15], v[152:155], a[108:111], v[0:15]
    ds_read_b128 v[124:127], v201 offset:3072
    s_add_u32 s3, s43, 30720
    buffer_load_dwordx4 a[200:203], v238, s[8:11], s3 offen offset:0 sc1
    buffer_load_dwordx4 a[204:207], v238, s[8:11], s3 offen offset:1024 sc1
    v_mfma_f32_32x32x16_bf16 v[16:31], v[156:159], a[108:111], v[16:31]
    ds_read_b128 v[128:131], v201 offset:4096
    v_mfma_f32_32x32x16_bf16 v[32:47], v[160:163], a[108:111], v[32:47]
    ds_read_b128 v[132:135], v201 offset:5120
    v_mfma_f32_32x32x16_bf16 v[48:63], v[164:167], a[108:111], v[48:63]
    ds_read_b128 v[136:139], v201 offset:6144
    s_add_u32 m0, s58, 57344
    s_waitcnt vmcnt(59)
    s_waitcnt lgkmcnt(4)
    v_mfma_f32_32x32x16_bf16 v[0:15], v[112:115], a[112:115], v[0:15]
    ds_read_b128 v[140:143], v201 offset:7168
    buffer_load_dwordx4 v238, s[28:31], s56 offen offset:0 sc1 lds
    v_lshlrev_b32 v207, 4, v205
    v_add_u32 v207, 143360, v207
    v_mfma_f32_32x32x16_bf16 v[16:31], v[116:119], a[112:115], v[16:31]
    ds_read_b128 v[144:147], v201 offset:8192
    buffer_load_dwordx4 v238, s[28:31], s56 offen offset:1024 sc1 lds
    s_mul_i32 s48, s59, 114688
    s_mul_i32 s4, s55, 7168
    v_mfma_f32_32x32x16_bf16 v[32:47], v[120:123], a[112:115], v[32:47]
    ds_read_b128 v[148:151], v201 offset:9216
    buffer_load_dwordx4 v238, s[28:31], s56 offen offset:2048 sc1 lds
    s_add_u32 s48, s48, s4
    s_waitcnt lgkmcnt(3)
    v_mfma_f32_32x32x16_bf16 v[48:63], v[124:127], a[112:115], v[48:63]
    ds_read_b128 v[152:155], v201 offset:10240
    buffer_load_dwordx4 v238, s[28:31], s56 offen offset:3072 sc1 lds
    s_add_u32 m0, s58, 61440
    v_mfma_f32_32x32x16_bf16 v[0:15], v[128:131], a[116:119], v[0:15]
    ds_read_b128 v[156:159], v201 offset:11264
    buffer_load_dwordx4 v238, s[28:31], s53 offen offset:0 sc1 lds
    s_lshl_b32 s47, s59, 12
    s_lshl_b32 s4, s55, 3
    v_mfma_f32_32x32x16_bf16 v[16:31], v[132:135], a[116:119], v[16:31]
    ds_read_b128 v[160:163], v201 offset:12288
    buffer_load_dwordx4 v238, s[28:31], s53 offen offset:1024 sc1 lds
    s_add_u32 s47, s47, s4
    s_add_u32 s47, s47, 67584
    v_mfma_f32_32x32x16_bf16 v[32:47], v[136:139], a[116:119], v[32:47]
    ds_read_b128 v[164:167], v201 offset:13312
    buffer_load_dwordx4 v238, s[28:31], s53 offen offset:2048 sc1 lds
    s_add_u32 s56, s56, 28672
    s_add_u32 s53, s53, 28672
    s_waitcnt lgkmcnt(4)
    v_mfma_f32_32x32x16_bf16 v[48:63], v[140:143], a[116:119], v[48:63]
    ds_read_b128 v[112:115], v201 offset:14336
    s_add_u32 s3, s43, 32768
    buffer_load_dwordx4 a[208:211], v238, s[8:11], s3 offen offset:0 sc1
    buffer_load_dwordx4 a[212:215], v238, s[8:11], s3 offen offset:1024 sc1
    v_mfma_f32_32x32x16_bf16 v[0:15], v[144:147], a[120:123], v[0:15]
    ds_read_b128 v[116:119], v201 offset:15360
    v_mfma_f32_32x32x16_bf16 v[16:31], v[148:151], a[120:123], v[16:31]
    ds_read_b128 v[120:123], v201 offset:16384
    s_waitcnt lgkmcnt(3)
    v_mfma_f32_32x32x16_bf16 v[32:47], v[152:155], a[120:123], v[32:47]
    ds_read_b128 v[124:127], v201 offset:17408
    s_add_u32 s3, s43, 34816
    buffer_load_dwordx4 a[216:219], v238, s[8:11], s3 offen offset:0 sc1
    buffer_load_dwordx4 a[220:223], v238, s[8:11], s3 offen offset:1024 sc1
    v_mfma_f32_32x32x16_bf16 v[48:63], v[156:159], a[120:123], v[48:63]
    ds_read_b128 v[128:131], v201 offset:18432
    v_mfma_f32_32x32x16_bf16 v[0:15], v[160:163], a[124:127], v[0:15]
    ds_read_b128 v[132:135], v201 offset:19456
    v_mfma_f32_32x32x16_bf16 v[16:31], v[164:167], a[124:127], v[16:31]
    ds_read_b128 v[136:139], v201 offset:20480
    s_waitcnt lgkmcnt(4)
    v_mfma_f32_32x32x16_bf16 v[32:47], v[112:115], a[124:127], v[32:47]
    ds_read_b128 v[140:143], v201 offset:21504
    ds_read_b128 v[144:147], v201 offset:22528
    s_add_u32 s3, s43, 43008
    buffer_load_dwordx4 a[224:227], v238, s[8:11], s3 offen offset:0 sc1
    buffer_load_dwordx4 a[228:231], v238, s[8:11], s3 offen offset:1024 sc1
    v_mfma_f32_32x32x16_bf16 v[48:63], v[116:119], a[124:127], v[48:63]
    ds_read_b128 v[148:151], v201 offset:23552
    ds_read_b128 v[152:155], v201 offset:24576
    ds_read_b128 v[168:171], v207 offset:0
    v_mfma_f32_32x32x16_bf16 v[64:79], v[120:123], a[0:3], 0
    ds_read_b128 v[156:159], v201 offset:25600
    s_waitcnt lgkmcnt(6)
    v_mfma_f32_32x32x16_bf16 v[80:95], v[124:127], a[0:3], 0
    ds_read_b128 v[160:163], v201 offset:26624
    s_add_u32 s3, s43, 45056
    buffer_load_dwordx4 a[232:235], v238, s[8:11], s3 offen offset:0 sc1
    buffer_load_dwordx4 a[236:239], v238, s[8:11], s3 offen offset:1024 sc1
    v_mfma_f32_32x32x16_bf16 v[96:111], v[128:131], a[0:3], 0
    ds_read_b128 v[164:167], v201 offset:27648
    ds_read_b128 v[172:175], v207 offset:448
    ds_read_b128 v[176:179], v207 offset:32
    v_mfma_f32_32x32x16_bf16 v[64:79], v[132:135], a[4:7], v[64:79]
    ds_read_b128 v[180:183], v207 offset:480
    ds_read_b128 v[208:211], v207 offset:64
    v_mfma_f32_32x32x16_bf16 v[80:95], v[136:139], a[4:7], v[80:95]
    ds_read_b128 v[212:215], v207 offset:512
    ds_read_b128 v[216:219], v207 offset:96
    ds_read_b128 v[220:223], v207 offset:544
    s_waitcnt vmcnt(50) lgkmcnt(0)
    s_barrier
    v_mfma_f32_32x32x16_bf16 v[96:111], v[140:143], a[4:7], v[96:111]
    ds_read_b128 v[112:115], v199 offset:0
    s_add_u32 s3, s43, 47104
    buffer_load_dwordx4 a[240:243], v238, s[8:11], s3 offen offset:0 sc1
    buffer_load_dwordx4 a[244:247], v238, s[8:11], s3 offen offset:1024 sc1
    v_mfma_f32_32x32x16_bf16 v[64:79], v[144:147], a[8:11], v[64:79]
    ds_read_b128 v[116:119], v199 offset:1024
    s_waitcnt lgkmcnt(6)
    v_fma_f32 v0, v168, v184, v0
    v_fma_f32 v1, v169, v184, v1
    v_fma_f32 v2, v170, v184, v2
    v_fma_f32 v3, v171, v184, v3
    v_fma_f32 v4, v172, v184, v4
    v_mfma_f32_32x32x16_bf16 v[80:95], v[148:151], a[8:11], v[80:95]
    ds_read_b128 v[120:123], v199 offset:2048
    v_fma_f32 v5, v173, v184, v5
    v_fma_f32 v6, v174, v184, v6
    v_fma_f32 v7, v175, v184, v7
    v_fma_f32 v8, v176, v184, v8
    v_fma_f32 v9, v177, v184, v9
    v_fma_f32 v10, v178, v184, v10
    v_fma_f32 v11, v179, v184, v11
    v_mfma_f32_32x32x16_bf16 v[96:111], v[152:155], a[8:11], v[96:111]
    ds_read_b128 v[124:127], v199 offset:3072
    s_add_u32 s3, s43, 49152
    buffer_load_dwordx4 a[248:251], v238, s[8:11], s3 offen offset:0 sc1
    buffer_load_dwordx4 a[252:255], v238, s[8:11], s3 offen offset:1024 sc1
    v_mfma_f32_32x32x16_bf16 v[64:79], v[156:159], a[12:15], v[64:79]
    ds_read_b128 v[128:131], v199 offset:4096
    v_fma_f32 v12, v180, v184, v12
    v_fma_f32 v13, v181, v184, v13
    v_fma_f32 v14, v182, v184, v14
    v_fma_f32 v15, v183, v184, v15
    v_mul_f32 v0, v0, v4
    v_mul_f32 v1, v1, v5
    v_mfma_f32_32x32x16_bf16 v[80:95], v[160:163], a[12:15], v[80:95]
    ds_read_b128 v[132:135], v199 offset:5120
    v_mul_f32 v2, v2, v6
    v_mul_f32 v3, v3, v7
    v_mul_f32 v8, v8, v12
    v_mul_f32 v9, v9, v13
    v_mul_f32 v10, v10, v14
    v_mul_f32 v11, v11, v15
    v_mul_f32 v0, v0, v186
    v_mfma_f32_32x32x16_bf16 v[96:111], v[164:167], a[12:15], v[96:111]
    ds_read_b128 v[136:139], v199 offset:6144
    v_mul_f32 v1, v1, v186
    v_mul_f32 v2, v2, v186
    v_mul_f32 v3, v3, v186
    v_mul_f32 v8, v8, v186
    v_mul_f32 v9, v9, v186
    v_mul_f32 v10, v10, v186
    s_waitcnt lgkmcnt(4)
    v_mfma_f32_32x32x16_bf16 v[64:79], v[112:115], a[16:19], v[64:79]
    ds_read_b128 v[140:143], v199 offset:7168
    s_add_u32 s3, s43, 8192
    buffer_load_dwordx4 a[0:3], v238, s[8:11], s3 offen offset:0 sc1
    buffer_load_dwordx4 a[4:7], v238, s[8:11], s3 offen offset:1024 sc1
    v_mfma_f32_32x32x16_bf16 v[80:95], v[116:119], a[16:19], v[80:95]
    ds_read_b128 v[144:147], v199 offset:8192
    v_mul_f32 v11, v11, v186
    v_cvt_pk_bf16_f32 v4, v0, v1
    v_cvt_pk_bf16_f32 v5, v2, v3
    v_cvt_pk_bf16_f32 v6, v8, v9
    v_cvt_pk_bf16_f32 v7, v10, v11
    buffer_store_dwordx4 v[4:7], v238, s[24:27], s48 offen offset:0 sc0 sc1
    v_mfma_f32_32x32x16_bf16 v[96:111], v[120:123], a[16:19], v[96:111]
    ds_read_b128 v[148:151], v199 offset:9216
    ds_read_b128 v[168:171], v207 offset:128
    ds_read_b128 v[172:175], v207 offset:576
    ds_read_b128 v[176:179], v207 offset:160
    ds_read_b128 v[180:183], v207 offset:608
    s_waitcnt lgkmcnt(7)
    v_mfma_f32_32x32x16_bf16 v[64:79], v[124:127], a[20:23], v[64:79]
    ds_read_b128 v[152:155], v199 offset:10240
    s_add_u32 s3, s43, 10240
    buffer_load_dwordx4 a[8:11], v238, s[8:11], s3 offen offset:0 sc1
    buffer_load_dwordx4 a[12:15], v238, s[8:11], s3 offen offset:1024 sc1
    v_mfma_f32_32x32x16_bf16 v[80:95], v[128:131], a[20:23], v[80:95]
    ds_read_b128 v[156:159], v199 offset:11264
    s_waitcnt lgkmcnt(15)
    v_fma_f32 v16, v208, v184, v16
    v_fma_f32 v17, v209, v184, v17
    v_fma_f32 v18, v210, v184, v18
    v_fma_f32 v19, v211, v184, v19
    v_fma_f32 v20, v212, v184, v20
    v_fma_f32 v21, v213, v184, v21
    v_fma_f32 v22, v214, v184, v22
    v_mfma_f32_32x32x16_bf16 v[96:111], v[132:135], a[20:23], v[96:111]
    ds_read_b128 v[160:163], v199 offset:12288
    v_fma_f32 v23, v215, v184, v23
    v_fma_f32 v24, v216, v184, v24
    v_fma_f32 v25, v217, v184, v25
    v_fma_f32 v26, v218, v184, v26
    v_fma_f32 v27, v219, v184, v27
    v_fma_f32 v28, v220, v184, v28
    v_fma_f32 v29, v221, v184, v29
    v_mfma_f32_32x32x16_bf16 v[64:79], v[136:139], a[24:27], v[64:79]
    ds_read_b128 v[164:167], v199 offset:13312
    v_fma_f32 v30, v222, v184, v30
    v_fma_f32 v31, v223, v184, v31
    v_mul_f32 v16, v16, v20
    v_mul_f32 v17, v17, v21
    v_mul_f32 v18, v18, v22
    v_mul_f32 v19, v19, v23
    v_mul_f32 v24, v24, v28
    s_waitcnt lgkmcnt(8)
    v_mfma_f32_32x32x16_bf16 v[80:95], v[140:143], a[24:27], v[80:95]
    ds_read_b128 v[112:115], v199 offset:14336
    s_add_u32 s3, s43, 12288
    buffer_load_dwordx4 a[16:19], v238, s[8:11], s3 offen offset:0 sc1
    buffer_load_dwordx4 a[20:23], v238, s[8:11], s3 offen offset:1024 sc1
    v_mfma_f32_32x32x16_bf16 v[96:111], v[144:147], a[24:27], v[96:111]
    ds_read_b128 v[116:119], v199 offset:15360
    v_mul_f32 v25, v25, v29
    v_mul_f32 v26, v26, v30
    v_mul_f32 v27, v27, v31
    v_mul_f32 v16, v16, v186
    v_mul_f32 v17, v17, v186
    v_mul_f32 v18, v18, v186
    v_mfma_f32_32x32x16_bf16 v[64:79], v[148:151], a[28:31], v[64:79]
    ds_read_b128 v[120:123], v199 offset:16384
    v_mul_f32 v19, v19, v186
    v_mul_f32 v24, v24, v186
    v_mul_f32 v25, v25, v186
    v_mul_f32 v26, v26, v186
    v_mul_f32 v27, v27, v186
    s_waitcnt lgkmcnt(3)
    v_mfma_f32_32x32x16_bf16 v[80:95], v[152:155], a[28:31], v[80:95]
    ds_read_b128 v[124:127], v199 offset:17408
    v_cvt_pk_bf16_f32 v20, v16, v17
    v_cvt_pk_bf16_f32 v21, v18, v19
    v_cvt_pk_bf16_f32 v22, v24, v25
    v_cvt_pk_bf16_f32 v23, v26, v27
    buffer_store_dwordx4 v[20:23], v238, s[24:27], s48 offen offset:1024 sc0 sc1
    v_mfma_f32_32x32x16_bf16 v[96:111], v[156:159], a[28:31], v[96:111]
    ds_read_b128 v[128:131], v199 offset:18432
    ds_read_b128 v[208:211], v207 offset:192
    ds_read_b128 v[212:215], v207 offset:640
    ds_read_b128 v[216:219], v207 offset:224
    ds_read_b128 v[220:223], v207 offset:672
    v_mfma_f32_32x32x16_bf16 v[64:79], v[160:163], a[32:35], v[64:79]
    ds_read_b128 v[132:135], v199 offset:19456
    s_waitcnt lgkmcnt(14)
    v_fma_f32 v32, v168, v184, v32
    v_fma_f32 v33, v169, v184, v33
    v_fma_f32 v34, v170, v184, v34
    v_fma_f32 v35, v171, v184, v35
    v_fma_f32 v36, v172, v184, v36
    v_mfma_f32_32x32x16_bf16 v[80:95], v[164:167], a[32:35], v[80:95]
    ds_read_b128 v[136:139], v199 offset:20480
    v_fma_f32 v37, v173, v184, v37
    v_fma_f32 v38, v174, v184, v38
    v_fma_f32 v39, v175, v184, v39
    v_fma_f32 v40, v176, v184, v40
    v_fma_f32 v41, v177, v184, v41
    v_fma_f32 v42, v178, v184, v42
    s_waitcnt lgkmcnt(8)
    v_mfma_f32_32x32x16_bf16 v[96:111], v[112:115], a[32:35], v[96:111]
    ds_read_b128 v[140:143], v199 offset:21504
    ds_read_b128 v[144:147], v199 offset:22528
    s_add_u32 s3, s43, 22528
    buffer_load_dwordx4 a[24:27], v238, s[8:11], s3 offen offset:0 sc1
    buffer_load_dwordx4 a[28:31], v238, s[8:11], s3 offen offset:1024 sc1
    v_mfma_f32_32x32x16_bf16 v[64:79], v[116:119], a[36:39], v[64:79]
    ds_read_b128 v[148:151], v199 offset:23552
    ds_read_b128 v[152:155], v199 offset:24576
    v_fma_f32 v43, v179, v184, v43
    v_fma_f32 v44, v180, v184, v44
    v_fma_f32 v45, v181, v184, v45
    v_fma_f32 v46, v182, v184, v46
    v_fma_f32 v47, v183, v184, v47
    v_mfma_f32_32x32x16_bf16 v[80:95], v[120:123], a[36:39], v[80:95]
    ds_read_b128 v[156:159], v199 offset:25600
    v_mul_f32 v32, v32, v36
    v_mul_f32 v33, v33, v37
    v_mul_f32 v34, v34, v38
    v_mul_f32 v35, v35, v39
    v_mul_f32 v40, v40, v44
    s_waitcnt lgkmcnt(5)
    v_mfma_f32_32x32x16_bf16 v[96:111], v[124:127], a[36:39], v[96:111]
    ds_read_b128 v[160:163], v199 offset:26624
    v_mul_f32 v41, v41, v45
    v_mul_f32 v42, v42, v46
    v_mul_f32 v43, v43, v47
    v_mul_f32 v32, v32, v186
    v_mul_f32 v33, v33, v186
    v_mul_f32 v34, v34, v186
    v_mfma_f32_32x32x16_bf16 v[64:79], v[128:131], a[40:43], v[64:79]
    ds_read_b128 v[164:167], v199 offset:27648
    v_mul_f32 v35, v35, v186
    v_mul_f32 v40, v40, v186
    v_mul_f32 v41, v41, v186
    v_mul_f32 v42, v42, v186
    v_mul_f32 v43, v43, v186
    v_mfma_f32_32x32x16_bf16 v[80:95], v[132:135], a[40:43], v[80:95]
    v_cvt_pk_bf16_f32 v36, v32, v33
    v_cvt_pk_bf16_f32 v37, v34, v35
    v_cvt_pk_bf16_f32 v38, v40, v41
    v_cvt_pk_bf16_f32 v39, v42, v43
    buffer_store_dwordx4 v[36:39], v238, s[24:27], s48 offen offset:2048 sc0 sc1
    v_mfma_f32_32x32x16_bf16 v[96:111], v[136:139], a[40:43], v[96:111]
    s_waitcnt lgkmcnt(9)
    v_fma_f32 v48, v208, v184, v48
    v_fma_f32 v49, v209, v184, v49
    v_fma_f32 v50, v210, v184, v50
    v_fma_f32 v51, v211, v184, v51
    v_fma_f32 v52, v212, v184, v52
    s_waitcnt vmcnt(42) lgkmcnt(0)
    s_barrier
    v_mfma_f32_32x32x16_bf16 v[64:79], v[140:143], a[44:47], v[64:79]
    ds_read_b128 v[112:115], v199 offset:28672
    s_add_u32 s3, s43, 24576
    buffer_load_dwordx4 a[32:35], v238, s[8:11], s3 offen offset:0 sc1
    buffer_load_dwordx4 a[36:39], v238, s[8:11], s3 offen offset:1024 sc1
    v_mfma_f32_32x32x16_bf16 v[80:95], v[144:147], a[44:47], v[80:95]
    ds_read_b128 v[116:119], v199 offset:29696
    v_fma_f32 v53, v213, v184, v53
    v_fma_f32 v54, v214, v184, v54
    v_fma_f32 v55, v215, v184, v55
    v_fma_f32 v56, v216, v184, v56
    v_fma_f32 v57, v217, v184, v57
    v_fma_f32 v58, v218, v184, v58
    v_mfma_f32_32x32x16_bf16 v[96:111], v[148:151], a[44:47], v[96:111]
    ds_read_b128 v[120:123], v199 offset:30720
    v_fma_f32 v59, v219, v184, v59
    v_fma_f32 v60, v220, v184, v60
    v_fma_f32 v61, v221, v184, v61
    v_fma_f32 v62, v222, v184, v62
    v_fma_f32 v63, v223, v184, v63
    v_mul_f32 v48, v48, v52
    v_mfma_f32_32x32x16_bf16 v[64:79], v[152:155], a[48:51], v[64:79]
    ds_read_b128 v[124:127], v199 offset:31744
    v_mul_f32 v49, v49, v53
    v_mul_f32 v50, v50, v54
    v_mul_f32 v51, v51, v55
    v_mul_f32 v56, v56, v60
    v_mul_f32 v57, v57, v61
    v_mul_f32 v58, v58, v62
    v_mfma_f32_32x32x16_bf16 v[80:95], v[156:159], a[48:51], v[80:95]
    ds_read_b128 v[128:131], v199 offset:32768
    v_mul_f32 v59, v59, v63
    v_mul_f32 v48, v48, v186
    v_mul_f32 v49, v49, v186
    v_mul_f32 v50, v50, v186
    v_mul_f32 v51, v51, v186
    v_mfma_f32_32x32x16_bf16 v[96:111], v[160:163], a[48:51], v[96:111]
    ds_read_b128 v[132:135], v199 offset:33792
    v_mul_f32 v56, v56, v186
    v_mul_f32 v57, v57, v186
    v_mul_f32 v58, v58, v186
    v_mul_f32 v59, v59, v186
    v_cvt_pk_bf16_f32 v52, v48, v49
    v_cvt_pk_bf16_f32 v53, v50, v51
    v_mfma_f32_32x32x16_bf16 v[64:79], v[164:167], a[52:55], v[64:79]
    ds_read_b128 v[136:139], v199 offset:34816
    v_cvt_pk_bf16_f32 v54, v56, v57
    v_cvt_pk_bf16_f32 v55, v58, v59
    buffer_store_dwordx4 v[52:55], v238, s[24:27], s48 offen offset:3072 sc0 sc1
    s_waitcnt lgkmcnt(4)
    v_mfma_f32_32x32x16_bf16 v[80:95], v[112:115], a[52:55], v[80:95]
    ds_read_b128 v[140:143], v199 offset:35840
    s_add_u32 s3, s43, 26624
    buffer_load_dwordx4 a[40:43], v238, s[8:11], s3 offen offset:0 sc1
    buffer_load_dwordx4 a[44:47], v238, s[8:11], s3 offen offset:1024 sc1
    v_mfma_f32_32x32x16_bf16 v[96:111], v[116:119], a[52:55], v[96:111]
    ds_read_b128 v[144:147], v199 offset:36864
    v_mfma_f32_32x32x16_bf16 v[64:79], v[120:123], a[56:59], v[64:79]
    ds_read_b128 v[148:151], v199 offset:37888
    s_waitcnt lgkmcnt(3)
    v_mfma_f32_32x32x16_bf16 v[80:95], v[124:127], a[56:59], v[80:95]
    ds_read_b128 v[152:155], v199 offset:38912
    v_mfma_f32_32x32x16_bf16 v[96:111], v[128:131], a[56:59], v[96:111]
    ds_read_b128 v[156:159], v199 offset:39936
    v_mfma_f32_32x32x16_bf16 v[64:79], v[132:135], a[60:63], v[64:79]
    ds_read_b128 v[160:163], v199 offset:40960
    v_mfma_f32_32x32x16_bf16 v[80:95], v[136:139], a[60:63], v[80:95]
    ds_read_b128 v[164:167], v199 offset:41984
    s_waitcnt lgkmcnt(4)
    v_mfma_f32_32x32x16_bf16 v[96:111], v[140:143], a[60:63], v[96:111]
    ds_read_b128 v[112:115], v199 offset:43008
    s_add_u32 s3, s43, 36864
    buffer_load_dwordx4 a[48:51], v238, s[8:11], s3 offen offset:0 sc1
    buffer_load_dwordx4 a[52:55], v238, s[8:11], s3 offen offset:1024 sc1
    v_mfma_f32_32x32x16_bf16 v[64:79], v[144:147], a[64:67], v[64:79]
    ds_read_b128 v[116:119], v199 offset:44032
    v_mfma_f32_32x32x16_bf16 v[80:95], v[148:151], a[64:67], v[80:95]
    ds_read_b128 v[120:123], v199 offset:45056
    s_waitcnt lgkmcnt(3)
    v_mfma_f32_32x32x16_bf16 v[96:111], v[152:155], a[64:67], v[96:111]
    ds_read_b128 v[124:127], v199 offset:46080
    v_mfma_f32_32x32x16_bf16 v[64:79], v[156:159], a[68:71], v[64:79]
    ds_read_b128 v[128:131], v199 offset:47104
    v_mfma_f32_32x32x16_bf16 v[80:95], v[160:163], a[68:71], v[80:95]
    ds_read_b128 v[132:135], v199 offset:48128
    v_mfma_f32_32x32x16_bf16 v[96:111], v[164:167], a[68:71], v[96:111]
    ds_read_b128 v[136:139], v199 offset:49152
    s_waitcnt lgkmcnt(4)
    v_mfma_f32_32x32x16_bf16 v[64:79], v[112:115], a[72:75], v[64:79]
    ds_read_b128 v[140:143], v199 offset:50176
    ds_read_b128 v[144:147], v199 offset:51200
    s_waitcnt vmcnt(4)
    buffer_store_dwordx2 v[250:251], off, s[64:67], s47 sc0 sc1
    v_mfma_f32_32x32x16_bf16 v[80:95], v[116:119], a[72:75], v[80:95]
    ds_read_b128 v[148:151], v199 offset:52224
    ds_read_b128 v[152:155], v199 offset:53248
    v_mfma_f32_32x32x16_bf16 v[96:111], v[120:123], a[72:75], v[96:111]
    ds_read_b128 v[156:159], v199 offset:54272
    s_waitcnt lgkmcnt(5)
    v_mfma_f32_32x32x16_bf16 v[64:79], v[124:127], a[76:79], v[64:79]
    ds_read_b128 v[160:163], v199 offset:55296
    s_add_u32 s3, s43, 38912
    buffer_load_dwordx4 a[56:59], v238, s[8:11], s3 offen offset:0 sc1
    buffer_load_dwordx4 a[60:63], v238, s[8:11], s3 offen offset:1024 sc1
    v_mfma_f32_32x32x16_bf16 v[80:95], v[128:131], a[76:79], v[80:95]
    ds_read_b128 v[164:167], v199 offset:56320
    v_mfma_f32_32x32x16_bf16 v[96:111], v[132:135], a[76:79], v[96:111]
    v_mfma_f32_32x32x16_bf16 v[64:79], v[136:139], a[80:83], v[64:79]
    s_waitcnt vmcnt(33) lgkmcnt(0)
    s_barrier
    v_mfma_f32_32x32x16_bf16 v[80:95], v[140:143], a[80:83], v[80:95]
    ds_read_b128 v[112:115], v200 offset:0
    v_mfma_f32_32x32x16_bf16 v[96:111], v[144:147], a[80:83], v[96:111]
    ds_read_b128 v[116:119], v200 offset:1024
    v_mfma_f32_32x32x16_bf16 v[64:79], v[148:151], a[84:87], v[64:79]
    ds_read_b128 v[120:123], v200 offset:2048
    v_mfma_f32_32x32x16_bf16 v[80:95], v[152:155], a[84:87], v[80:95]
    ds_read_b128 v[124:127], v200 offset:3072
    v_mfma_f32_32x32x16_bf16 v[96:111], v[156:159], a[84:87], v[96:111]
    ds_read_b128 v[128:131], v200 offset:4096
    v_mfma_f32_32x32x16_bf16 v[64:79], v[160:163], a[88:91], v[64:79]
    ds_read_b128 v[132:135], v200 offset:5120
    v_mfma_f32_32x32x16_bf16 v[80:95], v[164:167], a[88:91], v[80:95]
    ds_read_b128 v[136:139], v200 offset:6144
    s_waitcnt lgkmcnt(4)
    v_mfma_f32_32x32x16_bf16 v[96:111], v[112:115], a[88:91], v[96:111]
    ds_read_b128 v[140:143], v200 offset:7168
    v_mfma_f32_32x32x16_bf16 v[64:79], v[116:119], a[92:95], v[64:79]
    ds_read_b128 v[144:147], v200 offset:8192
    v_mfma_f32_32x32x16_bf16 v[80:95], v[120:123], a[92:95], v[80:95]
    ds_read_b128 v[148:151], v200 offset:9216
    s_waitcnt lgkmcnt(3)
    v_mfma_f32_32x32x16_bf16 v[96:111], v[124:127], a[92:95], v[96:111]
    ds_read_b128 v[152:155], v200 offset:10240
    v_mfma_f32_32x32x16_bf16 v[64:79], v[128:131], a[96:99], v[64:79]
    ds_read_b128 v[156:159], v200 offset:11264
    v_mfma_f32_32x32x16_bf16 v[80:95], v[132:135], a[96:99], v[80:95]
    ds_read_b128 v[160:163], v200 offset:12288
    v_mfma_f32_32x32x16_bf16 v[96:111], v[136:139], a[96:99], v[96:111]
    ds_read_b128 v[164:167], v200 offset:13312
    s_waitcnt lgkmcnt(4)
    v_mfma_f32_32x32x16_bf16 v[64:79], v[140:143], a[100:103], v[64:79]
    ds_read_b128 v[112:115], v200 offset:14336
    s_mul_i32 s44, s41, 114688
    s_mul_i32 s4, s94, 28672
    s_add_u32 s44, s44, s4
    v_mfma_f32_32x32x16_bf16 v[80:95], v[144:147], a[100:103], v[80:95]
    ds_read_b128 v[116:119], v200 offset:15360
    s_xor_b32 s5, s41, 0
    s_add_u32 s5, s5, 32
    s_sub_u32 s5, s5, s41
    v_mfma_f32_32x32x16_bf16 v[96:111], v[148:151], a[100:103], v[96:111]
    ds_read_b128 v[120:123], v200 offset:16384
    s_mul_i32 s4, s5, 114688
    s_add_u32 s45, s44, s4
    s_waitcnt lgkmcnt(3)
    v_mfma_f32_32x32x16_bf16 v[64:79], v[152:155], a[104:107], v[64:79]
    ds_read_b128 v[124:127], v200 offset:17408
    s_lshl_b32 s5, s5, 6
    s_lshl_b32 s38, s41, 12
    s_lshl_b32 s4, s94, 5
    s_add_u32 s38, s38, s4
    v_mfma_f32_32x32x16_bf16 v[80:95], v[156:159], a[104:107], v[80:95]
    ds_read_b128 v[128:131], v200 offset:18432
    s_add_u32 s38, s38, 67584
    v_bfe_u32 v239, v238, 4, 2
    v_lshlrev_b32 v239, 3, v239
    v_mfma_f32_32x32x16_bf16 v[96:111], v[160:163], a[104:107], v[96:111]
    ds_read_b128 v[132:135], v200 offset:19456
    v_and_b32 v252, 64, v238
    v_mad_u32_u24 v239, v252, s5, v239
    v_mfma_f32_32x32x16_bf16 v[64:79], v[164:167], a[108:111], v[64:79]
    ds_read_b128 v[136:139], v200 offset:20480
    s_mov_b32 s20, s88
    s_mov_b32 s21, s89
    s_mov_b32 s22, 0x200000
    s_mov_b32 s23, 0x00020000
    s_waitcnt lgkmcnt(4)
    v_mfma_f32_32x32x16_bf16 v[80:95], v[112:115], a[108:111], v[80:95]
    ds_read_b128 v[140:143], v200 offset:21504
    ds_read_b128 v[144:147], v200 offset:22528
    v_mfma_f32_32x32x16_bf16 v[96:111], v[116:119], a[108:111], v[96:111]
    ds_read_b128 v[148:151], v200 offset:23552
    ds_read_b128 v[152:155], v200 offset:24576
    v_mfma_f32_32x32x16_bf16 v[64:79], v[120:123], a[112:115], v[64:79]
    ds_read_b128 v[156:159], v200 offset:25600
    s_waitcnt lgkmcnt(5)
    v_mfma_f32_32x32x16_bf16 v[80:95], v[124:127], a[112:115], v[80:95]
    ds_read_b128 v[160:163], v200 offset:26624
    v_mfma_f32_32x32x16_bf16 v[96:111], v[128:131], a[112:115], v[96:111]
    ds_read_b128 v[164:167], v200 offset:27648
    v_mfma_f32_32x32x16_bf16 v[64:79], v[132:135], a[116:119], v[64:79]
    v_mfma_f32_32x32x16_bf16 v[80:95], v[136:139], a[116:119], v[80:95]
    s_waitcnt lgkmcnt(4)
    v_mfma_f32_32x32x16_bf16 v[96:111], v[140:143], a[116:119], v[96:111]
    v_mfma_f32_32x32x16_bf16 v[64:79], v[144:147], a[120:123], v[64:79]
    v_mfma_f32_32x32x16_bf16 v[80:95], v[148:151], a[120:123], v[80:95]
    s_waitcnt lgkmcnt(0)
    v_mfma_f32_32x32x16_bf16 v[96:111], v[152:155], a[120:123], v[96:111]
    v_mfma_f32_32x32x16_bf16 v[64:79], v[156:159], a[124:127], v[64:79]
    v_mfma_f32_32x32x16_bf16 v[80:95], v[160:163], a[124:127], v[80:95]
    v_mfma_f32_32x32x16_bf16 v[96:111], v[164:167], a[124:127], v[96:111]
    ds_read_b128 v[112:115], v207 offset:256
    ds_read_b128 v[116:119], v207 offset:704
    ds_read_b128 v[120:123], v207 offset:288
    ds_read_b128 v[124:127], v207 offset:736
    ds_read_b128 v[128:131], v207 offset:320
    ds_read_b128 v[132:135], v207 offset:768
    ds_read_b128 v[136:139], v207 offset:352
    ds_read_b128 v[140:143], v207 offset:800
    ds_read_b128 v[168:171], v207 offset:384
    ds_read_b128 v[172:175], v207 offset:832
    ds_read_b128 v[176:179], v207 offset:416
    ds_read_b128 v[180:183], v207 offset:864
    buffer_load_dwordx2 v[252:253], v239, s[64:67], s38 offen sc1
    s_add_u32 s48, s48, 4096
    s_waitcnt lgkmcnt(8)
    v_pk_fma_f32 v[64:65], v[112:113], v[184:185], v[64:65] op_sel_hi:[1,0,1]
    v_pk_fma_f32 v[66:67], v[114:115], v[184:185], v[66:67] op_sel_hi:[1,0,1]
    v_pk_fma_f32 v[68:69], v[116:117], v[184:185], v[68:69] op_sel_hi:[1,0,1]
    v_pk_fma_f32 v[70:71], v[118:119], v[184:185], v[70:71] op_sel_hi:[1,0,1]
    v_pk_fma_f32 v[72:73], v[120:121], v[184:185], v[72:73] op_sel_hi:[1,0,1]
    v_pk_fma_f32 v[74:75], v[122:123], v[184:185], v[74:75] op_sel_hi:[1,0,1]
    v_pk_fma_f32 v[76:77], v[124:125], v[184:185], v[76:77] op_sel_hi:[1,0,1]
    v_pk_fma_f32 v[78:79], v[126:127], v[184:185], v[78:79] op_sel_hi:[1,0,1]
    v_pk_mul_f32 v[64:65], v[64:65], v[68:69]
    v_pk_mul_f32 v[66:67], v[66:67], v[70:71]
    v_pk_mul_f32 v[72:73], v[72:73], v[76:77]
    v_pk_mul_f32 v[74:75], v[74:75], v[78:79]
    v_pk_mul_f32 v[64:65], v[64:65], v[186:187] op_sel_hi:[1,0]
    v_pk_mul_f32 v[66:67], v[66:67], v[186:187] op_sel_hi:[1,0]
    v_pk_mul_f32 v[72:73], v[72:73], v[186:187] op_sel_hi:[1,0]
    v_pk_mul_f32 v[74:75], v[74:75], v[186:187] op_sel_hi:[1,0]
    v_cvt_pk_bf16_f32 v68, v64, v65
    v_cvt_pk_bf16_f32 v69, v66, v67
    v_cvt_pk_bf16_f32 v70, v72, v73
    v_cvt_pk_bf16_f32 v71, v74, v75
    buffer_store_dwordx4 v[68:71], v238, s[24:27], s48 offen offset:0 sc0 sc1
    s_waitcnt lgkmcnt(4)
    v_pk_fma_f32 v[80:81], v[128:129], v[184:185], v[80:81] op_sel_hi:[1,0,1]
    v_pk_fma_f32 v[82:83], v[130:131], v[184:185], v[82:83] op_sel_hi:[1,0,1]
    v_pk_fma_f32 v[84:85], v[132:133], v[184:185], v[84:85] op_sel_hi:[1,0,1]
    v_pk_fma_f32 v[86:87], v[134:135], v[184:185], v[86:87] op_sel_hi:[1,0,1]
    v_pk_fma_f32 v[88:89], v[136:137], v[184:185], v[88:89] op_sel_hi:[1,0,1]
    v_pk_fma_f32 v[90:91], v[138:139], v[184:185], v[90:91] op_sel_hi:[1,0,1]
    v_pk_fma_f32 v[92:93], v[140:141], v[184:185], v[92:93] op_sel_hi:[1,0,1]
    v_pk_fma_f32 v[94:95], v[142:143], v[184:185], v[94:95] op_sel_hi:[1,0,1]
    v_pk_mul_f32 v[80:81], v[80:81], v[84:85]
    v_pk_mul_f32 v[82:83], v[82:83], v[86:87]
    v_pk_mul_f32 v[88:89], v[88:89], v[92:93]
    v_pk_mul_f32 v[90:91], v[90:91], v[94:95]
    v_pk_mul_f32 v[80:81], v[80:81], v[186:187] op_sel_hi:[1,0]
    v_pk_mul_f32 v[82:83], v[82:83], v[186:187] op_sel_hi:[1,0]
    v_pk_mul_f32 v[88:89], v[88:89], v[186:187] op_sel_hi:[1,0]
    v_pk_mul_f32 v[90:91], v[90:91], v[186:187] op_sel_hi:[1,0]
    v_cvt_pk_bf16_f32 v84, v80, v81
    v_cvt_pk_bf16_f32 v85, v82, v83
    v_cvt_pk_bf16_f32 v86, v88, v89
    v_cvt_pk_bf16_f32 v87, v90, v91
    buffer_store_dwordx4 v[84:87], v238, s[24:27], s48 offen offset:1024 sc0 sc1
    s_waitcnt lgkmcnt(0)
    v_pk_fma_f32 v[96:97], v[168:169], v[184:185], v[96:97] op_sel_hi:[1,0,1]
    v_pk_fma_f32 v[98:99], v[170:171], v[184:185], v[98:99] op_sel_hi:[1,0,1]
    v_pk_fma_f32 v[100:101], v[172:173], v[184:185], v[100:101] op_sel_hi:[1,0,1]
    v_pk_fma_f32 v[102:103], v[174:175], v[184:185], v[102:103] op_sel_hi:[1,0,1]
    v_pk_fma_f32 v[104:105], v[176:177], v[184:185], v[104:105] op_sel_hi:[1,0,1]
    v_pk_fma_f32 v[106:107], v[178:179], v[184:185], v[106:107] op_sel_hi:[1,0,1]
    v_pk_fma_f32 v[108:109], v[180:181], v[184:185], v[108:109] op_sel_hi:[1,0,1]
    v_pk_fma_f32 v[110:111], v[182:183], v[184:185], v[110:111] op_sel_hi:[1,0,1]
    v_pk_mul_f32 v[96:97], v[96:97], v[100:101]
    v_pk_mul_f32 v[98:99], v[98:99], v[102:103]
    v_pk_mul_f32 v[104:105], v[104:105], v[108:109]
    v_pk_mul_f32 v[106:107], v[106:107], v[110:111]
    v_pk_mul_f32 v[96:97], v[96:97], v[186:187] op_sel_hi:[1,0]
    v_pk_mul_f32 v[98:99], v[98:99], v[186:187] op_sel_hi:[1,0]
    v_pk_mul_f32 v[104:105], v[104:105], v[186:187] op_sel_hi:[1,0]
    v_pk_mul_f32 v[106:107], v[106:107], v[186:187] op_sel_hi:[1,0]
    v_cvt_pk_bf16_f32 v100, v96, v97
    v_cvt_pk_bf16_f32 v101, v98, v99
    v_cvt_pk_bf16_f32 v102, v104, v105
    v_cvt_pk_bf16_f32 v103, v106, v107
    buffer_store_dwordx4 v[100:103], v238, s[24:27], s48 offen offset:2048 sc0 sc1
    s_add_u32 s47, s47, 128
    s_waitcnt vmcnt(3)
    v_cmp_ne_u64 vcc, s[96:97], v[252:253]
    s_cbranch_vccnz spin_62
ok_61:
    s_add_u32 s38, s38, 128
    s_add_u32 s3, s44, 0
    buffer_load_dwordx4 v[64:67], v238, s[24:27], s3 offen offset:0 sc1
    s_add_u32 s3, s45, 0
    buffer_load_dwordx4 v[68:71], v238, s[24:27], s3 offen offset:0 sc1
    s_add_u32 s3, s44, 0
    buffer_load_dwordx4 v[72:75], v238, s[24:27], s3 offen offset:1024 sc1
    s_add_u32 s3, s45, 0
    buffer_load_dwordx4 v[76:79], v238, s[24:27], s3 offen offset:1024 sc1
    s_add_u32 s3, s44, 0
    buffer_load_dwordx4 v[80:83], v238, s[24:27], s3 offen offset:2048 sc1
    s_add_u32 s3, s45, 0
    buffer_load_dwordx4 v[84:87], v238, s[24:27], s3 offen offset:2048 sc1
    s_add_u32 s3, s44, 0
    buffer_load_dwordx4 v[88:91], v238, s[24:27], s3 offen offset:3072 sc1
    s_add_u32 s3, s45, 0
    buffer_load_dwordx4 v[92:95], v238, s[24:27], s3 offen offset:3072 sc1
    s_add_u32 s3, s44, 4096
    buffer_load_dwordx4 v[96:99], v238, s[24:27], s3 offen offset:3072 sc1
    s_add_u32 s3, s45, 4096
    buffer_load_dwordx4 v[100:103], v238, s[24:27], s3 offen offset:3072 sc1
    s_add_u32 s3, s44, 8192
    buffer_load_dwordx4 v[104:107], v238, s[24:27], s3 offen offset:0 sc1
    s_add_u32 s3, s45, 8192
    buffer_load_dwordx4 v[108:111], v238, s[24:27], s3 offen offset:0 sc1
    s_waitcnt vmcnt(12)
    buffer_store_dwordx2 v[250:251], off, s[64:67], s47 sc0 sc1
    s_add_u32 s3, s44, 8192
    buffer_load_dwordx4 v[112:115], v238, s[24:27], s3 offen offset:1024 sc1
    s_add_u32 s3, s45, 8192
    buffer_load_dwordx4 v[116:119], v238, s[24:27], s3 offen offset:1024 sc1
    s_add_u32 s3, s44, 8192
    buffer_load_dwordx4 v[120:123], v238, s[24:27], s3 offen offset:2048 sc1
    s_add_u32 s3, s45, 8192
    buffer_load_dwordx4 v[124:127], v238, s[24:27], s3 offen offset:2048 sc1
    s_barrier
    s_waitcnt vmcnt(13)
    v_mfma_f32_32x32x16_bf16 v[0:15], a[128:131], v[64:67], 0
    s_add_u32 s3, s44, 12288
    buffer_load_dwordx4 v[128:131], v238, s[24:27], s3 offen offset:2048 sc1
    v_mfma_f32_32x32x16_bf16 v[16:31], a[128:131], v[68:71], 0
    v_mfma_f32_32x32x16_bf16 v[32:47], a[132:135], v[64:67], 0
    s_add_u32 s3, s45, 12288
    buffer_load_dwordx4 v[132:135], v238, s[24:27], s3 offen offset:2048 sc1
    v_mfma_f32_32x32x16_bf16 v[48:63], a[132:135], v[68:71], 0
    v_mfma_f32_32x32x16_bf16 v[0:15], a[136:139], v[72:75], v[0:15]
    s_add_u32 s3, s44, 12288
    buffer_load_dwordx4 v[136:139], v238, s[24:27], s3 offen offset:3072 sc1
    v_mfma_f32_32x32x16_bf16 v[16:31], a[136:139], v[76:79], v[16:31]
    v_mfma_f32_32x32x16_bf16 v[32:47], a[140:143], v[72:75], v[32:47]
    s_add_u32 s3, s45, 12288
    buffer_load_dwordx4 v[140:143], v238, s[24:27], s3 offen offset:3072 sc1
    v_mfma_f32_32x32x16_bf16 v[48:63], a[140:143], v[76:79], v[48:63]
    s_waitcnt vmcnt(13)
    v_mfma_f32_32x32x16_bf16 v[0:15], a[144:147], v[80:83], v[0:15]
    s_add_u32 s3, s44, 16384
    buffer_load_dwordx4 v[144:147], v238, s[24:27], s3 offen offset:0 sc1
    v_mfma_f32_32x32x16_bf16 v[16:31], a[144:147], v[84:87], v[16:31]
    v_mfma_f32_32x32x16_bf16 v[32:47], a[148:151], v[80:83], v[32:47]
    s_add_u32 s3, s45, 16384
    buffer_load_dwordx4 v[148:151], v238, s[24:27], s3 offen offset:0 sc1
    v_mfma_f32_32x32x16_bf16 v[48:63], a[148:151], v[84:87], v[48:63]
    v_mfma_f32_32x32x16_bf16 v[0:15], a[152:155], v[88:91], v[0:15]
    s_add_u32 s3, s44, 16384
    buffer_load_dwordx4 v[152:155], v238, s[24:27], s3 offen offset:1024 sc1
    v_mfma_f32_32x32x16_bf16 v[16:31], a[152:155], v[92:95], v[16:31]
    v_mfma_f32_32x32x16_bf16 v[32:47], a[156:159], v[88:91], v[32:47]
    s_add_u32 s3, s45, 16384
    buffer_load_dwordx4 v[156:159], v238, s[24:27], s3 offen offset:1024 sc1
    v_mfma_f32_32x32x16_bf16 v[48:63], a[156:159], v[92:95], v[48:63]
    s_waitcnt vmcnt(13)
    v_mfma_f32_32x32x16_bf16 v[0:15], a[160:163], v[96:99], v[0:15]
    s_add_u32 s3, s44, 20480
    buffer_load_dwordx4 v[160:163], v238, s[24:27], s3 offen offset:1024 sc1
    v_mfma_f32_32x32x16_bf16 v[16:31], a[160:163], v[100:103], v[16:31]
    s_add_u32 s3, s45, 20480
    buffer_load_dwordx4 v[164:167], v238, s[24:27], s3 offen offset:1024 sc1
    v_mfma_f32_32x32x16_bf16 v[32:47], a[164:167], v[96:99], v[32:47]
    s_add_u32 s3, s44, 20480
    buffer_load_dwordx4 v[168:171], v238, s[24:27], s3 offen offset:2048 sc1
    v_mfma_f32_32x32x16_bf16 v[48:63], a[164:167], v[100:103], v[48:63]
    v_mfma_f32_32x32x16_bf16 v[0:15], a[168:171], v[104:107], v[0:15]
    s_add_u32 s3, s45, 20480
    buffer_load_dwordx4 v[172:175], v238, s[24:27], s3 offen offset:2048 sc1
    v_mfma_f32_32x32x16_bf16 v[16:31], a[168:171], v[108:111], v[16:31]
    s_add_u32 s3, s43, 40960
    buffer_load_dwordx4 a[64:67], v238, s[8:11], s3 offen offset:0 sc1
    buffer_load_dwordx4 a[68:71], v238, s[8:11], s3 offen offset:1024 sc1
    v_mfma_f32_32x32x16_bf16 v[32:47], a[172:175], v[104:107], v[32:47]
    s_add_u32 s3, s43, 51200
    buffer_load_dwordx4 a[72:75], v238, s[8:11], s3 offen offset:0 sc1
    buffer_load_dwordx4 a[76:79], v238, s[8:11], s3 offen offset:1024 sc1
    v_mfma_f32_32x32x16_bf16 v[48:63], a[172:175], v[108:111], v[48:63]
    s_waitcnt vmcnt(16)
    v_mfma_f32_32x32x16_bf16 v[0:15], a[176:179], v[112:115], v[0:15]
    s_add_u32 s3, s44, 20480
    buffer_load_dwordx4 v[176:179], v238, s[24:27], s3 offen offset:3072 sc1
    v_mfma_f32_32x32x16_bf16 v[16:31], a[176:179], v[116:119], v[16:31]
    s_add_u32 s3, s45, 20480
    buffer_load_dwordx4 v[180:183], v238, s[24:27], s3 offen offset:3072 sc1
    v_mfma_f32_32x32x16_bf16 v[32:47], a[180:183], v[112:115], v[32:47]
    s_add_u32 s3, s44, 24576
    buffer_load_dwordx4 v[184:187], v238, s[24:27], s3 offen offset:0 sc1
    v_mfma_f32_32x32x16_bf16 v[48:63], a[180:183], v[116:119], v[48:63]
    v_mfma_f32_32x32x16_bf16 v[0:15], a[184:187], v[120:123], v[0:15]
    s_add_u32 s3, s45, 24576
    buffer_load_dwordx4 v[188:191], v238, s[24:27], s3 offen offset:0 sc1
    v_mfma_f32_32x32x16_bf16 v[16:31], a[184:187], v[124:127], v[16:31]
    s_add_u32 s3, s43, 53248
    buffer_load_dwordx4 a[80:83], v238, s[8:11], s3 offen offset:0 sc1
    buffer_load_dwordx4 a[84:87], v238, s[8:11], s3 offen offset:1024 sc1
    v_mfma_f32_32x32x16_bf16 v[32:47], a[188:191], v[120:123], v[32:47]
    s_add_u32 s3, s43, 55296
    buffer_load_dwordx4 a[88:91], v238, s[8:11], s3 offen offset:0 sc1
    buffer_load_dwordx4 a[92:95], v238, s[8:11], s3 offen offset:1024 sc1
    v_mfma_f32_32x32x16_bf16 v[48:63], a[188:191], v[124:127], v[48:63]
    s_waitcnt vmcnt(20)
    v_mfma_f32_32x32x16_bf16 v[0:15], a[192:195], v[128:131], v[0:15]
    v_mfma_f32_32x32x16_bf16 v[16:31], a[192:195], v[132:135], v[16:31]
    v_mfma_f32_32x32x16_bf16 v[32:47], a[196:199], v[128:131], v[32:47]
    v_mfma_f32_32x32x16_bf16 v[48:63], a[196:199], v[132:135], v[48:63]
    v_mfma_f32_32x32x16_bf16 v[0:15], a[200:203], v[136:139], v[0:15]
    v_mfma_f32_32x32x16_bf16 v[16:31], a[200:203], v[140:143], v[16:31]
    v_mfma_f32_32x32x16_bf16 v[32:47], a[204:207], v[136:139], v[32:47]
    v_mfma_f32_32x32x16_bf16 v[48:63], a[204:207], v[140:143], v[48:63]
    s_waitcnt vmcnt(16)
    v_mfma_f32_32x32x16_bf16 v[0:15], a[208:211], v[144:147], v[0:15]
    buffer_load_dwordx2 v[252:253], v239, s[64:67], s38 offen sc1
    v_mfma_f32_32x32x16_bf16 v[16:31], a[208:211], v[148:151], v[16:31]
    v_mfma_f32_32x32x16_bf16 v[32:47], a[212:215], v[144:147], v[32:47]
    v_mfma_f32_32x32x16_bf16 v[48:63], a[212:215], v[148:151], v[48:63]
    v_mfma_f32_32x32x16_bf16 v[0:15], a[216:219], v[152:155], v[0:15]
    v_mfma_f32_32x32x16_bf16 v[16:31], a[216:219], v[156:159], v[16:31]
    v_mfma_f32_32x32x16_bf16 v[32:47], a[220:223], v[152:155], v[32:47]
    v_mfma_f32_32x32x16_bf16 v[48:63], a[220:223], v[156:159], v[48:63]
    s_waitcnt vmcnt(13)
    v_mfma_f32_32x32x16_bf16 v[0:15], a[224:227], v[160:163], v[0:15]
    v_mfma_f32_32x32x16_bf16 v[16:31], a[224:227], v[164:167], v[16:31]
    v_mfma_f32_32x32x16_bf16 v[32:47], a[228:231], v[160:163], v[32:47]
    v_mfma_f32_32x32x16_bf16 v[48:63], a[228:231], v[164:167], v[48:63]
    v_mfma_f32_32x32x16_bf16 v[0:15], a[232:235], v[168:171], v[0:15]
    v_mfma_f32_32x32x16_bf16 v[16:31], a[232:235], v[172:175], v[16:31]
    v_mfma_f32_32x32x16_bf16 v[32:47], a[236:239], v[168:171], v[32:47]
    v_mfma_f32_32x32x16_bf16 v[48:63], a[236:239], v[172:175], v[48:63]
    s_waitcnt vmcnt(0)
    v_cmp_ne_u64 vcc, s[96:97], v[252:253]
    s_cbranch_vccnz spin_64
ok_63:
    s_add_u32 s3, s44, 4096
    buffer_load_dwordx4 v[192:195], v238, s[24:27], s3 offen offset:0 sc1
    s_add_u32 s3, s45, 4096
    buffer_load_dwordx4 v[196:199], v238, s[24:27], s3 offen offset:0 sc1
    s_add_u32 s3, s44, 4096
    buffer_load_dwordx4 v[200:203], v238, s[24:27], s3 offen offset:1024 sc1
    s_add_u32 s3, s45, 4096
    buffer_load_dwordx4 v[204:207], v238, s[24:27], s3 offen offset:1024 sc1
    s_add_u32 s3, s44, 4096
    buffer_load_dwordx4 v[64:67], v238, s[24:27], s3 offen offset:2048 sc1
    s_add_u32 s3, s45, 4096
    buffer_load_dwordx4 v[68:71], v238, s[24:27], s3 offen offset:2048 sc1
    s_add_u32 s3, s44, 8192
    buffer_load_dwordx4 v[72:75], v238, s[24:27], s3 offen offset:3072 sc1
    s_add_u32 s3, s45, 8192
    buffer_load_dwordx4 v[76:79], v238, s[24:27], s3 offen offset:3072 sc1
    s_add_u32 s3, s44, 12288
    buffer_load_dwordx4 v[80:83], v238, s[24:27], s3 offen offset:0 sc1
    s_add_u32 s3, s45, 12288
    buffer_load_dwordx4 v[84:87], v238, s[24:27], s3 offen offset:0 sc1
    s_add_u32 s3, s44, 12288
    buffer_load_dwordx4 v[88:91], v238, s[24:27], s3 offen offset:1024 sc1
    s_add_u32 s3, s45, 12288
    buffer_load_dwordx4 v[92:95], v238, s[24:27], s3 offen offset:1024 sc1
    s_waitcnt vmcnt(17)
    v_mfma_f32_32x32x16_bf16 v[0:15], a[240:243], v[176:179], v[0:15]
    s_add_u32 s3, s44, 16384
    buffer_load_dwordx4 v[96:99], v238, s[24:27], s3 offen offset:2048 sc1
    v_mfma_f32_32x32x16_bf16 v[16:31], a[240:243], v[180:183], v[16:31]
    v_mfma_f32_32x32x16_bf16 v[32:47], a[244:247], v[176:179], v[32:47]
    s_add_u32 s3, s45, 16384
    buffer_load_dwordx4 v[100:103], v238, s[24:27], s3 offen offset:2048 sc1
    v_mfma_f32_32x32x16_bf16 v[48:63], a[244:247], v[180:183], v[48:63]
    v_mfma_f32_32x32x16_bf16 v[0:15], a[248:251], v[184:187], v[0:15]
    s_add_u32 s3, s44, 16384
    buffer_load_dwordx4 v[104:107], v238, s[24:27], s3 offen offset:3072 sc1
    v_mfma_f32_32x32x16_bf16 v[16:31], a[248:251], v[188:191], v[16:31]
    v_mfma_f32_32x32x16_bf16 v[32:47], a[252:255], v[184:187], v[32:47]
    s_add_u32 s3, s45, 16384
    buffer_load_dwordx4 v[108:111], v238, s[24:27], s3 offen offset:3072 sc1
    v_mfma_f32_32x32x16_bf16 v[48:63], a[252:255], v[188:191], v[48:63]
    s_waitcnt vmcnt(12)
    v_mfma_f32_32x32x16_bf16 v[0:15], a[0:3], v[192:195], v[0:15]
    s_add_u32 s3, s44, 20480
    buffer_load_dwordx4 v[112:115], v238, s[24:27], s3 offen offset:0 sc1
    v_mfma_f32_32x32x16_bf16 v[16:31], a[0:3], v[196:199], v[16:31]
    v_mfma_f32_32x32x16_bf16 v[32:47], a[4:7], v[192:195], v[32:47]
    s_add_u32 s3, s45, 20480
    buffer_load_dwordx4 v[116:119], v238, s[24:27], s3 offen offset:0 sc1
    v_mfma_f32_32x32x16_bf16 v[48:63], a[4:7], v[196:199], v[48:63]
    v_mfma_f32_32x32x16_bf16 v[0:15], a[8:11], v[200:203], v[0:15]
    s_add_u32 s3, s44, 24576
    buffer_load_dwordx4 v[120:123], v238, s[24:27], s3 offen offset:1024 sc1
    v_mfma_f32_32x32x16_bf16 v[16:31], a[8:11], v[204:207], v[16:31]
    v_mfma_f32_32x32x16_bf16 v[32:47], a[12:15], v[200:203], v[32:47]
    s_add_u32 s3, s45, 24576
    buffer_load_dwordx4 v[124:127], v238, s[24:27], s3 offen offset:1024 sc1
    v_mfma_f32_32x32x16_bf16 v[48:63], a[12:15], v[204:207], v[48:63]
    s_waitcnt vmcnt(12)
    v_mfma_f32_32x32x16_bf16 v[0:15], a[16:19], v[64:67], v[0:15]
    s_add_u32 s3, s44, 24576
    buffer_load_dwordx4 v[128:131], v238, s[24:27], s3 offen offset:2048 sc1
    v_mfma_f32_32x32x16_bf16 v[16:31], a[16:19], v[68:71], v[16:31]
    v_mfma_f32_32x32x16_bf16 v[32:47], a[20:23], v[64:67], v[32:47]
    s_add_u32 s3, s45, 24576
    buffer_load_dwordx4 v[132:135], v238, s[24:27], s3 offen offset:2048 sc1
    v_mfma_f32_32x32x16_bf16 v[48:63], a[20:23], v[68:71], v[48:63]
    v_mfma_f32_32x32x16_bf16 v[0:15], a[24:27], v[72:75], v[0:15]
    s_add_u32 s3, s44, 24576
    buffer_load_dwordx4 v[136:139], v238, s[24:27], s3 offen offset:3072 sc1
    v_mfma_f32_32x32x16_bf16 v[16:31], a[24:27], v[76:79], v[16:31]
    v_mfma_f32_32x32x16_bf16 v[32:47], a[28:31], v[72:75], v[32:47]
    s_add_u32 s3, s45, 24576
    buffer_load_dwordx4 v[140:143], v238, s[24:27], s3 offen offset:3072 sc1
    v_mfma_f32_32x32x16_bf16 v[48:63], a[28:31], v[76:79], v[48:63]
    s_waitcnt vmcnt(12)
    v_mfma_f32_32x32x16_bf16 v[0:15], a[32:35], v[80:83], v[0:15]
    v_mfma_f32_32x32x16_bf16 v[16:31], a[32:35], v[84:87], v[16:31]
    v_mfma_f32_32x32x16_bf16 v[32:47], a[36:39], v[80:83], v[32:47]
    v_mfma_f32_32x32x16_bf16 v[48:63], a[36:39], v[84:87], v[48:63]
    v_mfma_f32_32x32x16_bf16 v[0:15], a[40:43], v[88:91], v[0:15]
    v_mfma_f32_32x32x16_bf16 v[16:31], a[40:43], v[92:95], v[16:31]
    v_mfma_f32_32x32x16_bf16 v[32:47], a[44:47], v[88:91], v[32:47]
    v_mfma_f32_32x32x16_bf16 v[48:63], a[44:47], v[92:95], v[48:63]
    s_waitcnt vmcnt(8)
    v_mfma_f32_32x32x16_bf16 v[0:15], a[48:51], v[96:99], v[0:15]
    v_mfma_f32_32x32x16_bf16 v[16:31], a[48:51], v[100:103], v[16:31]
    v_mfma_f32_32x32x16_bf16 v[32:47], a[52:55], v[96:99], v[32:47]
    v_mfma_f32_32x32x16_bf16 v[48:63], a[52:55], v[100:103], v[48:63]
    v_mfma_f32_32x32x16_bf16 v[0:15], a[56:59], v[104:107], v[0:15]
    v_mfma_f32_32x32x16_bf16 v[16:31], a[56:59], v[108:111], v[16:31]
    v_mfma_f32_32x32x16_bf16 v[32:47], a[60:63], v[104:107], v[32:47]
    v_mfma_f32_32x32x16_bf16 v[48:63], a[60:63], v[108:111], v[48:63]
    s_waitcnt vmcnt(4)
    v_mfma_f32_32x32x16_bf16 v[0:15], a[64:67], v[112:115], v[0:15]
    s_lshl_b32 s3, s94, 14
    v_add_u32 v221, s3, v238
    v_add_u32 v221, 0x10000, v221
    v_mfma_f32_32x32x16_bf16 v[0:15], a[72:75], v[120:123], v[0:15]
    v_mfma_f32_32x32x16_bf16 v[16:31], a[64:67], v[116:119], v[16:31]
    v_mfma_f32_32x32x16_bf16 v[16:31], a[72:75], v[124:127], v[16:31]
    s_waitcnt vmcnt(0)
    v_mfma_f32_32x32x16_bf16 v[0:15], a[80:83], v[128:131], v[0:15]
    v_mfma_f32_32x32x16_bf16 v[0:15], a[88:91], v[136:139], v[0:15]
    v_mfma_f32_32x32x16_bf16 v[16:31], a[80:83], v[132:135], v[16:31]
    v_mfma_f32_32x32x16_bf16 v[16:31], a[88:91], v[140:143], v[16:31]
    s_nop 7
    v_mfma_f32_32x32x16_bf16 v[32:47], a[68:71], v[112:115], v[32:47]
    s_nop 1
    ds_write_b128 v245, v[0:3] offset:0
    ds_write_b128 v245, v[4:7] offset:1024
    v_mfma_f32_32x32x16_bf16 v[32:47], a[76:79], v[120:123], v[32:47]
    ds_write_b128 v245, v[8:11] offset:2048
    ds_write_b128 v245, v[12:15] offset:3072
    v_mfma_f32_32x32x16_bf16 v[32:47], a[84:87], v[128:131], v[32:47]
    ds_write_b128 v245, v[16:19] offset:16384
    ds_write_b128 v245, v[20:23] offset:17408
    v_mfma_f32_32x32x16_bf16 v[32:47], a[92:95], v[136:139], v[32:47]
    ds_write_b128 v245, v[24:27] offset:18432
    ds_write_b128 v245, v[28:31] offset:19456
    v_mfma_f32_32x32x16_bf16 v[48:63], a[68:71], v[116:119], v[48:63]
    v_mfma_f32_32x32x16_bf16 v[48:63], a[76:79], v[124:127], v[48:63]
    s_nop 7
    v_mfma_f32_32x32x16_bf16 v[48:63], a[84:87], v[132:135], v[48:63]
    s_nop 1
    ds_write_b128 v245, v[32:35] offset:32768
    ds_write_b128 v245, v[36:39] offset:33792
    v_mfma_f32_32x32x16_bf16 v[48:63], a[92:95], v[140:143], v[48:63]
    ds_write_b128 v245, v[40:43] offset:34816
    ds_write_b128 v245, v[44:47] offset:35840
    s_nop 7
    s_nop 1
    ds_write_b128 v245, v[48:51] offset:49152
    ds_write_b128 v245, v[52:55] offset:50176
    ds_write_b128 v245, v[56:59] offset:51200
    ds_write_b128 v245, v[60:63] offset:52224
    v_lshlrev_b32 v64, 16, v228
    v_and_b32 v65, 0xffff0000, v228
    v_lshlrev_b32 v66, 16, v229
    v_and_b32 v67, 0xffff0000, v229
    v_lshlrev_b32 v68, 16, v230
    v_and_b32 v69, 0xffff0000, v230
    v_lshlrev_b32 v70, 16, v231
    v_and_b32 v71, 0xffff0000, v231
    v_lshlrev_b32 v72, 16, v232
    v_and_b32 v73, 0xffff0000, v232
    v_lshlrev_b32 v74, 16, v233
    v_and_b32 v75, 0xffff0000, v233
    v_lshlrev_b32 v76, 16, v234
    v_and_b32 v77, 0xffff0000, v234
    v_lshlrev_b32 v78, 16, v235
    v_and_b32 v79, 0xffff0000, v235
    s_waitcnt lgkmcnt(0)
    s_barrier
    ds_read_b128 v[0:3], v221 offset:0
    ds_read_b128 v[4:7], v221 offset:1024
    ds_read_b128 v[8:11], v221 offset:2048
    ds_read_b128 v[12:15], v221 offset:3072
    ds_read_b128 v[16:19], v221 offset:4096
    ds_read_b128 v[20:23], v221 offset:5120
    ds_read_b128 v[24:27], v221 offset:6144
    ds_read_b128 v[28:31], v221 offset:7168
    ds_read_b128 v[32:35], v221 offset:8192
    ds_read_b128 v[36:39], v221 offset:9216
    ds_read_b128 v[40:43], v221 offset:10240
    ds_read_b128 v[44:47], v221 offset:11264
    ds_read_b128 v[48:51], v221 offset:12288
    ds_read_b128 v[52:55], v221 offset:13312
    ds_read_b128 v[56:59], v221 offset:14336
    ds_read_b128 v[60:63], v221 offset:15360
    s_waitcnt lgkmcnt(12)
    v_pk_add_f32 v[0:1], v[0:1], v[64:65]
    v_pk_add_f32 v[2:3], v[2:3], v[66:67]
    v_pk_add_f32 v[4:5], v[4:5], v[68:69]
    v_pk_add_f32 v[6:7], v[6:7], v[70:71]
    v_pk_add_f32 v[8:9], v[8:9], v[72:73]
    v_pk_add_f32 v[10:11], v[10:11], v[74:75]
    v_pk_add_f32 v[12:13], v[12:13], v[76:77]
    v_pk_add_f32 v[14:15], v[14:15], v[78:79]
    s_waitcnt lgkmcnt(8)
    v_pk_add_f32 v[0:1], v[0:1], v[16:17]
    v_pk_add_f32 v[2:3], v[2:3], v[18:19]
    v_pk_add_f32 v[4:5], v[4:5], v[20:21]
    v_pk_add_f32 v[6:7], v[6:7], v[22:23]
    v_pk_add_f32 v[8:9], v[8:9], v[24:25]
    v_pk_add_f32 v[10:11], v[10:11], v[26:27]
    v_pk_add_f32 v[12:13], v[12:13], v[28:29]
    v_pk_add_f32 v[14:15], v[14:15], v[30:31]
    s_waitcnt lgkmcnt(4)
    v_pk_add_f32 v[0:1], v[0:1], v[32:33]
    v_pk_add_f32 v[2:3], v[2:3], v[34:35]
    v_pk_add_f32 v[4:5], v[4:5], v[36:37]
    v_pk_add_f32 v[6:7], v[6:7], v[38:39]
    v_pk_add_f32 v[8:9], v[8:9], v[40:41]
    v_pk_add_f32 v[10:11], v[10:11], v[42:43]
    v_pk_add_f32 v[12:13], v[12:13], v[44:45]
    v_pk_add_f32 v[14:15], v[14:15], v[46:47]
    s_waitcnt lgkmcnt(0)
    v_pk_add_f32 v[0:1], v[0:1], v[48:49]
    v_pk_add_f32 v[2:3], v[2:3], v[50:51]
    v_pk_add_f32 v[4:5], v[4:5], v[52:53]
    v_pk_add_f32 v[6:7], v[6:7], v[54:55]
    v_pk_add_f32 v[8:9], v[8:9], v[56:57]
    v_pk_add_f32 v[10:11], v[10:11], v[58:59]
    v_pk_add_f32 v[12:13], v[12:13], v[60:61]
    v_pk_add_f32 v[14:15], v[14:15], v[62:63]
    v_cvt_pk_bf16_f32 v16, v0, v1
    v_cvt_pk_bf16_f32 v17, v2, v3
    v_cvt_pk_bf16_f32 v18, v4, v5
    v_cvt_pk_bf16_f32 v19, v6, v7
    v_cvt_pk_bf16_f32 v20, v8, v9
    v_cvt_pk_bf16_f32 v21, v10, v11
    v_cvt_pk_bf16_f32 v22, v12, v13
    v_cvt_pk_bf16_f32 v23, v14, v15
    s_nop 1
    v_permlane32_swap_b32 v16, v18
    v_permlane32_swap_b32 v17, v19
    v_permlane32_swap_b32 v20, v22
    v_permlane32_swap_b32 v21, v23
    buffer_store_dwordx4 v[16:19], v247, s[20:23], s63 offen
    buffer_store_dwordx4 v[20:23], v247, s[20:23], s63 offen offset:32
F_out:
    s_endpgm
spin_4:
    s_mov_b32 s100, 0x40000
spin_4b:
    buffer_load_dwordx2 v[252:253], v239, s[52:55], 0 offen sc1
    s_waitcnt vmcnt(0)
    v_cmp_eq_u32 vcc, 0, v252
    s_cbranch_vccz ok_3
    s_sub_u32 s100, s100, 1
    s_cmp_eq_u32 s100, 0
    s_cbranch_scc1 ok_3
    s_sleep 8
    s_branch spin_4b
spin_9:
    s_mov_b32 s100, 0x40000
spin_9b:
    buffer_load_dwordx2 v[252:253], v239, s[64:67], 0 offen sc1
    s_waitcnt vmcnt(0)
    v_cmp_ne_u64 vcc, s[96:97], v[252:253]
    s_cbranch_vccz ok_8
    s_sub_u32 s100, s100, 1
    s_cmp_eq_u32 s100, 0
    s_cbranch_scc1 ok_8
    s_sleep 8
    s_branch spin_9b
spin_12:
    s_mov_b32 s100, 0x40000
spin_12b:
    buffer_load_dwordx2 v[252:253], v239, s[64:67], s45 offen sc1
    s_waitcnt vmcnt(0)
    v_cmp_ne_u64 vcc, s[96:97], v[252:253]
    s_cbranch_vccz ok_11
    s_sub_u32 s100, s100, 1
    s_cmp_eq_u32 s100, 0
    s_cbranch_scc1 ok_11
    s_sleep 8
    s_branch spin_12b
spin_14:
    s_mov_b32 s100, 0x40000
spin_14b:
    buffer_load_dwordx2 v[252:253], v239, s[64:67], s49 offen sc1
    s_waitcnt vmcnt(0)
    v_cmp_ne_u64 vcc, s[96:97], v[252:253]
    s_cbranch_vccz ok_13
    s_sub_u32 s100, s100, 1
    s_cmp_eq_u32 s100, 0
    s_cbranch_scc1 ok_13
    s_sleep 8
    s_branch spin_14b
spin_20:
    s_mov_b32 s100, 0x40000
spin_20b:
    buffer_load_dwordx2 v[252:253], v239, s[64:67], s36 offen sc1
    s_waitcnt vmcnt(0)
    v_cmp_ne_u64 vcc, s[96:97], v[252:253]
    s_cbranch_vccz ok_19
    s_sub_u32 s100, s100, 1
    s_cmp_eq_u32 s100, 0
    s_cbranch_scc1 ok_19
    s_sleep 8
    s_branch spin_20b
spin_22:
    s_mov_b32 s100, 0x40000
spin_22b:
    buffer_load_dwordx2 v[252:253], v239, s[64:67], s39 offen sc1
    s_waitcnt vmcnt(0)
    v_cmp_ne_u64 vcc, s[96:97], v[252:253]
    s_cbranch_vccz ok_21
    s_sub_u32 s100, s100, 1
    s_cmp_eq_u32 s100, 0
    s_cbranch_scc1 ok_21
    s_sleep 8
    s_branch spin_22b
spin_26:
    s_mov_b32 s100, 0x40000
spin_26b:
    buffer_load_dwordx2 v[252:253], v239, s[64:67], s38 offen sc1
    s_waitcnt vmcnt(0)
    v_cmp_ne_u64 vcc, s[96:97], v[252:253]
    s_cbranch_vccz ok_25
    s_sub_u32 s100, s100, 1
    s_cmp_eq_u32 s100, 0
    s_cbranch_scc1 ok_25
    s_sleep 8
    s_branch spin_26b
K2_fx0:
    v_sub_f32 v0, v0, v228
    v_sub_f32 v1, v1, v228
    v_sub_f32 v2, v2, v228
    v_sub_f32 v3, v3, v228
    v_sub_f32 v4, v4, v228
    v_sub_f32 v5, v5, v228
    v_sub_f32 v6, v6, v228
    v_sub_f32 v7, v7, v228
    v_sub_f32 v8, v8, v228
    v_sub_f32 v9, v9, v228
    v_sub_f32 v10, v10, v228
    v_sub_f32 v11, v11, v228
    v_sub_f32 v12, v12, v228
    v_sub_f32 v13, v13, v228
    v_sub_f32 v14, v14, v228
    v_sub_f32 v15, v15, v228
    v_sub_f32 v64, v64, v229
    v_sub_f32 v65, v65, v229
    v_sub_f32 v66, v66, v229
    v_sub_f32 v67, v67, v229
    v_sub_f32 v68, v68, v229
    v_sub_f32 v69, v69, v229
    v_sub_f32 v70, v70, v229
    v_sub_f32 v71, v71, v229
    v_sub_f32 v72, v72, v229
    v_sub_f32 v73, v73, v229
    v_sub_f32 v74, v74, v229
    v_sub_f32 v75, v75, v229
    v_sub_f32 v76, v76, v229
    v_sub_f32 v77, v77, v229
    v_sub_f32 v78, v78, v229
    v_sub_f32 v79, v79, v229
    v_sub_f32 v80, v80, v229
    v_sub_f32 v81, v81, v229
    v_sub_f32 v82, v82, v229
    v_sub_f32 v83, v83, v229
    v_sub_f32 v84, v84, v229
    v_sub_f32 v85, v85, v229
    v_sub_f32 v86, v86, v229
    v_sub_f32 v87, v87, v229
    v_sub_f32 v88, v88, v229
    v_sub_f32 v89, v89, v229
    v_sub_f32 v90, v90, v229
    v_sub_f32 v91, v91, v229
    v_sub_f32 v92, v92, v229
    v_sub_f32 v93, v93, v229
    v_sub_f32 v94, v94, v229
    v_sub_f32 v95, v95, v229
    v_sub_f32 v96, v96, v229
    v_sub_f32 v97, v97, v229
    v_sub_f32 v98, v98, v229
    v_sub_f32 v99, v99, v229
    v_sub_f32 v100, v100, v229
    v_sub_f32 v101, v101, v229
    v_sub_f32 v102, v102, v229
    v_sub_f32 v103, v103, v229
    v_sub_f32 v104, v104, v229
    v_sub_f32 v105, v105, v229
    v_sub_f32 v106, v106, v229
    v_sub_f32 v107, v107, v229
    v_sub_f32 v108, v108, v229
    v_sub_f32 v109, v109, v229
    v_sub_f32 v110, v110, v229
    v_sub_f32 v111, v111, v229
    v_sub_f32 v112, v112, v229
    v_sub_f32 v113, v113, v229
    v_sub_f32 v114, v114, v229
    v_sub_f32 v115, v115, v229
    v_sub_f32 v116, v116, v229
    v_sub_f32 v117, v117, v229
    v_sub_f32 v118, v118, v229
    v_sub_f32 v119, v119, v229
    v_sub_f32 v120, v120, v229
    v_sub_f32 v121, v121, v229
    v_sub_f32 v122, v122, v229
    v_sub_f32 v123, v123, v229
    v_sub_f32 v124, v124, v229
    v_sub_f32 v125, v125, v229
    v_sub_f32 v126, v126, v229
    v_sub_f32 v127, v127, v229
    v_exp_f32 v208, v0
    v_exp_f32 v209, v1
    v_exp_f32 v210, v2
    v_add_f32 v232, v208, v209
    v_exp_f32 v211, v3
    v_cvt_pk_bf16_f32 v220, v208, v209
    v_exp_f32 v212, v4
    v_add_f32 v232, v232, v210
    v_exp_f32 v213, v5
    v_add_f32 v232, v232, v211
    v_cvt_pk_bf16_f32 v221, v210, v211
    v_exp_f32 v208, v6
    v_add_f32 v232, v232, v212
    v_exp_f32 v209, v7
    v_add_f32 v232, v232, v213
    v_cvt_pk_bf16_f32 v222, v212, v213
    v_exp_f32 v210, v8
    v_add_f32 v232, v232, v208
    v_exp_f32 v211, v9
    v_add_f32 v232, v232, v209
    v_cvt_pk_bf16_f32 v223, v208, v209
    v_exp_f32 v212, v10
    v_add_f32 v232, v232, v210
    v_exp_f32 v213, v11
    v_add_f32 v232, v232, v211
    v_cvt_pk_bf16_f32 v224, v210, v211
    v_exp_f32 v208, v12
    v_add_f32 v232, v232, v212
    v_exp_f32 v209, v13
    v_add_f32 v232, v232, v213
    v_cvt_pk_bf16_f32 v225, v212, v213
    v_exp_f32 v210, v14
    v_add_f32 v232, v232, v208
    v_exp_f32 v211, v15
    v_add_f32 v232, v232, v209
    v_cvt_pk_bf16_f32 v226, v208, v209
    v_add_f32 v232, v232, v210
    v_cvt_pk_bf16_f32 v227, v210, v211
    v_add_f32 v232, v232, v211
    v_exp_f32 v208, v64
    v_exp_f32 v209, v65
    v_exp_f32 v210, v66
    v_add_f32 v233, v208, v209
    v_exp_f32 v211, v67
    v_cvt_pk_bf16_f32 v144, v208, v209
    v_exp_f32 v212, v68
    v_add_f32 v233, v233, v210
    v_exp_f32 v213, v69
    v_add_f32 v233, v233, v211
    v_cvt_pk_bf16_f32 v145, v210, v211
    v_exp_f32 v208, v70
    v_add_f32 v233, v233, v212
    v_exp_f32 v209, v71
    v_add_f32 v233, v233, v213
    v_cvt_pk_bf16_f32 v146, v212, v213
    v_exp_f32 v210, v72
    v_add_f32 v233, v233, v208
    v_exp_f32 v211, v73
    v_add_f32 v233, v233, v209
    v_cvt_pk_bf16_f32 v147, v208, v209
    v_exp_f32 v212, v74
    v_add_f32 v233, v233, v210
    v_exp_f32 v213, v75
    v_add_f32 v233, v233, v211
    v_cvt_pk_bf16_f32 v148, v210, v211
    v_exp_f32 v208, v76
    v_add_f32 v233, v233, v212
    v_exp_f32 v209, v77
    v_add_f32 v233, v233, v213
    v_cvt_pk_bf16_f32 v149, v212, v213
    v_exp_f32 v210, v78
    v_add_f32 v233, v233, v208
    v_exp_f32 v211, v79
    v_add_f32 v233, v233, v209
    v_cvt_pk_bf16_f32 v150, v208, v209
    v_add_f32 v233, v233, v210
    v_cvt_pk_bf16_f32 v151, v210, v211
    v_add_f32 v233, v233, v211
    v_sub_f32 v176, 0, v228
    v_sub_f32 v177, 0, v228
    v_sub_f32 v178, 0, v228
    v_sub_f32 v179, 0, v228
    v_sub_f32 v180, 0, v228
    v_sub_f32 v181, 0, v228
    v_sub_f32 v182, 0, v228
    v_sub_f32 v183, 0, v228
    v_sub_f32 v184, 0, v228
    v_sub_f32 v185, 0, v228
    v_sub_f32 v186, 0, v228
    v_sub_f32 v187, 0, v228
    v_sub_f32 v188, 0, v228
    v_sub_f32 v189, 0, v228
    v_sub_f32 v190, 0, v228
    v_sub_f32 v191, 0, v228
    v_sub_f32 v192, 0, v229
    v_sub_f32 v193, 0, v229
    v_sub_f32 v194, 0, v229
    v_sub_f32 v195, 0, v229
    v_sub_f32 v196, 0, v229
    v_sub_f32 v197, 0, v229
    v_sub_f32 v198, 0, v229
    v_sub_f32 v199, 0, v229
    v_sub_f32 v200, 0, v229
    v_sub_f32 v201, 0, v229
    v_sub_f32 v202, 0, v229
    v_sub_f32 v203, 0, v229
    v_sub_f32 v204, 0, v229
    v_sub_f32 v205, 0, v229
    v_sub_f32 v206, 0, v229
    v_sub_f32 v207, 0, v229
    s_nop 1
    s_branch K2_D1e
K2_fx1:
    v_sub_f32 v0, v0, v228
    v_sub_f32 v1, v1, v228
    v_sub_f32 v2, v2, v228
    v_sub_f32 v3, v3, v228
    v_sub_f32 v4, v4, v228
    v_sub_f32 v5, v5, v228
    v_sub_f32 v6, v6, v228
    v_sub_f32 v7, v7, v228
    v_sub_f32 v8, v8, v228
    v_sub_f32 v9, v9, v228
    v_sub_f32 v10, v10, v228
    v_sub_f32 v11, v11, v228
    v_sub_f32 v12, v12, v228
    v_sub_f32 v13, v13, v228
    v_sub_f32 v14, v14, v228
    v_sub_f32 v15, v15, v228
    v_sub_f32 v64, v64, v229
    v_sub_f32 v65, v65, v229
    v_sub_f32 v66, v66, v229
    v_sub_f32 v67, v67, v229
    v_sub_f32 v68, v68, v229
    v_sub_f32 v69, v69, v229
    v_sub_f32 v70, v70, v229
    v_sub_f32 v71, v71, v229
    v_sub_f32 v72, v72, v229
    v_sub_f32 v73, v73, v229
    v_sub_f32 v74, v74, v229
    v_sub_f32 v75, v75, v229
    v_sub_f32 v76, v76, v229
    v_sub_f32 v77, v77, v229
    v_sub_f32 v78, v78, v229
    v_sub_f32 v79, v79, v229
    v_sub_f32 v80, v80, v229
    v_sub_f32 v81, v81, v229
    v_sub_f32 v82, v82, v229
    v_sub_f32 v83, v83, v229
    v_sub_f32 v84, v84, v229
    v_sub_f32 v85, v85, v229
    v_sub_f32 v86, v86, v229
    v_sub_f32 v87, v87, v229
    v_sub_f32 v88, v88, v229
    v_sub_f32 v89, v89, v229
    v_sub_f32 v90, v90, v229
    v_sub_f32 v91, v91, v229
    v_sub_f32 v92, v92, v229
    v_sub_f32 v93, v93, v229
    v_sub_f32 v94, v94, v229
    v_sub_f32 v95, v95, v229
    v_sub_f32 v96, v96, v229
    v_sub_f32 v97, v97, v229
    v_sub_f32 v98, v98, v229
    v_sub_f32 v99, v99, v229
    v_sub_f32 v100, v100, v229
    v_sub_f32 v101, v101, v229
    v_sub_f32 v102, v102, v229
    v_sub_f32 v103, v103, v229
    v_sub_f32 v104, v104, v229
    v_sub_f32 v105, v105, v229
    v_sub_f32 v106, v106, v229
    v_sub_f32 v107, v107, v229
    v_sub_f32 v108, v108, v229
    v_sub_f32 v109, v109, v229
    v_sub_f32 v110, v110, v229
    v_sub_f32 v111, v111, v229
    v_sub_f32 v112, v112, v228
    v_sub_f32 v113, v113, v228
    v_sub_f32 v114, v114, v228
    v_sub_f32 v115, v115, v228
    v_sub_f32 v116, v116, v228
    v_sub_f32 v117, v117, v228
    v_sub_f32 v118, v118, v228
    v_sub_f32 v119, v119, v228
    v_sub_f32 v120, v120, v228
    v_sub_f32 v121, v121, v228
    v_sub_f32 v122, v122, v228
    v_sub_f32 v123, v123, v228
    v_sub_f32 v124, v124, v228
    v_sub_f32 v125, v125, v228
    v_sub_f32 v126, v126, v228
    v_sub_f32 v127, v127, v228
    v_exp_f32 v208, v0
    v_exp_f32 v209, v1
    v_exp_f32 v210, v2
    v_add_f32 v232, v208, v209
    v_exp_f32 v211, v3
    v_cvt_pk_bf16_f32 v220, v208, v209
    v_exp_f32 v212, v4
    v_add_f32 v232, v232, v210
    v_exp_f32 v213, v5
    v_add_f32 v232, v232, v211
    v_cvt_pk_bf16_f32 v221, v210, v211
    v_exp_f32 v208, v6
    v_add_f32 v232, v232, v212
    v_exp_f32 v209, v7
    v_add_f32 v232, v232, v213
    v_cvt_pk_bf16_f32 v222, v212, v213
    v_exp_f32 v210, v8
    v_add_f32 v232, v232, v208
    v_exp_f32 v211, v9
    v_add_f32 v232, v232, v209
    v_cvt_pk_bf16_f32 v223, v208, v209
    v_exp_f32 v212, v10
    v_add_f32 v232, v232, v210
    v_exp_f32 v213, v11
    v_add_f32 v232, v232, v211
    v_cvt_pk_bf16_f32 v224, v210, v211
    v_exp_f32 v208, v12
    v_add_f32 v232, v232, v212
    v_exp_f32 v209, v13
    v_add_f32 v232, v232, v213
    v_cvt_pk_bf16_f32 v225, v212, v213
    v_exp_f32 v210, v14
    v_add_f32 v232, v232, v208
    v_exp_f32 v211, v15
    v_add_f32 v232, v232, v209
    v_cvt_pk_bf16_f32 v226, v208, v209
    v_add_f32 v232, v232, v210
    v_cvt_pk_bf16_f32 v227, v210, v211
    v_add_f32 v232, v232, v211
    v_exp_f32 v208, v64
    v_exp_f32 v209, v65
    v_exp_f32 v210, v66
    v_add_f32 v233, v208, v209
    v_exp_f32 v211, v67
    v_cvt_pk_bf16_f32 v144, v208, v209
    v_exp_f32 v212, v68
    v_add_f32 v233, v233, v210
    v_exp_f32 v213, v69
    v_add_f32 v233, v233, v211
    v_cvt_pk_bf16_f32 v145, v210, v211
    v_exp_f32 v208, v70
    v_add_f32 v233, v233, v212
    v_exp_f32 v209, v71
    v_add_f32 v233, v233, v213
    v_cvt_pk_bf16_f32 v146, v212, v213
    v_exp_f32 v210, v72
    v_add_f32 v233, v233, v208
    v_exp_f32 v211, v73
    v_add_f32 v233, v233, v209
    v_cvt_pk_bf16_f32 v147, v208, v209
    v_exp_f32 v212, v74
    v_add_f32 v233, v233, v210
    v_exp_f32 v213, v75
    v_add_f32 v233, v233, v211
    v_cvt_pk_bf16_f32 v148, v210, v211
    v_exp_f32 v208, v76
    v_add_f32 v233, v233, v212
    v_exp_f32 v209, v77
    v_add_f32 v233, v233, v213
    v_cvt_pk_bf16_f32 v149, v212, v213
    v_exp_f32 v210, v78
    v_add_f32 v233, v233, v208
    v_exp_f32 v211, v79
    v_add_f32 v233, v233, v209
    v_cvt_pk_bf16_f32 v150, v208, v209
    v_add_f32 v233, v233, v210
    v_cvt_pk_bf16_f32 v151, v210, v211
    v_add_f32 v233, v233, v211
    v_sub_f32 v176, 0, v228
    v_sub_f32 v177, 0, v228
    v_sub_f32 v178, 0, v228
    v_sub_f32 v179, 0, v228
    v_sub_f32 v180, 0, v228
    v_sub_f32 v181, 0, v228
    v_sub_f32 v182, 0, v228
    v_sub_f32 v183, 0, v228
    v_sub_f32 v184, 0, v228
    v_sub_f32 v185, 0, v228
    v_sub_f32 v186, 0, v228
    v_sub_f32 v187, 0, v228
    v_sub_f32 v188, 0, v228
    v_sub_f32 v189, 0, v228
    v_sub_f32 v190, 0, v228
    v_sub_f32 v191, 0, v228
    v_sub_f32 v192, 0, v229
    v_sub_f32 v193, 0, v229
    v_sub_f32 v194, 0, v229
    v_sub_f32 v195, 0, v229
    v_sub_f32 v196, 0, v229
    v_sub_f32 v197, 0, v229
    v_sub_f32 v198, 0, v229
    v_sub_f32 v199, 0, v229
    v_sub_f32 v200, 0, v229
    v_sub_f32 v201, 0, v229
    v_sub_f32 v202, 0, v229
    v_sub_f32 v203, 0, v229
    v_sub_f32 v204, 0, v229
    v_sub_f32 v205, 0, v229
    v_sub_f32 v206, 0, v229
    v_sub_f32 v207, 0, v229
    s_nop 1
    s_branch K2_D1e
K2_fx2:
    v_sub_f32 v0, v0, v228
    v_sub_f32 v1, v1, v228
    v_sub_f32 v2, v2, v228
    v_sub_f32 v3, v3, v228
    v_sub_f32 v4, v4, v228
    v_sub_f32 v5, v5, v228
    v_sub_f32 v6, v6, v228
    v_sub_f32 v7, v7, v228
    v_sub_f32 v8, v8, v228
    v_sub_f32 v9, v9, v228
    v_sub_f32 v10, v10, v228
    v_sub_f32 v11, v11, v228
    v_sub_f32 v12, v12, v228
    v_sub_f32 v13, v13, v228
    v_sub_f32 v14, v14, v228
    v_sub_f32 v15, v15, v228
    v_sub_f32 v64, v64, v229
    v_sub_f32 v65, v65, v229
    v_sub_f32 v66, v66, v229
    v_sub_f32 v67, v67, v229
    v_sub_f32 v68, v68, v229
    v_sub_f32 v69, v69, v229
    v_sub_f32 v70, v70, v229
    v_sub_f32 v71, v71, v229
    v_sub_f32 v72, v72, v229
    v_sub_f32 v73, v73, v229
    v_sub_f32 v74, v74, v229
    v_sub_f32 v75, v75, v229
    v_sub_f32 v76, v76, v229
    v_sub_f32 v77, v77, v229
    v_sub_f32 v78, v78, v229
    v_sub_f32 v79, v79, v229
    v_sub_f32 v80, v80, v229
    v_sub_f32 v81, v81, v229
    v_sub_f32 v82, v82, v229
    v_sub_f32 v83, v83, v229
    v_sub_f32 v84, v84, v229
    v_sub_f32 v85, v85, v229
    v_sub_f32 v86, v86, v229
    v_sub_f32 v87, v87, v229
    v_sub_f32 v88, v88, v229
    v_sub_f32 v89, v89, v229
    v_sub_f32 v90, v90, v229
    v_sub_f32 v91, v91, v229
    v_sub_f32 v92, v92, v229
    v_sub_f32 v93, v93, v229
    v_sub_f32 v94, v94, v229
    v_sub_f32 v95, v95, v229
    v_sub_f32 v96, v96, v228
    v_sub_f32 v97, v97, v228
    v_sub_f32 v98, v98, v228
    v_sub_f32 v99, v99, v228
    v_sub_f32 v100, v100, v228
    v_sub_f32 v101, v101, v228
    v_sub_f32 v102, v102, v228
    v_sub_f32 v103, v103, v228
    v_sub_f32 v104, v104, v228
    v_sub_f32 v105, v105, v228
    v_sub_f32 v106, v106, v228
    v_sub_f32 v107, v107, v228
    v_sub_f32 v108, v108, v228
    v_sub_f32 v109, v109, v228
    v_sub_f32 v110, v110, v228
    v_sub_f32 v111, v111, v228
    v_sub_f32 v112, v112, v228
    v_sub_f32 v113, v113, v228
    v_sub_f32 v114, v114, v228
    v_sub_f32 v115, v115, v228
    v_sub_f32 v116, v116, v228
    v_sub_f32 v117, v117, v228
    v_sub_f32 v118, v118, v228
    v_sub_f32 v119, v119, v228
    v_sub_f32 v120, v120, v228
    v_sub_f32 v121, v121, v228
    v_sub_f32 v122, v122, v228
    v_sub_f32 v123, v123, v228
    v_sub_f32 v124, v124, v228
    v_sub_f32 v125, v125, v228
    v_sub_f32 v126, v126, v228
    v_sub_f32 v127, v127, v228
    v_exp_f32 v208, v0
    v_exp_f32 v209, v1
    v_exp_f32 v210, v2
    v_add_f32 v232, v208, v209
    v_exp_f32 v211, v3
    v_cvt_pk_bf16_f32 v220, v208, v209
    v_exp_f32 v212, v4
    v_add_f32 v232, v232, v210
    v_exp_f32 v213, v5
    v_add_f32 v232, v232, v211
    v_cvt_pk_bf16_f32 v221, v210, v211
    v_exp_f32 v208, v6
    v_add_f32 v232, v232, v212
    v_exp_f32 v209, v7
    v_add_f32 v232, v232, v213
    v_cvt_pk_bf16_f32 v222, v212, v213
    v_exp_f32 v210, v8
    v_add_f32 v232, v232, v208
    v_exp_f32 v211, v9
    v_add_f32 v232, v232, v209
    v_cvt_pk_bf16_f32 v223, v208, v209
    v_exp_f32 v212, v10
    v_add_f32 v232, v232, v210
    v_exp_f32 v213, v11
    v_add_f32 v232, v232, v211
    v_cvt_pk_bf16_f32 v224, v210, v211
    v_exp_f32 v208, v12
    v_add_f32 v232, v232, v212
    v_exp_f32 v209, v13
    v_add_f32 v232, v232, v213
    v_cvt_pk_bf16_f32 v225, v212, v213
    v_exp_f32 v210, v14
    v_add_f32 v232, v232, v208
    v_exp_f32 v211, v15
    v_add_f32 v232, v232, v209
    v_cvt_pk_bf16_f32 v226, v208, v209
    v_add_f32 v232, v232, v210
    v_cvt_pk_bf16_f32 v227, v210, v211
    v_add_f32 v232, v232, v211
    v_exp_f32 v208, v64
    v_exp_f32 v209, v65
    v_exp_f32 v210, v66
    v_add_f32 v233, v208, v209
    v_exp_f32 v211, v67
    v_cvt_pk_bf16_f32 v144, v208, v209
    v_exp_f32 v212, v68
    v_add_f32 v233, v233, v210
    v_exp_f32 v213, v69
    v_add_f32 v233, v233, v211
    v_cvt_pk_bf16_f32 v145, v210, v211
    v_exp_f32 v208, v70
    v_add_f32 v233, v233, v212
    v_exp_f32 v209, v71
    v_add_f32 v233, v233, v213
    v_cvt_pk_bf16_f32 v146, v212, v213
    v_exp_f32 v210, v72
    v_add_f32 v233, v233, v208
    v_exp_f32 v211, v73
    v_add_f32 v233, v233, v209
    v_cvt_pk_bf16_f32 v147, v208, v209
    v_exp_f32 v212, v74
    v_add_f32 v233, v233, v210
    v_exp_f32 v213, v75
    v_add_f32 v233, v233, v211
    v_cvt_pk_bf16_f32 v148, v210, v211
    v_exp_f32 v208, v76
    v_add_f32 v233, v233, v212
    v_exp_f32 v209, v77
    v_add_f32 v233, v233, v213
    v_cvt_pk_bf16_f32 v149, v212, v213
    v_exp_f32 v210, v78
    v_add_f32 v233, v233, v208
    v_exp_f32 v211, v79
    v_add_f32 v233, v233, v209
    v_cvt_pk_bf16_f32 v150, v208, v209
    v_add_f32 v233, v233, v210
    v_cvt_pk_bf16_f32 v151, v210, v211
    v_add_f32 v233, v233, v211
    v_sub_f32 v176, 0, v228
    v_sub_f32 v177, 0, v228
    v_sub_f32 v178, 0, v228
    v_sub_f32 v179, 0, v228
    v_sub_f32 v180, 0, v228
    v_sub_f32 v181, 0, v228
    v_sub_f32 v182, 0, v228
    v_sub_f32 v183, 0, v228
    v_sub_f32 v184, 0, v228
    v_sub_f32 v185, 0, v228
    v_sub_f32 v186, 0, v228
    v_sub_f32 v187, 0, v228
    v_sub_f32 v188, 0, v228
    v_sub_f32 v189, 0, v228
    v_sub_f32 v190, 0, v228
    v_sub_f32 v191, 0, v228
    v_sub_f32 v192, 0, v229
    v_sub_f32 v193, 0, v229
    v_sub_f32 v194, 0, v229
    v_sub_f32 v195, 0, v229
    v_sub_f32 v196, 0, v229
    v_sub_f32 v197, 0, v229
    v_sub_f32 v198, 0, v229
    v_sub_f32 v199, 0, v229
    v_sub_f32 v200, 0, v229
    v_sub_f32 v201, 0, v229
    v_sub_f32 v202, 0, v229
    v_sub_f32 v203, 0, v229
    v_sub_f32 v204, 0, v229
    v_sub_f32 v205, 0, v229
    v_sub_f32 v206, 0, v229
    v_sub_f32 v207, 0, v229
    s_nop 1
    s_branch K2_D1e
K2_fx3:
    v_sub_f32 v0, v0, v228
    v_sub_f32 v1, v1, v228
    v_sub_f32 v2, v2, v228
    v_sub_f32 v3, v3, v228
    v_sub_f32 v4, v4, v228
    v_sub_f32 v5, v5, v228
    v_sub_f32 v6, v6, v228
    v_sub_f32 v7, v7, v228
    v_sub_f32 v8, v8, v228
    v_sub_f32 v9, v9, v228
    v_sub_f32 v10, v10, v228
    v_sub_f32 v11, v11, v228
    v_sub_f32 v12, v12, v228
    v_sub_f32 v13, v13, v228
    v_sub_f32 v14, v14, v228
    v_sub_f32 v15, v15, v228
    v_sub_f32 v64, v64, v229
    v_sub_f32 v65, v65, v229
    v_sub_f32 v66, v66, v229
    v_sub_f32 v67, v67, v229
    v_sub_f32 v68, v68, v229
    v_sub_f32 v69, v69, v229
    v_sub_f32 v70, v70, v229
    v_sub_f32 v71, v71, v229
    v_sub_f32 v72, v72, v229
    v_sub_f32 v73, v73, v229
    v_sub_f32 v74, v74, v229
    v_sub_f32 v75, v75, v229
    v_sub_f32 v76, v76, v229
    v_sub_f32 v77, v77, v229
    v_sub_f32 v78, v78, v229
    v_sub_f32 v79, v79, v229
    v_sub_f32 v80, v80, v228
    v_sub_f32 v81, v81, v228
    v_sub_f32 v82, v82, v228
    v_sub_f32 v83, v83, v228
    v_sub_f32 v84, v84, v228
    v_sub_f32 v85, v85, v228
    v_sub_f32 v86, v86, v228
    v_sub_f32 v87, v87, v228
    v_sub_f32 v88, v88, v228
    v_sub_f32 v89, v89, v228
    v_sub_f32 v90, v90, v228
    v_sub_f32 v91, v91, v228
    v_sub_f32 v92, v92, v228
    v_sub_f32 v93, v93, v228
    v_sub_f32 v94, v94, v228
    v_sub_f32 v95, v95, v228
    v_sub_f32 v96, v96, v228
    v_sub_f32 v97, v97, v228
    v_sub_f32 v98, v98, v228
    v_sub_f32 v99, v99, v228
    v_sub_f32 v100, v100, v228
    v_sub_f32 v101, v101, v228
    v_sub_f32 v102, v102, v228
    v_sub_f32 v103, v103, v228
    v_sub_f32 v104, v104, v228
    v_sub_f32 v105, v105, v228
    v_sub_f32 v106, v106, v228
    v_sub_f32 v107, v107, v228
    v_sub_f32 v108, v108, v228
    v_sub_f32 v109, v109, v228
    v_sub_f32 v110, v110, v228
    v_sub_f32 v111, v111, v228
    v_sub_f32 v112, v112, v228
    v_sub_f32 v113, v113, v228
    v_sub_f32 v114, v114, v228
    v_sub_f32 v115, v115, v228
    v_sub_f32 v116, v116, v228
    v_sub_f32 v117, v117, v228
    v_sub_f32 v118, v118, v228
    v_sub_f32 v119, v119, v228
    v_sub_f32 v120, v120, v228
    v_sub_f32 v121, v121, v228
    v_sub_f32 v122, v122, v228
    v_sub_f32 v123, v123, v228
    v_sub_f32 v124, v124, v228
    v_sub_f32 v125, v125, v228
    v_sub_f32 v126, v126, v228
    v_sub_f32 v127, v127, v228
    v_exp_f32 v208, v0
    v_exp_f32 v209, v1
    v_exp_f32 v210, v2
    v_add_f32 v232, v208, v209
    v_exp_f32 v211, v3
    v_cvt_pk_bf16_f32 v220, v208, v209
    v_exp_f32 v212, v4
    v_add_f32 v232, v232, v210
    v_exp_f32 v213, v5
    v_add_f32 v232, v232, v211
    v_cvt_pk_bf16_f32 v221, v210, v211
    v_exp_f32 v208, v6
    v_add_f32 v232, v232, v212
    v_exp_f32 v209, v7
    v_add_f32 v232, v232, v213
    v_cvt_pk_bf16_f32 v222, v212, v213
    v_exp_f32 v210, v8
    v_add_f32 v232, v232, v208
    v_exp_f32 v211, v9
    v_add_f32 v232, v232, v209
    v_cvt_pk_bf16_f32 v223, v208, v209
    v_exp_f32 v212, v10
    v_add_f32 v232, v232, v210
    v_exp_f32 v213, v11
    v_add_f32 v232, v232, v211
    v_cvt_pk_bf16_f32 v224, v210, v211
    v_exp_f32 v208, v12
    v_add_f32 v232, v232, v212
    v_exp_f32 v209, v13
    v_add_f32 v232, v232, v213
    v_cvt_pk_bf16_f32 v225, v212, v213
    v_exp_f32 v210, v14
    v_add_f32 v232, v232, v208
    v_exp_f32 v211, v15
    v_add_f32 v232, v232, v209
    v_cvt_pk_bf16_f32 v226, v208, v209
    v_add_f32 v232, v232, v210
    v_cvt_pk_bf16_f32 v227, v210, v211
    v_add_f32 v232, v232, v211
    v_exp_f32 v208, v64
    v_exp_f32 v209, v65
    v_exp_f32 v210, v66
    v_add_f32 v233, v208, v209
    v_exp_f32 v211, v67
    v_cvt_pk_bf16_f32 v144, v208, v209
    v_exp_f32 v212, v68
    v_add_f32 v233, v233, v210
    v_exp_f32 v213, v69
    v_add_f32 v233, v233, v211
    v_cvt_pk_bf16_f32 v145, v210, v211
    v_exp_f32 v208, v70
    v_add_f32 v233, v233, v212
    v_exp_f32 v209, v71
    v_add_f32 v233, v233, v213
    v_cvt_pk_bf16_f32 v146, v212, v213
    v_exp_f32 v210, v72
    v_add_f32 v233, v233, v208
    v_exp_f32 v211, v73
    v_add_f32 v233, v233, v209
    v_cvt_pk_bf16_f32 v147, v208, v209
    v_exp_f32 v212, v74
    v_add_f32 v233, v233, v210
    v_exp_f32 v213, v75
    v_add_f32 v233, v233, v211
    v_cvt_pk_bf16_f32 v148, v210, v211
    v_exp_f32 v208, v76
    v_add_f32 v233, v233, v212
    v_exp_f32 v209, v77
    v_add_f32 v233, v233, v213
    v_cvt_pk_bf16_f32 v149, v212, v213
    v_exp_f32 v210, v78
    v_add_f32 v233, v233, v208
    v_exp_f32 v211, v79
    v_add_f32 v233, v233, v209
    v_cvt_pk_bf16_f32 v150, v208, v209
    v_add_f32 v233, v233, v210
    v_cvt_pk_bf16_f32 v151, v210, v211
    v_add_f32 v233, v233, v211
    v_sub_f32 v176, 0, v228
    v_sub_f32 v177, 0, v228
    v_sub_f32 v178, 0, v228
    v_sub_f32 v179, 0, v228
    v_sub_f32 v180, 0, v228
    v_sub_f32 v181, 0, v228
    v_sub_f32 v182, 0, v228
    v_sub_f32 v183, 0, v228
    v_sub_f32 v184, 0, v228
    v_sub_f32 v185, 0, v228
    v_sub_f32 v186, 0, v228
    v_sub_f32 v187, 0, v228
    v_sub_f32 v188, 0, v228
    v_sub_f32 v189, 0, v228
    v_sub_f32 v190, 0, v228
    v_sub_f32 v191, 0, v228
    v_sub_f32 v192, 0, v229
    v_sub_f32 v193, 0, v229
    v_sub_f32 v194, 0, v229
    v_sub_f32 v195, 0, v229
    v_sub_f32 v196, 0, v229
    v_sub_f32 v197, 0, v229
    v_sub_f32 v198, 0, v229
    v_sub_f32 v199, 0, v229
    v_sub_f32 v200, 0, v229
    v_sub_f32 v201, 0, v229
    v_sub_f32 v202, 0, v229
    v_sub_f32 v203, 0, v229
    v_sub_f32 v204, 0, v229
    v_sub_f32 v205, 0, v229
    v_sub_f32 v206, 0, v229
    v_sub_f32 v207, 0, v229
    s_nop 1
    s_branch K2_D1e
rs_34:
    s_call_b64 s[6:7], K2_rare0
    s_branch rr_35
rs_36:
    s_call_b64 s[6:7], K2_rare0
    s_branch rr_37
rs_38:
    s_call_b64 s[6:7], K2_rare1
    s_branch rr_39
rs_40:
    s_call_b64 s[6:7], K2_rare1
    s_branch rr_41
pes_42:
    v_lshrrev_b32 v239, 1, v238
    v_and_b32 v239, 56, v239
    buffer_load_dwordx2 v[252:253], v239, s[64:67], s39 offen sc1
    s_branch per_43
spin_45:
    s_mov_b32 s100, 0x40000
spin_45b:
    buffer_load_dwordx2 v[252:253], v239, s[64:67], s45 offen sc1
    s_waitcnt vmcnt(0)
    v_cmp_ne_u64 vcc, s[96:97], v[252:253]
    s_cbranch_vccz ok_44
    s_sub_u32 s100, s100, 1
    s_cmp_eq_u32 s100, 0
    s_cbranch_scc1 ok_44
    s_sleep 8
    s_branch spin_45b
K2_rsf:
    s_call_b64 s[6:7], K2_rare0
    v_exp_f32 v208, v0
    v_exp_f32 v209, v1
    v_exp_f32 v210, v2
    v_add_f32 v214, v208, v209
    v_exp_f32 v211, v3
    v_cvt_pk_bf16_f32 v128, v208, v209
    v_exp_f32 v212, v4
    v_add_f32 v214, v214, v210
    v_exp_f32 v213, v5
    v_add_f32 v214, v214, v211
    v_cvt_pk_bf16_f32 v129, v210, v211
    v_exp_f32 v208, v6
    v_add_f32 v214, v214, v212
    v_exp_f32 v209, v7
    v_add_f32 v214, v214, v213
    v_cvt_pk_bf16_f32 v130, v212, v213
    v_exp_f32 v210, v8
    v_add_f32 v214, v214, v208
    v_exp_f32 v211, v9
    v_add_f32 v214, v214, v209
    v_cvt_pk_bf16_f32 v131, v208, v209
    v_exp_f32 v212, v10
    v_add_f32 v214, v214, v210
    v_exp_f32 v213, v11
    v_add_f32 v214, v214, v211
    v_cvt_pk_bf16_f32 v132, v210, v211
    v_exp_f32 v208, v12
    v_add_f32 v214, v214, v212
    v_exp_f32 v209, v13
    v_add_f32 v214, v214, v213
    v_cvt_pk_bf16_f32 v133, v212, v213
    v_exp_f32 v210, v14
    v_add_f32 v214, v214, v208
    v_exp_f32 v211, v15
    v_add_f32 v214, v214, v209
    v_cvt_pk_bf16_f32 v134, v208, v209
    v_exp_f32 v212, v16
    v_add_f32 v214, v214, v210
    v_exp_f32 v213, v17
    v_add_f32 v214, v214, v211
    v_cvt_pk_bf16_f32 v135, v210, v211
    v_exp_f32 v208, v18
    v_add_f32 v215, v212, v213
    v_exp_f32 v209, v19
    v_cvt_pk_bf16_f32 v136, v212, v213
    v_exp_f32 v210, v20
    v_add_f32 v215, v215, v208
    v_exp_f32 v211, v21
    v_add_f32 v215, v215, v209
    v_cvt_pk_bf16_f32 v137, v208, v209
    v_exp_f32 v212, v22
    v_add_f32 v215, v215, v210
    v_exp_f32 v213, v23
    v_add_f32 v215, v215, v211
    v_cvt_pk_bf16_f32 v138, v210, v211
    v_exp_f32 v208, v24
    v_add_f32 v215, v215, v212
    v_exp_f32 v209, v25
    v_add_f32 v215, v215, v213
    v_cvt_pk_bf16_f32 v139, v212, v213
    v_exp_f32 v210, v26
    v_add_f32 v215, v215, v208
    v_exp_f32 v211, v27
    v_add_f32 v215, v215, v209
    v_cvt_pk_bf16_f32 v140, v208, v209
    v_exp_f32 v212, v28
    v_add_f32 v215, v215, v210
    v_exp_f32 v213, v29
    v_add_f32 v215, v215, v211
    v_cvt_pk_bf16_f32 v141, v210, v211
    v_exp_f32 v208, v30
    v_add_f32 v215, v215, v212
    v_exp_f32 v209, v31
    v_add_f32 v215, v215, v213
    v_cvt_pk_bf16_f32 v142, v212, v213
    v_add_f32 v215, v215, v208
    v_cvt_pk_bf16_f32 v143, v208, v209
    v_add_f32 v215, v215, v209
    s_nop 1
    s_branch K2_retf
K2_FbN:
    s_waitcnt lgkmcnt(4)
    v_mfma_f32_32x32x16_bf16 a[0:15], a[192:195], v[128:131], a[0:15]
    ds_read_b128 a[224:227], v240 offset:40960
    ds_read_b128 a[228:231], v240 offset:41984
    v_exp_f32 v208, v32
    v_exp_f32 v209, v33
    v_mfma_f32_32x32x16_bf16 a[16:31], a[196:199], v[128:131], a[16:31]
    ds_read_b128 a[232:235], v240 offset:43008
    v_exp_f32 v210, v34
    v_add_f32 v214, v214, v208
    v_exp_f32 v211, v35
    v_mfma_f32_32x32x16_bf16 a[32:47], a[200:203], v[128:131], a[32:47]
    ds_read_b128 a[236:239], v240 offset:44032
    v_add_f32 v214, v214, v209
    v_cvt_pk_bf16_f32 v160, v208, v209
    v_exp_f32 v212, v36
    v_add_f32 v214, v214, v210
    v_mfma_f32_32x32x16_bf16 a[48:63], a[204:207], v[128:131], a[48:63]
    ds_read_b128 a[240:243], v240 offset:45056
    v_exp_f32 v213, v37
    v_add_f32 v214, v214, v211
    s_waitcnt lgkmcnt(5)
    v_mfma_f32_32x32x16_bf16 a[0:15], a[208:211], v[132:135], a[0:15]
    ds_read_b128 a[244:247], v240 offset:46080
    v_cvt_pk_bf16_f32 v161, v210, v211
    v_exp_f32 v208, v38
    v_add_f32 v214, v214, v212
    v_exp_f32 v209, v39
    v_mfma_f32_32x32x16_bf16 a[16:31], a[212:215], v[132:135], a[16:31]
    ds_read_b128 a[248:251], v240 offset:47104
    ds_read_b128 a[252:255], v240 offset:48128
    v_add_f32 v214, v214, v213
    v_cvt_pk_bf16_f32 v162, v212, v213
    v_exp_f32 v210, v40
    v_mfma_f32_32x32x16_bf16 a[32:47], a[216:219], v[132:135], a[32:47]
    ds_read_b128 a[192:195], v240 offset:49152
    v_add_f32 v214, v214, v208
    v_exp_f32 v211, v41
    v_add_f32 v214, v214, v209
    v_mfma_f32_32x32x16_bf16 a[48:63], a[220:223], v[132:135], a[48:63]
    ds_read_b128 a[196:199], v240 offset:50176
    v_cvt_pk_bf16_f32 v163, v208, v209
    v_exp_f32 v212, v42
    v_add_f32 v214, v214, v210
    s_waitcnt lgkmcnt(6)
    v_mfma_f32_32x32x16_bf16 a[0:15], a[224:227], v[136:139], a[0:15]
    ds_read_b128 a[200:203], v240 offset:51200
    v_exp_f32 v213, v43
    v_add_f32 v214, v214, v211
    v_cvt_pk_bf16_f32 v164, v210, v211
    v_mfma_f32_32x32x16_bf16 a[16:31], a[228:231], v[136:139], a[16:31]
    ds_read_b128 a[204:207], v240 offset:52224
    v_exp_f32 v208, v44
    v_add_f32 v214, v214, v212
    v_exp_f32 v209, v45
    v_add_f32 v214, v214, v213
    v_mfma_f32_32x32x16_bf16 a[32:47], a[232:235], v[136:139], a[32:47]
    ds_read_b128 a[208:211], v240 offset:53248
    ds_read_b128 a[212:215], v240 offset:54272
    v_cvt_pk_bf16_f32 v165, v212, v213
    v_exp_f32 v210, v46
    v_mfma_f32_32x32x16_bf16 a[48:63], a[236:239], v[136:139], a[48:63]
    ds_read_b128 a[216:219], v240 offset:55296
    v_add_f32 v214, v214, v208
    v_exp_f32 v211, v47
    v_add_f32 v214, v214, v209
    s_waitcnt lgkmcnt(7)
    v_mfma_f32_32x32x16_bf16 a[0:15], a[240:243], v[140:143], a[0:15]
    ds_read_b128 a[220:223], v240 offset:56320
    v_cvt_pk_bf16_f32 v166, v208, v209
    v_exp_f32 v212, v48
    v_add_f32 v214, v214, v210
    v_exp_f32 v213, v49
    v_mfma_f32_32x32x16_bf16 a[16:31], a[244:247], v[140:143], a[16:31]
    ds_read_b128 a[224:227], v240 offset:57344
    v_add_f32 v214, v214, v211
    v_cvt_pk_bf16_f32 v167, v210, v211
    v_exp_f32 v208, v50
    v_mfma_f32_32x32x16_bf16 a[32:47], a[248:251], v[140:143], a[32:47]
    ds_read_b128 a[228:231], v240 offset:58368
    v_add_f32 v215, v215, v212
    v_exp_f32 v209, v51
    v_add_f32 v215, v215, v213
    v_cvt_pk_bf16_f32 v168, v212, v213
    v_mfma_f32_32x32x16_bf16 a[48:63], a[252:255], v[140:143], a[48:63]
    ds_read_b128 a[232:235], v240 offset:59392
    ds_read_b128 a[236:239], v240 offset:60416
    v_exp_f32 v210, v52
    v_add_f32 v215, v215, v208
    v_exp_f32 v211, v53
    s_waitcnt lgkmcnt(8)
    v_mfma_f32_32x32x16_bf16 a[0:15], a[192:195], v[160:163], a[0:15]
    ds_read_b128 a[240:243], v240 offset:61440
    v_add_f32 v215, v215, v209
    v_cvt_pk_bf16_f32 v169, v208, v209
    v_exp_f32 v212, v54
    v_add_f32 v215, v215, v210
    v_mfma_f32_32x32x16_bf16 a[16:31], a[196:199], v[160:163], a[16:31]
    ds_read_b128 a[244:247], v240 offset:62464
    v_exp_f32 v213, v55
    v_add_f32 v215, v215, v211
    v_cvt_pk_bf16_f32 v170, v210, v211
    v_exp_f32 v208, v56
    v_mfma_f32_32x32x16_bf16 a[32:47], a[200:203], v[160:163], a[32:47]
    ds_read_b128 a[248:251], v240 offset:63488
    v_add_f32 v215, v215, v212
    v_exp_f32 v209, v57
    v_add_f32 v215, v215, v213
    v_cvt_pk_bf16_f32 v171, v212, v213
    v_mfma_f32_32x32x16_bf16 a[48:63], a[204:207], v[160:163], a[48:63]
    ds_read_b128 a[252:255], v240 offset:64512
    v_exp_f32 v210, v58
    v_add_f32 v215, v215, v208
    v_exp_f32 v211, v59
    s_waitcnt lgkmcnt(8)
    v_mfma_f32_32x32x16_bf16 a[0:15], a[208:211], v[164:167], a[0:15]
    v_add_f32 v215, v215, v209
    v_cvt_pk_bf16_f32 v172, v208, v209
    v_exp_f32 v212, v60
    v_add_f32 v215, v215, v210
    v_mfma_f32_32x32x16_bf16 a[16:31], a[212:215], v[164:167], a[16:31]
    v_exp_f32 v213, v61
    v_add_f32 v215, v215, v211
    v_cvt_pk_bf16_f32 v173, v210, v211
    v_exp_f32 v208, v62
    v_add_f32 v215, v215, v212
    v_mfma_f32_32x32x16_bf16 a[32:47], a[216:219], v[164:167], a[32:47]
    v_exp_f32 v209, v63
    v_add_f32 v215, v215, v213
    v_cvt_pk_bf16_f32 v174, v212, v213
    v_add_f32 v215, v215, v208
    v_cvt_pk_bf16_f32 v175, v208, v209
    v_add_f32 v215, v215, v209
    v_mfma_f32_32x32x16_bf16 a[48:63], a[220:223], v[164:167], a[48:63]
    s_waitcnt vmcnt(63) lgkmcnt(0)
    s_barrier
    v_mfma_f32_32x32x16_bf16 a[0:15], a[224:227], v[168:171], a[0:15]
    v_add_f32 v216, v216, v214
    v_mfma_f32_32x32x16_bf16 a[16:31], a[228:231], v[168:171], a[16:31]
    v_mfma_f32_32x32x16_bf16 a[32:47], a[232:235], v[168:171], a[32:47]
    v_add_f32 v216, v216, v215
    v_mfma_f32_32x32x16_bf16 a[48:63], a[236:239], v[168:171], a[48:63]
    v_mfma_f32_32x32x16_bf16 a[0:15], a[240:243], v[172:175], a[0:15]
    v_mfma_f32_32x32x16_bf16 a[16:31], a[244:247], v[172:175], a[16:31]
    v_mfma_f32_32x32x16_bf16 a[32:47], a[248:251], v[172:175], a[32:47]
    v_mfma_f32_32x32x16_bf16 a[48:63], a[252:255], v[172:175], a[48:63]
    s_branch K2_Fe
K2_rare0:
    s_nop 15
    v_max3_f32 v220, v0, v1, v2
    v_max3_f32 v220, v220, v3, v4
    v_max3_f32 v220, v220, v5, v6
    v_max3_f32 v220, v220, v7, v8
    v_max3_f32 v220, v220, v9, v10
    v_max3_f32 v220, v220, v11, v12
    v_max3_f32 v220, v220, v13, v14
    v_max_f32 v220, v220, v15
    v_max3_f32 v221, v16, v17, v18
    v_max3_f32 v221, v221, v19, v20
    v_max3_f32 v221, v221, v21, v22
    v_max3_f32 v221, v221, v23, v24
    v_max3_f32 v221, v221, v25, v26
    v_max3_f32 v221, v221, v27, v28
    v_max3_f32 v221, v221, v29, v30
    v_max_f32 v221, v221, v31
    v_max3_f32 v220, v220, v32, v33
    v_max3_f32 v220, v220, v34, v35
    v_max3_f32 v220, v220, v36, v37
    v_max3_f32 v220, v220, v38, v39
    v_max3_f32 v220, v220, v40, v41
    v_max3_f32 v220, v220, v42, v43
    v_max3_f32 v220, v220, v44, v45
    v_max3_f32 v220, v220, v46, v47
    v_max3_f32 v221, v221, v48, v49
    v_max3_f32 v221, v221, v50, v51
    v_max3_f32 v221, v221, v52, v53
    v_max3_f32 v221, v221, v54, v55
    v_max3_f32 v221, v221, v56, v57
    v_max3_f32 v221, v221, v58, v59
    v_max3_f32 v221, v221, v60, v61
    v_max3_f32 v221, v221, v62, v63
    v_mov_b32 v222, v220
    v_mov_b32 v223, v221
    s_nop 1
    v_permlane32_swap_b32 v220, v222
    v_permlane32_swap_b32 v221, v223
    s_nop 1
    v_max_f32 v220, v220, v222
    v_max_f32 v221, v221, v223
    v_max_f32 v220, 0, v220
    v_max_f32 v221, 0, v221
    v_max_f32 v222, v220, v221
    s_sub_u32 s3, s54, 2
    s_cmp_lt_u32 s3, s56
    s_cselect_b64 vcc, -1, 0
    v_cndmask_b32 v220, v222, v220, vcc
    v_cndmask_b32 v223, 0, v221, vcc
    v_cndmask_b32 v221, v222, v221, vcc
    s_cmp_lt_u32 s54, s55
    s_cselect_b64 vcc, -1, 0
    v_cndmask_b32 v224, v220, v223, vcc
    v_exp_f32 v225, -v220
    v_exp_f32 v226, -v223
    v_sub_f32 v0, v0, v220
    v_sub_f32 v64, v64, v220
    v_sub_f32 v1, v1, v220
    v_sub_f32 v65, v65, v220
    v_sub_f32 v2, v2, v220
    v_sub_f32 v66, v66, v220
    v_sub_f32 v3, v3, v220
    v_sub_f32 v67, v67, v220
    v_sub_f32 v4, v4, v220
    v_sub_f32 v68, v68, v220
    v_sub_f32 v5, v5, v220
    v_sub_f32 v69, v69, v220
    v_sub_f32 v6, v6, v220
    v_sub_f32 v70, v70, v220
    v_sub_f32 v7, v7, v220
    v_sub_f32 v71, v71, v220
    v_sub_f32 v8, v8, v220
    v_sub_f32 v72, v72, v220
    v_sub_f32 v9, v9, v220
    v_sub_f32 v73, v73, v220
    v_sub_f32 v10, v10, v220
    v_sub_f32 v74, v74, v220
    v_sub_f32 v11, v11, v220
    v_sub_f32 v75, v75, v220
    v_sub_f32 v12, v12, v220
    v_sub_f32 v76, v76, v220
    v_sub_f32 v13, v13, v220
    v_sub_f32 v77, v77, v220
    v_sub_f32 v14, v14, v220
    v_sub_f32 v78, v78, v220
    v_sub_f32 v15, v15, v220
    v_sub_f32 v79, v79, v220
    v_sub_f32 v16, v16, v221
    v_sub_f32 v80, v80, v224
    v_sub_f32 v17, v17, v221
    v_sub_f32 v81, v81, v224
    v_sub_f32 v18, v18, v221
    v_sub_f32 v82, v82, v224
    v_sub_f32 v19, v19, v221
    v_sub_f32 v83, v83, v224
    v_sub_f32 v20, v20, v221
    v_sub_f32 v84, v84, v224
    v_sub_f32 v21, v21, v221
    v_sub_f32 v85, v85, v224
    v_sub_f32 v22, v22, v221
    v_sub_f32 v86, v86, v224
    v_sub_f32 v23, v23, v221
    v_sub_f32 v87, v87, v224
    v_sub_f32 v24, v24, v221
    v_sub_f32 v88, v88, v224
    v_sub_f32 v25, v25, v221
    v_sub_f32 v89, v89, v224
    v_sub_f32 v26, v26, v221
    v_sub_f32 v90, v90, v224
    v_sub_f32 v27, v27, v221
    v_sub_f32 v91, v91, v224
    v_sub_f32 v28, v28, v221
    v_sub_f32 v92, v92, v224
    v_sub_f32 v29, v29, v221
    v_sub_f32 v93, v93, v224
    v_sub_f32 v30, v30, v221
    v_sub_f32 v94, v94, v224
    v_sub_f32 v31, v31, v221
    v_sub_f32 v95, v95, v224
    v_sub_f32 v32, v32, v220
    v_sub_f32 v96, v96, v220
    v_sub_f32 v33, v33, v220
    v_sub_f32 v97, v97, v220
    v_sub_f32 v34, v34, v220
    v_sub_f32 v98, v98, v220
    v_sub_f32 v35, v35, v220
    v_sub_f32 v99, v99, v220
    v_sub_f32 v36, v36, v220
    v_sub_f32 v100, v100, v220
    v_sub_f32 v37, v37, v220
    v_sub_f32 v101, v101, v220
    v_sub_f32 v38, v38, v220
    v_sub_f32 v102, v102, v220
    v_sub_f32 v39, v39, v220
    v_sub_f32 v103, v103, v220
    v_sub_f32 v40, v40, v220
    v_sub_f32 v104, v104, v220
    v_sub_f32 v41, v41, v220
    v_sub_f32 v105, v105, v220
    v_sub_f32 v42, v42, v220
    v_sub_f32 v106, v106, v220
    v_sub_f32 v43, v43, v220
    v_sub_f32 v107, v107, v220
    v_sub_f32 v44, v44, v220
    v_sub_f32 v108, v108, v220
    v_sub_f32 v45, v45, v220
    v_sub_f32 v109, v109, v220
    v_sub_f32 v46, v46, v220
    v_sub_f32 v110, v110, v220
    v_sub_f32 v47, v47, v220
    v_sub_f32 v111, v111, v220
    v_sub_f32 v48, v48, v221
    v_sub_f32 v112, v112, v224
    v_sub_f32 v49, v49, v221
    v_sub_f32 v113, v113, v224
    v_sub_f32 v50, v50, v221
    v_sub_f32 v114, v114, v224
    v_sub_f32 v51, v51, v221
    v_sub_f32 v115, v115, v224
    v_sub_f32 v52, v52, v221
    v_sub_f32 v116, v116, v224
    v_sub_f32 v53, v53, v221
    v_sub_f32 v117, v117, v224
    v_sub_f32 v54, v54, v221
    v_sub_f32 v118, v118, v224
    v_sub_f32 v55, v55, v221
    v_sub_f32 v119, v119, v224
    v_sub_f32 v56, v56, v221
    v_sub_f32 v120, v120, v224
    v_sub_f32 v57, v57, v221
    v_sub_f32 v121, v121, v224
    v_sub_f32 v58, v58, v221
    v_sub_f32 v122, v122, v224
    v_sub_f32 v59, v59, v221
    v_sub_f32 v123, v123, v224
    v_sub_f32 v60, v60, v221
    v_sub_f32 v124, v124, v224
    v_sub_f32 v61, v61, v221
    v_sub_f32 v125, v125, v224
    v_sub_f32 v62, v62, v221
    v_sub_f32 v126, v126, v224
    v_sub_f32 v63, v63, v221
    v_sub_f32 v127, v127, v224
    v_sub_f32 v176, v176, v220
    v_sub_f32 v177, v177, v220
    v_sub_f32 v178, v178, v220
    v_sub_f32 v179, v179, v220
    v_sub_f32 v180, v180, v220
    v_sub_f32 v181, v181, v220
    v_sub_f32 v182, v182, v220
    v_sub_f32 v183, v183, v220
    v_sub_f32 v184, v184, v220
    v_sub_f32 v185, v185, v220
    v_sub_f32 v186, v186, v220
    v_sub_f32 v187, v187, v220
    v_sub_f32 v188, v188, v220
    v_sub_f32 v189, v189, v220
    v_sub_f32 v190, v190, v220
    v_sub_f32 v191, v191, v220
    v_mul_f32 v216, v216, v225
    v_accvgpr_read_b32 v228, a0
    v_accvgpr_read_b32 v229, a1
    v_accvgpr_read_b32 v230, a2
    v_accvgpr_read_b32 v231, a3
    v_accvgpr_read_b32 v232, a4
    v_accvgpr_read_b32 v233, a5
    v_accvgpr_read_b32 v234, a6
    v_accvgpr_read_b32 v235, a7
    v_mul_f32 v228, v228, v225
    v_mul_f32 v229, v229, v225
    v_mul_f32 v230, v230, v225
    v_mul_f32 v231, v231, v225
    v_mul_f32 v232, v232, v225
    v_mul_f32 v233, v233, v225
    v_mul_f32 v234, v234, v225
    v_mul_f32 v235, v235, v225
    v_accvgpr_write_b32 a0, v228
    v_accvgpr_write_b32 a1, v229
    v_accvgpr_write_b32 a2, v230
    v_accvgpr_write_b32 a3, v231
    v_accvgpr_write_b32 a4, v232
    v_accvgpr_write_b32 a5, v233
    v_accvgpr_write_b32 a6, v234
    v_accvgpr_write_b32 a7, v235
    v_accvgpr_read_b32 v228, a8
    v_accvgpr_read_b32 v229, a9
    v_accvgpr_read_b32 v230, a10
    v_accvgpr_read_b32 v231, a11
    v_accvgpr_read_b32 v232, a12
    v_accvgpr_read_b32 v233, a13
    v_accvgpr_read_b32 v234, a14
    v_accvgpr_read_b32 v235, a15
    v_mul_f32 v228, v228, v225
    v_mul_f32 v229, v229, v225
    v_mul_f32 v230, v230, v225
    v_mul_f32 v231, v231, v225
    v_mul_f32 v232, v232, v225
    v_mul_f32 v233, v233, v225
    v_mul_f32 v234, v234, v225
    v_mul_f32 v235, v235, v225
    v_accvgpr_write_b32 a8, v228
    v_accvgpr_write_b32 a9, v229
    v_accvgpr_write_b32 a10, v230
    v_accvgpr_write_b32 a11, v231
    v_accvgpr_write_b32 a12, v232
    v_accvgpr_write_b32 a13, v233
    v_accvgpr_write_b32 a14, v234
    v_accvgpr_write_b32 a15, v235
    v_accvgpr_read_b32 v228, a16
    v_accvgpr_read_b32 v229, a17
    v_accvgpr_read_b32 v230, a18
    v_accvgpr_read_b32 v231, a19
    v_accvgpr_read_b32 v232, a20
    v_accvgpr_read_b32 v233, a21
    v_accvgpr_read_b32 v234, a22
    v_accvgpr_read_b32 v235, a23
    v_mul_f32 v228, v228, v225
    v_mul_f32 v229, v229, v225
    v_mul_f32 v230, v230, v225
    v_mul_f32 v231, v231, v225
    v_mul_f32 v232, v232, v225
    v_mul_f32 v233, v233, v225
    v_mul_f32 v234, v234, v225
    v_mul_f32 v235, v235, v225
    v_accvgpr_write_b32 a16, v228
    v_accvgpr_write_b32 a17, v229
    v_accvgpr_write_b32 a18, v230
    v_accvgpr_write_b32 a19, v231
    v_accvgpr_write_b32 a20, v232
    v_accvgpr_write_b32 a21, v233
    v_accvgpr_write_b32 a22, v234
    v_accvgpr_write_b32 a23, v235
    v_accvgpr_read_b32 v228, a24
    v_accvgpr_read_b32 v229, a25
    v_accvgpr_read_b32 v230, a26
    v_accvgpr_read_b32 v231, a27
    v_accvgpr_read_b32 v232, a28
    v_accvgpr_read_b32 v233, a29
    v_accvgpr_read_b32 v234, a30
    v_accvgpr_read_b32 v235, a31
    v_mul_f32 v228, v228, v225
    v_mul_f32 v229, v229, v225
    v_mul_f32 v230, v230, v225
    v_mul_f32 v231, v231, v225
    v_mul_f32 v232, v232, v225
    v_mul_f32 v233, v233, v225
    v_mul_f32 v234, v234, v225
    v_mul_f32 v235, v235, v225
    v_accvgpr_write_b32 a24, v228
    v_accvgpr_write_b32 a25, v229
    v_accvgpr_write_b32 a26, v230
    v_accvgpr_write_b32 a27, v231
    v_accvgpr_write_b32 a28, v232
    v_accvgpr_write_b32 a29, v233
    v_accvgpr_write_b32 a30, v234
    v_accvgpr_write_b32 a31, v235
    v_accvgpr_read_b32 v228, a32
    v_accvgpr_read_b32 v229, a33
    v_accvgpr_read_b32 v230, a34
    v_accvgpr_read_b32 v231, a35
    v_accvgpr_read_b32 v232, a36
    v_accvgpr_read_b32 v233, a37
    v_accvgpr_read_b32 v234, a38
    v_accvgpr_read_b32 v235, a39
    v_mul_f32 v228, v228, v225
    v_mul_f32 v229, v229, v225
    v_mul_f32 v230, v230, v225
    v_mul_f32 v231, v231, v225
    v_mul_f32 v232, v232, v225
    v_mul_f32 v233, v233, v225
    v_mul_f32 v234, v234, v225
    v_mul_f32 v235, v235, v225
    v_accvgpr_write_b32 a32, v228
    v_accvgpr_write_b32 a33, v229
    v_accvgpr_write_b32 a34, v230
    v_accvgpr_write_b32 a35, v231
    v_accvgpr_write_b32 a36, v232
    v_accvgpr_write_b32 a37, v233
    v_accvgpr_write_b32 a38, v234
    v_accvgpr_write_b32 a39, v235
    v_accvgpr_read_b32 v228, a40
    v_accvgpr_read_b32 v229, a41
    v_accvgpr_read_b32 v230, a42
    v_accvgpr_read_b32 v231, a43
    v_accvgpr_read_b32 v232, a44
    v_accvgpr_read_b32 v233, a45
    v_accvgpr_read_b32 v234, a46
    v_accvgpr_read_b32 v235, a47
    v_mul_f32 v228, v228, v225
    v_mul_f32 v229, v229, v225
    v_mul_f32 v230, v230, v225
    v_mul_f32 v231, v231, v225
    v_mul_f32 v232, v232, v225
    v_mul_f32 v233, v233, v225
    v_mul_f32 v234, v234, v225
    v_mul_f32 v235, v235, v225
    v_accvgpr_write_b32 a40, v228
    v_accvgpr_write_b32 a41, v229
    v_accvgpr_write_b32 a42, v230
    v_accvgpr_write_b32 a43, v231
    v_accvgpr_write_b32 a44, v232
    v_accvgpr_write_b32 a45, v233
    v_accvgpr_write_b32 a46, v234
    v_accvgpr_write_b32 a47, v235
    v_accvgpr_read_b32 v228, a48
    v_accvgpr_read_b32 v229, a49
    v_accvgpr_read_b32 v230, a50
    v_accvgpr_read_b32 v231, a51
    v_accvgpr_read_b32 v232, a52
    v_accvgpr_read_b32 v233, a53
    v_accvgpr_read_b32 v234, a54
    v_accvgpr_read_b32 v235, a55
    v_mul_f32 v228, v228, v225
    v_mul_f32 v229, v229, v225
    v_mul_f32 v230, v230, v225
    v_mul_f32 v231, v231, v225
    v_mul_f32 v232, v232, v225
    v_mul_f32 v233, v233, v225
    v_mul_f32 v234, v234, v225
    v_mul_f32 v235, v235, v225
    v_accvgpr_write_b32 a48, v228
    v_accvgpr_write_b32 a49, v229
    v_accvgpr_write_b32 a50, v230
    v_accvgpr_write_b32 a51, v231
    v_accvgpr_write_b32 a52, v232
    v_accvgpr_write_b32 a53, v233
    v_accvgpr_write_b32 a54, v234
    v_accvgpr_write_b32 a55, v235
    v_accvgpr_read_b32 v228, a56
    v_accvgpr_read_b32 v229, a57
    v_accvgpr_read_b32 v230, a58
    v_accvgpr_read_b32 v231, a59
    v_accvgpr_read_b32 v232, a60
    v_accvgpr_read_b32 v233, a61
    v_accvgpr_read_b32 v234, a62
    v_accvgpr_read_b32 v235, a63
    v_mul_f32 v228, v228, v225
    v_mul_f32 v229, v229, v225
    v_mul_f32 v230, v230, v225
    v_mul_f32 v231, v231, v225
    v_mul_f32 v232, v232, v225
    v_mul_f32 v233, v233, v225
    v_mul_f32 v234, v234, v225
    v_mul_f32 v235, v235, v225
    v_accvgpr_write_b32 a56, v228
    v_accvgpr_write_b32 a57, v229
    v_accvgpr_write_b32 a58, v230
    v_accvgpr_write_b32 a59, v231
    v_accvgpr_write_b32 a60, v232
    v_accvgpr_write_b32 a61, v233
    v_accvgpr_write_b32 a62, v234
    v_accvgpr_write_b32 a63, v235
    v_sub_f32 v192, v192, v223
    v_sub_f32 v193, v193, v223
    v_sub_f32 v194, v194, v223
    v_sub_f32 v195, v195, v223
    v_sub_f32 v196, v196, v223
    v_sub_f32 v197, v197, v223
    v_sub_f32 v198, v198, v223
    v_sub_f32 v199, v199, v223
    v_sub_f32 v200, v200, v223
    v_sub_f32 v201, v201, v223
    v_sub_f32 v202, v202, v223
    v_sub_f32 v203, v203, v223
    v_sub_f32 v204, v204, v223
    v_sub_f32 v205, v205, v223
    v_sub_f32 v206, v206, v223
    v_sub_f32 v207, v207, v223
    v_mul_f32 v217, v217, v226
    v_accvgpr_read_b32 v228, a64
    v_accvgpr_read_b32 v229, a65
    v_accvgpr_read_b32 v230, a66
    v_accvgpr_read_b32 v231, a67
    v_accvgpr_read_b32 v232, a68
    v_accvgpr_read_b32 v233, a69
    v_accvgpr_read_b32 v234, a70
    v_accvgpr_read_b32 v235, a71
    v_mul_f32 v228, v228, v226
    v_mul_f32 v229, v229, v226
    v_mul_f32 v230, v230, v226
    v_mul_f32 v231, v231, v226
    v_mul_f32 v232, v232, v226
    v_mul_f32 v233, v233, v226
    v_mul_f32 v234, v234, v226
    v_mul_f32 v235, v235, v226
    v_accvgpr_write_b32 a64, v228
    v_accvgpr_write_b32 a65, v229
    v_accvgpr_write_b32 a66, v230
    v_accvgpr_write_b32 a67, v231
    v_accvgpr_write_b32 a68, v232
    v_accvgpr_write_b32 a69, v233
    v_accvgpr_write_b32 a70, v234
    v_accvgpr_write_b32 a71, v235
    v_accvgpr_read_b32 v228, a72
    v_accvgpr_read_b32 v229, a73
    v_accvgpr_read_b32 v230, a74
    v_accvgpr_read_b32 v231, a75
    v_accvgpr_read_b32 v232, a76
    v_accvgpr_read_b32 v233, a77
    v_accvgpr_read_b32 v234, a78
    v_accvgpr_read_b32 v235, a79
    v_mul_f32 v228, v228, v226
    v_mul_f32 v229, v229, v226
    v_mul_f32 v230, v230, v226
    v_mul_f32 v231, v231, v226
    v_mul_f32 v232, v232, v226
    v_mul_f32 v233, v233, v226
    v_mul_f32 v234, v234, v226
    v_mul_f32 v235, v235, v226
    v_accvgpr_write_b32 a72, v228
    v_accvgpr_write_b32 a73, v229
    v_accvgpr_write_b32 a74, v230
    v_accvgpr_write_b32 a75, v231
    v_accvgpr_write_b32 a76, v232
    v_accvgpr_write_b32 a77, v233
    v_accvgpr_write_b32 a78, v234
    v_accvgpr_write_b32 a79, v235
    v_accvgpr_read_b32 v228, a80
    v_accvgpr_read_b32 v229, a81
    v_accvgpr_read_b32 v230, a82
    v_accvgpr_read_b32 v231, a83
    v_accvgpr_read_b32 v232, a84
    v_accvgpr_read_b32 v233, a85
    v_accvgpr_read_b32 v234, a86
    v_accvgpr_read_b32 v235, a87
    v_mul_f32 v228, v228, v226
    v_mul_f32 v229, v229, v226
    v_mul_f32 v230, v230, v226
    v_mul_f32 v231, v231, v226
    v_mul_f32 v232, v232, v226
    v_mul_f32 v233, v233, v226
    v_mul_f32 v234, v234, v226
    v_mul_f32 v235, v235, v226
    v_accvgpr_write_b32 a80, v228
    v_accvgpr_write_b32 a81, v229
    v_accvgpr_write_b32 a82, v230
    v_accvgpr_write_b32 a83, v231
    v_accvgpr_write_b32 a84, v232
    v_accvgpr_write_b32 a85, v233
    v_accvgpr_write_b32 a86, v234
    v_accvgpr_write_b32 a87, v235
    v_accvgpr_read_b32 v228, a88
    v_accvgpr_read_b32 v229, a89
    v_accvgpr_read_b32 v230, a90
    v_accvgpr_read_b32 v231, a91
    v_accvgpr_read_b32 v232, a92
    v_accvgpr_read_b32 v233, a93
    v_accvgpr_read_b32 v234, a94
    v_accvgpr_read_b32 v235, a95
    v_mul_f32 v228, v228, v226
    v_mul_f32 v229, v229, v226
    v_mul_f32 v230, v230, v226
    v_mul_f32 v231, v231, v226
    v_mul_f32 v232, v232, v226
    v_mul_f32 v233, v233, v226
    v_mul_f32 v234, v234, v226
    v_mul_f32 v235, v235, v226
    v_accvgpr_write_b32 a88, v228
    v_accvgpr_write_b32 a89, v229
    v_accvgpr_write_b32 a90, v230
    v_accvgpr_write_b32 a91, v231
    v_accvgpr_write_b32 a92, v232
    v_accvgpr_write_b32 a93, v233
    v_accvgpr_write_b32 a94, v234
    v_accvgpr_write_b32 a95, v235
    v_accvgpr_read_b32 v228, a96
    v_accvgpr_read_b32 v229, a97
    v_accvgpr_read_b32 v230, a98
    v_accvgpr_read_b32 v231, a99
    v_accvgpr_read_b32 v232, a100
    v_accvgpr_read_b32 v233, a101
    v_accvgpr_read_b32 v234, a102
    v_accvgpr_read_b32 v235, a103
    v_mul_f32 v228, v228, v226
    v_mul_f32 v229, v229, v226
    v_mul_f32 v230, v230, v226
    v_mul_f32 v231, v231, v226
    v_mul_f32 v232, v232, v226
    v_mul_f32 v233, v233, v226
    v_mul_f32 v234, v234, v226
    v_mul_f32 v235, v235, v226
    v_accvgpr_write_b32 a96, v228
    v_accvgpr_write_b32 a97, v229
    v_accvgpr_write_b32 a98, v230
    v_accvgpr_write_b32 a99, v231
    v_accvgpr_write_b32 a100, v232
    v_accvgpr_write_b32 a101, v233
    v_accvgpr_write_b32 a102, v234
    v_accvgpr_write_b32 a103, v235
    v_accvgpr_read_b32 v228, a104
    v_accvgpr_read_b32 v229, a105
    v_accvgpr_read_b32 v230, a106
    v_accvgpr_read_b32 v231, a107
    v_accvgpr_read_b32 v232, a108
    v_accvgpr_read_b32 v233, a109
    v_accvgpr_read_b32 v234, a110
    v_accvgpr_read_b32 v235, a111
    v_mul_f32 v228, v228, v226
    v_mul_f32 v229, v229, v226
    v_mul_f32 v230, v230, v226
    v_mul_f32 v231, v231, v226
    v_mul_f32 v232, v232, v226
    v_mul_f32 v233, v233, v226
    v_mul_f32 v234, v234, v226
    v_mul_f32 v235, v235, v226
    v_accvgpr_write_b32 a104, v228
    v_accvgpr_write_b32 a105, v229
    v_accvgpr_write_b32 a106, v230
    v_accvgpr_write_b32 a107, v231
    v_accvgpr_write_b32 a108, v232
    v_accvgpr_write_b32 a109, v233
    v_accvgpr_write_b32 a110, v234
    v_accvgpr_write_b32 a111, v235
    v_accvgpr_read_b32 v228, a112
    v_accvgpr_read_b32 v229, a113
    v_accvgpr_read_b32 v230, a114
    v_accvgpr_read_b32 v231, a115
    v_accvgpr_read_b32 v232, a116
    v_accvgpr_read_b32 v233, a117
    v_accvgpr_read_b32 v234, a118
    v_accvgpr_read_b32 v235, a119
    v_mul_f32 v228, v228, v226
    v_mul_f32 v229, v229, v226
    v_mul_f32 v230, v230, v226
    v_mul_f32 v231, v231, v226
    v_mul_f32 v232, v232, v226
    v_mul_f32 v233, v233, v226
    v_mul_f32 v234, v234, v226
    v_mul_f32 v235, v235, v226
    v_accvgpr_write_b32 a112, v228
    v_accvgpr_write_b32 a113, v229
    v_accvgpr_write_b32 a114, v230
    v_accvgpr_write_b32 a115, v231
    v_accvgpr_write_b32 a116, v232
    v_accvgpr_write_b32 a117, v233
    v_accvgpr_write_b32 a118, v234
    v_accvgpr_write_b32 a119, v235
    v_accvgpr_read_b32 v228, a120
    v_accvgpr_read_b32 v229, a121
    v_accvgpr_read_b32 v230, a122
    v_accvgpr_read_b32 v231, a123
    v_accvgpr_read_b32 v232, a124
    v_accvgpr_read_b32 v233, a125
    v_accvgpr_read_b32 v234, a126
    v_accvgpr_read_b32 v235, a127
    v_mul_f32 v228, v228, v226
    v_mul_f32 v229, v229, v226
    v_mul_f32 v230, v230, v226
    v_mul_f32 v231, v231, v226
    v_mul_f32 v232, v232, v226
    v_mul_f32 v233, v233, v226
    v_mul_f32 v234, v234, v226
    v_mul_f32 v235, v235, v226
    v_accvgpr_write_b32 a120, v228
    v_accvgpr_write_b32 a121, v229
    v_accvgpr_write_b32 a122, v230
    v_accvgpr_write_b32 a123, v231
    v_accvgpr_write_b32 a124, v232
    v_accvgpr_write_b32 a125, v233
    v_accvgpr_write_b32 a126, v234
    v_accvgpr_write_b32 a127, v235
    v_exp_f32 v208, v0
    v_exp_f32 v209, v1
    v_exp_f32 v210, v2
    v_add_f32 v214, v208, v209
    v_exp_f32 v211, v3
    v_cvt_pk_bf16_f32 v128, v208, v209
    v_exp_f32 v212, v4
    v_add_f32 v214, v214, v210
    v_exp_f32 v213, v5
    v_add_f32 v214, v214, v211
    v_cvt_pk_bf16_f32 v129, v210, v211
    v_exp_f32 v208, v6
    v_add_f32 v214, v214, v212
    v_exp_f32 v209, v7
    v_add_f32 v214, v214, v213
    v_cvt_pk_bf16_f32 v130, v212, v213
    v_exp_f32 v210, v8
    v_add_f32 v214, v214, v208
    v_exp_f32 v211, v9
    v_add_f32 v214, v214, v209
    v_cvt_pk_bf16_f32 v131, v208, v209
    v_exp_f32 v212, v10
    v_add_f32 v214, v214, v210
    v_exp_f32 v213, v11
    v_add_f32 v214, v214, v211
    v_cvt_pk_bf16_f32 v132, v210, v211
    v_exp_f32 v208, v12
    v_add_f32 v214, v214, v212
    v_exp_f32 v209, v13
    v_add_f32 v214, v214, v213
    v_cvt_pk_bf16_f32 v133, v212, v213
    v_exp_f32 v210, v14
    v_add_f32 v214, v214, v208
    v_exp_f32 v211, v15
    v_add_f32 v214, v214, v209
    v_cvt_pk_bf16_f32 v134, v208, v209
    v_exp_f32 v212, v16
    v_add_f32 v214, v214, v210
    v_exp_f32 v213, v17
    v_add_f32 v214, v214, v211
    v_cvt_pk_bf16_f32 v135, v210, v211
    v_exp_f32 v208, v18
    v_add_f32 v215, v212, v213
    v_exp_f32 v209, v19
    v_cvt_pk_bf16_f32 v136, v212, v213
    v_exp_f32 v210, v20
    v_add_f32 v215, v215, v208
    v_exp_f32 v211, v21
    v_add_f32 v215, v215, v209
    v_cvt_pk_bf16_f32 v137, v208, v209
    v_exp_f32 v212, v22
    v_add_f32 v215, v215, v210
    v_exp_f32 v213, v23
    v_add_f32 v215, v215, v211
    v_cvt_pk_bf16_f32 v138, v210, v211
    v_exp_f32 v208, v24
    v_add_f32 v215, v215, v212
    v_exp_f32 v209, v25
    v_add_f32 v215, v215, v213
    v_cvt_pk_bf16_f32 v139, v212, v213
    v_exp_f32 v210, v26
    v_add_f32 v215, v215, v208
    v_exp_f32 v211, v27
    v_add_f32 v215, v215, v209
    v_cvt_pk_bf16_f32 v140, v208, v209
    v_exp_f32 v212, v28
    v_add_f32 v215, v215, v210
    v_exp_f32 v213, v29
    v_add_f32 v215, v215, v211
    v_cvt_pk_bf16_f32 v141, v210, v211
    v_exp_f32 v208, v30
    v_add_f32 v215, v215, v212
    v_exp_f32 v209, v31
    v_add_f32 v215, v215, v213
    v_cvt_pk_bf16_f32 v142, v212, v213
    v_add_f32 v215, v215, v208
    v_cvt_pk_bf16_f32 v143, v208, v209
    v_add_f32 v215, v215, v209
    v_exp_f32 v208, v32
    v_exp_f32 v209, v33
    v_exp_f32 v210, v34
    v_add_f32 v214, v214, v208
    v_exp_f32 v211, v35
    v_add_f32 v214, v214, v209
    v_cvt_pk_bf16_f32 v160, v208, v209
    v_exp_f32 v212, v36
    v_add_f32 v214, v214, v210
    v_exp_f32 v213, v37
    v_add_f32 v214, v214, v211
    v_cvt_pk_bf16_f32 v161, v210, v211
    v_exp_f32 v208, v38
    v_add_f32 v214, v214, v212
    v_exp_f32 v209, v39
    v_add_f32 v214, v214, v213
    v_cvt_pk_bf16_f32 v162, v212, v213
    v_exp_f32 v210, v40
    v_add_f32 v214, v214, v208
    v_exp_f32 v211, v41
    v_add_f32 v214, v214, v209
    v_cvt_pk_bf16_f32 v163, v208, v209
    v_exp_f32 v212, v42
    v_add_f32 v214, v214, v210
    v_exp_f32 v213, v43
    v_add_f32 v214, v214, v211
    v_cvt_pk_bf16_f32 v164, v210, v211
    v_exp_f32 v208, v44
    v_add_f32 v214, v214, v212
    v_exp_f32 v209, v45
    v_add_f32 v214, v214, v213
    v_cvt_pk_bf16_f32 v165, v212, v213
    v_exp_f32 v210, v46
    v_add_f32 v214, v214, v208
    v_exp_f32 v211, v47
    v_add_f32 v214, v214, v209
    v_cvt_pk_bf16_f32 v166, v208, v209
    v_exp_f32 v212, v48
    v_add_f32 v214, v214, v210
    v_exp_f32 v213, v49
    v_add_f32 v214, v214, v211
    v_cvt_pk_bf16_f32 v167, v210, v211
    v_exp_f32 v208, v50
    v_add_f32 v215, v215, v212
    v_exp_f32 v209, v51
    v_add_f32 v215, v215, v213
    v_cvt_pk_bf16_f32 v168, v212, v213
    v_exp_f32 v210, v52
    v_add_f32 v215, v215, v208
    v_exp_f32 v211, v53
    v_add_f32 v215, v215, v209
    v_cvt_pk_bf16_f32 v169, v208, v209
    v_exp_f32 v212, v54
    v_add_f32 v215, v215, v210
    v_exp_f32 v213, v55
    v_add_f32 v215, v215, v211
    v_cvt_pk_bf16_f32 v170, v210, v211
    v_exp_f32 v208, v56
    v_add_f32 v215, v215, v212
    v_exp_f32 v209, v57
    v_add_f32 v215, v215, v213
    v_cvt_pk_bf16_f32 v171, v212, v213
    v_exp_f32 v210, v58
    v_add_f32 v215, v215, v208
    v_exp_f32 v211, v59
    v_add_f32 v215, v215, v209
    v_cvt_pk_bf16_f32 v172, v208, v209
    v_exp_f32 v212, v60
    v_add_f32 v215, v215, v210
    v_exp_f32 v213, v61
    v_add_f32 v215, v215, v211
    v_cvt_pk_bf16_f32 v173, v210, v211
    v_exp_f32 v208, v62
    v_add_f32 v215, v215, v212
    v_exp_f32 v209, v63
    v_add_f32 v215, v215, v213
    v_cvt_pk_bf16_f32 v174, v212, v213
    v_add_f32 v215, v215, v208
    v_cvt_pk_bf16_f32 v175, v208, v209
    v_add_f32 v215, v215, v209
    s_nop 1
    s_setpc_b64 s[6:7]
K2_rare1:
    s_nop 15
    v_max3_f32 v220, v64, v65, v66
    v_max3_f32 v220, v220, v67, v68
    v_max3_f32 v220, v220, v69, v70
    v_max3_f32 v220, v220, v71, v72
    v_max3_f32 v220, v220, v73, v74
    v_max3_f32 v220, v220, v75, v76
    v_max3_f32 v220, v220, v77, v78
    v_max_f32 v220, v220, v79
    v_max3_f32 v221, v80, v81, v82
    v_max3_f32 v221, v221, v83, v84
    v_max3_f32 v221, v221, v85, v86
    v_max3_f32 v221, v221, v87, v88
    v_max3_f32 v221, v221, v89, v90
    v_max3_f32 v221, v221, v91, v92
    v_max3_f32 v221, v221, v93, v94
    v_max_f32 v221, v221, v95
    v_max3_f32 v220, v220, v96, v97
    v_max3_f32 v220, v220, v98, v99
    v_max3_f32 v220, v220, v100, v101
    v_max3_f32 v220, v220, v102, v103
    v_max3_f32 v220, v220, v104, v105
    v_max3_f32 v220, v220, v106, v107
    v_max3_f32 v220, v220, v108, v109
    v_max3_f32 v220, v220, v110, v111
    v_max3_f32 v221, v221, v112, v113
    v_max3_f32 v221, v221, v114, v115
    v_max3_f32 v221, v221, v116, v117
    v_max3_f32 v221, v221, v118, v119
    v_max3_f32 v221, v221, v120, v121
    v_max3_f32 v221, v221, v122, v123
    v_max3_f32 v221, v221, v124, v125
    v_max3_f32 v221, v221, v126, v127
    v_mov_b32 v222, v220
    v_mov_b32 v223, v221
    s_nop 1
    v_permlane32_swap_b32 v220, v222
    v_permlane32_swap_b32 v221, v223
    s_nop 1
    v_max_f32 v220, v220, v222
    v_max_f32 v221, v221, v223
    v_max_f32 v220, 0, v220
    v_max_f32 v221, 0, v221
    v_max_f32 v222, v220, v221
    s_sub_u32 s3, s54, 2
    s_cmp_lt_u32 s3, s56
    s_cselect_b64 vcc, -1, 0
    v_cndmask_b32 v220, v222, v220, vcc
    v_cndmask_b32 v223, 0, v221, vcc
    v_cndmask_b32 v221, v222, v221, vcc
    s_cmp_lt_u32 s54, s55
    s_cselect_b64 vcc, -1, 0
    v_cndmask_b32 v224, v220, v223, vcc
    v_exp_f32 v225, -v220
    v_exp_f32 v226, -v223
    v_sub_f32 v64, v64, v220
    v_sub_f32 v0, v0, v220
    v_sub_f32 v65, v65, v220
    v_sub_f32 v1, v1, v220
    v_sub_f32 v66, v66, v220
    v_sub_f32 v2, v2, v220
    v_sub_f32 v67, v67, v220
    v_sub_f32 v3, v3, v220
    v_sub_f32 v68, v68, v220
    v_sub_f32 v4, v4, v220
    v_sub_f32 v69, v69, v220
    v_sub_f32 v5, v5, v220
    v_sub_f32 v70, v70, v220
    v_sub_f32 v6, v6, v220
    v_sub_f32 v71, v71, v220
    v_sub_f32 v7, v7, v220
    v_sub_f32 v72, v72, v220
    v_sub_f32 v8, v8, v220
    v_sub_f32 v73, v73, v220
    v_sub_f32 v9, v9, v220
    v_sub_f32 v74, v74, v220
    v_sub_f32 v10, v10, v220
    v_sub_f32 v75, v75, v220
    v_sub_f32 v11, v11, v220
    v_sub_f32 v76, v76, v220
    v_sub_f32 v12, v12, v220
    v_sub_f32 v77, v77, v220
    v_sub_f32 v13, v13, v220
    v_sub_f32 v78, v78, v220
    v_sub_f32 v14, v14, v220
    v_sub_f32 v79, v79, v220
    v_sub_f32 v15, v15, v220
    v_sub_f32 v80, v80, v221
    v_sub_f32 v16, v16, v224
    v_sub_f32 v81, v81, v221
    v_sub_f32 v17, v17, v224
    v_sub_f32 v82, v82, v221
    v_sub_f32 v18, v18, v224
    v_sub_f32 v83, v83, v221
    v_sub_f32 v19, v19, v224
    v_sub_f32 v84, v84, v221
    v_sub_f32 v20, v20, v224
    v_sub_f32 v85, v85, v221
    v_sub_f32 v21, v21, v224
    v_sub_f32 v86, v86, v221
    v_sub_f32 v22, v22, v224
    v_sub_f32 v87, v87, v221
    v_sub_f32 v23, v23, v224
    v_sub_f32 v88, v88, v221
    v_sub_f32 v24, v24, v224
    v_sub_f32 v89, v89, v221
    v_sub_f32 v25, v25, v224
    v_sub_f32 v90, v90, v221
    v_sub_f32 v26, v26, v224
    v_sub_f32 v91, v91, v221
    v_sub_f32 v27, v27, v224
    v_sub_f32 v92, v92, v221
    v_sub_f32 v28, v28, v224
    v_sub_f32 v93, v93, v221
    v_sub_f32 v29, v29, v224
    v_sub_f32 v94, v94, v221
    v_sub_f32 v30, v30, v224
    v_sub_f32 v95, v95, v221
    v_sub_f32 v31, v31, v224
    v_sub_f32 v96, v96, v220
    v_sub_f32 v32, v32, v220
    v_sub_f32 v97, v97, v220
    v_sub_f32 v33, v33, v220
    v_sub_f32 v98, v98, v220
    v_sub_f32 v34, v34, v220
    v_sub_f32 v99, v99, v220
    v_sub_f32 v35, v35, v220
    v_sub_f32 v100, v100, v220
    v_sub_f32 v36, v36, v220
    v_sub_f32 v101, v101, v220
    v_sub_f32 v37, v37, v220
    v_sub_f32 v102, v102, v220
    v_sub_f32 v38, v38, v220
    v_sub_f32 v103, v103, v220
    v_sub_f32 v39, v39, v220
    v_sub_f32 v104, v104, v220
    v_sub_f32 v40, v40, v220
    v_sub_f32 v105, v105, v220
    v_sub_f32 v41, v41, v220
    v_sub_f32 v106, v106, v220
    v_sub_f32 v42, v42, v220
    v_sub_f32 v107, v107, v220
    v_sub_f32 v43, v43, v220
    v_sub_f32 v108, v108, v220
    v_sub_f32 v44, v44, v220
    v_sub_f32 v109, v109, v220
    v_sub_f32 v45, v45, v220
    v_sub_f32 v110, v110, v220
    v_sub_f32 v46, v46, v220
    v_sub_f32 v111, v111, v220
    v_sub_f32 v47, v47, v220
    v_sub_f32 v112, v112, v221
    v_sub_f32 v48, v48, v224
    v_sub_f32 v113, v113, v221
    v_sub_f32 v49, v49, v224
    v_sub_f32 v114, v114, v221
    v_sub_f32 v50, v50, v224
    v_sub_f32 v115, v115, v221
    v_sub_f32 v51, v51, v224
    v_sub_f32 v116, v116, v221
    v_sub_f32 v52, v52, v224
    v_sub_f32 v117, v117, v221
    v_sub_f32 v53, v53, v224
    v_sub_f32 v118, v118, v221
    v_sub_f32 v54, v54, v224
    v_sub_f32 v119, v119, v221
    v_sub_f32 v55, v55, v224
    v_sub_f32 v120, v120, v221
    v_sub_f32 v56, v56, v224
    v_sub_f32 v121, v121, v221
    v_sub_f32 v57, v57, v224
    v_sub_f32 v122, v122, v221
    v_sub_f32 v58, v58, v224
    v_sub_f32 v123, v123, v221
    v_sub_f32 v59, v59, v224
    v_sub_f32 v124, v124, v221
    v_sub_f32 v60, v60, v224
    v_sub_f32 v125, v125, v221
    v_sub_f32 v61, v61, v224
    v_sub_f32 v126, v126, v221
    v_sub_f32 v62, v62, v224
    v_sub_f32 v127, v127, v221
    v_sub_f32 v63, v63, v224
    v_sub_f32 v176, v176, v220
    v_sub_f32 v177, v177, v220
    v_sub_f32 v178, v178, v220
    v_sub_f32 v179, v179, v220
    v_sub_f32 v180, v180, v220
    v_sub_f32 v181, v181, v220
    v_sub_f32 v182, v182, v220
    v_sub_f32 v183, v183, v220
    v_sub_f32 v184, v184, v220
    v_sub_f32 v185, v185, v220
    v_sub_f32 v186, v186, v220
    v_sub_f32 v187, v187, v220
    v_sub_f32 v188, v188, v220
    v_sub_f32 v189, v189, v220
    v_sub_f32 v190, v190, v220
    v_sub_f32 v191, v191, v220
    v_mul_f32 v216, v216, v225
    v_accvgpr_read_b32 v228, a0
    v_accvgpr_read_b32 v229, a1
    v_accvgpr_read_b32 v230, a2
    v_accvgpr_read_b32 v231, a3
    v_accvgpr_read_b32 v232, a4
    v_accvgpr_read_b32 v233, a5
    v_accvgpr_read_b32 v234, a6
    v_accvgpr_read_b32 v235, a7
    v_mul_f32 v228, v228, v225
    v_mul_f32 v229, v229, v225
    v_mul_f32 v230, v230, v225
    v_mul_f32 v231, v231, v225
    v_mul_f32 v232, v232, v225
    v_mul_f32 v233, v233, v225
    v_mul_f32 v234, v234, v225
    v_mul_f32 v235, v235, v225
    v_accvgpr_write_b32 a0, v228
    v_accvgpr_write_b32 a1, v229
    v_accvgpr_write_b32 a2, v230
    v_accvgpr_write_b32 a3, v231
    v_accvgpr_write_b32 a4, v232
    v_accvgpr_write_b32 a5, v233
    v_accvgpr_write_b32 a6, v234
    v_accvgpr_write_b32 a7, v235
    v_accvgpr_read_b32 v228, a8
    v_accvgpr_read_b32 v229, a9
    v_accvgpr_read_b32 v230, a10
    v_accvgpr_read_b32 v231, a11
    v_accvgpr_read_b32 v232, a12
    v_accvgpr_read_b32 v233, a13
    v_accvgpr_read_b32 v234, a14
    v_accvgpr_read_b32 v235, a15
    v_mul_f32 v228, v228, v225
    v_mul_f32 v229, v229, v225
    v_mul_f32 v230, v230, v225
    v_mul_f32 v231, v231, v225
    v_mul_f32 v232, v232, v225
    v_mul_f32 v233, v233, v225
    v_mul_f32 v234, v234, v225
    v_mul_f32 v235, v235, v225
    v_accvgpr_write_b32 a8, v228
    v_accvgpr_write_b32 a9, v229
    v_accvgpr_write_b32 a10, v230
    v_accvgpr_write_b32 a11, v231
    v_accvgpr_write_b32 a12, v232
    v_accvgpr_write_b32 a13, v233
    v_accvgpr_write_b32 a14, v234
    v_accvgpr_write_b32 a15, v235
    v_accvgpr_read_b32 v228, a16
    v_accvgpr_read_b32 v229, a17
    v_accvgpr_read_b32 v230, a18
    v_accvgpr_read_b32 v231, a19
    v_accvgpr_read_b32 v232, a20
    v_accvgpr_read_b32 v233, a21
    v_accvgpr_read_b32 v234, a22
    v_accvgpr_read_b32 v235, a23
    v_mul_f32 v228, v228, v225
    v_mul_f32 v229, v229, v225
    v_mul_f32 v230, v230, v225
    v_mul_f32 v231, v231, v225
    v_mul_f32 v232, v232, v225
    v_mul_f32 v233, v233, v225
    v_mul_f32 v234, v234, v225
    v_mul_f32 v235, v235, v225
    v_accvgpr_write_b32 a16, v228
    v_accvgpr_write_b32 a17, v229
    v_accvgpr_write_b32 a18, v230
    v_accvgpr_write_b32 a19, v231
    v_accvgpr_write_b32 a20, v232
    v_accvgpr_write_b32 a21, v233
    v_accvgpr_write_b32 a22, v234
    v_accvgpr_write_b32 a23, v235
    v_accvgpr_read_b32 v228, a24
    v_accvgpr_read_b32 v229, a25
    v_accvgpr_read_b32 v230, a26
    v_accvgpr_read_b32 v231, a27
    v_accvgpr_read_b32 v232, a28
    v_accvgpr_read_b32 v233, a29
    v_accvgpr_read_b32 v234, a30
    v_accvgpr_read_b32 v235, a31
    v_mul_f32 v228, v228, v225
    v_mul_f32 v229, v229, v225
    v_mul_f32 v230, v230, v225
    v_mul_f32 v231, v231, v225
    v_mul_f32 v232, v232, v225
    v_mul_f32 v233, v233, v225
    v_mul_f32 v234, v234, v225
    v_mul_f32 v235, v235, v225
    v_accvgpr_write_b32 a24, v228
    v_accvgpr_write_b32 a25, v229
    v_accvgpr_write_b32 a26, v230
    v_accvgpr_write_b32 a27, v231
    v_accvgpr_write_b32 a28, v232
    v_accvgpr_write_b32 a29, v233
    v_accvgpr_write_b32 a30, v234
    v_accvgpr_write_b32 a31, v235
    v_accvgpr_read_b32 v228, a32
    v_accvgpr_read_b32 v229, a33
    v_accvgpr_read_b32 v230, a34
    v_accvgpr_read_b32 v231, a35
    v_accvgpr_read_b32 v232, a36
    v_accvgpr_read_b32 v233, a37
    v_accvgpr_read_b32 v234, a38
    v_accvgpr_read_b32 v235, a39
    v_mul_f32 v228, v228, v225
    v_mul_f32 v229, v229, v225
    v_mul_f32 v230, v230, v225
    v_mul_f32 v231, v231, v225
    v_mul_f32 v232, v232, v225
    v_mul_f32 v233, v233, v225
    v_mul_f32 v234, v234, v225
    v_mul_f32 v235, v235, v225
    v_accvgpr_write_b32 a32, v228
    v_accvgpr_write_b32 a33, v229
    v_accvgpr_write_b32 a34, v230
    v_accvgpr_write_b32 a35, v231
    v_accvgpr_write_b32 a36, v232
    v_accvgpr_write_b32 a37, v233
    v_accvgpr_write_b32 a38, v234
    v_accvgpr_write_b32 a39, v235
    v_accvgpr_read_b32 v228, a40
    v_accvgpr_read_b32 v229, a41
    v_accvgpr_read_b32 v230, a42
    v_accvgpr_read_b32 v231, a43
    v_accvgpr_read_b32 v232, a44
    v_accvgpr_read_b32 v233, a45
    v_accvgpr_read_b32 v234, a46
    v_accvgpr_read_b32 v235, a47
    v_mul_f32 v228, v228, v225
    v_mul_f32 v229, v229, v225
    v_mul_f32 v230, v230, v225
    v_mul_f32 v231, v231, v225
    v_mul_f32 v232, v232, v225
    v_mul_f32 v233, v233, v225
    v_mul_f32 v234, v234, v225
    v_mul_f32 v235, v235, v225
    v_accvgpr_write_b32 a40, v228
    v_accvgpr_write_b32 a41, v229
    v_accvgpr_write_b32 a42, v230
    v_accvgpr_write_b32 a43, v231
    v_accvgpr_write_b32 a44, v232
    v_accvgpr_write_b32 a45, v233
    v_accvgpr_write_b32 a46, v234
    v_accvgpr_write_b32 a47, v235
    v_accvgpr_read_b32 v228, a48
    v_accvgpr_read_b32 v229, a49
    v_accvgpr_read_b32 v230, a50
    v_accvgpr_read_b32 v231, a51
    v_accvgpr_read_b32 v232, a52
    v_accvgpr_read_b32 v233, a53
    v_accvgpr_read_b32 v234, a54
    v_accvgpr_read_b32 v235, a55
    v_mul_f32 v228, v228, v225
    v_mul_f32 v229, v229, v225
    v_mul_f32 v230, v230, v225
    v_mul_f32 v231, v231, v225
    v_mul_f32 v232, v232, v225
    v_mul_f32 v233, v233, v225
    v_mul_f32 v234, v234, v225
    v_mul_f32 v235, v235, v225
    v_accvgpr_write_b32 a48, v228
    v_accvgpr_write_b32 a49, v229
    v_accvgpr_write_b32 a50, v230
    v_accvgpr_write_b32 a51, v231
    v_accvgpr_write_b32 a52, v232
    v_accvgpr_write_b32 a53, v233
    v_accvgpr_write_b32 a54, v234
    v_accvgpr_write_b32 a55, v235
    v_accvgpr_read_b32 v228, a56
    v_accvgpr_read_b32 v229, a57
    v_accvgpr_read_b32 v230, a58
    v_accvgpr_read_b32 v231, a59
    v_accvgpr_read_b32 v232, a60
    v_accvgpr_read_b32 v233, a61
    v_accvgpr_read_b32 v234, a62
    v_accvgpr_read_b32 v235, a63
    v_mul_f32 v228, v228, v225
    v_mul_f32 v229, v229, v225
    v_mul_f32 v230, v230, v225
    v_mul_f32 v231, v231, v225
    v_mul_f32 v232, v232, v225
    v_mul_f32 v233, v233, v225
    v_mul_f32 v234, v234, v225
    v_mul_f32 v235, v235, v225
    v_accvgpr_write_b32 a56, v228
    v_accvgpr_write_b32 a57, v229
    v_accvgpr_write_b32 a58, v230
    v_accvgpr_write_b32 a59, v231
    v_accvgpr_write_b32 a60, v232
    v_accvgpr_write_b32 a61, v233
    v_accvgpr_write_b32 a62, v234
    v_accvgpr_write_b32 a63, v235
    v_sub_f32 v192, v192, v223
    v_sub_f32 v193, v193, v223
    v_sub_f32 v194, v194, v223
    v_sub_f32 v195, v195, v223
    v_sub_f32 v196, v196, v223
    v_sub_f32 v197, v197, v223
    v_sub_f32 v198, v198, v223
    v_sub_f32 v199, v199, v223
    v_sub_f32 v200, v200, v223
    v_sub_f32 v201, v201, v223
    v_sub_f32 v202, v202, v223
    v_sub_f32 v203, v203, v223
    v_sub_f32 v204, v204, v223
    v_sub_f32 v205, v205, v223
    v_sub_f32 v206, v206, v223
    v_sub_f32 v207, v207, v223
    v_mul_f32 v217, v217, v226
    v_accvgpr_read_b32 v228, a64
    v_accvgpr_read_b32 v229, a65
    v_accvgpr_read_b32 v230, a66
    v_accvgpr_read_b32 v231, a67
    v_accvgpr_read_b32 v232, a68
    v_accvgpr_read_b32 v233, a69
    v_accvgpr_read_b32 v234, a70
    v_accvgpr_read_b32 v235, a71
    v_mul_f32 v228, v228, v226
    v_mul_f32 v229, v229, v226
    v_mul_f32 v230, v230, v226
    v_mul_f32 v231, v231, v226
    v_mul_f32 v232, v232, v226
    v_mul_f32 v233, v233, v226
    v_mul_f32 v234, v234, v226
    v_mul_f32 v235, v235, v226
    v_accvgpr_write_b32 a64, v228
    v_accvgpr_write_b32 a65, v229
    v_accvgpr_write_b32 a66, v230
    v_accvgpr_write_b32 a67, v231
    v_accvgpr_write_b32 a68, v232
    v_accvgpr_write_b32 a69, v233
    v_accvgpr_write_b32 a70, v234
    v_accvgpr_write_b32 a71, v235
    v_accvgpr_read_b32 v228, a72
    v_accvgpr_read_b32 v229, a73
    v_accvgpr_read_b32 v230, a74
    v_accvgpr_read_b32 v231, a75
    v_accvgpr_read_b32 v232, a76
    v_accvgpr_read_b32 v233, a77
    v_accvgpr_read_b32 v234, a78
    v_accvgpr_read_b32 v235, a79
    v_mul_f32 v228, v228, v226
    v_mul_f32 v229, v229, v226
    v_mul_f32 v230, v230, v226
    v_mul_f32 v231, v231, v226
    v_mul_f32 v232, v232, v226
    v_mul_f32 v233, v233, v226
    v_mul_f32 v234, v234, v226
    v_mul_f32 v235, v235, v226
    v_accvgpr_write_b32 a72, v228
    v_accvgpr_write_b32 a73, v229
    v_accvgpr_write_b32 a74, v230
    v_accvgpr_write_b32 a75, v231
    v_accvgpr_write_b32 a76, v232
    v_accvgpr_write_b32 a77, v233
    v_accvgpr_write_b32 a78, v234
    v_accvgpr_write_b32 a79, v235
    v_accvgpr_read_b32 v228, a80
    v_accvgpr_read_b32 v229, a81
    v_accvgpr_read_b32 v230, a82
    v_accvgpr_read_b32 v231, a83
    v_accvgpr_read_b32 v232, a84
    v_accvgpr_read_b32 v233, a85
    v_accvgpr_read_b32 v234, a86
    v_accvgpr_read_b32 v235, a87
    v_mul_f32 v228, v228, v226
    v_mul_f32 v229, v229, v226
    v_mul_f32 v230, v230, v226
    v_mul_f32 v231, v231, v226
    v_mul_f32 v232, v232, v226
    v_mul_f32 v233, v233, v226
    v_mul_f32 v234, v234, v226
    v_mul_f32 v235, v235, v226
    v_accvgpr_write_b32 a80, v228
    v_accvgpr_write_b32 a81, v229
    v_accvgpr_write_b32 a82, v230
    v_accvgpr_write_b32 a83, v231
    v_accvgpr_write_b32 a84, v232
    v_accvgpr_write_b32 a85, v233
    v_accvgpr_write_b32 a86, v234
    v_accvgpr_write_b32 a87, v235
    v_accvgpr_read_b32 v228, a88
    v_accvgpr_read_b32 v229, a89
    v_accvgpr_read_b32 v230, a90
    v_accvgpr_read_b32 v231, a91
    v_accvgpr_read_b32 v232, a92
    v_accvgpr_read_b32 v233, a93
    v_accvgpr_read_b32 v234, a94
    v_accvgpr_read_b32 v235, a95
    v_mul_f32 v228, v228, v226
    v_mul_f32 v229, v229, v226
    v_mul_f32 v230, v230, v226
    v_mul_f32 v231, v231, v226
    v_mul_f32 v232, v232, v226
    v_mul_f32 v233, v233, v226
    v_mul_f32 v234, v234, v226
    v_mul_f32 v235, v235, v226
    v_accvgpr_write_b32 a88, v228
    v_accvgpr_write_b32 a89, v229
    v_accvgpr_write_b32 a90, v230
    v_accvgpr_write_b32 a91, v231
    v_accvgpr_write_b32 a92, v232
    v_accvgpr_write_b32 a93, v233
    v_accvgpr_write_b32 a94, v234
    v_accvgpr_write_b32 a95, v235
    v_accvgpr_read_b32 v228, a96
    v_accvgpr_read_b32 v229, a97
    v_accvgpr_read_b32 v230, a98
    v_accvgpr_read_b32 v231, a99
    v_accvgpr_read_b32 v232, a100
    v_accvgpr_read_b32 v233, a101
    v_accvgpr_read_b32 v234, a102
    v_accvgpr_read_b32 v235, a103
    v_mul_f32 v228, v228, v226
    v_mul_f32 v229, v229, v226
    v_mul_f32 v230, v230, v226
    v_mul_f32 v231, v231, v226
    v_mul_f32 v232, v232, v226
    v_mul_f32 v233, v233, v226
    v_mul_f32 v234, v234, v226
    v_mul_f32 v235, v235, v226
    v_accvgpr_write_b32 a96, v228
    v_accvgpr_write_b32 a97, v229
    v_accvgpr_write_b32 a98, v230
    v_accvgpr_write_b32 a99, v231
    v_accvgpr_write_b32 a100, v232
    v_accvgpr_write_b32 a101, v233
    v_accvgpr_write_b32 a102, v234
    v_accvgpr_write_b32 a103, v235
    v_accvgpr_read_b32 v228, a104
    v_accvgpr_read_b32 v229, a105
    v_accvgpr_read_b32 v230, a106
    v_accvgpr_read_b32 v231, a107
    v_accvgpr_read_b32 v232, a108
    v_accvgpr_read_b32 v233, a109
    v_accvgpr_read_b32 v234, a110
    v_accvgpr_read_b32 v235, a111
    v_mul_f32 v228, v228, v226
    v_mul_f32 v229, v229, v226
    v_mul_f32 v230, v230, v226
    v_mul_f32 v231, v231, v226
    v_mul_f32 v232, v232, v226
    v_mul_f32 v233, v233, v226
    v_mul_f32 v234, v234, v226
    v_mul_f32 v235, v235, v226
    v_accvgpr_write_b32 a104, v228
    v_accvgpr_write_b32 a105, v229
    v_accvgpr_write_b32 a106, v230
    v_accvgpr_write_b32 a107, v231
    v_accvgpr_write_b32 a108, v232
    v_accvgpr_write_b32 a109, v233
    v_accvgpr_write_b32 a110, v234
    v_accvgpr_write_b32 a111, v235
    v_accvgpr_read_b32 v228, a112
    v_accvgpr_read_b32 v229, a113
    v_accvgpr_read_b32 v230, a114
    v_accvgpr_read_b32 v231, a115
    v_accvgpr_read_b32 v232, a116
    v_accvgpr_read_b32 v233, a117
    v_accvgpr_read_b32 v234, a118
    v_accvgpr_read_b32 v235, a119
    v_mul_f32 v228, v228, v226
    v_mul_f32 v229, v229, v226
    v_mul_f32 v230, v230, v226
    v_mul_f32 v231, v231, v226
    v_mul_f32 v232, v232, v226
    v_mul_f32 v233, v233, v226
    v_mul_f32 v234, v234, v226
    v_mul_f32 v235, v235, v226
    v_accvgpr_write_b32 a112, v228
    v_accvgpr_write_b32 a113, v229
    v_accvgpr_write_b32 a114, v230
    v_accvgpr_write_b32 a115, v231
    v_accvgpr_write_b32 a116, v232
    v_accvgpr_write_b32 a117, v233
    v_accvgpr_write_b32 a118, v234
    v_accvgpr_write_b32 a119, v235
    v_accvgpr_read_b32 v228, a120
    v_accvgpr_read_b32 v229, a121
    v_accvgpr_read_b32 v230, a122
    v_accvgpr_read_b32 v231, a123
    v_accvgpr_read_b32 v232, a124
    v_accvgpr_read_b32 v233, a125
    v_accvgpr_read_b32 v234, a126
    v_accvgpr_read_b32 v235, a127
    v_mul_f32 v228, v228, v226
    v_mul_f32 v229, v229, v226
    v_mul_f32 v230, v230, v226
    v_mul_f32 v231, v231, v226
    v_mul_f32 v232, v232, v226
    v_mul_f32 v233, v233, v226
    v_mul_f32 v234, v234, v226
    v_mul_f32 v235, v235, v226
    v_accvgpr_write_b32 a120, v228
    v_accvgpr_write_b32 a121, v229
    v_accvgpr_write_b32 a122, v230
    v_accvgpr_write_b32 a123, v231
    v_accvgpr_write_b32 a124, v232
    v_accvgpr_write_b32 a125, v233
    v_accvgpr_write_b32 a126, v234
    v_accvgpr_write_b32 a127, v235
    v_exp_f32 v208, v64
    v_exp_f32 v209, v65
    v_exp_f32 v210, v66
    v_add_f32 v214, v208, v209
    v_exp_f32 v211, v67
    v_cvt_pk_bf16_f32 v144, v208, v209
    v_exp_f32 v212, v68
    v_add_f32 v214, v214, v210
    v_exp_f32 v213, v69
    v_add_f32 v214, v214, v211
    v_cvt_pk_bf16_f32 v145, v210, v211
    v_exp_f32 v208, v70
    v_add_f32 v214, v214, v212
    v_exp_f32 v209, v71
    v_add_f32 v214, v214, v213
    v_cvt_pk_bf16_f32 v146, v212, v213
    v_exp_f32 v210, v72
    v_add_f32 v214, v214, v208
    v_exp_f32 v211, v73
    v_add_f32 v214, v214, v209
    v_cvt_pk_bf16_f32 v147, v208, v209
    v_exp_f32 v212, v74
    v_add_f32 v214, v214, v210
    v_exp_f32 v213, v75
    v_add_f32 v214, v214, v211
    v_cvt_pk_bf16_f32 v148, v210, v211
    v_exp_f32 v208, v76
    v_add_f32 v214, v214, v212
    v_exp_f32 v209, v77
    v_add_f32 v214, v214, v213
    v_cvt_pk_bf16_f32 v149, v212, v213
    v_exp_f32 v210, v78
    v_add_f32 v214, v214, v208
    v_exp_f32 v211, v79
    v_add_f32 v214, v214, v209
    v_cvt_pk_bf16_f32 v150, v208, v209
    v_exp_f32 v212, v80
    v_add_f32 v214, v214, v210
    v_exp_f32 v213, v81
    v_add_f32 v214, v214, v211
    v_cvt_pk_bf16_f32 v151, v210, v211
    v_exp_f32 v208, v82
    v_add_f32 v215, v212, v213
    v_exp_f32 v209, v83
    v_cvt_pk_bf16_f32 v152, v212, v213
    v_exp_f32 v210, v84
    v_add_f32 v215, v215, v208
    v_exp_f32 v211, v85
    v_add_f32 v215, v215, v209
    v_cvt_pk_bf16_f32 v153, v208, v209
    v_exp_f32 v212, v86
    v_add_f32 v215, v215, v210
    v_exp_f32 v213, v87
    v_add_f32 v215, v215, v211
    v_cvt_pk_bf16_f32 v154, v210, v211
    v_exp_f32 v208, v88
    v_add_f32 v215, v215, v212
    v_exp_f32 v209, v89
    v_add_f32 v215, v215, v213
    v_cvt_pk_bf16_f32 v155, v212, v213
    v_exp_f32 v210, v90
    v_add_f32 v215, v215, v208
    v_exp_f32 v211, v91
    v_add_f32 v215, v215, v209
    v_cvt_pk_bf16_f32 v156, v208, v209
    v_exp_f32 v212, v92
    v_add_f32 v215, v215, v210
    v_exp_f32 v213, v93
    v_add_f32 v215, v215, v211
    v_cvt_pk_bf16_f32 v157, v210, v211
    v_exp_f32 v208, v94
    v_add_f32 v215, v215, v212
    v_exp_f32 v209, v95
    v_add_f32 v215, v215, v213
    v_cvt_pk_bf16_f32 v158, v212, v213
    v_add_f32 v215, v215, v208
    v_cvt_pk_bf16_f32 v159, v208, v209
    v_add_f32 v215, v215, v209
    v_exp_f32 v208, v96
    v_exp_f32 v209, v97
    v_exp_f32 v210, v98
    v_add_f32 v214, v214, v208
    v_exp_f32 v211, v99
    v_add_f32 v214, v214, v209
    v_cvt_pk_bf16_f32 v160, v208, v209
    v_exp_f32 v212, v100
    v_add_f32 v214, v214, v210
    v_exp_f32 v213, v101
    v_add_f32 v214, v214, v211
    v_cvt_pk_bf16_f32 v161, v210, v211
    v_exp_f32 v208, v102
    v_add_f32 v214, v214, v212
    v_exp_f32 v209, v103
    v_add_f32 v214, v214, v213
    v_cvt_pk_bf16_f32 v162, v212, v213
    v_exp_f32 v210, v104
    v_add_f32 v214, v214, v208
    v_exp_f32 v211, v105
    v_add_f32 v214, v214, v209
    v_cvt_pk_bf16_f32 v163, v208, v209
    v_exp_f32 v212, v106
    v_add_f32 v214, v214, v210
    v_exp_f32 v213, v107
    v_add_f32 v214, v214, v211
    v_cvt_pk_bf16_f32 v164, v210, v211
    v_exp_f32 v208, v108
    v_add_f32 v214, v214, v212
    v_exp_f32 v209, v109
    v_add_f32 v214, v214, v213
    v_cvt_pk_bf16_f32 v165, v212, v213
    v_exp_f32 v210, v110
    v_add_f32 v214, v214, v208
    v_exp_f32 v211, v111
    v_add_f32 v214, v214, v209
    v_cvt_pk_bf16_f32 v166, v208, v209
    v_exp_f32 v212, v112
    v_add_f32 v214, v214, v210
    v_exp_f32 v213, v113
    v_add_f32 v214, v214, v211
    v_cvt_pk_bf16_f32 v167, v210, v211
    v_exp_f32 v208, v114
    v_add_f32 v215, v215, v212
    v_exp_f32 v209, v115
    v_add_f32 v215, v215, v213
    v_cvt_pk_bf16_f32 v168, v212, v213
    v_exp_f32 v210, v116
    v_add_f32 v215, v215, v208
    v_exp_f32 v211, v117
    v_add_f32 v215, v215, v209
    v_cvt_pk_bf16_f32 v169, v208, v209
    v_exp_f32 v212, v118
    v_add_f32 v215, v215, v210
    v_exp_f32 v213, v119
    v_add_f32 v215, v215, v211
    v_cvt_pk_bf16_f32 v170, v210, v211
    v_exp_f32 v208, v120
    v_add_f32 v215, v215, v212
    v_exp_f32 v209, v121
    v_add_f32 v215, v215, v213
    v_cvt_pk_bf16_f32 v171, v212, v213
    v_exp_f32 v210, v122
    v_add_f32 v215, v215, v208
    v_exp_f32 v211, v123
    v_add_f32 v215, v215, v209
    v_cvt_pk_bf16_f32 v172, v208, v209
    v_exp_f32 v212, v124
    v_add_f32 v215, v215, v210
    v_exp_f32 v213, v125
    v_add_f32 v215, v215, v211
    v_cvt_pk_bf16_f32 v173, v210, v211
    v_exp_f32 v208, v126
    v_add_f32 v215, v215, v212
    v_exp_f32 v209, v127
    v_add_f32 v215, v215, v213
    v_cvt_pk_bf16_f32 v174, v212, v213
    v_add_f32 v215, v215, v208
    v_cvt_pk_bf16_f32 v175, v208, v209
    v_add_f32 v215, v215, v209
    s_nop 1
    s_setpc_b64 s[6:7]
spin_58:
    s_mov_b32 s100, 0x40000
spin_58b:
    buffer_load_dwordx2 v[252:253], v239, s[64:67], s50 offen sc1
    s_waitcnt vmcnt(0)
    v_cmp_ne_u64 vcc, s[96:97], v[252:253]
    s_cbranch_vccz ok_57
    s_sub_u32 s100, s100, 1
    s_cmp_eq_u32 s100, 0
    s_cbranch_scc1 ok_57
    s_sleep 8
    s_branch spin_58b
spin_60:
    s_mov_b32 s100, 0x40000
spin_60b:
    buffer_load_dwordx2 v[252:253], v239, s[64:67], s51 offen sc1
    s_waitcnt vmcnt(0)
    v_cmp_ne_u64 vcc, s[96:97], v[252:253]
    s_cbranch_vccz ok_59
    s_sub_u32 s100, s100, 1
    s_cmp_eq_u32 s100, 0
    s_cbranch_scc1 ok_59
    s_sleep 8
    s_branch spin_60b
spin_62:
    s_waitcnt vmcnt(0)
    buffer_store_dwordx2 v[250:251], off, s[64:67], s47 sc0 sc1
    s_mov_b32 s100, 0x40000
spin_62b:
    buffer_load_dwordx2 v[252:253], v239, s[64:67], s38 offen sc1
    s_waitcnt vmcnt(0)
    v_cmp_ne_u64 vcc, s[96:97], v[252:253]
    s_cbranch_vccz ok_61
    s_sub_u32 s100, s100, 1
    s_cmp_eq_u32 s100, 0
    s_cbranch_scc1 ok_61
    s_sleep 8
    s_branch spin_62b
spin_64:
    s_mov_b32 s100, 0x40000
spin_64b:
    buffer_load_dwordx2 v[252:253], v239, s[64:67], s38 offen sc1
    s_waitcnt vmcnt(0)
    v_cmp_ne_u64 vcc, s[96:97], v[252:253]
    s_cbranch_vccz ok_63
    s_sub_u32 s100, s100, 1
    s_cmp_eq_u32 s100, 0
    s_cbranch_scc1 ok_63
    s_sleep 8
    s_branch spin_64b
F_done:
    s_endpgm
.section .rodata,"a"
.p2align 6
.amdhsa_kernel sequential_preLN__compressed_kv_cla__glu_gated_bilinear__prompt_kernel
  .amdhsa_next_free_vgpr 512
  .amdhsa_next_free_sgpr 102
  .amdhsa_accum_offset 256
  .amdhsa_group_segment_fixed_size 0
  .amdhsa_kernarg_size 104
  .amdhsa_user_sgpr_count 2
  .amdhsa_user_sgpr_kernarg_segment_ptr 1
  .amdhsa_system_sgpr_workgroup_id_x 1
  .amdhsa_float_denorm_mode_32 3
.end_amdhsa_kernel
```
